```python
import torch

def _softmax(x, axis=-1):
    return torch.softmax(x, dim=axis)

def _gelu(x):
    return torch.nn.functional.gelu(x, approximate='tanh')

def _silu(x):
    return torch.nn.functional.silu(x)

def _sigmoid(x):
    return torch.sigmoid(x)

def _layernorm(x, axis=-1, eps=1e-05):
    m = x.mean(dim=axis, keepdim=True)
    v = x.var(dim=axis, keepdim=True, unbiased=False)
    return (x - m) / torch.sqrt(v + eps)

def _scatter_add(tgt, idx, src, axis=0):
    return tgt.clone().index_add_(axis, idx, src)

def _segment_sum(src, seg, n):
    out = torch.zeros((n,) + src.shape[1:], dtype=src.dtype)
    return out.index_add_(0, seg, src)

def _pad(x, pw):
    flat = tuple((v for pair in reversed(pw) for v in pair))
    return torch.nn.functional.pad(x, flat)
kernel_name = 'sequential_preLN__memory_aug_recurrent_mem_tr__dense_activation_relu__prompt'

def setup_inputs():

    _w = lambda a: (lambda t: t.to(torch.bfloat16) if t.is_floating_point() else t)(torch.as_tensor(a))

    def _A_setup():
        B, S, Dm = (1, 2048, 448)
        H, Dh = (16, 256)
        M, seg = (8, 32)
        seg = min(seg, S)
        S = S // seg * seg
        return {'x': _w((lambda *s: torch.randn(*s, dtype=torch.bfloat16) * 0.05)(B, S, Dm)), 'mem0': _w((lambda *s: torch.randn(*s, dtype=torch.bfloat16) * 0.2)(B, M, Dm)), 'Wq': _w((lambda *s: torch.randn(*s, dtype=torch.bfloat16) * 1.6)(Dm, H, Dh) * Dm ** (-0.5)), 'Wk': _w((lambda *s: torch.randn(*s, dtype=torch.bfloat16) * 1.6)(Dm, H, Dh) * Dm ** (-0.5)), 'Wv': _w((lambda *s: torch.randn(*s, dtype=torch.bfloat16) * 0.2)(Dm, H, Dh) * Dm ** (-0.5)), 'Wo': _w((lambda *s: torch.randn(*s, dtype=torch.bfloat16) * 0.2)(H, Dh, Dm) * (H * Dh) ** (-0.5)), 'seg_len': seg}
    _A_in = _A_setup()

    def _B_setup():
        B, S, D, Dff = (1, 2048, 448, 1792)
        return {'x': _w((lambda *s: torch.randn(*s, dtype=torch.bfloat16) * 0.05)(B, S, D)), 'w1': _w((lambda *s: torch.randn(*s, dtype=torch.bfloat16) * 0.05)(D, Dff)), 'w2': _w((lambda *s: torch.randn(*s, dtype=torch.bfloat16) * 0.05)(Dff, D))}
    _B_in = _B_setup()
    return {'A_x': _A_in['x'], 'A_mem0': _A_in['mem0'], 'A_Wq': _A_in['Wq'], 'A_Wk': _A_in['Wk'], 'A_Wv': _A_in['Wv'], 'A_Wo': _A_in['Wo'], 'A_seg_len': _A_in['seg_len'], 'B_x': _B_in['x'], 'B_w1': _B_in['w1'], 'B_w2': _B_in['w2']}

def reference(A_x, A_mem0, A_Wq, A_Wk, A_Wv, A_Wo, A_seg_len, B_x, B_w1, B_w2):

    def _A_ref(x, mem0, Wq, Wk, Wv, Wo, seg_len):
        B, S, Dm = x.shape
        H, Dh = (Wq.shape[1], Wq.shape[2])
        M = mem0.shape[1]
        scale = Dh ** (-0.5)
        n_seg = S // seg_len
        L = M + seg_len
        idx = torch.arange(L)
        mask = (idx[:, None] < M) | (idx[:, None] >= idx[None, :])
        mem = mem0
        outs = []
        for s in range(n_seg):
            xs = x[:, s * seg_len:(s + 1) * seg_len, :].clone()
            h = torch.concatenate([mem, xs], axis=1)
            q = torch.einsum('btd,dhe->bhte', h, Wq)
            k = torch.einsum('btd,dhe->bhte', h, Wk)
            v = torch.einsum('btd,dhe->bhte', h, Wv)
            scores = torch.einsum('bhqe,bhke->bhqk', q, k) * scale
            scores = torch.where(mask[None, None], scores, -1000000000.0)
            p = _softmax(scores, axis=-1)
            o = torch.einsum('bhqk,bhke->bhqe', p, v)
            o = torch.einsum('bhte,hed->btd', o, Wo)
            mem = o[:, :M, :].clone()
            outs.append(o[:, M:, :])
        return torch.concatenate(outs, axis=1)

    def _B_ref(x, w1, w2):
        h = torch.einsum('bsd,df->bsf', x, w1)
        zero = torch.zeros_like(h)
        h = torch.maximum(h, zero)
        return torch.einsum('bsf,fd->bsd', h, w2)
    x = A_x
    h = x + _A_ref(_layernorm(x, axis=-1), A_mem0, A_Wq, A_Wk, A_Wv, A_Wo, A_seg_len)
    h2 = h + _B_ref(_layernorm(h, axis=-1), B_w1, B_w2)
    return h2
```

```asm
; @launch kernel=prep_kernel grid=(256,1,1) block=(256,1,1) lds=163840
; @launch kernel=main_kernel grid=(256,1,1) block=(256,1,1) lds=163840
.amdgcn_target "amdgcn-amd-amdhsa--gfx950"
.text
.globl prep_kernel
.p2align 8
.type prep_kernel,@function
prep_kernel:
    s_getpc_b64 s[40:41]
P_pc:
    v_lshlrev_b32 v12, 7, v0
    global_load_dword v255, v12, s[40:41]
    s_load_dwordx8 s[24:31], s[0:1], 16
    s_load_dwordx4 s[32:35], s[0:1], 0
    s_cmp_ge_u32 s2, 256
    s_cbranch_scc1 P_exit
    s_and_b32 s21, s2, 7
    s_lshr_b32 s22, s2, 3
    s_mul_i32 s23, s22, 37
    s_lshr_b32 s23, s23, 8
    s_mul_i32 s36, s23, 7
    s_sub_u32 s36, s22, s36
    s_lshl_b32 s37, s21, 1
    s_lshr_b32 s38, s23, 1
    s_add_u32 s38, s38, s37
    s_lshl_b32 s46, s36, 19
    s_lshl_b32 s47, s38, 9
    s_add_u32 s46, s46, s47
    v_lshrrev_b32 v9, 2, v0
    v_and_b32 v10, 3, v0
    v_lshlrev_b32 v9, 13, v9
    v_lshl_add_u32 v9, v10, 7, v9
    v_add_u32 v9, s46, v9
    s_cmp_ge_u32 s22, 28
    s_cbranch_scc1 P_e2
    s_bitcmp1_b32 s23, 0
    s_waitcnt lgkmcnt(0)
    s_cbranch_scc1 P_e1
    global_load_dword v14, v9, s[26:27]
    global_load_dword v15, v9, s[24:25]
    s_branch P_e2
P_e1:
    s_mul_i32 s46, s38, 229376
    s_lshl_b32 s47, s36, 7
    s_add_u32 s46, s46, s47
    v_mul_u32_u24 v10, 896, v0
    v_add_u32 v10, s46, v10
    global_load_dword v14, v10, s[30:31]
    global_load_dword v15, v9, s[28:29]
P_e2:
    s_load_dwordx2 s[4:5], s[0:1], 96
    s_load_dwordx2 s[6:7], s[0:1], 88
    v_lshrrev_b32 v2, 6, v0
    v_and_b32 v1, 63, v0
    v_readfirstlane_b32 s20, v2
    s_waitcnt lgkmcnt(0)
    s_mov_b32 s8, s4
    s_and_b32 s9, s5, 0xffff
    s_mov_b32 s10, 268435456
    s_mov_b32 s11, 0x20000
    s_cmp_ge_u32 s22, 28
    s_cbranch_scc1 P_ln
    s_mul_i32 s23, s22, 37
    s_lshr_b32 s23, s23, 8
    s_mul_i32 s36, s23, 7
    s_sub_u32 s36, s22, s36
    s_lshl_b32 s21, s21, 2
    s_add_u32 s21, s21, s23
    s_and_b32 s37, s21, 1
    s_lshr_b32 s38, s21, 1
    s_cmp_eq_u32 s37, 0
    s_cselect_b32 s40, s24, s28
    s_cselect_b32 s41, s25, s29
    s_cselect_b32 s42, s26, s30
    s_cselect_b32 s43, s27, s31
    s_mov_b32 s12, s40
    s_and_b32 s13, s41, 0xffff
    s_mov_b32 s14, 3670016
    s_mov_b32 s15, 0x20000
    s_mov_b32 s16, s42
    s_and_b32 s17, s43, 0xffff
    s_mov_b32 s18, 3670016
    s_mov_b32 s19, 0x20000
    s_lshl_b32 s39, s20, 2
    s_cmp_eq_u32 s20, 3
    s_cselect_b32 s39, 11, s39
    v_and_b32 v4, 15, v1
    v_lshrrev_b32 v5, 4, v1
    v_lshrrev_b32 v6, 5, v1
    v_and_b32 v7, 31, v1
    v_xor_b32 v7, v7, v6
    v_lshlrev_b32 v8, 13, v6
    v_lshl_add_u32 v8, v7, 4, v8
    s_lshl_b32 s50, s20, 14
    s_lshl_b32 s44, s39, 18
    s_lshl_b32 s45, s38, 9
    s_add_u32 s44, s44, s45
    v_xor_b32 v16, 0, v8
    v_xor_b32 v17, 32, v8
    v_xor_b32 v18, 64, v8
    v_xor_b32 v19, 96, v8
    v_xor_b32 v20, 128, v8
    v_xor_b32 v21, 160, v8
    v_xor_b32 v22, 192, v8
    v_xor_b32 v23, 224, v8
    v_lshrrev_b32 v6, 2, v4
    v_and_b32 v7, 3, v4
    v_lshl_add_u32 v6, v6, 3, v7
    v_lshlrev_b32 v6, 9, v6
    v_add_u32 v6, s50, v6
    v_xor_b32 v7, v5, v4
    v_xor_b32 v9, 0, v7
    v_lshl_add_u32 v24, v9, 4, v6
    v_xor_b32 v9, 4, v7
    v_lshl_add_u32 v25, v9, 4, v6
    v_xor_b32 v9, 8, v7
    v_lshl_add_u32 v26, v9, 4, v6
    v_xor_b32 v9, 12, v7
    v_lshl_add_u32 v27, v9, 4, v6
    s_cmp_eq_u32 s37, 0
    s_cbranch_scc0 P_t1
    s_lshl_b32 s47, s36, 19
    s_add_u32 s47, s47, s45
    s_lshl_b32 s46, s20, 17
    s_add_u32 s47, s47, s46
    s_lshl_b32 s51, s20, 13
    s_mov_b32 s48, 1035512379
    s_add_u32 m0, s51, 131072
    s_add_u32 s46, s47, 0
    buffer_load_dwordx4 v16, s[16:19], s46 offen  lds
    s_add_u32 m0, s51, 132096
    s_add_u32 s46, s47, 16384
    buffer_load_dwordx4 v17, s[16:19], s46 offen  lds
    s_add_u32 m0, s51, 133120
    s_add_u32 s46, s47, 32768
    buffer_load_dwordx4 v18, s[16:19], s46 offen  lds
    s_add_u32 m0, s51, 134144
    s_add_u32 s46, s47, 49152
    buffer_load_dwordx4 v19, s[16:19], s46 offen  lds
    s_add_u32 m0, s51, 135168
    s_add_u32 s46, s47, 65536
    buffer_load_dwordx4 v20, s[16:19], s46 offen  lds
    s_add_u32 m0, s51, 136192
    s_add_u32 s46, s47, 81920
    buffer_load_dwordx4 v21, s[16:19], s46 offen  lds
    s_add_u32 m0, s51, 137216
    s_add_u32 s46, s47, 98304
    buffer_load_dwordx4 v22, s[16:19], s46 offen  lds
    s_add_u32 m0, s51, 138240
    s_add_u32 s46, s47, 114688
    buffer_load_dwordx4 v23, s[16:19], s46 offen  lds
    s_branch P_tj
P_t1:
    v_lshrrev_b32 v10, 3, v1
    v_and_b32 v11, 7, v1
    v_mul_u32_u24 v9, 896, v10
    v_and_b32 v12, 2, v10
    v_xor_b32 v11, v11, v12
    v_lshl_add_u32 v9, v11, 4, v9
    v_xor_b32 v13, 64, v9
    s_mul_i32 s47, s38, 229376
    s_lshl_b32 s46, s36, 7
    s_add_u32 s47, s47, s46
    s_mul_i32 s46, s20, 57344
    s_add_u32 s47, s47, s46
    s_lshl_b32 s51, s20, 13
    s_mov_b32 s48, 1.0
    s_add_u32 m0, s51, 131072
    s_add_u32 s46, s47, 0
    buffer_load_dwordx4 v9, s[16:19], s46 offen  lds
    s_add_u32 m0, s51, 132096
    s_add_u32 s46, s47, 7168
    buffer_load_dwordx4 v13, s[16:19], s46 offen  lds
    s_add_u32 m0, s51, 133120
    s_add_u32 s46, s47, 14336
    buffer_load_dwordx4 v9, s[16:19], s46 offen  lds
    s_add_u32 m0, s51, 134144
    s_add_u32 s46, s47, 21504
    buffer_load_dwordx4 v13, s[16:19], s46 offen  lds
    s_add_u32 m0, s51, 135168
    s_add_u32 s46, s47, 28672
    buffer_load_dwordx4 v9, s[16:19], s46 offen  lds
    s_add_u32 m0, s51, 136192
    s_add_u32 s46, s47, 35840
    buffer_load_dwordx4 v13, s[16:19], s46 offen  lds
    s_add_u32 m0, s51, 137216
    s_add_u32 s46, s47, 43008
    buffer_load_dwordx4 v9, s[16:19], s46 offen  lds
    s_add_u32 m0, s51, 138240
    s_add_u32 s46, s47, 50176
    buffer_load_dwordx4 v13, s[16:19], s46 offen  lds
P_tj:
    s_add_u32 m0, s50, 0
    s_add_u32 s46, s44, 0
    buffer_load_dwordx4 v16, s[12:15], s46 offen lds
    s_add_u32 m0, s50, 1024
    s_add_u32 s46, s44, 16384
    buffer_load_dwordx4 v17, s[12:15], s46 offen lds
    s_add_u32 m0, s50, 2048
    s_add_u32 s46, s44, 32768
    buffer_load_dwordx4 v16, s[12:15], s46 offen lds
    s_add_u32 m0, s50, 3072
    s_add_u32 s46, s44, 49152
    buffer_load_dwordx4 v17, s[12:15], s46 offen lds
    s_add_u32 m0, s50, 4096
    s_add_u32 s46, s44, 65536
    buffer_load_dwordx4 v18, s[12:15], s46 offen lds
    s_add_u32 m0, s50, 5120
    s_add_u32 s46, s44, 81920
    buffer_load_dwordx4 v19, s[12:15], s46 offen lds
    s_add_u32 m0, s50, 6144
    s_add_u32 s46, s44, 98304
    buffer_load_dwordx4 v18, s[12:15], s46 offen lds
    s_add_u32 m0, s50, 7168
    s_add_u32 s46, s44, 114688
    buffer_load_dwordx4 v19, s[12:15], s46 offen lds
    s_add_u32 m0, s50, 8192
    s_add_u32 s46, s44, 131072
    buffer_load_dwordx4 v20, s[12:15], s46 offen lds
    s_add_u32 m0, s50, 9216
    s_add_u32 s46, s44, 147456
    buffer_load_dwordx4 v21, s[12:15], s46 offen lds
    s_add_u32 m0, s50, 10240
    s_add_u32 s46, s44, 163840
    buffer_load_dwordx4 v20, s[12:15], s46 offen lds
    s_add_u32 m0, s50, 11264
    s_add_u32 s46, s44, 180224
    buffer_load_dwordx4 v21, s[12:15], s46 offen lds
    s_add_u32 m0, s50, 12288
    s_add_u32 s46, s44, 196608
    buffer_load_dwordx4 v22, s[12:15], s46 offen lds
    s_add_u32 m0, s50, 13312
    s_add_u32 s46, s44, 212992
    buffer_load_dwordx4 v23, s[12:15], s46 offen lds
    s_add_u32 m0, s50, 14336
    s_add_u32 s46, s44, 229376
    buffer_load_dwordx4 v22, s[12:15], s46 offen lds
    s_add_u32 m0, s50, 15360
    s_add_u32 s46, s44, 245760
    buffer_load_dwordx4 v23, s[12:15], s46 offen lds
    s_waitcnt vmcnt(16)
    s_barrier
    s_cmp_eq_u32 s37, 0
    s_cbranch_scc0 P_r1
    v_lshlrev_b32 v6, 9, v4
    v_add_u32 v6, 131072, v6
    v_xor_b32 v9, 0, v7
    v_lshl_add_u32 v28, v9, 4, v6
    v_xor_b32 v9, 4, v7
    v_lshl_add_u32 v29, v9, 4, v6
    v_xor_b32 v9, 8, v7
    v_lshl_add_u32 v30, v9, 4, v6
    v_xor_b32 v9, 12, v7
    v_lshl_add_u32 v31, v9, 4, v6
    ds_read_b128 a[0:3], v28 offset:0
    ds_read_b128 a[4:7], v28 offset:8192
    s_add_u32 m0, s50, 65536
    s_add_u32 s46, s44, 262144
    buffer_load_dwordx4 v16, s[12:15], s46 offen lds
    ds_read_b128 a[8:11], v28 offset:16384
    ds_read_b128 a[12:15], v28 offset:24576
    s_add_u32 m0, s50, 66560
    s_add_u32 s46, s44, 278528
    buffer_load_dwordx4 v17, s[12:15], s46 offen lds
    ds_read_b128 a[16:19], v29 offset:0
    ds_read_b128 a[20:23], v29 offset:8192
    s_add_u32 m0, s50, 67584
    s_add_u32 s46, s44, 294912
    buffer_load_dwordx4 v16, s[12:15], s46 offen lds
    ds_read_b128 a[24:27], v29 offset:16384
    ds_read_b128 a[28:31], v29 offset:24576
    s_add_u32 m0, s50, 68608
    s_add_u32 s46, s44, 311296
    buffer_load_dwordx4 v17, s[12:15], s46 offen lds
    ds_read_b128 a[32:35], v30 offset:0
    ds_read_b128 a[36:39], v30 offset:8192
    s_add_u32 m0, s50, 69632
    s_add_u32 s46, s44, 327680
    buffer_load_dwordx4 v18, s[12:15], s46 offen lds
    ds_read_b128 a[40:43], v30 offset:16384
    ds_read_b128 a[44:47], v30 offset:24576
    s_add_u32 m0, s50, 70656
    s_add_u32 s46, s44, 344064
    buffer_load_dwordx4 v19, s[12:15], s46 offen lds
    ds_read_b128 a[48:51], v31 offset:0
    ds_read_b128 a[52:55], v31 offset:8192
    s_add_u32 m0, s50, 71680
    s_add_u32 s46, s44, 360448
    buffer_load_dwordx4 v18, s[12:15], s46 offen lds
    ds_read_b128 a[56:59], v31 offset:16384
    ds_read_b128 a[60:63], v31 offset:24576
    s_add_u32 m0, s50, 72704
    s_add_u32 s46, s44, 376832
    buffer_load_dwordx4 v19, s[12:15], s46 offen lds
    ds_read_b128 a[64:67], v28 offset:256
    ds_read_b128 a[68:71], v28 offset:8448
    s_add_u32 m0, s50, 73728
    s_add_u32 s46, s44, 393216
    buffer_load_dwordx4 v20, s[12:15], s46 offen lds
    ds_read_b128 a[72:75], v28 offset:16640
    ds_read_b128 a[76:79], v28 offset:24832
    s_add_u32 m0, s50, 74752
    s_add_u32 s46, s44, 409600
    buffer_load_dwordx4 v21, s[12:15], s46 offen lds
    ds_read_b128 a[80:83], v29 offset:256
    ds_read_b128 a[84:87], v29 offset:8448
    s_add_u32 m0, s50, 75776
    s_add_u32 s46, s44, 425984
    buffer_load_dwordx4 v20, s[12:15], s46 offen lds
    ds_read_b128 a[88:91], v29 offset:16640
    ds_read_b128 a[92:95], v29 offset:24832
    s_add_u32 m0, s50, 76800
    s_add_u32 s46, s44, 442368
    buffer_load_dwordx4 v21, s[12:15], s46 offen lds
    ds_read_b128 a[96:99], v30 offset:256
    ds_read_b128 a[100:103], v30 offset:8448
    s_add_u32 m0, s50, 77824
    s_add_u32 s46, s44, 458752
    buffer_load_dwordx4 v22, s[12:15], s46 offen lds
    ds_read_b128 a[104:107], v30 offset:16640
    ds_read_b128 a[108:111], v30 offset:24832
    s_add_u32 m0, s50, 78848
    s_add_u32 s46, s44, 475136
    buffer_load_dwordx4 v23, s[12:15], s46 offen lds
    ds_read_b128 a[112:115], v31 offset:256
    ds_read_b128 a[116:119], v31 offset:8448
    s_add_u32 m0, s50, 79872
    s_add_u32 s46, s44, 491520
    buffer_load_dwordx4 v22, s[12:15], s46 offen lds
    ds_read_b128 a[120:123], v31 offset:16640
    ds_read_b128 a[124:127], v31 offset:24832
    s_add_u32 m0, s50, 80896
    s_add_u32 s46, s44, 507904
    buffer_load_dwordx4 v23, s[12:15], s46 offen lds
    s_branch P_rj
P_r1:
    v_bfe_u32 v10, v1, 2, 2
    v_lshl_add_u32 v11, v5, 3, v10
    v_lshlrev_b32 v13, 7, v11
    v_add_u32 v13, 131072, v13
    v_and_b32 v11, 3, v1
    v_lshl_add_u32 v13, v11, 3, v13
    v_lshrrev_b32 v10, 1, v10
    v_and_b32 v11, 1, v5
    v_lshl_add_u32 v10, v11, 1, v10
    v_xor_b32 v9, 0, v10
    v_lshl_add_u32 v28, v9, 5, v13
    v_xor_b32 v9, 1, v10
    v_lshl_add_u32 v29, v9, 5, v13
    v_xor_b32 v9, 2, v10
    v_lshl_add_u32 v30, v9, 5, v13
    v_xor_b32 v9, 3, v10
    v_lshl_add_u32 v31, v9, 5, v13
    ds_read_b64_tr_b16 a[0:1], v28 offset:0
    ds_read_b64_tr_b16 a[2:3], v28 offset:512
    ds_read_b64_tr_b16 a[4:5], v29 offset:0
    ds_read_b64_tr_b16 a[6:7], v29 offset:512
    s_add_u32 m0, s50, 65536
    s_add_u32 s46, s44, 262144
    buffer_load_dwordx4 v16, s[12:15], s46 offen lds
    ds_read_b64_tr_b16 a[8:9], v30 offset:0
    ds_read_b64_tr_b16 a[10:11], v30 offset:512
    ds_read_b64_tr_b16 a[12:13], v31 offset:0
    ds_read_b64_tr_b16 a[14:15], v31 offset:512
    s_add_u32 m0, s50, 66560
    s_add_u32 s46, s44, 278528
    buffer_load_dwordx4 v17, s[12:15], s46 offen lds
    ds_read_b64_tr_b16 a[16:17], v28 offset:4096
    ds_read_b64_tr_b16 a[18:19], v28 offset:4608
    ds_read_b64_tr_b16 a[20:21], v29 offset:4096
    ds_read_b64_tr_b16 a[22:23], v29 offset:4608
    s_add_u32 m0, s50, 67584
    s_add_u32 s46, s44, 294912
    buffer_load_dwordx4 v16, s[12:15], s46 offen lds
    ds_read_b64_tr_b16 a[24:25], v30 offset:4096
    ds_read_b64_tr_b16 a[26:27], v30 offset:4608
    ds_read_b64_tr_b16 a[28:29], v31 offset:4096
    ds_read_b64_tr_b16 a[30:31], v31 offset:4608
    s_add_u32 m0, s50, 68608
    s_add_u32 s46, s44, 311296
    buffer_load_dwordx4 v17, s[12:15], s46 offen lds
    ds_read_b64_tr_b16 a[32:33], v28 offset:8192
    ds_read_b64_tr_b16 a[34:35], v28 offset:8704
    ds_read_b64_tr_b16 a[36:37], v29 offset:8192
    ds_read_b64_tr_b16 a[38:39], v29 offset:8704
    s_add_u32 m0, s50, 69632
    s_add_u32 s46, s44, 327680
    buffer_load_dwordx4 v18, s[12:15], s46 offen lds
    ds_read_b64_tr_b16 a[40:41], v30 offset:8192
    ds_read_b64_tr_b16 a[42:43], v30 offset:8704
    ds_read_b64_tr_b16 a[44:45], v31 offset:8192
    ds_read_b64_tr_b16 a[46:47], v31 offset:8704
    s_add_u32 m0, s50, 70656
    s_add_u32 s46, s44, 344064
    buffer_load_dwordx4 v19, s[12:15], s46 offen lds
    ds_read_b64_tr_b16 a[48:49], v28 offset:12288
    ds_read_b64_tr_b16 a[50:51], v28 offset:12800
    ds_read_b64_tr_b16 a[52:53], v29 offset:12288
    ds_read_b64_tr_b16 a[54:55], v29 offset:12800
    s_add_u32 m0, s50, 71680
    s_add_u32 s46, s44, 360448
    buffer_load_dwordx4 v18, s[12:15], s46 offen lds
    ds_read_b64_tr_b16 a[56:57], v30 offset:12288
    ds_read_b64_tr_b16 a[58:59], v30 offset:12800
    ds_read_b64_tr_b16 a[60:61], v31 offset:12288
    ds_read_b64_tr_b16 a[62:63], v31 offset:12800
    s_add_u32 m0, s50, 72704
    s_add_u32 s46, s44, 376832
    buffer_load_dwordx4 v19, s[12:15], s46 offen lds
    ds_read_b64_tr_b16 a[64:65], v28 offset:16384
    ds_read_b64_tr_b16 a[66:67], v28 offset:16896
    ds_read_b64_tr_b16 a[68:69], v29 offset:16384
    ds_read_b64_tr_b16 a[70:71], v29 offset:16896
    s_add_u32 m0, s50, 73728
    s_add_u32 s46, s44, 393216
    buffer_load_dwordx4 v20, s[12:15], s46 offen lds
    ds_read_b64_tr_b16 a[72:73], v30 offset:16384
    ds_read_b64_tr_b16 a[74:75], v30 offset:16896
    ds_read_b64_tr_b16 a[76:77], v31 offset:16384
    ds_read_b64_tr_b16 a[78:79], v31 offset:16896
    s_add_u32 m0, s50, 74752
    s_add_u32 s46, s44, 409600
    buffer_load_dwordx4 v21, s[12:15], s46 offen lds
    ds_read_b64_tr_b16 a[80:81], v28 offset:20480
    ds_read_b64_tr_b16 a[82:83], v28 offset:20992
    ds_read_b64_tr_b16 a[84:85], v29 offset:20480
    ds_read_b64_tr_b16 a[86:87], v29 offset:20992
    s_add_u32 m0, s50, 75776
    s_add_u32 s46, s44, 425984
    buffer_load_dwordx4 v20, s[12:15], s46 offen lds
    ds_read_b64_tr_b16 a[88:89], v30 offset:20480
    ds_read_b64_tr_b16 a[90:91], v30 offset:20992
    ds_read_b64_tr_b16 a[92:93], v31 offset:20480
    ds_read_b64_tr_b16 a[94:95], v31 offset:20992
    s_add_u32 m0, s50, 76800
    s_add_u32 s46, s44, 442368
    buffer_load_dwordx4 v21, s[12:15], s46 offen lds
    ds_read_b64_tr_b16 a[96:97], v28 offset:24576
    ds_read_b64_tr_b16 a[98:99], v28 offset:25088
    ds_read_b64_tr_b16 a[100:101], v29 offset:24576
    ds_read_b64_tr_b16 a[102:103], v29 offset:25088
    s_add_u32 m0, s50, 77824
    s_add_u32 s46, s44, 458752
    buffer_load_dwordx4 v22, s[12:15], s46 offen lds
    ds_read_b64_tr_b16 a[104:105], v30 offset:24576
    ds_read_b64_tr_b16 a[106:107], v30 offset:25088
    ds_read_b64_tr_b16 a[108:109], v31 offset:24576
    ds_read_b64_tr_b16 a[110:111], v31 offset:25088
    s_add_u32 m0, s50, 78848
    s_add_u32 s46, s44, 475136
    buffer_load_dwordx4 v23, s[12:15], s46 offen lds
    ds_read_b64_tr_b16 a[112:113], v28 offset:28672
    ds_read_b64_tr_b16 a[114:115], v28 offset:29184
    ds_read_b64_tr_b16 a[116:117], v29 offset:28672
    ds_read_b64_tr_b16 a[118:119], v29 offset:29184
    s_add_u32 m0, s50, 79872
    s_add_u32 s46, s44, 491520
    buffer_load_dwordx4 v22, s[12:15], s46 offen lds
    ds_read_b64_tr_b16 a[120:121], v30 offset:28672
    ds_read_b64_tr_b16 a[122:123], v30 offset:29184
    ds_read_b64_tr_b16 a[124:125], v31 offset:28672
    ds_read_b64_tr_b16 a[126:127], v31 offset:29184
    s_add_u32 m0, s50, 80896
    s_add_u32 s46, s44, 507904
    buffer_load_dwordx4 v23, s[12:15], s46 offen lds
P_rj:
    s_mul_i32 s52, s37, 448
    s_mul_i32 s47, s38, 28
    s_add_u32 s52, s52, s47
    s_lshl_b32 s47, s36, 2
    s_add_u32 s52, s52, s47
    s_mul_i32 s52, s52, 14336
    s_lshl_b32 s47, s39, 10
    s_add_u32 s52, s52, s47
    s_add_u32 s52, s52, 2097152
    s_mov_b32 s49, s48
    v_lshlrev_b32 v3, 4, v1
    s_waitcnt vmcnt(16)
    v_add_u32 v10, 65536, v24
    v_add_u32 v11, 65536, v25
    v_add_u32 v12, 65536, v26
    v_add_u32 v13, 65536, v27
    ds_read_b128 v[32:35], v24 offset:0
    ds_read_b128 v[36:39], v25 offset:0
    ds_read_b128 v[40:43], v26 offset:0
    ds_read_b128 v[44:47], v27 offset:0
    ds_read_b128 v[48:51], v24 offset:256
    ds_read_b128 v[52:55], v25 offset:256
    ds_read_b128 v[56:59], v26 offset:256
    ds_read_b128 v[60:63], v27 offset:256
    ds_read_b128 v[64:67], v24 offset:2048
    ds_read_b128 v[68:71], v25 offset:2048
    ds_read_b128 v[72:75], v26 offset:2048
    ds_read_b128 v[76:79], v27 offset:2048
    ds_read_b128 v[80:83], v24 offset:2304
    ds_read_b128 v[84:87], v25 offset:2304
    ds_read_b128 v[88:91], v26 offset:2304
    ds_read_b128 v[92:95], v27 offset:2304
    v_lshlrev_b32 v240, 4, v0
    v_mov_b32 v244, -1
    v_mov_b32 v245, -1
    v_mov_b32 v246, -1
    v_mov_b32 v247, -1
    s_mul_i32 s53, s2, 12288
    s_add_u32 s53, s53, 19922944
    s_add_u32 s54, s53, 0
    s_and_b32 s55, s54, 0xffffe000
    s_cmp_eq_u32 s55, 19922944
    s_cbranch_scc1 P_fs_1
    s_cmp_eq_u32 s55, 22151168
    s_cbranch_scc1 P_fs_1
    s_cmp_ge_u32 s54, 23003136
    s_cselect_b32 s55, 0, -1
    v_mov_b32 v244, s55
    v_mov_b32 v245, s55
    v_mov_b32 v246, s55
    v_mov_b32 v247, s55
    buffer_store_dwordx4 v[244:247], v240, s[8:11], s54 offen sc1
    s_nop 1
P_fs_1:
    s_add_u32 s54, s53, 4096
    s_and_b32 s55, s54, 0xffffe000
    s_cmp_eq_u32 s55, 19922944
    s_cbranch_scc1 P_fs_2
    s_cmp_eq_u32 s55, 22151168
    s_cbranch_scc1 P_fs_2
    s_cmp_ge_u32 s54, 23003136
    s_cselect_b32 s55, 0, -1
    v_mov_b32 v244, s55
    v_mov_b32 v245, s55
    v_mov_b32 v246, s55
    v_mov_b32 v247, s55
    buffer_store_dwordx4 v[244:247], v240, s[8:11], s54 offen sc1
    s_nop 1
P_fs_2:
    s_add_u32 s54, s53, 8192
    s_and_b32 s55, s54, 0xffffe000
    s_cmp_eq_u32 s55, 19922944
    s_cbranch_scc1 P_fs_3
    s_cmp_eq_u32 s55, 22151168
    s_cbranch_scc1 P_fs_3
    s_cmp_ge_u32 s54, 23003136
    s_cselect_b32 s55, 0, -1
    v_mov_b32 v244, s55
    v_mov_b32 v245, s55
    v_mov_b32 v246, s55
    v_mov_b32 v247, s55
    buffer_store_dwordx4 v[244:247], v240, s[8:11], s54 offen sc1
    s_nop 1
P_fs_3:
    s_waitcnt lgkmcnt(0)
    s_nop 0
    v_mfma_f32_16x16x32_bf16 v[160:163], v[32:35], a[0:3], 0
    s_add_u32 m0, s50, 0
    s_add_u32 s46, s44, 524288
    buffer_load_dwordx4 v16, s[12:15], s46 offen lds
    v_mfma_f32_16x16x32_bf16 v[164:167], v[32:35], a[4:7], 0
    v_mfma_f32_16x16x32_bf16 v[168:171], v[32:35], a[8:11], 0
    v_mfma_f32_16x16x32_bf16 v[172:175], v[32:35], a[12:15], 0
    s_add_u32 m0, s50, 1024
    s_add_u32 s46, s44, 540672
    buffer_load_dwordx4 v17, s[12:15], s46 offen lds
    v_mfma_f32_16x16x32_bf16 v[160:163], v[36:39], a[16:19], v[160:163]
    v_mfma_f32_16x16x32_bf16 v[164:167], v[36:39], a[20:23], v[164:167]
    v_mfma_f32_16x16x32_bf16 v[168:171], v[36:39], a[24:27], v[168:171]
    s_add_u32 m0, s50, 2048
    s_add_u32 s46, s44, 557056
    buffer_load_dwordx4 v16, s[12:15], s46 offen lds
    v_mfma_f32_16x16x32_bf16 v[172:175], v[36:39], a[28:31], v[172:175]
    v_mfma_f32_16x16x32_bf16 v[160:163], v[40:43], a[32:35], v[160:163]
    v_mfma_f32_16x16x32_bf16 v[164:167], v[40:43], a[36:39], v[164:167]
    s_add_u32 m0, s50, 3072
    s_add_u32 s46, s44, 573440
    buffer_load_dwordx4 v17, s[12:15], s46 offen lds
    v_mfma_f32_16x16x32_bf16 v[168:171], v[40:43], a[40:43], v[168:171]
    v_mfma_f32_16x16x32_bf16 v[172:175], v[40:43], a[44:47], v[172:175]
    v_mfma_f32_16x16x32_bf16 v[160:163], v[44:47], a[48:51], v[160:163]
    s_add_u32 m0, s50, 4096
    s_add_u32 s46, s44, 589824
    buffer_load_dwordx4 v18, s[12:15], s46 offen lds
    v_mfma_f32_16x16x32_bf16 v[164:167], v[44:47], a[52:55], v[164:167]
    v_mfma_f32_16x16x32_bf16 v[168:171], v[44:47], a[56:59], v[168:171]
    v_mfma_f32_16x16x32_bf16 v[172:175], v[44:47], a[60:63], v[172:175]
    s_add_u32 m0, s50, 5120
    s_add_u32 s46, s44, 606208
    buffer_load_dwordx4 v19, s[12:15], s46 offen lds
    v_mfma_f32_16x16x32_bf16 v[160:163], v[48:51], a[64:67], v[160:163]
    v_mfma_f32_16x16x32_bf16 v[164:167], v[48:51], a[68:71], v[164:167]
    v_mfma_f32_16x16x32_bf16 v[168:171], v[48:51], a[72:75], v[168:171]
    s_add_u32 m0, s50, 6144
    s_add_u32 s46, s44, 622592
    buffer_load_dwordx4 v18, s[12:15], s46 offen lds
    v_mfma_f32_16x16x32_bf16 v[172:175], v[48:51], a[76:79], v[172:175]
    v_mfma_f32_16x16x32_bf16 v[160:163], v[52:55], a[80:83], v[160:163]
    v_mfma_f32_16x16x32_bf16 v[164:167], v[52:55], a[84:87], v[164:167]
    s_add_u32 m0, s50, 7168
    s_add_u32 s46, s44, 638976
    buffer_load_dwordx4 v19, s[12:15], s46 offen lds
    v_mfma_f32_16x16x32_bf16 v[168:171], v[52:55], a[88:91], v[168:171]
    v_mfma_f32_16x16x32_bf16 v[172:175], v[52:55], a[92:95], v[172:175]
    v_mfma_f32_16x16x32_bf16 v[160:163], v[56:59], a[96:99], v[160:163]
    s_add_u32 m0, s50, 8192
    s_add_u32 s46, s44, 655360
    buffer_load_dwordx4 v20, s[12:15], s46 offen lds
    v_mfma_f32_16x16x32_bf16 v[164:167], v[56:59], a[100:103], v[164:167]
    v_mfma_f32_16x16x32_bf16 v[168:171], v[56:59], a[104:107], v[168:171]
    v_mfma_f32_16x16x32_bf16 v[172:175], v[56:59], a[108:111], v[172:175]
    s_add_u32 m0, s50, 9216
    s_add_u32 s46, s44, 671744
    buffer_load_dwordx4 v21, s[12:15], s46 offen lds
    v_mfma_f32_16x16x32_bf16 v[160:163], v[60:63], a[112:115], v[160:163]
    v_mfma_f32_16x16x32_bf16 v[164:167], v[60:63], a[116:119], v[164:167]
    v_mfma_f32_16x16x32_bf16 v[168:171], v[60:63], a[120:123], v[168:171]
    s_add_u32 m0, s50, 10240
    s_add_u32 s46, s44, 688128
    buffer_load_dwordx4 v20, s[12:15], s46 offen lds
    v_mfma_f32_16x16x32_bf16 v[172:175], v[60:63], a[124:127], v[172:175]
    v_mfma_f32_16x16x32_bf16 v[176:179], v[64:67], a[0:3], 0
    v_mfma_f32_16x16x32_bf16 v[180:183], v[64:67], a[4:7], 0
    s_add_u32 m0, s50, 11264
    s_add_u32 s46, s44, 704512
    buffer_load_dwordx4 v21, s[12:15], s46 offen lds
    v_mfma_f32_16x16x32_bf16 v[184:187], v[64:67], a[8:11], 0
    v_mfma_f32_16x16x32_bf16 v[188:191], v[64:67], a[12:15], 0
    v_mfma_f32_16x16x32_bf16 v[176:179], v[68:71], a[16:19], v[176:179]
    s_add_u32 m0, s50, 12288
    s_add_u32 s46, s44, 720896
    buffer_load_dwordx4 v22, s[12:15], s46 offen lds
    v_mfma_f32_16x16x32_bf16 v[180:183], v[68:71], a[20:23], v[180:183]
    v_mfma_f32_16x16x32_bf16 v[184:187], v[68:71], a[24:27], v[184:187]
    v_mfma_f32_16x16x32_bf16 v[188:191], v[68:71], a[28:31], v[188:191]
    s_add_u32 m0, s50, 13312
    s_add_u32 s46, s44, 737280
    buffer_load_dwordx4 v23, s[12:15], s46 offen lds
    v_mfma_f32_16x16x32_bf16 v[176:179], v[72:75], a[32:35], v[176:179]
    v_mfma_f32_16x16x32_bf16 v[180:183], v[72:75], a[36:39], v[180:183]
    v_mfma_f32_16x16x32_bf16 v[184:187], v[72:75], a[40:43], v[184:187]
    s_add_u32 m0, s50, 14336
    s_add_u32 s46, s44, 753664
    buffer_load_dwordx4 v22, s[12:15], s46 offen lds
    v_mfma_f32_16x16x32_bf16 v[188:191], v[72:75], a[44:47], v[188:191]
    v_mfma_f32_16x16x32_bf16 v[176:179], v[76:79], a[48:51], v[176:179]
    s_waitcnt vmcnt(15)
    ds_read_b128 v[96:99], v10 offset:0
    v_mfma_f32_16x16x32_bf16 v[180:183], v[76:79], a[52:55], v[180:183]
    s_add_u32 m0, s50, 15360
    s_add_u32 s46, s44, 770048
    buffer_load_dwordx4 v23, s[12:15], s46 offen lds
    ds_read_b128 v[100:103], v11 offset:0
    v_mfma_f32_16x16x32_bf16 v[184:187], v[76:79], a[56:59], v[184:187]
    ds_read_b128 v[104:107], v12 offset:0
    v_mfma_f32_16x16x32_bf16 v[188:191], v[76:79], a[60:63], v[188:191]
    ds_read_b128 v[108:111], v13 offset:0
    v_mfma_f32_16x16x32_bf16 v[176:179], v[80:83], a[64:67], v[176:179]
    ds_read_b128 v[112:115], v10 offset:256
    v_mfma_f32_16x16x32_bf16 v[180:183], v[80:83], a[68:71], v[180:183]
    ds_read_b128 v[116:119], v11 offset:256
    v_mfma_f32_16x16x32_bf16 v[184:187], v[80:83], a[72:75], v[184:187]
    ds_read_b128 v[120:123], v12 offset:256
    v_mfma_f32_16x16x32_bf16 v[188:191], v[80:83], a[76:79], v[188:191]
    ds_read_b128 v[124:127], v13 offset:256
    v_mfma_f32_16x16x32_bf16 v[176:179], v[84:87], a[80:83], v[176:179]
    ds_read_b128 v[128:131], v10 offset:2048
    v_mfma_f32_16x16x32_bf16 v[180:183], v[84:87], a[84:87], v[180:183]
    ds_read_b128 v[132:135], v11 offset:2048
    v_mfma_f32_16x16x32_bf16 v[184:187], v[84:87], a[88:91], v[184:187]
    ds_read_b128 v[136:139], v12 offset:2048
    v_mfma_f32_16x16x32_bf16 v[188:191], v[84:87], a[92:95], v[188:191]
    ds_read_b128 v[140:143], v13 offset:2048
    v_mfma_f32_16x16x32_bf16 v[176:179], v[88:91], a[96:99], v[176:179]
    ds_read_b128 v[144:147], v10 offset:2304
    v_mfma_f32_16x16x32_bf16 v[180:183], v[88:91], a[100:103], v[180:183]
    ds_read_b128 v[148:151], v11 offset:2304
    v_mfma_f32_16x16x32_bf16 v[184:187], v[88:91], a[104:107], v[184:187]
    ds_read_b128 v[152:155], v12 offset:2304
    v_mfma_f32_16x16x32_bf16 v[188:191], v[88:91], a[108:111], v[188:191]
    ds_read_b128 v[156:159], v13 offset:2304
    v_mfma_f32_16x16x32_bf16 v[176:179], v[92:95], a[112:115], v[176:179]
    v_mfma_f32_16x16x32_bf16 v[180:183], v[92:95], a[116:119], v[180:183]
    v_mfma_f32_16x16x32_bf16 v[184:187], v[92:95], a[120:123], v[184:187]
    v_mfma_f32_16x16x32_bf16 v[188:191], v[92:95], a[124:127], v[188:191]
    s_waitcnt lgkmcnt(0)
    s_cmp_lt_u32 s20, 2
    s_nop 4
    s_cbranch_scc1 P_b40
    v_mfma_f32_16x16x32_bf16 v[192:195], v[96:99], a[0:3], 0
    v_mfma_f32_16x16x32_bf16 v[196:199], v[96:99], a[4:7], 0
    v_mfma_f32_16x16x32_bf16 v[200:203], v[96:99], a[8:11], 0
    v_mfma_f32_16x16x32_bf16 v[204:207], v[96:99], a[12:15], 0
    v_pk_mul_f32 v[160:161], v[160:161], s[48:49]
    v_mfma_f32_16x16x32_bf16 v[192:195], v[100:103], a[16:19], v[192:195]
    v_pk_mul_f32 v[162:163], v[162:163], s[48:49]
    v_mfma_f32_16x16x32_bf16 v[196:199], v[100:103], a[20:23], v[196:199]
    v_pk_mul_f32 v[176:177], v[176:177], s[48:49]
    v_mfma_f32_16x16x32_bf16 v[200:203], v[100:103], a[24:27], v[200:203]
    v_pk_mul_f32 v[178:179], v[178:179], s[48:49]
    v_mfma_f32_16x16x32_bf16 v[204:207], v[100:103], a[28:31], v[204:207]
    v_cvt_pk_bf16_f32 v224, v160, v161
    v_mfma_f32_16x16x32_bf16 v[192:195], v[104:107], a[32:35], v[192:195]
    v_cvt_pk_bf16_f32 v225, v162, v163
    v_mfma_f32_16x16x32_bf16 v[196:199], v[104:107], a[36:39], v[196:199]
    v_cvt_pk_bf16_f32 v226, v176, v177
    v_mfma_f32_16x16x32_bf16 v[200:203], v[104:107], a[40:43], v[200:203]
    v_cvt_pk_bf16_f32 v227, v178, v179
    v_mfma_f32_16x16x32_bf16 v[204:207], v[104:107], a[44:47], v[204:207]
    v_pk_mul_f32 v[164:165], v[164:165], s[48:49]
    v_mfma_f32_16x16x32_bf16 v[192:195], v[108:111], a[48:51], v[192:195]
    s_add_u32 s47, s52, 0
    buffer_store_dwordx4 v[224:227], v3, s[8:11], s47 offen offset:0 sc1
    v_pk_mul_f32 v[166:167], v[166:167], s[48:49]
    v_mfma_f32_16x16x32_bf16 v[196:199], v[108:111], a[52:55], v[196:199]
    v_pk_mul_f32 v[180:181], v[180:181], s[48:49]
    v_mfma_f32_16x16x32_bf16 v[200:203], v[108:111], a[56:59], v[200:203]
    v_pk_mul_f32 v[182:183], v[182:183], s[48:49]
    v_mfma_f32_16x16x32_bf16 v[204:207], v[108:111], a[60:63], v[204:207]
    v_cvt_pk_bf16_f32 v228, v164, v165
    v_mfma_f32_16x16x32_bf16 v[192:195], v[112:115], a[64:67], v[192:195]
    v_cvt_pk_bf16_f32 v229, v166, v167
    v_mfma_f32_16x16x32_bf16 v[196:199], v[112:115], a[68:71], v[196:199]
    v_cvt_pk_bf16_f32 v230, v180, v181
    v_mfma_f32_16x16x32_bf16 v[200:203], v[112:115], a[72:75], v[200:203]
    v_cvt_pk_bf16_f32 v231, v182, v183
    v_mfma_f32_16x16x32_bf16 v[204:207], v[112:115], a[76:79], v[204:207]
    v_pk_mul_f32 v[168:169], v[168:169], s[48:49]
    v_mfma_f32_16x16x32_bf16 v[192:195], v[116:119], a[80:83], v[192:195]
    s_add_u32 s47, s52, 14336
    buffer_store_dwordx4 v[228:231], v3, s[8:11], s47 offen offset:0 sc1
    v_pk_mul_f32 v[170:171], v[170:171], s[48:49]
    v_mfma_f32_16x16x32_bf16 v[196:199], v[116:119], a[84:87], v[196:199]
    v_pk_mul_f32 v[184:185], v[184:185], s[48:49]
    v_mfma_f32_16x16x32_bf16 v[200:203], v[116:119], a[88:91], v[200:203]
    v_pk_mul_f32 v[186:187], v[186:187], s[48:49]
    v_mfma_f32_16x16x32_bf16 v[204:207], v[116:119], a[92:95], v[204:207]
    v_cvt_pk_bf16_f32 v232, v168, v169
    v_mfma_f32_16x16x32_bf16 v[192:195], v[120:123], a[96:99], v[192:195]
    v_cvt_pk_bf16_f32 v233, v170, v171
    v_mfma_f32_16x16x32_bf16 v[196:199], v[120:123], a[100:103], v[196:199]
    v_cvt_pk_bf16_f32 v234, v184, v185
    v_mfma_f32_16x16x32_bf16 v[200:203], v[120:123], a[104:107], v[200:203]
    v_cvt_pk_bf16_f32 v235, v186, v187
    v_mfma_f32_16x16x32_bf16 v[204:207], v[120:123], a[108:111], v[204:207]
    v_pk_mul_f32 v[172:173], v[172:173], s[48:49]
    v_mfma_f32_16x16x32_bf16 v[192:195], v[124:127], a[112:115], v[192:195]
    s_add_u32 s47, s52, 28672
    buffer_store_dwordx4 v[232:235], v3, s[8:11], s47 offen offset:0 sc1
    v_pk_mul_f32 v[174:175], v[174:175], s[48:49]
    v_mfma_f32_16x16x32_bf16 v[196:199], v[124:127], a[116:119], v[196:199]
    v_pk_mul_f32 v[188:189], v[188:189], s[48:49]
    v_mfma_f32_16x16x32_bf16 v[200:203], v[124:127], a[120:123], v[200:203]
    v_pk_mul_f32 v[190:191], v[190:191], s[48:49]
    v_mfma_f32_16x16x32_bf16 v[204:207], v[124:127], a[124:127], v[204:207]
    v_cvt_pk_bf16_f32 v236, v172, v173
    v_mfma_f32_16x16x32_bf16 v[208:211], v[128:131], a[0:3], 0
    v_cvt_pk_bf16_f32 v237, v174, v175
    v_mfma_f32_16x16x32_bf16 v[212:215], v[128:131], a[4:7], 0
    v_cvt_pk_bf16_f32 v238, v188, v189
    v_mfma_f32_16x16x32_bf16 v[216:219], v[128:131], a[8:11], 0
    v_cvt_pk_bf16_f32 v239, v190, v191
    v_mfma_f32_16x16x32_bf16 v[220:223], v[128:131], a[12:15], 0
    v_mfma_f32_16x16x32_bf16 v[208:211], v[132:135], a[16:19], v[208:211]
    s_add_u32 s47, s52, 43008
    buffer_store_dwordx4 v[236:239], v3, s[8:11], s47 offen offset:0 sc1
    v_mfma_f32_16x16x32_bf16 v[212:215], v[132:135], a[20:23], v[212:215]
    v_mfma_f32_16x16x32_bf16 v[216:219], v[132:135], a[24:27], v[216:219]
    v_mfma_f32_16x16x32_bf16 v[220:223], v[132:135], a[28:31], v[220:223]
    v_mfma_f32_16x16x32_bf16 v[208:211], v[136:139], a[32:35], v[208:211]
    v_mfma_f32_16x16x32_bf16 v[212:215], v[136:139], a[36:39], v[212:215]
    v_mfma_f32_16x16x32_bf16 v[216:219], v[136:139], a[40:43], v[216:219]
    v_mfma_f32_16x16x32_bf16 v[220:223], v[136:139], a[44:47], v[220:223]
    v_mfma_f32_16x16x32_bf16 v[208:211], v[140:143], a[48:51], v[208:211]
    s_waitcnt vmcnt(4)
    ds_read_b128 v[32:35], v24 offset:0
    v_mfma_f32_16x16x32_bf16 v[212:215], v[140:143], a[52:55], v[212:215]
    ds_read_b128 v[36:39], v25 offset:0
    v_mfma_f32_16x16x32_bf16 v[216:219], v[140:143], a[56:59], v[216:219]
    ds_read_b128 v[40:43], v26 offset:0
    v_mfma_f32_16x16x32_bf16 v[220:223], v[140:143], a[60:63], v[220:223]
    ds_read_b128 v[44:47], v27 offset:0
    v_mfma_f32_16x16x32_bf16 v[208:211], v[144:147], a[64:67], v[208:211]
    ds_read_b128 v[48:51], v24 offset:256
    v_mfma_f32_16x16x32_bf16 v[212:215], v[144:147], a[68:71], v[212:215]
    ds_read_b128 v[52:55], v25 offset:256
    v_mfma_f32_16x16x32_bf16 v[216:219], v[144:147], a[72:75], v[216:219]
    ds_read_b128 v[56:59], v26 offset:256
    v_mfma_f32_16x16x32_bf16 v[220:223], v[144:147], a[76:79], v[220:223]
    ds_read_b128 v[60:63], v27 offset:256
    v_mfma_f32_16x16x32_bf16 v[208:211], v[148:151], a[80:83], v[208:211]
    ds_read_b128 v[64:67], v24 offset:2048
    v_mfma_f32_16x16x32_bf16 v[212:215], v[148:151], a[84:87], v[212:215]
    ds_read_b128 v[68:71], v25 offset:2048
    v_mfma_f32_16x16x32_bf16 v[216:219], v[148:151], a[88:91], v[216:219]
    ds_read_b128 v[72:75], v26 offset:2048
    v_mfma_f32_16x16x32_bf16 v[220:223], v[148:151], a[92:95], v[220:223]
    ds_read_b128 v[76:79], v27 offset:2048
    v_mfma_f32_16x16x32_bf16 v[208:211], v[152:155], a[96:99], v[208:211]
    ds_read_b128 v[80:83], v24 offset:2304
    v_mfma_f32_16x16x32_bf16 v[212:215], v[152:155], a[100:103], v[212:215]
    ds_read_b128 v[84:87], v25 offset:2304
    v_mfma_f32_16x16x32_bf16 v[216:219], v[152:155], a[104:107], v[216:219]
    ds_read_b128 v[88:91], v26 offset:2304
    v_mfma_f32_16x16x32_bf16 v[220:223], v[152:155], a[108:111], v[220:223]
    ds_read_b128 v[92:95], v27 offset:2304
    v_mfma_f32_16x16x32_bf16 v[208:211], v[156:159], a[112:115], v[208:211]
    v_mfma_f32_16x16x32_bf16 v[212:215], v[156:159], a[116:119], v[212:215]
    v_mfma_f32_16x16x32_bf16 v[216:219], v[156:159], a[120:123], v[216:219]
    v_mfma_f32_16x16x32_bf16 v[220:223], v[156:159], a[124:127], v[220:223]
    s_waitcnt lgkmcnt(0)
    v_mfma_f32_16x16x32_bf16 v[160:163], v[32:35], a[0:3], 0
    v_mfma_f32_16x16x32_bf16 v[164:167], v[32:35], a[4:7], 0
    v_mfma_f32_16x16x32_bf16 v[168:171], v[32:35], a[8:11], 0
    v_mfma_f32_16x16x32_bf16 v[172:175], v[32:35], a[12:15], 0
    v_pk_mul_f32 v[192:193], v[192:193], s[48:49]
    v_mfma_f32_16x16x32_bf16 v[160:163], v[36:39], a[16:19], v[160:163]
    v_pk_mul_f32 v[194:195], v[194:195], s[48:49]
    v_mfma_f32_16x16x32_bf16 v[164:167], v[36:39], a[20:23], v[164:167]
    v_pk_mul_f32 v[208:209], v[208:209], s[48:49]
    v_mfma_f32_16x16x32_bf16 v[168:171], v[36:39], a[24:27], v[168:171]
    v_pk_mul_f32 v[210:211], v[210:211], s[48:49]
    v_mfma_f32_16x16x32_bf16 v[172:175], v[36:39], a[28:31], v[172:175]
    v_cvt_pk_bf16_f32 v224, v192, v193
    v_mfma_f32_16x16x32_bf16 v[160:163], v[40:43], a[32:35], v[160:163]
    v_cvt_pk_bf16_f32 v225, v194, v195
    v_mfma_f32_16x16x32_bf16 v[164:167], v[40:43], a[36:39], v[164:167]
    v_cvt_pk_bf16_f32 v226, v208, v209
    v_mfma_f32_16x16x32_bf16 v[168:171], v[40:43], a[40:43], v[168:171]
    v_cvt_pk_bf16_f32 v227, v210, v211
    v_mfma_f32_16x16x32_bf16 v[172:175], v[40:43], a[44:47], v[172:175]
    v_pk_mul_f32 v[196:197], v[196:197], s[48:49]
    v_mfma_f32_16x16x32_bf16 v[160:163], v[44:47], a[48:51], v[160:163]
    s_add_u32 s47, s52, 0
    buffer_store_dwordx4 v[224:227], v3, s[8:11], s47 offen offset:1024 sc1
    v_pk_mul_f32 v[198:199], v[198:199], s[48:49]
    v_mfma_f32_16x16x32_bf16 v[164:167], v[44:47], a[52:55], v[164:167]
    v_pk_mul_f32 v[212:213], v[212:213], s[48:49]
    v_mfma_f32_16x16x32_bf16 v[168:171], v[44:47], a[56:59], v[168:171]
    v_pk_mul_f32 v[214:215], v[214:215], s[48:49]
    v_mfma_f32_16x16x32_bf16 v[172:175], v[44:47], a[60:63], v[172:175]
    v_cvt_pk_bf16_f32 v228, v196, v197
    v_mfma_f32_16x16x32_bf16 v[160:163], v[48:51], a[64:67], v[160:163]
    v_cvt_pk_bf16_f32 v229, v198, v199
    v_mfma_f32_16x16x32_bf16 v[164:167], v[48:51], a[68:71], v[164:167]
    v_cvt_pk_bf16_f32 v230, v212, v213
    v_mfma_f32_16x16x32_bf16 v[168:171], v[48:51], a[72:75], v[168:171]
    v_cvt_pk_bf16_f32 v231, v214, v215
    v_mfma_f32_16x16x32_bf16 v[172:175], v[48:51], a[76:79], v[172:175]
    v_pk_mul_f32 v[200:201], v[200:201], s[48:49]
    v_mfma_f32_16x16x32_bf16 v[160:163], v[52:55], a[80:83], v[160:163]
    s_add_u32 s47, s52, 14336
    buffer_store_dwordx4 v[228:231], v3, s[8:11], s47 offen offset:1024 sc1
    v_pk_mul_f32 v[202:203], v[202:203], s[48:49]
    v_mfma_f32_16x16x32_bf16 v[164:167], v[52:55], a[84:87], v[164:167]
    v_pk_mul_f32 v[216:217], v[216:217], s[48:49]
    v_mfma_f32_16x16x32_bf16 v[168:171], v[52:55], a[88:91], v[168:171]
    v_pk_mul_f32 v[218:219], v[218:219], s[48:49]
    v_mfma_f32_16x16x32_bf16 v[172:175], v[52:55], a[92:95], v[172:175]
    v_cvt_pk_bf16_f32 v232, v200, v201
    v_mfma_f32_16x16x32_bf16 v[160:163], v[56:59], a[96:99], v[160:163]
    v_cvt_pk_bf16_f32 v233, v202, v203
    v_mfma_f32_16x16x32_bf16 v[164:167], v[56:59], a[100:103], v[164:167]
    v_cvt_pk_bf16_f32 v234, v216, v217
    v_mfma_f32_16x16x32_bf16 v[168:171], v[56:59], a[104:107], v[168:171]
    v_cvt_pk_bf16_f32 v235, v218, v219
    v_mfma_f32_16x16x32_bf16 v[172:175], v[56:59], a[108:111], v[172:175]
    v_pk_mul_f32 v[204:205], v[204:205], s[48:49]
    v_mfma_f32_16x16x32_bf16 v[160:163], v[60:63], a[112:115], v[160:163]
    s_add_u32 s47, s52, 28672
    buffer_store_dwordx4 v[232:235], v3, s[8:11], s47 offen offset:1024 sc1
    v_pk_mul_f32 v[206:207], v[206:207], s[48:49]
    v_mfma_f32_16x16x32_bf16 v[164:167], v[60:63], a[116:119], v[164:167]
    v_pk_mul_f32 v[220:221], v[220:221], s[48:49]
    v_mfma_f32_16x16x32_bf16 v[168:171], v[60:63], a[120:123], v[168:171]
    v_pk_mul_f32 v[222:223], v[222:223], s[48:49]
    v_mfma_f32_16x16x32_bf16 v[172:175], v[60:63], a[124:127], v[172:175]
    v_cvt_pk_bf16_f32 v236, v204, v205
    v_mfma_f32_16x16x32_bf16 v[176:179], v[64:67], a[0:3], 0
    v_cvt_pk_bf16_f32 v237, v206, v207
    v_mfma_f32_16x16x32_bf16 v[180:183], v[64:67], a[4:7], 0
    v_cvt_pk_bf16_f32 v238, v220, v221
    v_mfma_f32_16x16x32_bf16 v[184:187], v[64:67], a[8:11], 0
    v_cvt_pk_bf16_f32 v239, v222, v223
    v_mfma_f32_16x16x32_bf16 v[188:191], v[64:67], a[12:15], 0
    v_mfma_f32_16x16x32_bf16 v[176:179], v[68:71], a[16:19], v[176:179]
    s_add_u32 s47, s52, 43008
    buffer_store_dwordx4 v[236:239], v3, s[8:11], s47 offen offset:1024 sc1
    v_mfma_f32_16x16x32_bf16 v[180:183], v[68:71], a[20:23], v[180:183]
    v_mfma_f32_16x16x32_bf16 v[184:187], v[68:71], a[24:27], v[184:187]
    v_mfma_f32_16x16x32_bf16 v[188:191], v[68:71], a[28:31], v[188:191]
    v_mfma_f32_16x16x32_bf16 v[176:179], v[72:75], a[32:35], v[176:179]
    v_mfma_f32_16x16x32_bf16 v[180:183], v[72:75], a[36:39], v[180:183]
    v_mfma_f32_16x16x32_bf16 v[184:187], v[72:75], a[40:43], v[184:187]
    v_mfma_f32_16x16x32_bf16 v[188:191], v[72:75], a[44:47], v[188:191]
    v_mfma_f32_16x16x32_bf16 v[176:179], v[76:79], a[48:51], v[176:179]
    v_mfma_f32_16x16x32_bf16 v[180:183], v[76:79], a[52:55], v[180:183]
    v_mfma_f32_16x16x32_bf16 v[184:187], v[76:79], a[56:59], v[184:187]
    v_mfma_f32_16x16x32_bf16 v[188:191], v[76:79], a[60:63], v[188:191]
    v_mfma_f32_16x16x32_bf16 v[176:179], v[80:83], a[64:67], v[176:179]
    v_mfma_f32_16x16x32_bf16 v[180:183], v[80:83], a[68:71], v[180:183]
    v_mfma_f32_16x16x32_bf16 v[184:187], v[80:83], a[72:75], v[184:187]
    v_mfma_f32_16x16x32_bf16 v[188:191], v[80:83], a[76:79], v[188:191]
    v_mfma_f32_16x16x32_bf16 v[176:179], v[84:87], a[80:83], v[176:179]
    v_mfma_f32_16x16x32_bf16 v[180:183], v[84:87], a[84:87], v[180:183]
    v_mfma_f32_16x16x32_bf16 v[184:187], v[84:87], a[88:91], v[184:187]
    v_mfma_f32_16x16x32_bf16 v[188:191], v[84:87], a[92:95], v[188:191]
    v_mfma_f32_16x16x32_bf16 v[176:179], v[88:91], a[96:99], v[176:179]
    v_mfma_f32_16x16x32_bf16 v[180:183], v[88:91], a[100:103], v[180:183]
    v_mfma_f32_16x16x32_bf16 v[184:187], v[88:91], a[104:107], v[184:187]
    v_mfma_f32_16x16x32_bf16 v[188:191], v[88:91], a[108:111], v[188:191]
    v_mfma_f32_16x16x32_bf16 v[176:179], v[92:95], a[112:115], v[176:179]
    v_mfma_f32_16x16x32_bf16 v[180:183], v[92:95], a[116:119], v[180:183]
    v_mfma_f32_16x16x32_bf16 v[184:187], v[92:95], a[120:123], v[184:187]
    v_mfma_f32_16x16x32_bf16 v[188:191], v[92:95], a[124:127], v[188:191]
    v_pk_mul_f32 v[160:161], v[160:161], s[48:49]
    v_pk_mul_f32 v[162:163], v[162:163], s[48:49]
    v_pk_mul_f32 v[176:177], v[176:177], s[48:49]
    v_pk_mul_f32 v[178:179], v[178:179], s[48:49]
    v_cvt_pk_bf16_f32 v224, v160, v161
    v_cvt_pk_bf16_f32 v225, v162, v163
    v_cvt_pk_bf16_f32 v226, v176, v177
    v_cvt_pk_bf16_f32 v227, v178, v179
    s_add_u32 s47, s52, 0
    buffer_store_dwordx4 v[224:227], v3, s[8:11], s47 offen offset:2048 sc1
    v_pk_mul_f32 v[164:165], v[164:165], s[48:49]
    v_pk_mul_f32 v[166:167], v[166:167], s[48:49]
    v_pk_mul_f32 v[180:181], v[180:181], s[48:49]
    v_pk_mul_f32 v[182:183], v[182:183], s[48:49]
    v_cvt_pk_bf16_f32 v228, v164, v165
    v_cvt_pk_bf16_f32 v229, v166, v167
    v_cvt_pk_bf16_f32 v230, v180, v181
    v_cvt_pk_bf16_f32 v231, v182, v183
    s_add_u32 s47, s52, 14336
    buffer_store_dwordx4 v[228:231], v3, s[8:11], s47 offen offset:2048 sc1
    v_pk_mul_f32 v[168:169], v[168:169], s[48:49]
    v_pk_mul_f32 v[170:171], v[170:171], s[48:49]
    v_pk_mul_f32 v[184:185], v[184:185], s[48:49]
    v_pk_mul_f32 v[186:187], v[186:187], s[48:49]
    v_cvt_pk_bf16_f32 v232, v168, v169
    v_cvt_pk_bf16_f32 v233, v170, v171
    v_cvt_pk_bf16_f32 v234, v184, v185
    v_cvt_pk_bf16_f32 v235, v186, v187
    s_add_u32 s47, s52, 28672
    buffer_store_dwordx4 v[232:235], v3, s[8:11], s47 offen offset:2048 sc1
    v_pk_mul_f32 v[172:173], v[172:173], s[48:49]
    v_pk_mul_f32 v[174:175], v[174:175], s[48:49]
    v_pk_mul_f32 v[188:189], v[188:189], s[48:49]
    v_pk_mul_f32 v[190:191], v[190:191], s[48:49]
    v_cvt_pk_bf16_f32 v236, v172, v173
    v_cvt_pk_bf16_f32 v237, v174, v175
    v_cvt_pk_bf16_f32 v238, v188, v189
    v_cvt_pk_bf16_f32 v239, v190, v191
    s_add_u32 s47, s52, 43008
    buffer_store_dwordx4 v[236:239], v3, s[8:11], s47 offen offset:2048 sc1
    s_nop 0
    s_branch P_last
P_b40:
    s_nop 1
    v_mfma_f32_16x16x32_bf16 v[192:195], v[96:99], a[0:3], 0
    s_add_u32 m0, s50, 65536
    s_add_u32 s46, s44, 786432
    buffer_load_dwordx4 v16, s[12:15], s46 offen lds
    v_mfma_f32_16x16x32_bf16 v[196:199], v[96:99], a[4:7], 0
    v_mfma_f32_16x16x32_bf16 v[200:203], v[96:99], a[8:11], 0
    v_mfma_f32_16x16x32_bf16 v[204:207], v[96:99], a[12:15], 0
    s_add_u32 m0, s50, 66560
    s_add_u32 s46, s44, 802816
    buffer_load_dwordx4 v17, s[12:15], s46 offen lds
    v_pk_mul_f32 v[160:161], v[160:161], s[48:49]
    v_mfma_f32_16x16x32_bf16 v[192:195], v[100:103], a[16:19], v[192:195]
    v_pk_mul_f32 v[162:163], v[162:163], s[48:49]
    v_mfma_f32_16x16x32_bf16 v[196:199], v[100:103], a[20:23], v[196:199]
    v_pk_mul_f32 v[176:177], v[176:177], s[48:49]
    v_mfma_f32_16x16x32_bf16 v[200:203], v[100:103], a[24:27], v[200:203]
    s_add_u32 m0, s50, 67584
    s_add_u32 s46, s44, 819200
    buffer_load_dwordx4 v16, s[12:15], s46 offen lds
    v_pk_mul_f32 v[178:179], v[178:179], s[48:49]
    v_mfma_f32_16x16x32_bf16 v[204:207], v[100:103], a[28:31], v[204:207]
    v_cvt_pk_bf16_f32 v224, v160, v161
    v_mfma_f32_16x16x32_bf16 v[192:195], v[104:107], a[32:35], v[192:195]
    v_cvt_pk_bf16_f32 v225, v162, v163
    v_mfma_f32_16x16x32_bf16 v[196:199], v[104:107], a[36:39], v[196:199]
    s_add_u32 m0, s50, 68608
    s_add_u32 s46, s44, 835584
    buffer_load_dwordx4 v17, s[12:15], s46 offen lds
    v_cvt_pk_bf16_f32 v226, v176, v177
    v_mfma_f32_16x16x32_bf16 v[200:203], v[104:107], a[40:43], v[200:203]
    v_cvt_pk_bf16_f32 v227, v178, v179
    v_mfma_f32_16x16x32_bf16 v[204:207], v[104:107], a[44:47], v[204:207]
    v_pk_mul_f32 v[164:165], v[164:165], s[48:49]
    v_mfma_f32_16x16x32_bf16 v[192:195], v[108:111], a[48:51], v[192:195]
    s_add_u32 m0, s50, 69632
    s_add_u32 s46, s44, 851968
    buffer_load_dwordx4 v18, s[12:15], s46 offen lds
    v_pk_mul_f32 v[166:167], v[166:167], s[48:49]
    v_mfma_f32_16x16x32_bf16 v[196:199], v[108:111], a[52:55], v[196:199]
    s_add_u32 s47, s52, 0
    buffer_store_dwordx4 v[224:227], v3, s[8:11], s47 offen offset:0 sc1
    v_pk_mul_f32 v[180:181], v[180:181], s[48:49]
    v_mfma_f32_16x16x32_bf16 v[200:203], v[108:111], a[56:59], v[200:203]
    v_pk_mul_f32 v[182:183], v[182:183], s[48:49]
    v_mfma_f32_16x16x32_bf16 v[204:207], v[108:111], a[60:63], v[204:207]
    s_add_u32 m0, s50, 70656
    s_add_u32 s46, s44, 868352
    buffer_load_dwordx4 v19, s[12:15], s46 offen lds
    v_cvt_pk_bf16_f32 v228, v164, v165
    v_mfma_f32_16x16x32_bf16 v[192:195], v[112:115], a[64:67], v[192:195]
    v_cvt_pk_bf16_f32 v229, v166, v167
    v_mfma_f32_16x16x32_bf16 v[196:199], v[112:115], a[68:71], v[196:199]
    v_cvt_pk_bf16_f32 v230, v180, v181
    v_mfma_f32_16x16x32_bf16 v[200:203], v[112:115], a[72:75], v[200:203]
    s_add_u32 m0, s50, 71680
    s_add_u32 s46, s44, 884736
    buffer_load_dwordx4 v18, s[12:15], s46 offen lds
    v_cvt_pk_bf16_f32 v231, v182, v183
    v_mfma_f32_16x16x32_bf16 v[204:207], v[112:115], a[76:79], v[204:207]
    v_pk_mul_f32 v[168:169], v[168:169], s[48:49]
    v_mfma_f32_16x16x32_bf16 v[192:195], v[116:119], a[80:83], v[192:195]
    s_add_u32 s47, s52, 14336
    buffer_store_dwordx4 v[228:231], v3, s[8:11], s47 offen offset:0 sc1
    v_pk_mul_f32 v[170:171], v[170:171], s[48:49]
    v_mfma_f32_16x16x32_bf16 v[196:199], v[116:119], a[84:87], v[196:199]
    s_add_u32 m0, s50, 72704
    s_add_u32 s46, s44, 901120
    buffer_load_dwordx4 v19, s[12:15], s46 offen lds
    v_pk_mul_f32 v[184:185], v[184:185], s[48:49]
    v_mfma_f32_16x16x32_bf16 v[200:203], v[116:119], a[88:91], v[200:203]
    v_pk_mul_f32 v[186:187], v[186:187], s[48:49]
    v_mfma_f32_16x16x32_bf16 v[204:207], v[116:119], a[92:95], v[204:207]
    v_cvt_pk_bf16_f32 v232, v168, v169
    v_mfma_f32_16x16x32_bf16 v[192:195], v[120:123], a[96:99], v[192:195]
    s_add_u32 m0, s50, 73728
    s_add_u32 s46, s44, 917504
    buffer_load_dwordx4 v20, s[12:15], s46 offen lds
    v_cvt_pk_bf16_f32 v233, v170, v171
    v_mfma_f32_16x16x32_bf16 v[196:199], v[120:123], a[100:103], v[196:199]
    v_cvt_pk_bf16_f32 v234, v184, v185
    v_mfma_f32_16x16x32_bf16 v[200:203], v[120:123], a[104:107], v[200:203]
    v_cvt_pk_bf16_f32 v235, v186, v187
    v_mfma_f32_16x16x32_bf16 v[204:207], v[120:123], a[108:111], v[204:207]
    s_add_u32 m0, s50, 74752
    s_add_u32 s46, s44, 933888
    buffer_load_dwordx4 v21, s[12:15], s46 offen lds
    v_pk_mul_f32 v[172:173], v[172:173], s[48:49]
    v_mfma_f32_16x16x32_bf16 v[192:195], v[124:127], a[112:115], v[192:195]
    s_add_u32 s47, s52, 28672
    buffer_store_dwordx4 v[232:235], v3, s[8:11], s47 offen offset:0 sc1
    v_pk_mul_f32 v[174:175], v[174:175], s[48:49]
    v_mfma_f32_16x16x32_bf16 v[196:199], v[124:127], a[116:119], v[196:199]
    v_pk_mul_f32 v[188:189], v[188:189], s[48:49]
    v_mfma_f32_16x16x32_bf16 v[200:203], v[124:127], a[120:123], v[200:203]
    s_add_u32 m0, s50, 75776
    s_add_u32 s46, s44, 950272
    buffer_load_dwordx4 v20, s[12:15], s46 offen lds
    v_pk_mul_f32 v[190:191], v[190:191], s[48:49]
    v_mfma_f32_16x16x32_bf16 v[204:207], v[124:127], a[124:127], v[204:207]
    v_cvt_pk_bf16_f32 v236, v172, v173
    v_mfma_f32_16x16x32_bf16 v[208:211], v[128:131], a[0:3], 0
    v_cvt_pk_bf16_f32 v237, v174, v175
    v_mfma_f32_16x16x32_bf16 v[212:215], v[128:131], a[4:7], 0
    s_add_u32 m0, s50, 76800
    s_add_u32 s46, s44, 966656
    buffer_load_dwordx4 v21, s[12:15], s46 offen lds
    v_cvt_pk_bf16_f32 v238, v188, v189
    v_mfma_f32_16x16x32_bf16 v[216:219], v[128:131], a[8:11], 0
    v_cvt_pk_bf16_f32 v239, v190, v191
    v_mfma_f32_16x16x32_bf16 v[220:223], v[128:131], a[12:15], 0
    v_mfma_f32_16x16x32_bf16 v[208:211], v[132:135], a[16:19], v[208:211]
    s_add_u32 m0, s50, 77824
    s_add_u32 s46, s44, 983040
    buffer_load_dwordx4 v22, s[12:15], s46 offen lds
    v_mfma_f32_16x16x32_bf16 v[212:215], v[132:135], a[20:23], v[212:215]
    s_add_u32 s47, s52, 43008
    buffer_store_dwordx4 v[236:239], v3, s[8:11], s47 offen offset:0 sc1
    v_mfma_f32_16x16x32_bf16 v[216:219], v[132:135], a[24:27], v[216:219]
    v_mfma_f32_16x16x32_bf16 v[220:223], v[132:135], a[28:31], v[220:223]
    s_add_u32 m0, s50, 78848
    s_add_u32 s46, s44, 999424
    buffer_load_dwordx4 v23, s[12:15], s46 offen lds
    v_mfma_f32_16x16x32_bf16 v[208:211], v[136:139], a[32:35], v[208:211]
    v_mfma_f32_16x16x32_bf16 v[212:215], v[136:139], a[36:39], v[212:215]
    v_mfma_f32_16x16x32_bf16 v[216:219], v[136:139], a[40:43], v[216:219]
    s_add_u32 m0, s50, 79872
    s_add_u32 s46, s44, 1015808
    buffer_load_dwordx4 v22, s[12:15], s46 offen lds
    v_mfma_f32_16x16x32_bf16 v[220:223], v[136:139], a[44:47], v[220:223]
    v_mfma_f32_16x16x32_bf16 v[208:211], v[140:143], a[48:51], v[208:211]
    s_waitcnt vmcnt(19)
    ds_read_b128 v[32:35], v24 offset:0
    v_mfma_f32_16x16x32_bf16 v[212:215], v[140:143], a[52:55], v[212:215]
    s_add_u32 m0, s50, 80896
    s_add_u32 s46, s44, 1032192
    buffer_load_dwordx4 v23, s[12:15], s46 offen lds
    ds_read_b128 v[36:39], v25 offset:0
    v_mfma_f32_16x16x32_bf16 v[216:219], v[140:143], a[56:59], v[216:219]
    ds_read_b128 v[40:43], v26 offset:0
    v_mfma_f32_16x16x32_bf16 v[220:223], v[140:143], a[60:63], v[220:223]
    ds_read_b128 v[44:47], v27 offset:0
    v_mfma_f32_16x16x32_bf16 v[208:211], v[144:147], a[64:67], v[208:211]
    ds_read_b128 v[48:51], v24 offset:256
    v_mfma_f32_16x16x32_bf16 v[212:215], v[144:147], a[68:71], v[212:215]
    ds_read_b128 v[52:55], v25 offset:256
    v_mfma_f32_16x16x32_bf16 v[216:219], v[144:147], a[72:75], v[216:219]
    ds_read_b128 v[56:59], v26 offset:256
    v_mfma_f32_16x16x32_bf16 v[220:223], v[144:147], a[76:79], v[220:223]
    ds_read_b128 v[60:63], v27 offset:256
    v_mfma_f32_16x16x32_bf16 v[208:211], v[148:151], a[80:83], v[208:211]
    ds_read_b128 v[64:67], v24 offset:2048
    v_mfma_f32_16x16x32_bf16 v[212:215], v[148:151], a[84:87], v[212:215]
    ds_read_b128 v[68:71], v25 offset:2048
    v_mfma_f32_16x16x32_bf16 v[216:219], v[148:151], a[88:91], v[216:219]
    ds_read_b128 v[72:75], v26 offset:2048
    v_mfma_f32_16x16x32_bf16 v[220:223], v[148:151], a[92:95], v[220:223]
    ds_read_b128 v[76:79], v27 offset:2048
    v_mfma_f32_16x16x32_bf16 v[208:211], v[152:155], a[96:99], v[208:211]
    ds_read_b128 v[80:83], v24 offset:2304
    v_mfma_f32_16x16x32_bf16 v[212:215], v[152:155], a[100:103], v[212:215]
    ds_read_b128 v[84:87], v25 offset:2304
    v_mfma_f32_16x16x32_bf16 v[216:219], v[152:155], a[104:107], v[216:219]
    ds_read_b128 v[88:91], v26 offset:2304
    v_mfma_f32_16x16x32_bf16 v[220:223], v[152:155], a[108:111], v[220:223]
    ds_read_b128 v[92:95], v27 offset:2304
    v_mfma_f32_16x16x32_bf16 v[208:211], v[156:159], a[112:115], v[208:211]
    v_mfma_f32_16x16x32_bf16 v[212:215], v[156:159], a[116:119], v[212:215]
    v_mfma_f32_16x16x32_bf16 v[216:219], v[156:159], a[120:123], v[216:219]
    v_mfma_f32_16x16x32_bf16 v[220:223], v[156:159], a[124:127], v[220:223]
    s_waitcnt lgkmcnt(0)
    v_mfma_f32_16x16x32_bf16 v[160:163], v[32:35], a[0:3], 0
    v_mfma_f32_16x16x32_bf16 v[164:167], v[32:35], a[4:7], 0
    v_mfma_f32_16x16x32_bf16 v[168:171], v[32:35], a[8:11], 0
    v_mfma_f32_16x16x32_bf16 v[172:175], v[32:35], a[12:15], 0
    v_pk_mul_f32 v[192:193], v[192:193], s[48:49]
    v_mfma_f32_16x16x32_bf16 v[160:163], v[36:39], a[16:19], v[160:163]
    v_pk_mul_f32 v[194:195], v[194:195], s[48:49]
    v_mfma_f32_16x16x32_bf16 v[164:167], v[36:39], a[20:23], v[164:167]
    v_pk_mul_f32 v[208:209], v[208:209], s[48:49]
    v_mfma_f32_16x16x32_bf16 v[168:171], v[36:39], a[24:27], v[168:171]
    v_pk_mul_f32 v[210:211], v[210:211], s[48:49]
    v_mfma_f32_16x16x32_bf16 v[172:175], v[36:39], a[28:31], v[172:175]
    v_cvt_pk_bf16_f32 v224, v192, v193
    v_mfma_f32_16x16x32_bf16 v[160:163], v[40:43], a[32:35], v[160:163]
    v_cvt_pk_bf16_f32 v225, v194, v195
    v_mfma_f32_16x16x32_bf16 v[164:167], v[40:43], a[36:39], v[164:167]
    v_cvt_pk_bf16_f32 v226, v208, v209
    v_mfma_f32_16x16x32_bf16 v[168:171], v[40:43], a[40:43], v[168:171]
    v_cvt_pk_bf16_f32 v227, v210, v211
    v_mfma_f32_16x16x32_bf16 v[172:175], v[40:43], a[44:47], v[172:175]
    v_pk_mul_f32 v[196:197], v[196:197], s[48:49]
    v_mfma_f32_16x16x32_bf16 v[160:163], v[44:47], a[48:51], v[160:163]
    s_add_u32 s47, s52, 0
    buffer_store_dwordx4 v[224:227], v3, s[8:11], s47 offen offset:1024 sc1
    v_pk_mul_f32 v[198:199], v[198:199], s[48:49]
    v_mfma_f32_16x16x32_bf16 v[164:167], v[44:47], a[52:55], v[164:167]
    v_pk_mul_f32 v[212:213], v[212:213], s[48:49]
    v_mfma_f32_16x16x32_bf16 v[168:171], v[44:47], a[56:59], v[168:171]
    v_pk_mul_f32 v[214:215], v[214:215], s[48:49]
    v_mfma_f32_16x16x32_bf16 v[172:175], v[44:47], a[60:63], v[172:175]
    v_cvt_pk_bf16_f32 v228, v196, v197
    v_mfma_f32_16x16x32_bf16 v[160:163], v[48:51], a[64:67], v[160:163]
    v_cvt_pk_bf16_f32 v229, v198, v199
    v_mfma_f32_16x16x32_bf16 v[164:167], v[48:51], a[68:71], v[164:167]
    v_cvt_pk_bf16_f32 v230, v212, v213
    v_mfma_f32_16x16x32_bf16 v[168:171], v[48:51], a[72:75], v[168:171]
    v_cvt_pk_bf16_f32 v231, v214, v215
    v_mfma_f32_16x16x32_bf16 v[172:175], v[48:51], a[76:79], v[172:175]
    v_pk_mul_f32 v[200:201], v[200:201], s[48:49]
    v_mfma_f32_16x16x32_bf16 v[160:163], v[52:55], a[80:83], v[160:163]
    s_add_u32 s47, s52, 14336
    buffer_store_dwordx4 v[228:231], v3, s[8:11], s47 offen offset:1024 sc1
    v_pk_mul_f32 v[202:203], v[202:203], s[48:49]
    v_mfma_f32_16x16x32_bf16 v[164:167], v[52:55], a[84:87], v[164:167]
    v_pk_mul_f32 v[216:217], v[216:217], s[48:49]
    v_mfma_f32_16x16x32_bf16 v[168:171], v[52:55], a[88:91], v[168:171]
    v_pk_mul_f32 v[218:219], v[218:219], s[48:49]
    v_mfma_f32_16x16x32_bf16 v[172:175], v[52:55], a[92:95], v[172:175]
    v_cvt_pk_bf16_f32 v232, v200, v201
    v_mfma_f32_16x16x32_bf16 v[160:163], v[56:59], a[96:99], v[160:163]
    v_cvt_pk_bf16_f32 v233, v202, v203
    v_mfma_f32_16x16x32_bf16 v[164:167], v[56:59], a[100:103], v[164:167]
    v_cvt_pk_bf16_f32 v234, v216, v217
    v_mfma_f32_16x16x32_bf16 v[168:171], v[56:59], a[104:107], v[168:171]
    v_cvt_pk_bf16_f32 v235, v218, v219
    v_mfma_f32_16x16x32_bf16 v[172:175], v[56:59], a[108:111], v[172:175]
    v_pk_mul_f32 v[204:205], v[204:205], s[48:49]
    v_mfma_f32_16x16x32_bf16 v[160:163], v[60:63], a[112:115], v[160:163]
    s_add_u32 s47, s52, 28672
    buffer_store_dwordx4 v[232:235], v3, s[8:11], s47 offen offset:1024 sc1
    v_pk_mul_f32 v[206:207], v[206:207], s[48:49]
    v_mfma_f32_16x16x32_bf16 v[164:167], v[60:63], a[116:119], v[164:167]
    v_pk_mul_f32 v[220:221], v[220:221], s[48:49]
    v_mfma_f32_16x16x32_bf16 v[168:171], v[60:63], a[120:123], v[168:171]
    v_pk_mul_f32 v[222:223], v[222:223], s[48:49]
    v_mfma_f32_16x16x32_bf16 v[172:175], v[60:63], a[124:127], v[172:175]
    v_cvt_pk_bf16_f32 v236, v204, v205
    v_mfma_f32_16x16x32_bf16 v[176:179], v[64:67], a[0:3], 0
    v_cvt_pk_bf16_f32 v237, v206, v207
    v_mfma_f32_16x16x32_bf16 v[180:183], v[64:67], a[4:7], 0
    v_cvt_pk_bf16_f32 v238, v220, v221
    v_mfma_f32_16x16x32_bf16 v[184:187], v[64:67], a[8:11], 0
    v_cvt_pk_bf16_f32 v239, v222, v223
    v_mfma_f32_16x16x32_bf16 v[188:191], v[64:67], a[12:15], 0
    v_mfma_f32_16x16x32_bf16 v[176:179], v[68:71], a[16:19], v[176:179]
    s_add_u32 s47, s52, 43008
    buffer_store_dwordx4 v[236:239], v3, s[8:11], s47 offen offset:1024 sc1
    v_mfma_f32_16x16x32_bf16 v[180:183], v[68:71], a[20:23], v[180:183]
    v_mfma_f32_16x16x32_bf16 v[184:187], v[68:71], a[24:27], v[184:187]
    v_mfma_f32_16x16x32_bf16 v[188:191], v[68:71], a[28:31], v[188:191]
    v_mfma_f32_16x16x32_bf16 v[176:179], v[72:75], a[32:35], v[176:179]
    v_mfma_f32_16x16x32_bf16 v[180:183], v[72:75], a[36:39], v[180:183]
    v_mfma_f32_16x16x32_bf16 v[184:187], v[72:75], a[40:43], v[184:187]
    v_mfma_f32_16x16x32_bf16 v[188:191], v[72:75], a[44:47], v[188:191]
    v_mfma_f32_16x16x32_bf16 v[176:179], v[76:79], a[48:51], v[176:179]
    s_waitcnt vmcnt(4)
    ds_read_b128 v[96:99], v10 offset:0
    v_mfma_f32_16x16x32_bf16 v[180:183], v[76:79], a[52:55], v[180:183]
    ds_read_b128 v[100:103], v11 offset:0
    v_mfma_f32_16x16x32_bf16 v[184:187], v[76:79], a[56:59], v[184:187]
    ds_read_b128 v[104:107], v12 offset:0
    v_mfma_f32_16x16x32_bf16 v[188:191], v[76:79], a[60:63], v[188:191]
    ds_read_b128 v[108:111], v13 offset:0
    v_mfma_f32_16x16x32_bf16 v[176:179], v[80:83], a[64:67], v[176:179]
    ds_read_b128 v[112:115], v10 offset:256
    v_mfma_f32_16x16x32_bf16 v[180:183], v[80:83], a[68:71], v[180:183]
    ds_read_b128 v[116:119], v11 offset:256
    v_mfma_f32_16x16x32_bf16 v[184:187], v[80:83], a[72:75], v[184:187]
    ds_read_b128 v[120:123], v12 offset:256
    v_mfma_f32_16x16x32_bf16 v[188:191], v[80:83], a[76:79], v[188:191]
    ds_read_b128 v[124:127], v13 offset:256
    v_mfma_f32_16x16x32_bf16 v[176:179], v[84:87], a[80:83], v[176:179]
    ds_read_b128 v[128:131], v10 offset:2048
    v_mfma_f32_16x16x32_bf16 v[180:183], v[84:87], a[84:87], v[180:183]
    ds_read_b128 v[132:135], v11 offset:2048
    v_mfma_f32_16x16x32_bf16 v[184:187], v[84:87], a[88:91], v[184:187]
    ds_read_b128 v[136:139], v12 offset:2048
    v_mfma_f32_16x16x32_bf16 v[188:191], v[84:87], a[92:95], v[188:191]
    ds_read_b128 v[140:143], v13 offset:2048
    v_mfma_f32_16x16x32_bf16 v[176:179], v[88:91], a[96:99], v[176:179]
    ds_read_b128 v[144:147], v10 offset:2304
    v_mfma_f32_16x16x32_bf16 v[180:183], v[88:91], a[100:103], v[180:183]
    ds_read_b128 v[148:151], v11 offset:2304
    v_mfma_f32_16x16x32_bf16 v[184:187], v[88:91], a[104:107], v[184:187]
    ds_read_b128 v[152:155], v12 offset:2304
    v_mfma_f32_16x16x32_bf16 v[188:191], v[88:91], a[108:111], v[188:191]
    ds_read_b128 v[156:159], v13 offset:2304
    v_mfma_f32_16x16x32_bf16 v[176:179], v[92:95], a[112:115], v[176:179]
    v_mfma_f32_16x16x32_bf16 v[180:183], v[92:95], a[116:119], v[180:183]
    v_mfma_f32_16x16x32_bf16 v[184:187], v[92:95], a[120:123], v[184:187]
    v_mfma_f32_16x16x32_bf16 v[188:191], v[92:95], a[124:127], v[188:191]
    s_waitcnt lgkmcnt(0)
    v_mfma_f32_16x16x32_bf16 v[192:195], v[96:99], a[0:3], 0
    v_mfma_f32_16x16x32_bf16 v[196:199], v[96:99], a[4:7], 0
    v_mfma_f32_16x16x32_bf16 v[200:203], v[96:99], a[8:11], 0
    v_mfma_f32_16x16x32_bf16 v[204:207], v[96:99], a[12:15], 0
    v_pk_mul_f32 v[160:161], v[160:161], s[48:49]
    v_mfma_f32_16x16x32_bf16 v[192:195], v[100:103], a[16:19], v[192:195]
    v_pk_mul_f32 v[162:163], v[162:163], s[48:49]
    v_mfma_f32_16x16x32_bf16 v[196:199], v[100:103], a[20:23], v[196:199]
    v_pk_mul_f32 v[176:177], v[176:177], s[48:49]
    v_mfma_f32_16x16x32_bf16 v[200:203], v[100:103], a[24:27], v[200:203]
    v_pk_mul_f32 v[178:179], v[178:179], s[48:49]
    v_mfma_f32_16x16x32_bf16 v[204:207], v[100:103], a[28:31], v[204:207]
    v_cvt_pk_bf16_f32 v224, v160, v161
    v_mfma_f32_16x16x32_bf16 v[192:195], v[104:107], a[32:35], v[192:195]
    v_cvt_pk_bf16_f32 v225, v162, v163
    v_mfma_f32_16x16x32_bf16 v[196:199], v[104:107], a[36:39], v[196:199]
    v_cvt_pk_bf16_f32 v226, v176, v177
    v_mfma_f32_16x16x32_bf16 v[200:203], v[104:107], a[40:43], v[200:203]
    v_cvt_pk_bf16_f32 v227, v178, v179
    v_mfma_f32_16x16x32_bf16 v[204:207], v[104:107], a[44:47], v[204:207]
    v_pk_mul_f32 v[164:165], v[164:165], s[48:49]
    v_mfma_f32_16x16x32_bf16 v[192:195], v[108:111], a[48:51], v[192:195]
    s_add_u32 s47, s52, 0
    buffer_store_dwordx4 v[224:227], v3, s[8:11], s47 offen offset:2048 sc1
    v_pk_mul_f32 v[166:167], v[166:167], s[48:49]
    v_mfma_f32_16x16x32_bf16 v[196:199], v[108:111], a[52:55], v[196:199]
    v_pk_mul_f32 v[180:181], v[180:181], s[48:49]
    v_mfma_f32_16x16x32_bf16 v[200:203], v[108:111], a[56:59], v[200:203]
    v_pk_mul_f32 v[182:183], v[182:183], s[48:49]
    v_mfma_f32_16x16x32_bf16 v[204:207], v[108:111], a[60:63], v[204:207]
    v_cvt_pk_bf16_f32 v228, v164, v165
    v_mfma_f32_16x16x32_bf16 v[192:195], v[112:115], a[64:67], v[192:195]
    v_cvt_pk_bf16_f32 v229, v166, v167
    v_mfma_f32_16x16x32_bf16 v[196:199], v[112:115], a[68:71], v[196:199]
    v_cvt_pk_bf16_f32 v230, v180, v181
    v_mfma_f32_16x16x32_bf16 v[200:203], v[112:115], a[72:75], v[200:203]
    v_cvt_pk_bf16_f32 v231, v182, v183
    v_mfma_f32_16x16x32_bf16 v[204:207], v[112:115], a[76:79], v[204:207]
    v_pk_mul_f32 v[168:169], v[168:169], s[48:49]
    v_mfma_f32_16x16x32_bf16 v[192:195], v[116:119], a[80:83], v[192:195]
    s_add_u32 s47, s52, 14336
    buffer_store_dwordx4 v[228:231], v3, s[8:11], s47 offen offset:2048 sc1
    v_pk_mul_f32 v[170:171], v[170:171], s[48:49]
    v_mfma_f32_16x16x32_bf16 v[196:199], v[116:119], a[84:87], v[196:199]
    v_pk_mul_f32 v[184:185], v[184:185], s[48:49]
    v_mfma_f32_16x16x32_bf16 v[200:203], v[116:119], a[88:91], v[200:203]
    v_pk_mul_f32 v[186:187], v[186:187], s[48:49]
    v_mfma_f32_16x16x32_bf16 v[204:207], v[116:119], a[92:95], v[204:207]
    v_cvt_pk_bf16_f32 v232, v168, v169
    v_mfma_f32_16x16x32_bf16 v[192:195], v[120:123], a[96:99], v[192:195]
    v_cvt_pk_bf16_f32 v233, v170, v171
    v_mfma_f32_16x16x32_bf16 v[196:199], v[120:123], a[100:103], v[196:199]
    v_cvt_pk_bf16_f32 v234, v184, v185
    v_mfma_f32_16x16x32_bf16 v[200:203], v[120:123], a[104:107], v[200:203]
    v_cvt_pk_bf16_f32 v235, v186, v187
    v_mfma_f32_16x16x32_bf16 v[204:207], v[120:123], a[108:111], v[204:207]
    v_pk_mul_f32 v[172:173], v[172:173], s[48:49]
    v_mfma_f32_16x16x32_bf16 v[192:195], v[124:127], a[112:115], v[192:195]
    s_add_u32 s47, s52, 28672
    buffer_store_dwordx4 v[232:235], v3, s[8:11], s47 offen offset:2048 sc1
    v_pk_mul_f32 v[174:175], v[174:175], s[48:49]
    v_mfma_f32_16x16x32_bf16 v[196:199], v[124:127], a[116:119], v[196:199]
    v_pk_mul_f32 v[188:189], v[188:189], s[48:49]
    v_mfma_f32_16x16x32_bf16 v[200:203], v[124:127], a[120:123], v[200:203]
    v_pk_mul_f32 v[190:191], v[190:191], s[48:49]
    v_mfma_f32_16x16x32_bf16 v[204:207], v[124:127], a[124:127], v[204:207]
    v_cvt_pk_bf16_f32 v236, v172, v173
    v_mfma_f32_16x16x32_bf16 v[208:211], v[128:131], a[0:3], 0
    v_cvt_pk_bf16_f32 v237, v174, v175
    v_mfma_f32_16x16x32_bf16 v[212:215], v[128:131], a[4:7], 0
    v_cvt_pk_bf16_f32 v238, v188, v189
    v_mfma_f32_16x16x32_bf16 v[216:219], v[128:131], a[8:11], 0
    v_cvt_pk_bf16_f32 v239, v190, v191
    v_mfma_f32_16x16x32_bf16 v[220:223], v[128:131], a[12:15], 0
    v_mfma_f32_16x16x32_bf16 v[208:211], v[132:135], a[16:19], v[208:211]
    s_add_u32 s47, s52, 43008
    buffer_store_dwordx4 v[236:239], v3, s[8:11], s47 offen offset:2048 sc1
    v_mfma_f32_16x16x32_bf16 v[212:215], v[132:135], a[20:23], v[212:215]
    v_mfma_f32_16x16x32_bf16 v[216:219], v[132:135], a[24:27], v[216:219]
    v_mfma_f32_16x16x32_bf16 v[220:223], v[132:135], a[28:31], v[220:223]
    v_mfma_f32_16x16x32_bf16 v[208:211], v[136:139], a[32:35], v[208:211]
    v_mfma_f32_16x16x32_bf16 v[212:215], v[136:139], a[36:39], v[212:215]
    v_mfma_f32_16x16x32_bf16 v[216:219], v[136:139], a[40:43], v[216:219]
    v_mfma_f32_16x16x32_bf16 v[220:223], v[136:139], a[44:47], v[220:223]
    v_mfma_f32_16x16x32_bf16 v[208:211], v[140:143], a[48:51], v[208:211]
    v_mfma_f32_16x16x32_bf16 v[212:215], v[140:143], a[52:55], v[212:215]
    v_mfma_f32_16x16x32_bf16 v[216:219], v[140:143], a[56:59], v[216:219]
    v_mfma_f32_16x16x32_bf16 v[220:223], v[140:143], a[60:63], v[220:223]
    v_mfma_f32_16x16x32_bf16 v[208:211], v[144:147], a[64:67], v[208:211]
    v_mfma_f32_16x16x32_bf16 v[212:215], v[144:147], a[68:71], v[212:215]
    v_mfma_f32_16x16x32_bf16 v[216:219], v[144:147], a[72:75], v[216:219]
    v_mfma_f32_16x16x32_bf16 v[220:223], v[144:147], a[76:79], v[220:223]
    v_mfma_f32_16x16x32_bf16 v[208:211], v[148:151], a[80:83], v[208:211]
    v_mfma_f32_16x16x32_bf16 v[212:215], v[148:151], a[84:87], v[212:215]
    v_mfma_f32_16x16x32_bf16 v[216:219], v[148:151], a[88:91], v[216:219]
    v_mfma_f32_16x16x32_bf16 v[220:223], v[148:151], a[92:95], v[220:223]
    v_mfma_f32_16x16x32_bf16 v[208:211], v[152:155], a[96:99], v[208:211]
    v_mfma_f32_16x16x32_bf16 v[212:215], v[152:155], a[100:103], v[212:215]
    v_mfma_f32_16x16x32_bf16 v[216:219], v[152:155], a[104:107], v[216:219]
    v_mfma_f32_16x16x32_bf16 v[220:223], v[152:155], a[108:111], v[220:223]
    v_mfma_f32_16x16x32_bf16 v[208:211], v[156:159], a[112:115], v[208:211]
    v_mfma_f32_16x16x32_bf16 v[212:215], v[156:159], a[116:119], v[212:215]
    v_mfma_f32_16x16x32_bf16 v[216:219], v[156:159], a[120:123], v[216:219]
    v_mfma_f32_16x16x32_bf16 v[220:223], v[156:159], a[124:127], v[220:223]
    v_pk_mul_f32 v[192:193], v[192:193], s[48:49]
    v_pk_mul_f32 v[194:195], v[194:195], s[48:49]
    v_pk_mul_f32 v[208:209], v[208:209], s[48:49]
    v_pk_mul_f32 v[210:211], v[210:211], s[48:49]
    v_cvt_pk_bf16_f32 v224, v192, v193
    v_cvt_pk_bf16_f32 v225, v194, v195
    v_cvt_pk_bf16_f32 v226, v208, v209
    v_cvt_pk_bf16_f32 v227, v210, v211
    s_add_u32 s47, s52, 0
    buffer_store_dwordx4 v[224:227], v3, s[8:11], s47 offen offset:3072 sc1
    v_pk_mul_f32 v[196:197], v[196:197], s[48:49]
    v_pk_mul_f32 v[198:199], v[198:199], s[48:49]
    v_pk_mul_f32 v[212:213], v[212:213], s[48:49]
    v_pk_mul_f32 v[214:215], v[214:215], s[48:49]
    v_cvt_pk_bf16_f32 v228, v196, v197
    v_cvt_pk_bf16_f32 v229, v198, v199
    v_cvt_pk_bf16_f32 v230, v212, v213
    v_cvt_pk_bf16_f32 v231, v214, v215
    s_add_u32 s47, s52, 14336
    buffer_store_dwordx4 v[228:231], v3, s[8:11], s47 offen offset:3072 sc1
    v_pk_mul_f32 v[200:201], v[200:201], s[48:49]
    v_pk_mul_f32 v[202:203], v[202:203], s[48:49]
    v_pk_mul_f32 v[216:217], v[216:217], s[48:49]
    v_pk_mul_f32 v[218:219], v[218:219], s[48:49]
    v_cvt_pk_bf16_f32 v232, v200, v201
    v_cvt_pk_bf16_f32 v233, v202, v203
    v_cvt_pk_bf16_f32 v234, v216, v217
    v_cvt_pk_bf16_f32 v235, v218, v219
    s_add_u32 s47, s52, 28672
    buffer_store_dwordx4 v[232:235], v3, s[8:11], s47 offen offset:3072 sc1
    v_pk_mul_f32 v[204:205], v[204:205], s[48:49]
    v_pk_mul_f32 v[206:207], v[206:207], s[48:49]
    v_pk_mul_f32 v[220:221], v[220:221], s[48:49]
    v_pk_mul_f32 v[222:223], v[222:223], s[48:49]
    v_cvt_pk_bf16_f32 v236, v204, v205
    v_cvt_pk_bf16_f32 v237, v206, v207
    v_cvt_pk_bf16_f32 v238, v220, v221
    v_cvt_pk_bf16_f32 v239, v222, v223
    s_add_u32 s47, s52, 43008
    buffer_store_dwordx4 v[236:239], v3, s[8:11], s47 offen offset:3072 sc1
    s_nop 0
    s_branch P_last
P_last:
    s_branch P_exit
P_ln:
    s_mov_b32 s12, s32
    s_and_b32 s13, s33, 0xffff
    s_mov_b32 s14, 1835008
    s_mov_b32 s15, 0x20000
    s_mov_b32 s16, s34
    s_and_b32 s17, s35, 0xffff
    s_mov_b32 s18, 7168
    s_mov_b32 s19, 0x20000
    s_sub_u32 s22, s22, 28
    s_lshl_b32 s21, s21, 2
    s_add_u32 s21, s21, s22
    s_lshl_b32 s21, s21, 2
    s_add_u32 s21, s21, s20
    v_lshrrev_b32 v4, 2, v1
    v_and_b32 v5, 3, v1
    v_mul_u32_u24 v6, 896, v4
    v_lshl_add_u32 v6, v5, 4, v6
    s_mul_i32 s23, s21, 14336
    buffer_load_dwordx4 v[16:19], v6, s[12:15], s23 offen offset:0
    buffer_load_dwordx4 v[20:23], v6, s[12:15], s23 offen offset:64
    buffer_load_dwordx4 v[24:27], v6, s[12:15], s23 offen offset:128
    buffer_load_dwordx4 v[28:31], v6, s[12:15], s23 offen offset:192
    buffer_load_dwordx4 v[32:35], v6, s[12:15], s23 offen offset:256
    buffer_load_dwordx4 v[36:39], v6, s[12:15], s23 offen offset:320
    buffer_load_dwordx4 v[40:43], v6, s[12:15], s23 offen offset:384
    buffer_load_dwordx4 v[44:47], v6, s[12:15], s23 offen offset:448
    buffer_load_dwordx4 v[48:51], v6, s[12:15], s23 offen offset:512
    buffer_load_dwordx4 v[52:55], v6, s[12:15], s23 offen offset:576
    buffer_load_dwordx4 v[56:59], v6, s[12:15], s23 offen offset:640
    buffer_load_dwordx4 v[60:63], v6, s[12:15], s23 offen offset:704
    buffer_load_dwordx4 v[64:67], v6, s[12:15], s23 offen offset:768
    buffer_load_dwordx4 v[68:71], v6, s[12:15], s23 offen offset:832
    v_lshlrev_b32 v240, 4, v0
    v_mov_b32 v244, -1
    v_mov_b32 v245, -1
    v_mov_b32 v246, -1
    v_mov_b32 v247, -1
    s_mul_i32 s53, s2, 12288
    s_add_u32 s53, s53, 19922944
    s_add_u32 s54, s53, 0
    s_and_b32 s55, s54, 0xffffe000
    s_cmp_eq_u32 s55, 19922944
    s_cbranch_scc1 P_fs_4
    s_cmp_eq_u32 s55, 22151168
    s_cbranch_scc1 P_fs_4
    s_cmp_ge_u32 s54, 23003136
    s_cselect_b32 s55, 0, -1
    v_mov_b32 v244, s55
    v_mov_b32 v245, s55
    v_mov_b32 v246, s55
    v_mov_b32 v247, s55
    buffer_store_dwordx4 v[244:247], v240, s[8:11], s54 offen sc1
    s_nop 1
P_fs_4:
    s_add_u32 s54, s53, 4096
    s_and_b32 s55, s54, 0xffffe000
    s_cmp_eq_u32 s55, 19922944
    s_cbranch_scc1 P_fs_5
    s_cmp_eq_u32 s55, 22151168
    s_cbranch_scc1 P_fs_5
    s_cmp_ge_u32 s54, 23003136
    s_cselect_b32 s55, 0, -1
    v_mov_b32 v244, s55
    v_mov_b32 v245, s55
    v_mov_b32 v246, s55
    v_mov_b32 v247, s55
    buffer_store_dwordx4 v[244:247], v240, s[8:11], s54 offen sc1
    s_nop 1
P_fs_5:
    s_add_u32 s54, s53, 8192
    s_and_b32 s55, s54, 0xffffe000
    s_cmp_eq_u32 s55, 19922944
    s_cbranch_scc1 P_fs_6
    s_cmp_eq_u32 s55, 22151168
    s_cbranch_scc1 P_fs_6
    s_cmp_ge_u32 s54, 23003136
    s_cselect_b32 s55, 0, -1
    v_mov_b32 v244, s55
    v_mov_b32 v245, s55
    v_mov_b32 v246, s55
    v_mov_b32 v247, s55
    buffer_store_dwordx4 v[244:247], v240, s[8:11], s54 offen sc1
    s_nop 1
P_fs_6:
    s_cmp_ge_u32 s21, 28
    s_cbranch_scc1 P_m0_7
    v_bfe_u32 v8, v1, 3, 1
    v_lshlrev_b32 v8, 9, v8
    v_bfe_u32 v9, v1, 2, 1
    v_lshl_add_u32 v8, v9, 6, v8
    v_and_b32 v9, 1, v1
    v_lshl_add_u32 v8, v9, 5, v8
    v_lshrrev_b32 v9, 4, v1
    v_lshl_add_u32 v8, v9, 3, v8
    v_bfe_u32 v9, v1, 1, 1
    v_lshl_add_u32 v8, v9, 2, v8
    v_lshrrev_b32 v9, 4, v1
    v_mul_u32_u24 v9, 1792, v9
    v_and_b32 v7, 15, v1
    v_lshl_add_u32 v9, v7, 1, v9
    s_lshl_b32 s36, s21, 5
    buffer_load_ushort v200, v9, s[16:19], s36 offen
    buffer_load_ushort v201, v9, s[16:19], s36 offen offset:896
    s_lshr_b32 s36, s21, 2
    s_lshl_b32 s36, s36, 10
    s_and_b32 s37, s21, 3
    s_lshl_b32 s37, s37, 7
    s_add_u32 s36, s36, s37
    s_add_u32 s37, s36, 22151168
    s_add_u32 s36, s36, 19922944
    s_waitcnt vmcnt(0)
    v_lshl_or_b32 v200, v201, 16, v200
    buffer_store_dword v200, v8, s[8:11], s36 offen sc1
    buffer_store_dword v200, v8, s[8:11], s37 offen sc1
P_m0_7:
    s_waitcnt vmcnt(0)
    v_lshlrev_b32 v80, 16, v16
    v_and_b32 v81, 0xffff0000, v16
    v_lshlrev_b32 v82, 16, v17
    v_and_b32 v83, 0xffff0000, v17
    v_pk_add_f32 v[10:11], v[80:81], v[82:83]
    v_lshlrev_b32 v84, 16, v18
    v_and_b32 v85, 0xffff0000, v18
    v_pk_add_f32 v[10:11], v[10:11], v[84:85]
    v_lshlrev_b32 v86, 16, v19
    v_and_b32 v87, 0xffff0000, v19
    v_pk_add_f32 v[10:11], v[10:11], v[86:87]
    v_lshlrev_b32 v88, 16, v20
    v_and_b32 v89, 0xffff0000, v20
    v_pk_add_f32 v[10:11], v[10:11], v[88:89]
    v_lshlrev_b32 v90, 16, v21
    v_and_b32 v91, 0xffff0000, v21
    v_pk_add_f32 v[10:11], v[10:11], v[90:91]
    v_lshlrev_b32 v92, 16, v22
    v_and_b32 v93, 0xffff0000, v22
    v_pk_add_f32 v[10:11], v[10:11], v[92:93]
    v_lshlrev_b32 v94, 16, v23
    v_and_b32 v95, 0xffff0000, v23
    v_pk_add_f32 v[10:11], v[10:11], v[94:95]
    v_lshlrev_b32 v96, 16, v24
    v_and_b32 v97, 0xffff0000, v24
    v_pk_add_f32 v[10:11], v[10:11], v[96:97]
    v_lshlrev_b32 v98, 16, v25
    v_and_b32 v99, 0xffff0000, v25
    v_pk_add_f32 v[10:11], v[10:11], v[98:99]
    v_lshlrev_b32 v100, 16, v26
    v_and_b32 v101, 0xffff0000, v26
    v_pk_add_f32 v[10:11], v[10:11], v[100:101]
    v_lshlrev_b32 v102, 16, v27
    v_and_b32 v103, 0xffff0000, v27
    v_pk_add_f32 v[10:11], v[10:11], v[102:103]
    v_lshlrev_b32 v104, 16, v28
    v_and_b32 v105, 0xffff0000, v28
    v_pk_add_f32 v[10:11], v[10:11], v[104:105]
    v_lshlrev_b32 v106, 16, v29
    v_and_b32 v107, 0xffff0000, v29
    v_pk_add_f32 v[10:11], v[10:11], v[106:107]
    v_lshlrev_b32 v108, 16, v30
    v_and_b32 v109, 0xffff0000, v30
    v_pk_add_f32 v[10:11], v[10:11], v[108:109]
    v_lshlrev_b32 v110, 16, v31
    v_and_b32 v111, 0xffff0000, v31
    v_pk_add_f32 v[10:11], v[10:11], v[110:111]
    v_lshlrev_b32 v112, 16, v32
    v_and_b32 v113, 0xffff0000, v32
    v_pk_add_f32 v[10:11], v[10:11], v[112:113]
    v_lshlrev_b32 v114, 16, v33
    v_and_b32 v115, 0xffff0000, v33
    v_pk_add_f32 v[10:11], v[10:11], v[114:115]
    v_lshlrev_b32 v116, 16, v34
    v_and_b32 v117, 0xffff0000, v34
    v_pk_add_f32 v[10:11], v[10:11], v[116:117]
    v_lshlrev_b32 v118, 16, v35
    v_and_b32 v119, 0xffff0000, v35
    v_pk_add_f32 v[10:11], v[10:11], v[118:119]
    v_lshlrev_b32 v120, 16, v36
    v_and_b32 v121, 0xffff0000, v36
    v_pk_add_f32 v[10:11], v[10:11], v[120:121]
    v_lshlrev_b32 v122, 16, v37
    v_and_b32 v123, 0xffff0000, v37
    v_pk_add_f32 v[10:11], v[10:11], v[122:123]
    v_lshlrev_b32 v124, 16, v38
    v_and_b32 v125, 0xffff0000, v38
    v_pk_add_f32 v[10:11], v[10:11], v[124:125]
    v_lshlrev_b32 v126, 16, v39
    v_and_b32 v127, 0xffff0000, v39
    v_pk_add_f32 v[10:11], v[10:11], v[126:127]
    v_lshlrev_b32 v128, 16, v40
    v_and_b32 v129, 0xffff0000, v40
    v_pk_add_f32 v[10:11], v[10:11], v[128:129]
    v_lshlrev_b32 v130, 16, v41
    v_and_b32 v131, 0xffff0000, v41
    v_pk_add_f32 v[10:11], v[10:11], v[130:131]
    v_lshlrev_b32 v132, 16, v42
    v_and_b32 v133, 0xffff0000, v42
    v_pk_add_f32 v[10:11], v[10:11], v[132:133]
    v_lshlrev_b32 v134, 16, v43
    v_and_b32 v135, 0xffff0000, v43
    v_pk_add_f32 v[10:11], v[10:11], v[134:135]
    v_lshlrev_b32 v136, 16, v44
    v_and_b32 v137, 0xffff0000, v44
    v_pk_add_f32 v[10:11], v[10:11], v[136:137]
    v_lshlrev_b32 v138, 16, v45
    v_and_b32 v139, 0xffff0000, v45
    v_pk_add_f32 v[10:11], v[10:11], v[138:139]
    v_lshlrev_b32 v140, 16, v46
    v_and_b32 v141, 0xffff0000, v46
    v_pk_add_f32 v[10:11], v[10:11], v[140:141]
    v_lshlrev_b32 v142, 16, v47
    v_and_b32 v143, 0xffff0000, v47
    v_pk_add_f32 v[10:11], v[10:11], v[142:143]
    v_lshlrev_b32 v144, 16, v48
    v_and_b32 v145, 0xffff0000, v48
    v_pk_add_f32 v[10:11], v[10:11], v[144:145]
    v_lshlrev_b32 v146, 16, v49
    v_and_b32 v147, 0xffff0000, v49
    v_pk_add_f32 v[10:11], v[10:11], v[146:147]
    v_lshlrev_b32 v148, 16, v50
    v_and_b32 v149, 0xffff0000, v50
    v_pk_add_f32 v[10:11], v[10:11], v[148:149]
    v_lshlrev_b32 v150, 16, v51
    v_and_b32 v151, 0xffff0000, v51
    v_pk_add_f32 v[10:11], v[10:11], v[150:151]
    v_lshlrev_b32 v152, 16, v52
    v_and_b32 v153, 0xffff0000, v52
    v_pk_add_f32 v[10:11], v[10:11], v[152:153]
    v_lshlrev_b32 v154, 16, v53
    v_and_b32 v155, 0xffff0000, v53
    v_pk_add_f32 v[10:11], v[10:11], v[154:155]
    v_lshlrev_b32 v156, 16, v54
    v_and_b32 v157, 0xffff0000, v54
    v_pk_add_f32 v[10:11], v[10:11], v[156:157]
    v_lshlrev_b32 v158, 16, v55
    v_and_b32 v159, 0xffff0000, v55
    v_pk_add_f32 v[10:11], v[10:11], v[158:159]
    v_lshlrev_b32 v160, 16, v56
    v_and_b32 v161, 0xffff0000, v56
    v_pk_add_f32 v[10:11], v[10:11], v[160:161]
    v_lshlrev_b32 v162, 16, v57
    v_and_b32 v163, 0xffff0000, v57
    v_pk_add_f32 v[10:11], v[10:11], v[162:163]
    v_lshlrev_b32 v164, 16, v58
    v_and_b32 v165, 0xffff0000, v58
    v_pk_add_f32 v[10:11], v[10:11], v[164:165]
    v_lshlrev_b32 v166, 16, v59
    v_and_b32 v167, 0xffff0000, v59
    v_pk_add_f32 v[10:11], v[10:11], v[166:167]
    v_lshlrev_b32 v168, 16, v60
    v_and_b32 v169, 0xffff0000, v60
    v_pk_add_f32 v[10:11], v[10:11], v[168:169]
    v_lshlrev_b32 v170, 16, v61
    v_and_b32 v171, 0xffff0000, v61
    v_pk_add_f32 v[10:11], v[10:11], v[170:171]
    v_lshlrev_b32 v172, 16, v62
    v_and_b32 v173, 0xffff0000, v62
    v_pk_add_f32 v[10:11], v[10:11], v[172:173]
    v_lshlrev_b32 v174, 16, v63
    v_and_b32 v175, 0xffff0000, v63
    v_pk_add_f32 v[10:11], v[10:11], v[174:175]
    v_lshlrev_b32 v176, 16, v64
    v_and_b32 v177, 0xffff0000, v64
    v_pk_add_f32 v[10:11], v[10:11], v[176:177]
    v_lshlrev_b32 v178, 16, v65
    v_and_b32 v179, 0xffff0000, v65
    v_pk_add_f32 v[10:11], v[10:11], v[178:179]
    v_lshlrev_b32 v180, 16, v66
    v_and_b32 v181, 0xffff0000, v66
    v_pk_add_f32 v[10:11], v[10:11], v[180:181]
    v_lshlrev_b32 v182, 16, v67
    v_and_b32 v183, 0xffff0000, v67
    v_pk_add_f32 v[10:11], v[10:11], v[182:183]
    v_lshlrev_b32 v184, 16, v68
    v_and_b32 v185, 0xffff0000, v68
    v_pk_add_f32 v[10:11], v[10:11], v[184:185]
    v_lshlrev_b32 v186, 16, v69
    v_and_b32 v187, 0xffff0000, v69
    v_pk_add_f32 v[10:11], v[10:11], v[186:187]
    v_lshlrev_b32 v188, 16, v70
    v_and_b32 v189, 0xffff0000, v70
    v_pk_add_f32 v[10:11], v[10:11], v[188:189]
    v_lshlrev_b32 v190, 16, v71
    v_and_b32 v191, 0xffff0000, v71
    v_pk_add_f32 v[10:11], v[10:11], v[190:191]
    v_add_f32 v10, v10, v11
    s_nop 1
    v_add_f32_dpp v10, v10, v10 quad_perm:[1,0,3,2] row_mask:0xf bank_mask:0xf
    s_nop 1
    v_add_f32_dpp v10, v10, v10 quad_perm:[2,3,0,1] row_mask:0xf bank_mask:0xf
    v_mul_f32 v14, 0xbb124925, v10
    v_mul_f32 v15, 0xbb124925, v10
    v_pk_add_f32 v[72:73], v[80:81], v[14:15]
    v_pk_mul_f32 v[10:11], v[72:73], v[72:73]
    v_pk_add_f32 v[12:13], v[82:83], v[14:15]
    v_pk_fma_f32 v[10:11], v[12:13], v[12:13], v[10:11]
    v_pk_add_f32 v[72:73], v[84:85], v[14:15]
    v_pk_fma_f32 v[10:11], v[72:73], v[72:73], v[10:11]
    v_pk_add_f32 v[12:13], v[86:87], v[14:15]
    v_pk_fma_f32 v[10:11], v[12:13], v[12:13], v[10:11]
    v_pk_add_f32 v[72:73], v[88:89], v[14:15]
    v_pk_fma_f32 v[10:11], v[72:73], v[72:73], v[10:11]
    v_pk_add_f32 v[12:13], v[90:91], v[14:15]
    v_pk_fma_f32 v[10:11], v[12:13], v[12:13], v[10:11]
    v_pk_add_f32 v[72:73], v[92:93], v[14:15]
    v_pk_fma_f32 v[10:11], v[72:73], v[72:73], v[10:11]
    v_pk_add_f32 v[12:13], v[94:95], v[14:15]
    v_pk_fma_f32 v[10:11], v[12:13], v[12:13], v[10:11]
    v_pk_add_f32 v[72:73], v[96:97], v[14:15]
    v_pk_fma_f32 v[10:11], v[72:73], v[72:73], v[10:11]
    v_pk_add_f32 v[12:13], v[98:99], v[14:15]
    v_pk_fma_f32 v[10:11], v[12:13], v[12:13], v[10:11]
    v_pk_add_f32 v[72:73], v[100:101], v[14:15]
    v_pk_fma_f32 v[10:11], v[72:73], v[72:73], v[10:11]
    v_pk_add_f32 v[12:13], v[102:103], v[14:15]
    v_pk_fma_f32 v[10:11], v[12:13], v[12:13], v[10:11]
    v_pk_add_f32 v[72:73], v[104:105], v[14:15]
    v_pk_fma_f32 v[10:11], v[72:73], v[72:73], v[10:11]
    v_pk_add_f32 v[12:13], v[106:107], v[14:15]
    v_pk_fma_f32 v[10:11], v[12:13], v[12:13], v[10:11]
    v_pk_add_f32 v[72:73], v[108:109], v[14:15]
    v_pk_fma_f32 v[10:11], v[72:73], v[72:73], v[10:11]
    v_pk_add_f32 v[12:13], v[110:111], v[14:15]
    v_pk_fma_f32 v[10:11], v[12:13], v[12:13], v[10:11]
    v_pk_add_f32 v[72:73], v[112:113], v[14:15]
    v_pk_fma_f32 v[10:11], v[72:73], v[72:73], v[10:11]
    v_pk_add_f32 v[12:13], v[114:115], v[14:15]
    v_pk_fma_f32 v[10:11], v[12:13], v[12:13], v[10:11]
    v_pk_add_f32 v[72:73], v[116:117], v[14:15]
    v_pk_fma_f32 v[10:11], v[72:73], v[72:73], v[10:11]
    v_pk_add_f32 v[12:13], v[118:119], v[14:15]
    v_pk_fma_f32 v[10:11], v[12:13], v[12:13], v[10:11]
    v_pk_add_f32 v[72:73], v[120:121], v[14:15]
    v_pk_fma_f32 v[10:11], v[72:73], v[72:73], v[10:11]
    v_pk_add_f32 v[12:13], v[122:123], v[14:15]
    v_pk_fma_f32 v[10:11], v[12:13], v[12:13], v[10:11]
    v_pk_add_f32 v[72:73], v[124:125], v[14:15]
    v_pk_fma_f32 v[10:11], v[72:73], v[72:73], v[10:11]
    v_pk_add_f32 v[12:13], v[126:127], v[14:15]
    v_pk_fma_f32 v[10:11], v[12:13], v[12:13], v[10:11]
    v_pk_add_f32 v[72:73], v[128:129], v[14:15]
    v_pk_fma_f32 v[10:11], v[72:73], v[72:73], v[10:11]
    v_pk_add_f32 v[12:13], v[130:131], v[14:15]
    v_pk_fma_f32 v[10:11], v[12:13], v[12:13], v[10:11]
    v_pk_add_f32 v[72:73], v[132:133], v[14:15]
    v_pk_fma_f32 v[10:11], v[72:73], v[72:73], v[10:11]
    v_pk_add_f32 v[12:13], v[134:135], v[14:15]
    v_pk_fma_f32 v[10:11], v[12:13], v[12:13], v[10:11]
    v_pk_add_f32 v[72:73], v[136:137], v[14:15]
    v_pk_fma_f32 v[10:11], v[72:73], v[72:73], v[10:11]
    v_pk_add_f32 v[12:13], v[138:139], v[14:15]
    v_pk_fma_f32 v[10:11], v[12:13], v[12:13], v[10:11]
    v_pk_add_f32 v[72:73], v[140:141], v[14:15]
    v_pk_fma_f32 v[10:11], v[72:73], v[72:73], v[10:11]
    v_pk_add_f32 v[12:13], v[142:143], v[14:15]
    v_pk_fma_f32 v[10:11], v[12:13], v[12:13], v[10:11]
    v_pk_add_f32 v[72:73], v[144:145], v[14:15]
    v_pk_fma_f32 v[10:11], v[72:73], v[72:73], v[10:11]
    v_pk_add_f32 v[12:13], v[146:147], v[14:15]
    v_pk_fma_f32 v[10:11], v[12:13], v[12:13], v[10:11]
    v_pk_add_f32 v[72:73], v[148:149], v[14:15]
    v_pk_fma_f32 v[10:11], v[72:73], v[72:73], v[10:11]
    v_pk_add_f32 v[12:13], v[150:151], v[14:15]
    v_pk_fma_f32 v[10:11], v[12:13], v[12:13], v[10:11]
    v_pk_add_f32 v[72:73], v[152:153], v[14:15]
    v_pk_fma_f32 v[10:11], v[72:73], v[72:73], v[10:11]
    v_pk_add_f32 v[12:13], v[154:155], v[14:15]
    v_pk_fma_f32 v[10:11], v[12:13], v[12:13], v[10:11]
    v_pk_add_f32 v[72:73], v[156:157], v[14:15]
    v_pk_fma_f32 v[10:11], v[72:73], v[72:73], v[10:11]
    v_pk_add_f32 v[12:13], v[158:159], v[14:15]
    v_pk_fma_f32 v[10:11], v[12:13], v[12:13], v[10:11]
    v_pk_add_f32 v[72:73], v[160:161], v[14:15]
    v_pk_fma_f32 v[10:11], v[72:73], v[72:73], v[10:11]
    v_pk_add_f32 v[12:13], v[162:163], v[14:15]
    v_pk_fma_f32 v[10:11], v[12:13], v[12:13], v[10:11]
    v_pk_add_f32 v[72:73], v[164:165], v[14:15]
    v_pk_fma_f32 v[10:11], v[72:73], v[72:73], v[10:11]
    v_pk_add_f32 v[12:13], v[166:167], v[14:15]
    v_pk_fma_f32 v[10:11], v[12:13], v[12:13], v[10:11]
    v_pk_add_f32 v[72:73], v[168:169], v[14:15]
    v_pk_fma_f32 v[10:11], v[72:73], v[72:73], v[10:11]
    v_pk_add_f32 v[12:13], v[170:171], v[14:15]
    v_pk_fma_f32 v[10:11], v[12:13], v[12:13], v[10:11]
    v_pk_add_f32 v[72:73], v[172:173], v[14:15]
    v_pk_fma_f32 v[10:11], v[72:73], v[72:73], v[10:11]
    v_pk_add_f32 v[12:13], v[174:175], v[14:15]
    v_pk_fma_f32 v[10:11], v[12:13], v[12:13], v[10:11]
    v_pk_add_f32 v[72:73], v[176:177], v[14:15]
    v_pk_fma_f32 v[10:11], v[72:73], v[72:73], v[10:11]
    v_pk_add_f32 v[12:13], v[178:179], v[14:15]
    v_pk_fma_f32 v[10:11], v[12:13], v[12:13], v[10:11]
    v_pk_add_f32 v[72:73], v[180:181], v[14:15]
    v_pk_fma_f32 v[10:11], v[72:73], v[72:73], v[10:11]
    v_pk_add_f32 v[12:13], v[182:183], v[14:15]
    v_pk_fma_f32 v[10:11], v[12:13], v[12:13], v[10:11]
    v_pk_add_f32 v[72:73], v[184:185], v[14:15]
    v_pk_fma_f32 v[10:11], v[72:73], v[72:73], v[10:11]
    v_pk_add_f32 v[12:13], v[186:187], v[14:15]
    v_pk_fma_f32 v[10:11], v[12:13], v[12:13], v[10:11]
    v_pk_add_f32 v[72:73], v[188:189], v[14:15]
    v_pk_fma_f32 v[10:11], v[72:73], v[72:73], v[10:11]
    v_pk_add_f32 v[12:13], v[190:191], v[14:15]
    v_pk_fma_f32 v[10:11], v[12:13], v[12:13], v[10:11]
    v_add_f32 v10, v10, v11
    s_nop 1
    v_add_f32_dpp v10, v10, v10 quad_perm:[1,0,3,2] row_mask:0xf bank_mask:0xf
    s_nop 1
    v_add_f32_dpp v10, v10, v10 quad_perm:[2,3,0,1] row_mask:0xf bank_mask:0xf
    v_mul_f32 v76, 0x3b124925, v10
    v_cvt_pk_bf16_f32 v76, v76, v76
    v_and_b32 v76, 0xffff0000, v76
    v_add_f32 v76, 0x3727c5ac, v76
    v_cvt_pk_bf16_f32 v76, v76, v76
    v_and_b32 v76, 0xffff0000, v76
    v_sqrt_f32 v76, v76
    s_nop 0
    v_cvt_pk_bf16_f32 v76, v76, v76
    v_and_b32 v76, 0xffff0000, v76
    v_rcp_f32 v76, v76
    v_cvt_pk_bf16_f32 v14, v14, v14
    v_and_b32 v14, 0xffff0000, v14
    v_mov_b32 v15, v14
    v_mov_b32 v77, v76
    v_pk_add_f32 v[80:81], v[80:81], v[14:15]
    v_cvt_pk_bf16_f32 v16, v80, v81
    v_lshlrev_b32 v80, 16, v16
    v_and_b32 v81, 0xffff0000, v16
    v_pk_mul_f32 v[80:81], v[80:81], v[76:77]
    v_cvt_pk_bf16_f32 v16, v80, v81
    v_pk_add_f32 v[82:83], v[82:83], v[14:15]
    v_cvt_pk_bf16_f32 v17, v82, v83
    v_lshlrev_b32 v82, 16, v17
    v_and_b32 v83, 0xffff0000, v17
    v_pk_mul_f32 v[82:83], v[82:83], v[76:77]
    v_cvt_pk_bf16_f32 v17, v82, v83
    v_pk_add_f32 v[84:85], v[84:85], v[14:15]
    v_cvt_pk_bf16_f32 v18, v84, v85
    v_lshlrev_b32 v84, 16, v18
    v_and_b32 v85, 0xffff0000, v18
    v_pk_mul_f32 v[84:85], v[84:85], v[76:77]
    v_cvt_pk_bf16_f32 v18, v84, v85
    v_pk_add_f32 v[86:87], v[86:87], v[14:15]
    v_cvt_pk_bf16_f32 v19, v86, v87
    v_lshlrev_b32 v86, 16, v19
    v_and_b32 v87, 0xffff0000, v19
    v_pk_mul_f32 v[86:87], v[86:87], v[76:77]
    v_cvt_pk_bf16_f32 v19, v86, v87
    v_pk_add_f32 v[88:89], v[88:89], v[14:15]
    v_cvt_pk_bf16_f32 v20, v88, v89
    v_lshlrev_b32 v88, 16, v20
    v_and_b32 v89, 0xffff0000, v20
    v_pk_mul_f32 v[88:89], v[88:89], v[76:77]
    v_cvt_pk_bf16_f32 v20, v88, v89
    v_pk_add_f32 v[90:91], v[90:91], v[14:15]
    v_cvt_pk_bf16_f32 v21, v90, v91
    v_lshlrev_b32 v90, 16, v21
    v_and_b32 v91, 0xffff0000, v21
    v_pk_mul_f32 v[90:91], v[90:91], v[76:77]
    v_cvt_pk_bf16_f32 v21, v90, v91
    v_pk_add_f32 v[92:93], v[92:93], v[14:15]
    v_cvt_pk_bf16_f32 v22, v92, v93
    v_lshlrev_b32 v92, 16, v22
    v_and_b32 v93, 0xffff0000, v22
    v_pk_mul_f32 v[92:93], v[92:93], v[76:77]
    v_cvt_pk_bf16_f32 v22, v92, v93
    v_pk_add_f32 v[94:95], v[94:95], v[14:15]
    v_cvt_pk_bf16_f32 v23, v94, v95
    v_lshlrev_b32 v94, 16, v23
    v_and_b32 v95, 0xffff0000, v23
    v_pk_mul_f32 v[94:95], v[94:95], v[76:77]
    v_cvt_pk_bf16_f32 v23, v94, v95
    v_pk_add_f32 v[96:97], v[96:97], v[14:15]
    v_cvt_pk_bf16_f32 v24, v96, v97
    v_lshlrev_b32 v96, 16, v24
    v_and_b32 v97, 0xffff0000, v24
    v_pk_mul_f32 v[96:97], v[96:97], v[76:77]
    v_cvt_pk_bf16_f32 v24, v96, v97
    v_pk_add_f32 v[98:99], v[98:99], v[14:15]
    v_cvt_pk_bf16_f32 v25, v98, v99
    v_lshlrev_b32 v98, 16, v25
    v_and_b32 v99, 0xffff0000, v25
    v_pk_mul_f32 v[98:99], v[98:99], v[76:77]
    v_cvt_pk_bf16_f32 v25, v98, v99
    v_pk_add_f32 v[100:101], v[100:101], v[14:15]
    v_cvt_pk_bf16_f32 v26, v100, v101
    v_lshlrev_b32 v100, 16, v26
    v_and_b32 v101, 0xffff0000, v26
    v_pk_mul_f32 v[100:101], v[100:101], v[76:77]
    v_cvt_pk_bf16_f32 v26, v100, v101
    v_pk_add_f32 v[102:103], v[102:103], v[14:15]
    v_cvt_pk_bf16_f32 v27, v102, v103
    v_lshlrev_b32 v102, 16, v27
    v_and_b32 v103, 0xffff0000, v27
    v_pk_mul_f32 v[102:103], v[102:103], v[76:77]
    v_cvt_pk_bf16_f32 v27, v102, v103
    v_pk_add_f32 v[104:105], v[104:105], v[14:15]
    v_cvt_pk_bf16_f32 v28, v104, v105
    v_lshlrev_b32 v104, 16, v28
    v_and_b32 v105, 0xffff0000, v28
    v_pk_mul_f32 v[104:105], v[104:105], v[76:77]
    v_cvt_pk_bf16_f32 v28, v104, v105
    v_pk_add_f32 v[106:107], v[106:107], v[14:15]
    v_cvt_pk_bf16_f32 v29, v106, v107
    v_lshlrev_b32 v106, 16, v29
    v_and_b32 v107, 0xffff0000, v29
    v_pk_mul_f32 v[106:107], v[106:107], v[76:77]
    v_cvt_pk_bf16_f32 v29, v106, v107
    v_pk_add_f32 v[108:109], v[108:109], v[14:15]
    v_cvt_pk_bf16_f32 v30, v108, v109
    v_lshlrev_b32 v108, 16, v30
    v_and_b32 v109, 0xffff0000, v30
    v_pk_mul_f32 v[108:109], v[108:109], v[76:77]
    v_cvt_pk_bf16_f32 v30, v108, v109
    v_pk_add_f32 v[110:111], v[110:111], v[14:15]
    v_cvt_pk_bf16_f32 v31, v110, v111
    v_lshlrev_b32 v110, 16, v31
    v_and_b32 v111, 0xffff0000, v31
    v_pk_mul_f32 v[110:111], v[110:111], v[76:77]
    v_cvt_pk_bf16_f32 v31, v110, v111
    v_pk_add_f32 v[112:113], v[112:113], v[14:15]
    v_cvt_pk_bf16_f32 v32, v112, v113
    v_lshlrev_b32 v112, 16, v32
    v_and_b32 v113, 0xffff0000, v32
    v_pk_mul_f32 v[112:113], v[112:113], v[76:77]
    v_cvt_pk_bf16_f32 v32, v112, v113
    v_pk_add_f32 v[114:115], v[114:115], v[14:15]
    v_cvt_pk_bf16_f32 v33, v114, v115
    v_lshlrev_b32 v114, 16, v33
    v_and_b32 v115, 0xffff0000, v33
    v_pk_mul_f32 v[114:115], v[114:115], v[76:77]
    v_cvt_pk_bf16_f32 v33, v114, v115
    v_pk_add_f32 v[116:117], v[116:117], v[14:15]
    v_cvt_pk_bf16_f32 v34, v116, v117
    v_lshlrev_b32 v116, 16, v34
    v_and_b32 v117, 0xffff0000, v34
    v_pk_mul_f32 v[116:117], v[116:117], v[76:77]
    v_cvt_pk_bf16_f32 v34, v116, v117
    v_pk_add_f32 v[118:119], v[118:119], v[14:15]
    v_cvt_pk_bf16_f32 v35, v118, v119
    v_lshlrev_b32 v118, 16, v35
    v_and_b32 v119, 0xffff0000, v35
    v_pk_mul_f32 v[118:119], v[118:119], v[76:77]
    v_cvt_pk_bf16_f32 v35, v118, v119
    v_pk_add_f32 v[120:121], v[120:121], v[14:15]
    v_cvt_pk_bf16_f32 v36, v120, v121
    v_lshlrev_b32 v120, 16, v36
    v_and_b32 v121, 0xffff0000, v36
    v_pk_mul_f32 v[120:121], v[120:121], v[76:77]
    v_cvt_pk_bf16_f32 v36, v120, v121
    v_pk_add_f32 v[122:123], v[122:123], v[14:15]
    v_cvt_pk_bf16_f32 v37, v122, v123
    v_lshlrev_b32 v122, 16, v37
    v_and_b32 v123, 0xffff0000, v37
    v_pk_mul_f32 v[122:123], v[122:123], v[76:77]
    v_cvt_pk_bf16_f32 v37, v122, v123
    v_pk_add_f32 v[124:125], v[124:125], v[14:15]
    v_cvt_pk_bf16_f32 v38, v124, v125
    v_lshlrev_b32 v124, 16, v38
    v_and_b32 v125, 0xffff0000, v38
    v_pk_mul_f32 v[124:125], v[124:125], v[76:77]
    v_cvt_pk_bf16_f32 v38, v124, v125
    v_pk_add_f32 v[126:127], v[126:127], v[14:15]
    v_cvt_pk_bf16_f32 v39, v126, v127
    v_lshlrev_b32 v126, 16, v39
    v_and_b32 v127, 0xffff0000, v39
    v_pk_mul_f32 v[126:127], v[126:127], v[76:77]
    v_cvt_pk_bf16_f32 v39, v126, v127
    v_pk_add_f32 v[128:129], v[128:129], v[14:15]
    v_cvt_pk_bf16_f32 v40, v128, v129
    v_lshlrev_b32 v128, 16, v40
    v_and_b32 v129, 0xffff0000, v40
    v_pk_mul_f32 v[128:129], v[128:129], v[76:77]
    v_cvt_pk_bf16_f32 v40, v128, v129
    v_pk_add_f32 v[130:131], v[130:131], v[14:15]
    v_cvt_pk_bf16_f32 v41, v130, v131
    v_lshlrev_b32 v130, 16, v41
    v_and_b32 v131, 0xffff0000, v41
    v_pk_mul_f32 v[130:131], v[130:131], v[76:77]
    v_cvt_pk_bf16_f32 v41, v130, v131
    v_pk_add_f32 v[132:133], v[132:133], v[14:15]
    v_cvt_pk_bf16_f32 v42, v132, v133
    v_lshlrev_b32 v132, 16, v42
    v_and_b32 v133, 0xffff0000, v42
    v_pk_mul_f32 v[132:133], v[132:133], v[76:77]
    v_cvt_pk_bf16_f32 v42, v132, v133
    v_pk_add_f32 v[134:135], v[134:135], v[14:15]
    v_cvt_pk_bf16_f32 v43, v134, v135
    v_lshlrev_b32 v134, 16, v43
    v_and_b32 v135, 0xffff0000, v43
    v_pk_mul_f32 v[134:135], v[134:135], v[76:77]
    v_cvt_pk_bf16_f32 v43, v134, v135
    v_pk_add_f32 v[136:137], v[136:137], v[14:15]
    v_cvt_pk_bf16_f32 v44, v136, v137
    v_lshlrev_b32 v136, 16, v44
    v_and_b32 v137, 0xffff0000, v44
    v_pk_mul_f32 v[136:137], v[136:137], v[76:77]
    v_cvt_pk_bf16_f32 v44, v136, v137
    v_pk_add_f32 v[138:139], v[138:139], v[14:15]
    v_cvt_pk_bf16_f32 v45, v138, v139
    v_lshlrev_b32 v138, 16, v45
    v_and_b32 v139, 0xffff0000, v45
    v_pk_mul_f32 v[138:139], v[138:139], v[76:77]
    v_cvt_pk_bf16_f32 v45, v138, v139
    v_pk_add_f32 v[140:141], v[140:141], v[14:15]
    v_cvt_pk_bf16_f32 v46, v140, v141
    v_lshlrev_b32 v140, 16, v46
    v_and_b32 v141, 0xffff0000, v46
    v_pk_mul_f32 v[140:141], v[140:141], v[76:77]
    v_cvt_pk_bf16_f32 v46, v140, v141
    v_pk_add_f32 v[142:143], v[142:143], v[14:15]
    v_cvt_pk_bf16_f32 v47, v142, v143
    v_lshlrev_b32 v142, 16, v47
    v_and_b32 v143, 0xffff0000, v47
    v_pk_mul_f32 v[142:143], v[142:143], v[76:77]
    v_cvt_pk_bf16_f32 v47, v142, v143
    v_pk_add_f32 v[144:145], v[144:145], v[14:15]
    v_cvt_pk_bf16_f32 v48, v144, v145
    v_lshlrev_b32 v144, 16, v48
    v_and_b32 v145, 0xffff0000, v48
    v_pk_mul_f32 v[144:145], v[144:145], v[76:77]
    v_cvt_pk_bf16_f32 v48, v144, v145
    v_pk_add_f32 v[146:147], v[146:147], v[14:15]
    v_cvt_pk_bf16_f32 v49, v146, v147
    v_lshlrev_b32 v146, 16, v49
    v_and_b32 v147, 0xffff0000, v49
    v_pk_mul_f32 v[146:147], v[146:147], v[76:77]
    v_cvt_pk_bf16_f32 v49, v146, v147
    v_pk_add_f32 v[148:149], v[148:149], v[14:15]
    v_cvt_pk_bf16_f32 v50, v148, v149
    v_lshlrev_b32 v148, 16, v50
    v_and_b32 v149, 0xffff0000, v50
    v_pk_mul_f32 v[148:149], v[148:149], v[76:77]
    v_cvt_pk_bf16_f32 v50, v148, v149
    v_pk_add_f32 v[150:151], v[150:151], v[14:15]
    v_cvt_pk_bf16_f32 v51, v150, v151
    v_lshlrev_b32 v150, 16, v51
    v_and_b32 v151, 0xffff0000, v51
    v_pk_mul_f32 v[150:151], v[150:151], v[76:77]
    v_cvt_pk_bf16_f32 v51, v150, v151
    v_pk_add_f32 v[152:153], v[152:153], v[14:15]
    v_cvt_pk_bf16_f32 v52, v152, v153
    v_lshlrev_b32 v152, 16, v52
    v_and_b32 v153, 0xffff0000, v52
    v_pk_mul_f32 v[152:153], v[152:153], v[76:77]
    v_cvt_pk_bf16_f32 v52, v152, v153
    v_pk_add_f32 v[154:155], v[154:155], v[14:15]
    v_cvt_pk_bf16_f32 v53, v154, v155
    v_lshlrev_b32 v154, 16, v53
    v_and_b32 v155, 0xffff0000, v53
    v_pk_mul_f32 v[154:155], v[154:155], v[76:77]
    v_cvt_pk_bf16_f32 v53, v154, v155
    v_pk_add_f32 v[156:157], v[156:157], v[14:15]
    v_cvt_pk_bf16_f32 v54, v156, v157
    v_lshlrev_b32 v156, 16, v54
    v_and_b32 v157, 0xffff0000, v54
    v_pk_mul_f32 v[156:157], v[156:157], v[76:77]
    v_cvt_pk_bf16_f32 v54, v156, v157
    v_pk_add_f32 v[158:159], v[158:159], v[14:15]
    v_cvt_pk_bf16_f32 v55, v158, v159
    v_lshlrev_b32 v158, 16, v55
    v_and_b32 v159, 0xffff0000, v55
    v_pk_mul_f32 v[158:159], v[158:159], v[76:77]
    v_cvt_pk_bf16_f32 v55, v158, v159
    v_pk_add_f32 v[160:161], v[160:161], v[14:15]
    v_cvt_pk_bf16_f32 v56, v160, v161
    v_lshlrev_b32 v160, 16, v56
    v_and_b32 v161, 0xffff0000, v56
    v_pk_mul_f32 v[160:161], v[160:161], v[76:77]
    v_cvt_pk_bf16_f32 v56, v160, v161
    v_pk_add_f32 v[162:163], v[162:163], v[14:15]
    v_cvt_pk_bf16_f32 v57, v162, v163
    v_lshlrev_b32 v162, 16, v57
    v_and_b32 v163, 0xffff0000, v57
    v_pk_mul_f32 v[162:163], v[162:163], v[76:77]
    v_cvt_pk_bf16_f32 v57, v162, v163
    v_pk_add_f32 v[164:165], v[164:165], v[14:15]
    v_cvt_pk_bf16_f32 v58, v164, v165
    v_lshlrev_b32 v164, 16, v58
    v_and_b32 v165, 0xffff0000, v58
    v_pk_mul_f32 v[164:165], v[164:165], v[76:77]
    v_cvt_pk_bf16_f32 v58, v164, v165
    v_pk_add_f32 v[166:167], v[166:167], v[14:15]
    v_cvt_pk_bf16_f32 v59, v166, v167
    v_lshlrev_b32 v166, 16, v59
    v_and_b32 v167, 0xffff0000, v59
    v_pk_mul_f32 v[166:167], v[166:167], v[76:77]
    v_cvt_pk_bf16_f32 v59, v166, v167
    v_pk_add_f32 v[168:169], v[168:169], v[14:15]
    v_cvt_pk_bf16_f32 v60, v168, v169
    v_lshlrev_b32 v168, 16, v60
    v_and_b32 v169, 0xffff0000, v60
    v_pk_mul_f32 v[168:169], v[168:169], v[76:77]
    v_cvt_pk_bf16_f32 v60, v168, v169
    v_pk_add_f32 v[170:171], v[170:171], v[14:15]
    v_cvt_pk_bf16_f32 v61, v170, v171
    v_lshlrev_b32 v170, 16, v61
    v_and_b32 v171, 0xffff0000, v61
    v_pk_mul_f32 v[170:171], v[170:171], v[76:77]
    v_cvt_pk_bf16_f32 v61, v170, v171
    v_pk_add_f32 v[172:173], v[172:173], v[14:15]
    v_cvt_pk_bf16_f32 v62, v172, v173
    v_lshlrev_b32 v172, 16, v62
    v_and_b32 v173, 0xffff0000, v62
    v_pk_mul_f32 v[172:173], v[172:173], v[76:77]
    v_cvt_pk_bf16_f32 v62, v172, v173
    v_pk_add_f32 v[174:175], v[174:175], v[14:15]
    v_cvt_pk_bf16_f32 v63, v174, v175
    v_lshlrev_b32 v174, 16, v63
    v_and_b32 v175, 0xffff0000, v63
    v_pk_mul_f32 v[174:175], v[174:175], v[76:77]
    v_cvt_pk_bf16_f32 v63, v174, v175
    v_pk_add_f32 v[176:177], v[176:177], v[14:15]
    v_cvt_pk_bf16_f32 v64, v176, v177
    v_lshlrev_b32 v176, 16, v64
    v_and_b32 v177, 0xffff0000, v64
    v_pk_mul_f32 v[176:177], v[176:177], v[76:77]
    v_cvt_pk_bf16_f32 v64, v176, v177
    v_pk_add_f32 v[178:179], v[178:179], v[14:15]
    v_cvt_pk_bf16_f32 v65, v178, v179
    v_lshlrev_b32 v178, 16, v65
    v_and_b32 v179, 0xffff0000, v65
    v_pk_mul_f32 v[178:179], v[178:179], v[76:77]
    v_cvt_pk_bf16_f32 v65, v178, v179
    v_pk_add_f32 v[180:181], v[180:181], v[14:15]
    v_cvt_pk_bf16_f32 v66, v180, v181
    v_lshlrev_b32 v180, 16, v66
    v_and_b32 v181, 0xffff0000, v66
    v_pk_mul_f32 v[180:181], v[180:181], v[76:77]
    v_cvt_pk_bf16_f32 v66, v180, v181
    v_pk_add_f32 v[182:183], v[182:183], v[14:15]
    v_cvt_pk_bf16_f32 v67, v182, v183
    v_lshlrev_b32 v182, 16, v67
    v_and_b32 v183, 0xffff0000, v67
    v_pk_mul_f32 v[182:183], v[182:183], v[76:77]
    v_cvt_pk_bf16_f32 v67, v182, v183
    v_pk_add_f32 v[184:185], v[184:185], v[14:15]
    v_cvt_pk_bf16_f32 v68, v184, v185
    v_lshlrev_b32 v184, 16, v68
    v_and_b32 v185, 0xffff0000, v68
    v_pk_mul_f32 v[184:185], v[184:185], v[76:77]
    v_cvt_pk_bf16_f32 v68, v184, v185
    v_pk_add_f32 v[186:187], v[186:187], v[14:15]
    v_cvt_pk_bf16_f32 v69, v186, v187
    v_lshlrev_b32 v186, 16, v69
    v_and_b32 v187, 0xffff0000, v69
    v_pk_mul_f32 v[186:187], v[186:187], v[76:77]
    v_cvt_pk_bf16_f32 v69, v186, v187
    v_pk_add_f32 v[188:189], v[188:189], v[14:15]
    v_cvt_pk_bf16_f32 v70, v188, v189
    v_lshlrev_b32 v188, 16, v70
    v_and_b32 v189, 0xffff0000, v70
    v_pk_mul_f32 v[188:189], v[188:189], v[76:77]
    v_cvt_pk_bf16_f32 v70, v188, v189
    v_pk_add_f32 v[190:191], v[190:191], v[14:15]
    v_cvt_pk_bf16_f32 v71, v190, v191
    v_lshlrev_b32 v190, 16, v71
    v_and_b32 v191, 0xffff0000, v71
    v_pk_mul_f32 v[190:191], v[190:191], v[76:77]
    v_cvt_pk_bf16_f32 v71, v190, v191
    s_mul_i32 s36, s20, 16128
    v_mul_u32_u24 v7, 288, v5
    v_lshl_add_u32 v7, v4, 4, v7
    v_add_u32 v7, s36, v7
    v_lshlrev_b32 v3, 4, v1
    v_lshrrev_b32 v6, 4, v1
    v_mul_u32_u24 v6, 288, v6
    v_and_b32 v8, 15, v1
    v_lshl_add_u32 v8, v8, 4, v6
    v_add_u32 v8, s36, v8
    ds_write_b128 v7, v[16:19] offset:0
    ds_write_b128 v7, v[20:23] offset:1152
    ds_write_b128 v7, v[24:27] offset:2304
    ds_write_b128 v7, v[28:31] offset:3456
    ds_write_b128 v7, v[32:35] offset:4608
    ds_write_b128 v7, v[36:39] offset:5760
    ds_write_b128 v7, v[40:43] offset:6912
    ds_write_b128 v7, v[44:47] offset:8064
    ds_write_b128 v7, v[48:51] offset:9216
    ds_write_b128 v7, v[52:55] offset:10368
    ds_write_b128 v7, v[56:59] offset:11520
    ds_write_b128 v7, v[60:63] offset:12672
    ds_write_b128 v7, v[64:67] offset:13824
    ds_write_b128 v7, v[68:71] offset:14976
    s_mul_i32 s36, s21, 14336
    s_add_u32 s36, s36, 0
    ds_read_b128 v[80:83], v8 offset:0
    ds_read_b128 v[84:87], v8 offset:1152
    ds_read_b128 v[88:91], v8 offset:2304
    ds_read_b128 v[92:95], v8 offset:3456
    ds_read_b128 v[96:99], v8 offset:4608
    ds_read_b128 v[100:103], v8 offset:5760
    ds_read_b128 v[104:107], v8 offset:6912
    ds_read_b128 v[108:111], v8 offset:8064
    ds_read_b128 v[112:115], v8 offset:9216
    ds_read_b128 v[116:119], v8 offset:10368
    ds_read_b128 v[120:123], v8 offset:11520
    ds_read_b128 v[124:127], v8 offset:12672
    ds_read_b128 v[128:131], v8 offset:13824
    ds_read_b128 v[132:135], v8 offset:14976
    s_waitcnt lgkmcnt(13)
    buffer_store_dwordx4 v[80:83], v3, s[8:11], s36 offen offset:0 sc1
    s_waitcnt lgkmcnt(12)
    buffer_store_dwordx4 v[84:87], v3, s[8:11], s36 offen offset:1024 sc1
    s_waitcnt lgkmcnt(11)
    buffer_store_dwordx4 v[88:91], v3, s[8:11], s36 offen offset:2048 sc1
    s_waitcnt lgkmcnt(10)
    buffer_store_dwordx4 v[92:95], v3, s[8:11], s36 offen offset:3072 sc1
    s_add_u32 s36, s36, 4096
    s_waitcnt lgkmcnt(9)
    buffer_store_dwordx4 v[96:99], v3, s[8:11], s36 offen offset:0 sc1
    s_waitcnt lgkmcnt(8)
    buffer_store_dwordx4 v[100:103], v3, s[8:11], s36 offen offset:1024 sc1
    s_waitcnt lgkmcnt(7)
    buffer_store_dwordx4 v[104:107], v3, s[8:11], s36 offen offset:2048 sc1
    s_waitcnt lgkmcnt(6)
    buffer_store_dwordx4 v[108:111], v3, s[8:11], s36 offen offset:3072 sc1
    s_add_u32 s36, s36, 4096
    s_waitcnt lgkmcnt(5)
    buffer_store_dwordx4 v[112:115], v3, s[8:11], s36 offen offset:0 sc1
    s_waitcnt lgkmcnt(4)
    buffer_store_dwordx4 v[116:119], v3, s[8:11], s36 offen offset:1024 sc1
    s_waitcnt lgkmcnt(3)
    buffer_store_dwordx4 v[120:123], v3, s[8:11], s36 offen offset:2048 sc1
    s_waitcnt lgkmcnt(2)
    buffer_store_dwordx4 v[124:127], v3, s[8:11], s36 offen offset:3072 sc1
    s_add_u32 s36, s36, 4096
    s_waitcnt lgkmcnt(1)
    buffer_store_dwordx4 v[128:131], v3, s[8:11], s36 offen offset:0 sc1
    s_waitcnt lgkmcnt(0)
    buffer_store_dwordx4 v[132:135], v3, s[8:11], s36 offen offset:1024 sc1
    s_nop 1
P_exit:
    s_endpgm
.globl main_kernel
.p2align 8
.type main_kernel,@function
main_kernel:
    s_getpc_b64 s[40:41]
M_pc:
    v_lshlrev_b32 v12, 7, v0
    global_load_dword v255, v12, s[40:41]
    v_add_u32 v12, 32768, v12
    v_min_u32 v11, L_end-M_pc, v12
    global_load_dword v255, v11, s[40:41]
    s_cmp_ge_u32 s2, 256
    s_cbranch_scc1 L_end
    s_load_dwordx2 s[4:5], s[0:1], 96
    s_load_dwordx2 s[6:7], s[0:1], 88
    s_getreg_b32 s18, hwreg(HW_REG_XCC_ID, 0, 4)
    v_lshrrev_b32 v2, 6, v0
    v_and_b32 v1, 63, v0
    v_readfirstlane_b32 s17, v2
    s_and_b32 s18, s18, 7
    s_waitcnt lgkmcnt(0)
    s_mov_b32 s8, s4
    s_and_b32 s9, s5, 0xffff
    s_mov_b32 s10, 268435456
    s_mov_b32 s11, 0x20000
    s_mov_b32 s12, s6
    s_and_b32 s13, s7, 0xffff
    s_mov_b32 s14, 256
    s_mov_b32 s15, 0x20000
    v_mov_b32 v4, 163824
    s_cmp_lg_u32 s17, 0
    s_cbranch_scc1 L_role_wait
    s_mov_b64 exec, 1
    s_mov_b32 s26, 0
L_role_try:
    s_mov_b32 s27, s18
    s_add_u32 s27, s27, s26
    s_and_b32 s27, s27, 7
    s_lshl_b32 s16, s27, 7
    s_add_u32 s16, s16, 23060480
    v_mov_b32 v2, s16
    v_mov_b32 v3, 1
    buffer_atomic_add v3, v2, s[8:11], 0 offen sc0
    s_waitcnt vmcnt(0)
    v_readfirstlane_b32 s16, v3
    s_nop 0
    s_cmp_lt_u32 s16, 32
    s_nop 1
    s_cbranch_scc1 L_role_got
    s_add_u32 s26, s26, 1
    s_cmp_lt_u32 s26, 8
    s_cbranch_scc1 L_role_try
    s_mov_b32 s16, 31
    s_mov_b32 s27, 0
L_role_got:
    s_lshl_b32 s27, s27, 5
    s_add_u32 s16, s16, s27
    v_mov_b32 v2, s16
    ds_write_b32 v4, v2
    s_mov_b64 exec, -1
    s_waitcnt lgkmcnt(0)
L_role_wait:
    s_barrier
    ds_read_b32 v2, v4
    s_waitcnt lgkmcnt(0)
    v_readfirstlane_b32 s16, v2
    s_nop 0
    s_cmp_ge_u32 s16, 32
    s_nop 1
    s_cbranch_scc1 M_worker
    s_cmp_lt_u32 s16, 30
    s_cbranch_scc1 L_nothelp
    v_mov_b32 v112, v1
    s_cmp_lg_u32 s17, 0
    s_cbranch_scc1 L_reg_9
    s_cmp_eq_u32 s18, 0
    s_cselect_b32 s26, 1, 0x10001
    s_mov_b64 exec, 1
    v_mov_b32 v2, 64
    v_mov_b32 v3, s26
    buffer_atomic_add v3, v2, s[12:15], 0 offen
    s_mov_b64 exec, -1
L_reg_9:
    v_lshlrev_b32 v0, 3, v112
    s_mul_i32 s26, s17, 1792
    v_lshlrev_b32 v1, 4, v112
    v_add_u32 v1, s26, v1
    v_and_b32 v113, 2, v112
    v_cmp_ne_u32 vcc, 0, v113
    v_mov_b32 v113, 0x4444
    v_mov_b32 v114, 0xeeee
    v_cndmask_b32 v2, v113, v114, vcc
    v_lshlrev_b32 v4, 7, v112
    v_mov_b32 v3, v4
    v_mov_b32 v5, 0
    v_mov_b32 v6, 14
    s_sub_u32 s16, s16, 30
    s_lshl_b32 s23, s16, 2
    s_add_u32 s23, s23, s17
    s_mov_b32 s19, 0
    s_mov_b32 s21, 19931136
    s_mov_b32 s37, 136314880
    s_mul_i32 s24, s23, 7168
    s_add_u32 s24, s24, 0
    s_mov_b32 s22, 28672
    s_cmp_lt_u32 s23, 4
    s_cbranch_scc1 H_t
    s_sub_u32 s24, s23, 4
    s_mul_i32 s24, s24, 6144
    s_add_u32 s24, s24, 20971520
    s_mov_b32 s22, 16384
    s_cmp_lt_u32 s23, 6
    s_cbranch_scc1 H_t
    s_mov_b32 s24, 19931136
    s_mov_b32 s22, 8192
    s_cmp_lt_u32 s23, 8
    s_cbranch_scc1 H_t
    s_mov_b32 s24, 67108864
    s_mov_b32 s22, 458752
    v_mul_u32_u24 v3, 7168, v112
H_t:
    s_mov_b32 s28, 0
L_mode_10:
    v_mov_b32 v12, 64
    buffer_load_dword v13, v12, s[12:15], 0 offen sc1
    s_waitcnt vmcnt(0)
L_modep_12:
    s_nop 0
    v_readfirstlane_b32 s26, v13
    s_nop 0
    s_and_b32 s27, s26, 0xffff
    s_cmp_ge_u32 s27, 32
    s_nop 0
    s_cbranch_scc1 L_moded_11
    s_sleep 2
    s_add_u32 s28, s28, 1
    s_cmp_lt_u32 s28, 20000
    s_cbranch_scc1 L_mode_10
    s_mov_b32 s26, 0x10000
L_moded_11:
    s_lshr_b32 s26, s26, 16
    s_cmp_eq_u32 s26, 0
    s_cselect_b32 s20, 1, 0
    s_mov_b32 s29, 20000
    s_mov_b32 s29, 80000
    s_getpc_b64 s[70:71]
H_pc:
    s_lshl_b32 s26, s23, 12
    v_lshrrev_b32 v10, 1, v4
    s_add_u32 s70, s70, s26
    s_addc_u32 s71, s71, 0
    s_add_u32 s70, s70, L_nothelp-H_pc
    s_addc_u32 s71, s71, 0
    s_mov_b32 s72, s24
    s_mov_b32 s28, 0
    s_mov_b32 s73, 20971520
H_warm:
    s_mov_b32 s24, s72
    global_load_dword v8, v10, s[70:71] sc1
    buffer_load_dword v7, v3, s[8:11], s24 offen sc1
    s_add_u32 s24, s24, s22
    buffer_load_dword v7, v3, s[8:11], s24 offen sc1
    s_add_u32 s24, s24, s22
    buffer_load_dword v7, v3, s[8:11], s24 offen sc1
    s_add_u32 s24, s24, s22
    buffer_load_dword v7, v3, s[8:11], s24 offen sc1
    s_add_u32 s24, s24, s22
    buffer_load_dword v9, v5, s[8:11], s73 offen sc1
    s_add_u32 s28, s28, 1
    s_waitcnt vmcnt(0)
    v_cmp_eq_u32 vcc, -1, v9
    s_cbranch_vccz H_warmed
    s_sleep 8
    s_cmp_lt_u32 s28, s29
    s_cbranch_scc1 H_warm
H_warmed:
    s_mov_b32 s38, 23003136
H_top:
    s_mov_b32 s28, 0
H_poll:
    buffer_load_dwordx4 v[12:15], v1, s[8:11], s21 offen sc1
    buffer_load_dwordx4 v[16:19], v1, s[8:11], s21 offen offset:768 sc1
    buffer_load_dword v30, v5, s[8:11], s38 offen sc1
    s_add_u32 s28, s28, 1
    s_waitcnt vmcnt(0)
    v_max3_u32 v20, v12, v13, v14
    v_max3_u32 v20, v20, v15, v16
    v_max3_u32 v20, v20, v17, v18
    v_max_u32 v20, v20, v19
    v_readfirstlane_b32 s26, v30
    v_cmp_eq_u32 vcc, -1, v20
    s_nop 2
    s_cbranch_vccz H_ok_15
    s_sleep 2
    s_cmp_lt_u32 s28, s29
    s_cbranch_scc1 H_poll
    s_mov_b32 s29, 1
H_ok_15:
    s_cmp_lg_u32 s16, 0
    s_cbranch_scc1 H_sk_13
    s_add_u32 s27, s21, 2228224
    buffer_store_dwordx4 v[12:15], v1, s[8:11], s27 offen sc1
    buffer_store_dwordx4 v[16:19], v1, s[8:11], s27 offen offset:768 sc1
    s_nop 1
H_sk_13:
    s_cmp_ge_u32 s19, 60
    s_cbranch_scc1 H_sk_14
    buffer_load_dword v7, v3, s[8:11], s24 offen sc1
    s_add_u32 s24, s24, s22
H_sk_14:
    s_add_u32 s19, s19, 1
    s_add_u32 s21, s21, 8192
    s_cmp_lt_u32 s19, 62
    s_cbranch_scc1 H_top
    s_branch L_exit
L_nothelp:
    s_cmp_ge_u32 s16, 16
    s_cbranch_scc1 L_comb
    v_mov_b32 v44, v1
    s_cmp_lg_u32 s17, 0
    s_cbranch_scc1 L_reg_16
    s_cmp_eq_u32 s18, 0
    s_cselect_b32 s26, 1, 0x10001
    s_mov_b64 exec, 1
    v_mov_b32 v2, 64
    v_mov_b32 v3, s26
    buffer_atomic_add v3, v2, s[12:15], 0 offen
    s_mov_b64 exec, -1
L_reg_16:
    v_lshlrev_b32 v0, 3, v44
    s_mul_i32 s26, s17, 1792
    v_lshlrev_b32 v1, 4, v44
    v_add_u32 v1, s26, v1
    v_and_b32 v45, 2, v44
    v_cmp_ne_u32 vcc, 0, v45
    v_mov_b32 v45, 0x4444
    v_mov_b32 v46, 0xeeee
    v_cndmask_b32 v2, v45, v46, vcc
    v_bfe_u32 v3, v44, 3, 1
    v_lshlrev_b32 v3, 9, v3
    v_bfe_u32 v45, v44, 2, 1
    v_lshl_add_u32 v3, v45, 6, v3
    v_and_b32 v45, 1, v44
    v_lshl_add_u32 v3, v45, 5, v3
    v_lshrrev_b32 v45, 4, v44
    v_lshl_add_u32 v3, v45, 3, v3
    v_bfe_u32 v45, v44, 1, 1
    v_lshl_add_u32 v3, v45, 2, v3
    v_lshlrev_b32 v4, 4, v44
    v_lshrrev_b32 v45, 4, v44
    v_bfe_u32 v46, v44, 2, 2
    v_bfe_u32 v47, v44, 1, 1
    v_and_b32 v48, 1, v44
    v_and_b32 v49, 15, v44
    v_lshlrev_b32 v5, 4, v49
    v_lshrrev_b32 v49, 1, v45
    v_lshl_add_u32 v5, v49, 8, v5
    v_and_b32 v49, 1, v45
    v_lshl_add_u32 v5, v49, 3, v5
    s_and_b32 s26, s16, 1
    s_lshl_b32 s26, s26, 4
    s_lshr_b32 s27, s16, 2
    s_lshl_b32 s27, s27, 9
    s_add_u32 s26, s26, s27
    s_and_b32 s27, s16, 2
    s_lshl_b32 s27, s27, 1
    s_add_u32 s26, s26, s27
    s_add_u32 s26, s26, 8192
    v_and_b32 v6, 0xffffffef, v0
    v_add_u32 v6, s26, v6
    s_lshl_b32 s26, s16, 9
    v_add_u32 v5, s26, v5
    v_lshlrev_b32 v49, 4, v48
    v_mov_b32 v9, 0xffff
    v_lshlrev_b32 v9, v49, v9
    v_cmp_eq_u32 vcc, v46, v45
    v_mov_b32 v49, 0
    s_nop 0
    v_cndmask_b32 v9, v49, v9, vcc
    v_cmp_eq_u32 vcc, 0, v47
    v_mov_b32 v50, 0xff800000
    s_nop 0
    v_cndmask_b32 v7, v49, v9, vcc
    v_cndmask_b32 v8, v9, v49, vcc
    v_cndmask_b32 v10, v50, v49, vcc
    s_mul_i32 s27, s16, 401408
    s_add_u32 s27, s27, 2097152
    s_cmp_lg_u32 s17, 0
    s_cbranch_scc1 L_swn_18
    s_add_u32 s26, s27, 0
    buffer_load_dwordx4 a[0:3], v4, s[8:11], s26 offen offset:0
    buffer_load_dwordx4 a[4:7], v4, s[8:11], s26 offen offset:1024
    buffer_load_dwordx4 a[8:11], v4, s[8:11], s26 offen offset:2048
    buffer_load_dwordx4 a[12:15], v4, s[8:11], s26 offen offset:3072
    s_add_u32 s26, s27, 4096
    buffer_load_dwordx4 a[16:19], v4, s[8:11], s26 offen offset:0
    buffer_load_dwordx4 a[20:23], v4, s[8:11], s26 offen offset:1024
    buffer_load_dwordx4 a[24:27], v4, s[8:11], s26 offen offset:2048
    buffer_load_dwordx4 a[28:31], v4, s[8:11], s26 offen offset:3072
    s_waitcnt vmcnt(7)
    s_add_u32 s26, s27, 8192
    buffer_load_dwordx4 a[32:35], v4, s[8:11], s26 offen offset:0
    s_waitcnt vmcnt(7)
    buffer_load_dwordx4 a[36:39], v4, s[8:11], s26 offen offset:1024
    s_waitcnt vmcnt(7)
    buffer_load_dwordx4 a[40:43], v4, s[8:11], s26 offen offset:2048
    s_waitcnt vmcnt(7)
    buffer_load_dwordx4 a[44:47], v4, s[8:11], s26 offen offset:3072
    s_waitcnt vmcnt(7)
    s_add_u32 s26, s27, 12288
    buffer_load_dwordx4 a[48:51], v4, s[8:11], s26 offen offset:0
    s_waitcnt vmcnt(7)
    buffer_load_dwordx4 a[52:55], v4, s[8:11], s26 offen offset:1024
    s_waitcnt vmcnt(7)
    s_add_u32 s26, s27, 57344
    buffer_load_dwordx4 a[56:59], v4, s[8:11], s26 offen offset:0
    s_waitcnt vmcnt(7)
    buffer_load_dwordx4 a[60:63], v4, s[8:11], s26 offen offset:1024
    s_waitcnt vmcnt(7)
    buffer_load_dwordx4 a[64:67], v4, s[8:11], s26 offen offset:2048
    s_waitcnt vmcnt(7)
    buffer_load_dwordx4 a[68:71], v4, s[8:11], s26 offen offset:3072
    s_waitcnt vmcnt(7)
    s_add_u32 s26, s27, 61440
    buffer_load_dwordx4 a[72:75], v4, s[8:11], s26 offen offset:0
    s_waitcnt vmcnt(7)
    buffer_load_dwordx4 a[76:79], v4, s[8:11], s26 offen offset:1024
    s_waitcnt vmcnt(7)
    buffer_load_dwordx4 a[80:83], v4, s[8:11], s26 offen offset:2048
    s_waitcnt vmcnt(7)
    buffer_load_dwordx4 a[84:87], v4, s[8:11], s26 offen offset:3072
    s_waitcnt vmcnt(7)
    s_add_u32 s26, s27, 65536
    buffer_load_dwordx4 a[88:91], v4, s[8:11], s26 offen offset:0
    s_waitcnt vmcnt(7)
    buffer_load_dwordx4 a[92:95], v4, s[8:11], s26 offen offset:1024
    s_waitcnt vmcnt(7)
    buffer_load_dwordx4 a[96:99], v4, s[8:11], s26 offen offset:2048
    s_waitcnt vmcnt(7)
    buffer_load_dwordx4 a[100:103], v4, s[8:11], s26 offen offset:3072
    s_waitcnt vmcnt(7)
    s_add_u32 s26, s27, 69632
    buffer_load_dwordx4 a[104:107], v4, s[8:11], s26 offen offset:0
    s_waitcnt vmcnt(7)
    buffer_load_dwordx4 a[108:111], v4, s[8:11], s26 offen offset:1024
    s_waitcnt vmcnt(7)
    s_add_u32 s26, s27, 114688
    buffer_load_dwordx4 a[112:115], v4, s[8:11], s26 offen offset:0
    s_waitcnt vmcnt(7)
    buffer_load_dwordx4 a[116:119], v4, s[8:11], s26 offen offset:1024
    s_waitcnt vmcnt(7)
    buffer_load_dwordx4 a[120:123], v4, s[8:11], s26 offen offset:2048
    s_waitcnt vmcnt(7)
    buffer_load_dwordx4 a[124:127], v4, s[8:11], s26 offen offset:3072
    s_waitcnt vmcnt(7)
    s_add_u32 s26, s27, 118784
    buffer_load_dwordx4 a[128:131], v4, s[8:11], s26 offen offset:0
    s_waitcnt vmcnt(7)
    buffer_load_dwordx4 a[132:135], v4, s[8:11], s26 offen offset:1024
    s_waitcnt vmcnt(7)
    buffer_load_dwordx4 a[136:139], v4, s[8:11], s26 offen offset:2048
    s_waitcnt vmcnt(7)
    buffer_load_dwordx4 a[140:143], v4, s[8:11], s26 offen offset:3072
    s_waitcnt vmcnt(7)
    s_add_u32 s26, s27, 122880
    buffer_load_dwordx4 a[144:147], v4, s[8:11], s26 offen offset:0
    s_waitcnt vmcnt(7)
    buffer_load_dwordx4 a[148:151], v4, s[8:11], s26 offen offset:1024
    s_waitcnt vmcnt(7)
    buffer_load_dwordx4 a[152:155], v4, s[8:11], s26 offen offset:2048
    s_waitcnt vmcnt(7)
    buffer_load_dwordx4 a[156:159], v4, s[8:11], s26 offen offset:3072
    s_waitcnt vmcnt(7)
    s_add_u32 s26, s27, 126976
    buffer_load_dwordx4 a[160:163], v4, s[8:11], s26 offen offset:0
    s_waitcnt vmcnt(7)
    buffer_load_dwordx4 a[164:167], v4, s[8:11], s26 offen offset:1024
    s_waitcnt vmcnt(7)
    s_add_u32 s26, s27, 172032
    buffer_load_dwordx4 a[168:171], v4, s[8:11], s26 offen offset:0
    s_waitcnt vmcnt(7)
    buffer_load_dwordx4 a[172:175], v4, s[8:11], s26 offen offset:1024
    s_waitcnt vmcnt(7)
    buffer_load_dwordx4 a[176:179], v4, s[8:11], s26 offen offset:2048
    s_waitcnt vmcnt(7)
    buffer_load_dwordx4 a[180:183], v4, s[8:11], s26 offen offset:3072
    s_waitcnt vmcnt(7)
    s_add_u32 s26, s27, 176128
    buffer_load_dwordx4 a[184:187], v4, s[8:11], s26 offen offset:0
    s_waitcnt vmcnt(7)
    buffer_load_dwordx4 a[188:191], v4, s[8:11], s26 offen offset:1024
    s_waitcnt vmcnt(7)
    buffer_load_dwordx4 a[192:195], v4, s[8:11], s26 offen offset:2048
    s_waitcnt vmcnt(7)
    buffer_load_dwordx4 a[196:199], v4, s[8:11], s26 offen offset:3072
    s_waitcnt vmcnt(7)
    s_add_u32 s26, s27, 180224
    buffer_load_dwordx4 a[200:203], v4, s[8:11], s26 offen offset:0
    s_waitcnt vmcnt(7)
    buffer_load_dwordx4 a[204:207], v4, s[8:11], s26 offen offset:1024
    s_waitcnt vmcnt(7)
    buffer_load_dwordx4 a[208:211], v4, s[8:11], s26 offen offset:2048
    s_waitcnt vmcnt(7)
    buffer_load_dwordx4 a[212:215], v4, s[8:11], s26 offen offset:3072
    s_waitcnt vmcnt(7)
    s_add_u32 s26, s27, 184320
    buffer_load_dwordx4 a[216:219], v4, s[8:11], s26 offen offset:0
    s_waitcnt vmcnt(7)
    buffer_load_dwordx4 a[220:223], v4, s[8:11], s26 offen offset:1024
    s_waitcnt vmcnt(7)
    s_add_u32 s26, s27, 229376
    buffer_load_dwordx4 a[224:227], v4, s[8:11], s26 offen offset:0
    s_waitcnt vmcnt(7)
    buffer_load_dwordx4 a[228:231], v4, s[8:11], s26 offen offset:1024
    s_waitcnt vmcnt(7)
    buffer_load_dwordx4 a[232:235], v4, s[8:11], s26 offen offset:2048
    s_waitcnt vmcnt(7)
    buffer_load_dwordx4 a[236:239], v4, s[8:11], s26 offen offset:3072
    s_waitcnt vmcnt(7)
    s_add_u32 s26, s27, 233472
    buffer_load_dwordx4 a[240:243], v4, s[8:11], s26 offen offset:0
    s_waitcnt vmcnt(7)
    buffer_load_dwordx4 a[244:247], v4, s[8:11], s26 offen offset:1024
    s_waitcnt vmcnt(7)
    buffer_load_dwordx4 a[248:251], v4, s[8:11], s26 offen offset:2048
    s_waitcnt vmcnt(7)
    buffer_load_dwordx4 a[252:255], v4, s[8:11], s26 offen offset:3072
    s_waitcnt vmcnt(7)
    s_add_u32 s26, s27, 237568
    buffer_load_dwordx4 v[64:67], v4, s[8:11], s26 offen offset:0
    s_waitcnt vmcnt(7)
    buffer_load_dwordx4 v[68:71], v4, s[8:11], s26 offen offset:1024
    s_waitcnt vmcnt(7)
    buffer_load_dwordx4 v[72:75], v4, s[8:11], s26 offen offset:2048
    s_waitcnt vmcnt(7)
    buffer_load_dwordx4 v[76:79], v4, s[8:11], s26 offen offset:3072
    s_waitcnt vmcnt(7)
    s_add_u32 s26, s27, 241664
    buffer_load_dwordx4 v[80:83], v4, s[8:11], s26 offen offset:0
    s_waitcnt vmcnt(7)
    buffer_load_dwordx4 v[84:87], v4, s[8:11], s26 offen offset:1024
    s_waitcnt vmcnt(7)
    s_add_u32 s26, s27, 286720
    buffer_load_dwordx4 v[88:91], v4, s[8:11], s26 offen offset:0
    s_waitcnt vmcnt(7)
    buffer_load_dwordx4 v[92:95], v4, s[8:11], s26 offen offset:1024
    s_waitcnt vmcnt(7)
    buffer_load_dwordx4 v[96:99], v4, s[8:11], s26 offen offset:2048
    s_waitcnt vmcnt(7)
    buffer_load_dwordx4 v[100:103], v4, s[8:11], s26 offen offset:3072
    s_waitcnt vmcnt(7)
    s_add_u32 s26, s27, 290816
    buffer_load_dwordx4 v[104:107], v4, s[8:11], s26 offen offset:0
    s_waitcnt vmcnt(7)
    buffer_load_dwordx4 v[108:111], v4, s[8:11], s26 offen offset:1024
    s_waitcnt vmcnt(7)
    buffer_load_dwordx4 v[112:115], v4, s[8:11], s26 offen offset:2048
    s_waitcnt vmcnt(7)
    buffer_load_dwordx4 v[116:119], v4, s[8:11], s26 offen offset:3072
    s_waitcnt vmcnt(7)
    s_add_u32 s26, s27, 294912
    buffer_load_dwordx4 v[120:123], v4, s[8:11], s26 offen offset:0
    s_waitcnt vmcnt(7)
    buffer_load_dwordx4 v[124:127], v4, s[8:11], s26 offen offset:1024
    s_waitcnt vmcnt(7)
    buffer_load_dwordx4 v[128:131], v4, s[8:11], s26 offen offset:2048
    s_waitcnt vmcnt(7)
    buffer_load_dwordx4 v[132:135], v4, s[8:11], s26 offen offset:3072
    s_waitcnt vmcnt(7)
    s_add_u32 s26, s27, 299008
    buffer_load_dwordx4 v[136:139], v4, s[8:11], s26 offen offset:0
    s_waitcnt vmcnt(7)
    buffer_load_dwordx4 v[140:143], v4, s[8:11], s26 offen offset:1024
    s_waitcnt vmcnt(7)
    s_add_u32 s26, s27, 344064
    buffer_load_dwordx4 v[144:147], v4, s[8:11], s26 offen offset:0
    s_waitcnt vmcnt(7)
    buffer_load_dwordx4 v[148:151], v4, s[8:11], s26 offen offset:1024
    s_waitcnt vmcnt(7)
    buffer_load_dwordx4 v[152:155], v4, s[8:11], s26 offen offset:2048
    s_waitcnt vmcnt(7)
    buffer_load_dwordx4 v[156:159], v4, s[8:11], s26 offen offset:3072
    s_waitcnt vmcnt(7)
    s_add_u32 s26, s27, 348160
    buffer_load_dwordx4 v[160:163], v4, s[8:11], s26 offen offset:0
    s_waitcnt vmcnt(7)
    buffer_load_dwordx4 v[164:167], v4, s[8:11], s26 offen offset:1024
    s_waitcnt vmcnt(7)
    buffer_load_dwordx4 v[168:171], v4, s[8:11], s26 offen offset:2048
    s_waitcnt vmcnt(7)
    buffer_load_dwordx4 v[172:175], v4, s[8:11], s26 offen offset:3072
    s_waitcnt vmcnt(7)
    s_add_u32 s26, s27, 352256
    buffer_load_dwordx4 v[176:179], v4, s[8:11], s26 offen offset:0
    s_waitcnt vmcnt(7)
    buffer_load_dwordx4 v[180:183], v4, s[8:11], s26 offen offset:1024
    s_waitcnt vmcnt(7)
    buffer_load_dwordx4 v[184:187], v4, s[8:11], s26 offen offset:2048
    s_waitcnt vmcnt(7)
    buffer_load_dwordx4 v[188:191], v4, s[8:11], s26 offen offset:3072
    s_waitcnt vmcnt(7)
    s_add_u32 s26, s27, 356352
    buffer_load_dwordx4 v[192:195], v4, s[8:11], s26 offen offset:0
    s_waitcnt vmcnt(7)
    buffer_load_dwordx4 v[196:199], v4, s[8:11], s26 offen offset:1024
    s_waitcnt vmcnt(7)
    s_add_u32 s26, s27, 372736
    buffer_load_dwordx4 v[200:203], v4, s[8:11], s26 offen offset:0
    s_waitcnt vmcnt(7)
    buffer_load_dwordx4 v[204:207], v4, s[8:11], s26 offen offset:1024
    s_waitcnt vmcnt(7)
    buffer_load_dwordx4 v[208:211], v4, s[8:11], s26 offen offset:2048
    s_waitcnt vmcnt(7)
    buffer_load_dwordx4 v[212:215], v4, s[8:11], s26 offen offset:3072
    s_waitcnt vmcnt(7)
    s_add_u32 s26, s27, 376832
    buffer_load_dwordx4 v[216:219], v4, s[8:11], s26 offen offset:0
    s_waitcnt vmcnt(7)
    buffer_load_dwordx4 v[220:223], v4, s[8:11], s26 offen offset:1024
    s_waitcnt vmcnt(7)
    buffer_load_dwordx4 v[224:227], v4, s[8:11], s26 offen offset:2048
    s_waitcnt vmcnt(7)
    buffer_load_dwordx4 v[228:231], v4, s[8:11], s26 offen offset:3072
    s_waitcnt vmcnt(7)
    s_add_u32 s26, s27, 380928
    buffer_load_dwordx4 v[232:235], v4, s[8:11], s26 offen offset:0
    s_waitcnt vmcnt(7)
    buffer_load_dwordx4 v[236:239], v4, s[8:11], s26 offen offset:1024
    s_waitcnt vmcnt(7)
    buffer_load_dwordx4 v[240:243], v4, s[8:11], s26 offen offset:2048
    s_waitcnt vmcnt(7)
    buffer_load_dwordx4 v[244:247], v4, s[8:11], s26 offen offset:3072
    s_waitcnt vmcnt(7)
    s_add_u32 s26, s27, 385024
    buffer_load_dwordx4 v[248:251], v4, s[8:11], s26 offen offset:0
    s_waitcnt vmcnt(7)
    buffer_load_dwordx4 v[252:255], v4, s[8:11], s26 offen offset:1024
    s_waitcnt vmcnt(7)
    s_branch L_sw_17
L_swn_18:
    s_cmp_lg_u32 s17, 1
    s_cbranch_scc1 L_swn_19
    s_add_u32 s26, s27, 14336
    buffer_load_dwordx4 a[0:3], v4, s[8:11], s26 offen offset:0
    buffer_load_dwordx4 a[4:7], v4, s[8:11], s26 offen offset:1024
    buffer_load_dwordx4 a[8:11], v4, s[8:11], s26 offen offset:2048
    buffer_load_dwordx4 a[12:15], v4, s[8:11], s26 offen offset:3072
    s_add_u32 s26, s27, 18432
    buffer_load_dwordx4 a[16:19], v4, s[8:11], s26 offen offset:0
    buffer_load_dwordx4 a[20:23], v4, s[8:11], s26 offen offset:1024
    buffer_load_dwordx4 a[24:27], v4, s[8:11], s26 offen offset:2048
    buffer_load_dwordx4 a[28:31], v4, s[8:11], s26 offen offset:3072
    s_waitcnt vmcnt(7)
    s_add_u32 s26, s27, 22528
    buffer_load_dwordx4 a[32:35], v4, s[8:11], s26 offen offset:0
    s_waitcnt vmcnt(7)
    buffer_load_dwordx4 a[36:39], v4, s[8:11], s26 offen offset:1024
    s_waitcnt vmcnt(7)
    buffer_load_dwordx4 a[40:43], v4, s[8:11], s26 offen offset:2048
    s_waitcnt vmcnt(7)
    buffer_load_dwordx4 a[44:47], v4, s[8:11], s26 offen offset:3072
    s_waitcnt vmcnt(7)
    s_add_u32 s26, s27, 26624
    buffer_load_dwordx4 a[48:51], v4, s[8:11], s26 offen offset:0
    s_waitcnt vmcnt(7)
    buffer_load_dwordx4 a[52:55], v4, s[8:11], s26 offen offset:1024
    s_waitcnt vmcnt(7)
    s_add_u32 s26, s27, 71680
    buffer_load_dwordx4 a[56:59], v4, s[8:11], s26 offen offset:0
    s_waitcnt vmcnt(7)
    buffer_load_dwordx4 a[60:63], v4, s[8:11], s26 offen offset:1024
    s_waitcnt vmcnt(7)
    buffer_load_dwordx4 a[64:67], v4, s[8:11], s26 offen offset:2048
    s_waitcnt vmcnt(7)
    buffer_load_dwordx4 a[68:71], v4, s[8:11], s26 offen offset:3072
    s_waitcnt vmcnt(7)
    s_add_u32 s26, s27, 75776
    buffer_load_dwordx4 a[72:75], v4, s[8:11], s26 offen offset:0
    s_waitcnt vmcnt(7)
    buffer_load_dwordx4 a[76:79], v4, s[8:11], s26 offen offset:1024
    s_waitcnt vmcnt(7)
    buffer_load_dwordx4 a[80:83], v4, s[8:11], s26 offen offset:2048
    s_waitcnt vmcnt(7)
    buffer_load_dwordx4 a[84:87], v4, s[8:11], s26 offen offset:3072
    s_waitcnt vmcnt(7)
    s_add_u32 s26, s27, 79872
    buffer_load_dwordx4 a[88:91], v4, s[8:11], s26 offen offset:0
    s_waitcnt vmcnt(7)
    buffer_load_dwordx4 a[92:95], v4, s[8:11], s26 offen offset:1024
    s_waitcnt vmcnt(7)
    buffer_load_dwordx4 a[96:99], v4, s[8:11], s26 offen offset:2048
    s_waitcnt vmcnt(7)
    buffer_load_dwordx4 a[100:103], v4, s[8:11], s26 offen offset:3072
    s_waitcnt vmcnt(7)
    s_add_u32 s26, s27, 83968
    buffer_load_dwordx4 a[104:107], v4, s[8:11], s26 offen offset:0
    s_waitcnt vmcnt(7)
    buffer_load_dwordx4 a[108:111], v4, s[8:11], s26 offen offset:1024
    s_waitcnt vmcnt(7)
    s_add_u32 s26, s27, 129024
    buffer_load_dwordx4 a[112:115], v4, s[8:11], s26 offen offset:0
    s_waitcnt vmcnt(7)
    buffer_load_dwordx4 a[116:119], v4, s[8:11], s26 offen offset:1024
    s_waitcnt vmcnt(7)
    buffer_load_dwordx4 a[120:123], v4, s[8:11], s26 offen offset:2048
    s_waitcnt vmcnt(7)
    buffer_load_dwordx4 a[124:127], v4, s[8:11], s26 offen offset:3072
    s_waitcnt vmcnt(7)
    s_add_u32 s26, s27, 133120
    buffer_load_dwordx4 a[128:131], v4, s[8:11], s26 offen offset:0
    s_waitcnt vmcnt(7)
    buffer_load_dwordx4 a[132:135], v4, s[8:11], s26 offen offset:1024
    s_waitcnt vmcnt(7)
    buffer_load_dwordx4 a[136:139], v4, s[8:11], s26 offen offset:2048
    s_waitcnt vmcnt(7)
    buffer_load_dwordx4 a[140:143], v4, s[8:11], s26 offen offset:3072
    s_waitcnt vmcnt(7)
    s_add_u32 s26, s27, 137216
    buffer_load_dwordx4 a[144:147], v4, s[8:11], s26 offen offset:0
    s_waitcnt vmcnt(7)
    buffer_load_dwordx4 a[148:151], v4, s[8:11], s26 offen offset:1024
    s_waitcnt vmcnt(7)
    buffer_load_dwordx4 a[152:155], v4, s[8:11], s26 offen offset:2048
    s_waitcnt vmcnt(7)
    buffer_load_dwordx4 a[156:159], v4, s[8:11], s26 offen offset:3072
    s_waitcnt vmcnt(7)
    s_add_u32 s26, s27, 141312
    buffer_load_dwordx4 a[160:163], v4, s[8:11], s26 offen offset:0
    s_waitcnt vmcnt(7)
    buffer_load_dwordx4 a[164:167], v4, s[8:11], s26 offen offset:1024
    s_waitcnt vmcnt(7)
    s_add_u32 s26, s27, 186368
    buffer_load_dwordx4 a[168:171], v4, s[8:11], s26 offen offset:0
    s_waitcnt vmcnt(7)
    buffer_load_dwordx4 a[172:175], v4, s[8:11], s26 offen offset:1024
    s_waitcnt vmcnt(7)
    buffer_load_dwordx4 a[176:179], v4, s[8:11], s26 offen offset:2048
    s_waitcnt vmcnt(7)
    buffer_load_dwordx4 a[180:183], v4, s[8:11], s26 offen offset:3072
    s_waitcnt vmcnt(7)
    s_add_u32 s26, s27, 190464
    buffer_load_dwordx4 a[184:187], v4, s[8:11], s26 offen offset:0
    s_waitcnt vmcnt(7)
    buffer_load_dwordx4 a[188:191], v4, s[8:11], s26 offen offset:1024
    s_waitcnt vmcnt(7)
    buffer_load_dwordx4 a[192:195], v4, s[8:11], s26 offen offset:2048
    s_waitcnt vmcnt(7)
    buffer_load_dwordx4 a[196:199], v4, s[8:11], s26 offen offset:3072
    s_waitcnt vmcnt(7)
    s_add_u32 s26, s27, 194560
    buffer_load_dwordx4 a[200:203], v4, s[8:11], s26 offen offset:0
    s_waitcnt vmcnt(7)
    buffer_load_dwordx4 a[204:207], v4, s[8:11], s26 offen offset:1024
    s_waitcnt vmcnt(7)
    buffer_load_dwordx4 a[208:211], v4, s[8:11], s26 offen offset:2048
    s_waitcnt vmcnt(7)
    buffer_load_dwordx4 a[212:215], v4, s[8:11], s26 offen offset:3072
    s_waitcnt vmcnt(7)
    s_add_u32 s26, s27, 198656
    buffer_load_dwordx4 a[216:219], v4, s[8:11], s26 offen offset:0
    s_waitcnt vmcnt(7)
    buffer_load_dwordx4 a[220:223], v4, s[8:11], s26 offen offset:1024
    s_waitcnt vmcnt(7)
    s_add_u32 s26, s27, 243712
    buffer_load_dwordx4 a[224:227], v4, s[8:11], s26 offen offset:0
    s_waitcnt vmcnt(7)
    buffer_load_dwordx4 a[228:231], v4, s[8:11], s26 offen offset:1024
    s_waitcnt vmcnt(7)
    buffer_load_dwordx4 a[232:235], v4, s[8:11], s26 offen offset:2048
    s_waitcnt vmcnt(7)
    buffer_load_dwordx4 a[236:239], v4, s[8:11], s26 offen offset:3072
    s_waitcnt vmcnt(7)
    s_add_u32 s26, s27, 247808
    buffer_load_dwordx4 a[240:243], v4, s[8:11], s26 offen offset:0
    s_waitcnt vmcnt(7)
    buffer_load_dwordx4 a[244:247], v4, s[8:11], s26 offen offset:1024
    s_waitcnt vmcnt(7)
    buffer_load_dwordx4 a[248:251], v4, s[8:11], s26 offen offset:2048
    s_waitcnt vmcnt(7)
    buffer_load_dwordx4 a[252:255], v4, s[8:11], s26 offen offset:3072
    s_waitcnt vmcnt(7)
    s_add_u32 s26, s27, 251904
    buffer_load_dwordx4 v[64:67], v4, s[8:11], s26 offen offset:0
    s_waitcnt vmcnt(7)
    buffer_load_dwordx4 v[68:71], v4, s[8:11], s26 offen offset:1024
    s_waitcnt vmcnt(7)
    buffer_load_dwordx4 v[72:75], v4, s[8:11], s26 offen offset:2048
    s_waitcnt vmcnt(7)
    buffer_load_dwordx4 v[76:79], v4, s[8:11], s26 offen offset:3072
    s_waitcnt vmcnt(7)
    s_add_u32 s26, s27, 256000
    buffer_load_dwordx4 v[80:83], v4, s[8:11], s26 offen offset:0
    s_waitcnt vmcnt(7)
    buffer_load_dwordx4 v[84:87], v4, s[8:11], s26 offen offset:1024
    s_waitcnt vmcnt(7)
    s_add_u32 s26, s27, 301056
    buffer_load_dwordx4 v[88:91], v4, s[8:11], s26 offen offset:0
    s_waitcnt vmcnt(7)
    buffer_load_dwordx4 v[92:95], v4, s[8:11], s26 offen offset:1024
    s_waitcnt vmcnt(7)
    buffer_load_dwordx4 v[96:99], v4, s[8:11], s26 offen offset:2048
    s_waitcnt vmcnt(7)
    buffer_load_dwordx4 v[100:103], v4, s[8:11], s26 offen offset:3072
    s_waitcnt vmcnt(7)
    s_add_u32 s26, s27, 305152
    buffer_load_dwordx4 v[104:107], v4, s[8:11], s26 offen offset:0
    s_waitcnt vmcnt(7)
    buffer_load_dwordx4 v[108:111], v4, s[8:11], s26 offen offset:1024
    s_waitcnt vmcnt(7)
    buffer_load_dwordx4 v[112:115], v4, s[8:11], s26 offen offset:2048
    s_waitcnt vmcnt(7)
    buffer_load_dwordx4 v[116:119], v4, s[8:11], s26 offen offset:3072
    s_waitcnt vmcnt(7)
    s_add_u32 s26, s27, 309248
    buffer_load_dwordx4 v[120:123], v4, s[8:11], s26 offen offset:0
    s_waitcnt vmcnt(7)
    buffer_load_dwordx4 v[124:127], v4, s[8:11], s26 offen offset:1024
    s_waitcnt vmcnt(7)
    buffer_load_dwordx4 v[128:131], v4, s[8:11], s26 offen offset:2048
    s_waitcnt vmcnt(7)
    buffer_load_dwordx4 v[132:135], v4, s[8:11], s26 offen offset:3072
    s_waitcnt vmcnt(7)
    s_add_u32 s26, s27, 313344
    buffer_load_dwordx4 v[136:139], v4, s[8:11], s26 offen offset:0
    s_waitcnt vmcnt(7)
    buffer_load_dwordx4 v[140:143], v4, s[8:11], s26 offen offset:1024
    s_waitcnt vmcnt(7)
    s_add_u32 s26, s27, 358400
    buffer_load_dwordx4 v[144:147], v4, s[8:11], s26 offen offset:0
    s_waitcnt vmcnt(7)
    buffer_load_dwordx4 v[148:151], v4, s[8:11], s26 offen offset:1024
    s_waitcnt vmcnt(7)
    buffer_load_dwordx4 v[152:155], v4, s[8:11], s26 offen offset:2048
    s_waitcnt vmcnt(7)
    buffer_load_dwordx4 v[156:159], v4, s[8:11], s26 offen offset:3072
    s_waitcnt vmcnt(7)
    s_add_u32 s26, s27, 362496
    buffer_load_dwordx4 v[160:163], v4, s[8:11], s26 offen offset:0
    s_waitcnt vmcnt(7)
    buffer_load_dwordx4 v[164:167], v4, s[8:11], s26 offen offset:1024
    s_waitcnt vmcnt(7)
    buffer_load_dwordx4 v[168:171], v4, s[8:11], s26 offen offset:2048
    s_waitcnt vmcnt(7)
    buffer_load_dwordx4 v[172:175], v4, s[8:11], s26 offen offset:3072
    s_waitcnt vmcnt(7)
    s_add_u32 s26, s27, 366592
    buffer_load_dwordx4 v[176:179], v4, s[8:11], s26 offen offset:0
    s_waitcnt vmcnt(7)
    buffer_load_dwordx4 v[180:183], v4, s[8:11], s26 offen offset:1024
    s_waitcnt vmcnt(7)
    buffer_load_dwordx4 v[184:187], v4, s[8:11], s26 offen offset:2048
    s_waitcnt vmcnt(7)
    buffer_load_dwordx4 v[188:191], v4, s[8:11], s26 offen offset:3072
    s_waitcnt vmcnt(7)
    s_add_u32 s26, s27, 370688
    buffer_load_dwordx4 v[192:195], v4, s[8:11], s26 offen offset:0
    s_waitcnt vmcnt(7)
    buffer_load_dwordx4 v[196:199], v4, s[8:11], s26 offen offset:1024
    s_waitcnt vmcnt(7)
    s_add_u32 s26, s27, 387072
    buffer_load_dwordx4 v[200:203], v4, s[8:11], s26 offen offset:0
    s_waitcnt vmcnt(7)
    buffer_load_dwordx4 v[204:207], v4, s[8:11], s26 offen offset:1024
    s_waitcnt vmcnt(7)
    buffer_load_dwordx4 v[208:211], v4, s[8:11], s26 offen offset:2048
    s_waitcnt vmcnt(7)
    buffer_load_dwordx4 v[212:215], v4, s[8:11], s26 offen offset:3072
    s_waitcnt vmcnt(7)
    s_add_u32 s26, s27, 391168
    buffer_load_dwordx4 v[216:219], v4, s[8:11], s26 offen offset:0
    s_waitcnt vmcnt(7)
    buffer_load_dwordx4 v[220:223], v4, s[8:11], s26 offen offset:1024
    s_waitcnt vmcnt(7)
    buffer_load_dwordx4 v[224:227], v4, s[8:11], s26 offen offset:2048
    s_waitcnt vmcnt(7)
    buffer_load_dwordx4 v[228:231], v4, s[8:11], s26 offen offset:3072
    s_waitcnt vmcnt(7)
    s_add_u32 s26, s27, 395264
    buffer_load_dwordx4 v[232:235], v4, s[8:11], s26 offen offset:0
    s_waitcnt vmcnt(7)
    buffer_load_dwordx4 v[236:239], v4, s[8:11], s26 offen offset:1024
    s_waitcnt vmcnt(7)
    buffer_load_dwordx4 v[240:243], v4, s[8:11], s26 offen offset:2048
    s_waitcnt vmcnt(7)
    buffer_load_dwordx4 v[244:247], v4, s[8:11], s26 offen offset:3072
    s_waitcnt vmcnt(7)
    s_add_u32 s26, s27, 399360
    buffer_load_dwordx4 v[248:251], v4, s[8:11], s26 offen offset:0
    s_waitcnt vmcnt(7)
    buffer_load_dwordx4 v[252:255], v4, s[8:11], s26 offen offset:1024
    s_waitcnt vmcnt(7)
    s_branch L_sw_17
L_swn_19:
    s_cmp_lg_u32 s17, 2
    s_cbranch_scc1 L_swn_20
    s_add_u32 s26, s27, 28672
    buffer_load_dwordx4 a[0:3], v4, s[8:11], s26 offen offset:0
    buffer_load_dwordx4 a[4:7], v4, s[8:11], s26 offen offset:1024
    buffer_load_dwordx4 a[8:11], v4, s[8:11], s26 offen offset:2048
    buffer_load_dwordx4 a[12:15], v4, s[8:11], s26 offen offset:3072
    s_add_u32 s26, s27, 32768
    buffer_load_dwordx4 a[16:19], v4, s[8:11], s26 offen offset:0
    buffer_load_dwordx4 a[20:23], v4, s[8:11], s26 offen offset:1024
    buffer_load_dwordx4 a[24:27], v4, s[8:11], s26 offen offset:2048
    buffer_load_dwordx4 a[28:31], v4, s[8:11], s26 offen offset:3072
    s_waitcnt vmcnt(7)
    s_add_u32 s26, s27, 36864
    buffer_load_dwordx4 a[32:35], v4, s[8:11], s26 offen offset:0
    s_waitcnt vmcnt(7)
    buffer_load_dwordx4 a[36:39], v4, s[8:11], s26 offen offset:1024
    s_waitcnt vmcnt(7)
    buffer_load_dwordx4 a[40:43], v4, s[8:11], s26 offen offset:2048
    s_waitcnt vmcnt(7)
    buffer_load_dwordx4 a[44:47], v4, s[8:11], s26 offen offset:3072
    s_waitcnt vmcnt(7)
    s_add_u32 s26, s27, 40960
    buffer_load_dwordx4 a[48:51], v4, s[8:11], s26 offen offset:0
    s_waitcnt vmcnt(7)
    buffer_load_dwordx4 a[52:55], v4, s[8:11], s26 offen offset:1024
    s_waitcnt vmcnt(7)
    s_add_u32 s26, s27, 86016
    buffer_load_dwordx4 a[56:59], v4, s[8:11], s26 offen offset:0
    s_waitcnt vmcnt(7)
    buffer_load_dwordx4 a[60:63], v4, s[8:11], s26 offen offset:1024
    s_waitcnt vmcnt(7)
    buffer_load_dwordx4 a[64:67], v4, s[8:11], s26 offen offset:2048
    s_waitcnt vmcnt(7)
    buffer_load_dwordx4 a[68:71], v4, s[8:11], s26 offen offset:3072
    s_waitcnt vmcnt(7)
    s_add_u32 s26, s27, 90112
    buffer_load_dwordx4 a[72:75], v4, s[8:11], s26 offen offset:0
    s_waitcnt vmcnt(7)
    buffer_load_dwordx4 a[76:79], v4, s[8:11], s26 offen offset:1024
    s_waitcnt vmcnt(7)
    buffer_load_dwordx4 a[80:83], v4, s[8:11], s26 offen offset:2048
    s_waitcnt vmcnt(7)
    buffer_load_dwordx4 a[84:87], v4, s[8:11], s26 offen offset:3072
    s_waitcnt vmcnt(7)
    s_add_u32 s26, s27, 94208
    buffer_load_dwordx4 a[88:91], v4, s[8:11], s26 offen offset:0
    s_waitcnt vmcnt(7)
    buffer_load_dwordx4 a[92:95], v4, s[8:11], s26 offen offset:1024
    s_waitcnt vmcnt(7)
    buffer_load_dwordx4 a[96:99], v4, s[8:11], s26 offen offset:2048
    s_waitcnt vmcnt(7)
    buffer_load_dwordx4 a[100:103], v4, s[8:11], s26 offen offset:3072
    s_waitcnt vmcnt(7)
    s_add_u32 s26, s27, 98304
    buffer_load_dwordx4 a[104:107], v4, s[8:11], s26 offen offset:0
    s_waitcnt vmcnt(7)
    buffer_load_dwordx4 a[108:111], v4, s[8:11], s26 offen offset:1024
    s_waitcnt vmcnt(7)
    s_add_u32 s26, s27, 143360
    buffer_load_dwordx4 a[112:115], v4, s[8:11], s26 offen offset:0
    s_waitcnt vmcnt(7)
    buffer_load_dwordx4 a[116:119], v4, s[8:11], s26 offen offset:1024
    s_waitcnt vmcnt(7)
    buffer_load_dwordx4 a[120:123], v4, s[8:11], s26 offen offset:2048
    s_waitcnt vmcnt(7)
    buffer_load_dwordx4 a[124:127], v4, s[8:11], s26 offen offset:3072
    s_waitcnt vmcnt(7)
    s_add_u32 s26, s27, 147456
    buffer_load_dwordx4 a[128:131], v4, s[8:11], s26 offen offset:0
    s_waitcnt vmcnt(7)
    buffer_load_dwordx4 a[132:135], v4, s[8:11], s26 offen offset:1024
    s_waitcnt vmcnt(7)
    buffer_load_dwordx4 a[136:139], v4, s[8:11], s26 offen offset:2048
    s_waitcnt vmcnt(7)
    buffer_load_dwordx4 a[140:143], v4, s[8:11], s26 offen offset:3072
    s_waitcnt vmcnt(7)
    s_add_u32 s26, s27, 151552
    buffer_load_dwordx4 a[144:147], v4, s[8:11], s26 offen offset:0
    s_waitcnt vmcnt(7)
    buffer_load_dwordx4 a[148:151], v4, s[8:11], s26 offen offset:1024
    s_waitcnt vmcnt(7)
    buffer_load_dwordx4 a[152:155], v4, s[8:11], s26 offen offset:2048
    s_waitcnt vmcnt(7)
    buffer_load_dwordx4 a[156:159], v4, s[8:11], s26 offen offset:3072
    s_waitcnt vmcnt(7)
    s_add_u32 s26, s27, 155648
    buffer_load_dwordx4 a[160:163], v4, s[8:11], s26 offen offset:0
    s_waitcnt vmcnt(7)
    buffer_load_dwordx4 a[164:167], v4, s[8:11], s26 offen offset:1024
    s_waitcnt vmcnt(7)
    s_add_u32 s26, s27, 200704
    buffer_load_dwordx4 a[168:171], v4, s[8:11], s26 offen offset:0
    s_waitcnt vmcnt(7)
    buffer_load_dwordx4 a[172:175], v4, s[8:11], s26 offen offset:1024
    s_waitcnt vmcnt(7)
    buffer_load_dwordx4 a[176:179], v4, s[8:11], s26 offen offset:2048
    s_waitcnt vmcnt(7)
    buffer_load_dwordx4 a[180:183], v4, s[8:11], s26 offen offset:3072
    s_waitcnt vmcnt(7)
    s_add_u32 s26, s27, 204800
    buffer_load_dwordx4 a[184:187], v4, s[8:11], s26 offen offset:0
    s_waitcnt vmcnt(7)
    buffer_load_dwordx4 a[188:191], v4, s[8:11], s26 offen offset:1024
    s_waitcnt vmcnt(7)
    buffer_load_dwordx4 a[192:195], v4, s[8:11], s26 offen offset:2048
    s_waitcnt vmcnt(7)
    buffer_load_dwordx4 a[196:199], v4, s[8:11], s26 offen offset:3072
    s_waitcnt vmcnt(7)
    s_add_u32 s26, s27, 208896
    buffer_load_dwordx4 a[200:203], v4, s[8:11], s26 offen offset:0
    s_waitcnt vmcnt(7)
    buffer_load_dwordx4 a[204:207], v4, s[8:11], s26 offen offset:1024
    s_waitcnt vmcnt(7)
    buffer_load_dwordx4 a[208:211], v4, s[8:11], s26 offen offset:2048
    s_waitcnt vmcnt(7)
    buffer_load_dwordx4 a[212:215], v4, s[8:11], s26 offen offset:3072
    s_waitcnt vmcnt(7)
    s_add_u32 s26, s27, 212992
    buffer_load_dwordx4 a[216:219], v4, s[8:11], s26 offen offset:0
    s_waitcnt vmcnt(7)
    buffer_load_dwordx4 a[220:223], v4, s[8:11], s26 offen offset:1024
    s_waitcnt vmcnt(7)
    s_add_u32 s26, s27, 258048
    buffer_load_dwordx4 a[224:227], v4, s[8:11], s26 offen offset:0
    s_waitcnt vmcnt(7)
    buffer_load_dwordx4 a[228:231], v4, s[8:11], s26 offen offset:1024
    s_waitcnt vmcnt(7)
    buffer_load_dwordx4 a[232:235], v4, s[8:11], s26 offen offset:2048
    s_waitcnt vmcnt(7)
    buffer_load_dwordx4 a[236:239], v4, s[8:11], s26 offen offset:3072
    s_waitcnt vmcnt(7)
    s_add_u32 s26, s27, 262144
    buffer_load_dwordx4 a[240:243], v4, s[8:11], s26 offen offset:0
    s_waitcnt vmcnt(7)
    buffer_load_dwordx4 a[244:247], v4, s[8:11], s26 offen offset:1024
    s_waitcnt vmcnt(7)
    buffer_load_dwordx4 a[248:251], v4, s[8:11], s26 offen offset:2048
    s_waitcnt vmcnt(7)
    buffer_load_dwordx4 a[252:255], v4, s[8:11], s26 offen offset:3072
    s_waitcnt vmcnt(7)
    s_add_u32 s26, s27, 266240
    buffer_load_dwordx4 v[64:67], v4, s[8:11], s26 offen offset:0
    s_waitcnt vmcnt(7)
    buffer_load_dwordx4 v[68:71], v4, s[8:11], s26 offen offset:1024
    s_waitcnt vmcnt(7)
    buffer_load_dwordx4 v[72:75], v4, s[8:11], s26 offen offset:2048
    s_waitcnt vmcnt(7)
    buffer_load_dwordx4 v[76:79], v4, s[8:11], s26 offen offset:3072
    s_waitcnt vmcnt(7)
    s_add_u32 s26, s27, 270336
    buffer_load_dwordx4 v[80:83], v4, s[8:11], s26 offen offset:0
    s_waitcnt vmcnt(7)
    buffer_load_dwordx4 v[84:87], v4, s[8:11], s26 offen offset:1024
    s_waitcnt vmcnt(7)
    s_add_u32 s26, s27, 315392
    buffer_load_dwordx4 v[88:91], v4, s[8:11], s26 offen offset:0
    s_waitcnt vmcnt(7)
    buffer_load_dwordx4 v[92:95], v4, s[8:11], s26 offen offset:1024
    s_waitcnt vmcnt(7)
    buffer_load_dwordx4 v[96:99], v4, s[8:11], s26 offen offset:2048
    s_waitcnt vmcnt(7)
    buffer_load_dwordx4 v[100:103], v4, s[8:11], s26 offen offset:3072
    s_waitcnt vmcnt(7)
    s_add_u32 s26, s27, 319488
    buffer_load_dwordx4 v[104:107], v4, s[8:11], s26 offen offset:0
    s_waitcnt vmcnt(7)
    buffer_load_dwordx4 v[108:111], v4, s[8:11], s26 offen offset:1024
    s_waitcnt vmcnt(7)
    buffer_load_dwordx4 v[112:115], v4, s[8:11], s26 offen offset:2048
    s_waitcnt vmcnt(7)
    buffer_load_dwordx4 v[116:119], v4, s[8:11], s26 offen offset:3072
    s_waitcnt vmcnt(7)
    s_add_u32 s26, s27, 323584
    buffer_load_dwordx4 v[120:123], v4, s[8:11], s26 offen offset:0
    s_waitcnt vmcnt(7)
    buffer_load_dwordx4 v[124:127], v4, s[8:11], s26 offen offset:1024
    s_waitcnt vmcnt(7)
    buffer_load_dwordx4 v[128:131], v4, s[8:11], s26 offen offset:2048
    s_waitcnt vmcnt(7)
    buffer_load_dwordx4 v[132:135], v4, s[8:11], s26 offen offset:3072
    s_waitcnt vmcnt(7)
    s_add_u32 s26, s27, 327680
    buffer_load_dwordx4 v[136:139], v4, s[8:11], s26 offen offset:0
    s_waitcnt vmcnt(7)
    buffer_load_dwordx4 v[140:143], v4, s[8:11], s26 offen offset:1024
    s_waitcnt vmcnt(7)
    s_add_u32 s26, s27, 329728
    buffer_load_dwordx4 v[144:147], v4, s[8:11], s26 offen offset:0
    s_waitcnt vmcnt(7)
    buffer_load_dwordx4 v[148:151], v4, s[8:11], s26 offen offset:1024
    s_waitcnt vmcnt(7)
    buffer_load_dwordx4 v[152:155], v4, s[8:11], s26 offen offset:2048
    s_waitcnt vmcnt(7)
    buffer_load_dwordx4 v[156:159], v4, s[8:11], s26 offen offset:3072
    s_waitcnt vmcnt(7)
    s_add_u32 s26, s27, 333824
    buffer_load_dwordx4 v[160:163], v4, s[8:11], s26 offen offset:0
    s_waitcnt vmcnt(7)
    buffer_load_dwordx4 v[164:167], v4, s[8:11], s26 offen offset:1024
    s_waitcnt vmcnt(7)
    buffer_load_dwordx4 v[168:171], v4, s[8:11], s26 offen offset:2048
    s_waitcnt vmcnt(7)
    buffer_load_dwordx4 v[172:175], v4, s[8:11], s26 offen offset:3072
    s_waitcnt vmcnt(7)
    s_add_u32 s26, s27, 337920
    buffer_load_dwordx4 v[176:179], v4, s[8:11], s26 offen offset:0
    s_waitcnt vmcnt(7)
    buffer_load_dwordx4 v[180:183], v4, s[8:11], s26 offen offset:1024
    s_waitcnt vmcnt(7)
    buffer_load_dwordx4 v[184:187], v4, s[8:11], s26 offen offset:2048
    s_waitcnt vmcnt(7)
    buffer_load_dwordx4 v[188:191], v4, s[8:11], s26 offen offset:3072
    s_waitcnt vmcnt(7)
    s_add_u32 s26, s27, 342016
    buffer_load_dwordx4 v[192:195], v4, s[8:11], s26 offen offset:0
    s_waitcnt vmcnt(7)
    buffer_load_dwordx4 v[196:199], v4, s[8:11], s26 offen offset:1024
    s_waitcnt vmcnt(7)
    s_branch L_sw_17
L_swn_20:
    s_add_u32 s26, s27, 43008
    buffer_load_dwordx4 a[0:3], v4, s[8:11], s26 offen offset:0
    buffer_load_dwordx4 a[4:7], v4, s[8:11], s26 offen offset:1024
    buffer_load_dwordx4 a[8:11], v4, s[8:11], s26 offen offset:2048
    buffer_load_dwordx4 a[12:15], v4, s[8:11], s26 offen offset:3072
    s_add_u32 s26, s27, 47104
    buffer_load_dwordx4 a[16:19], v4, s[8:11], s26 offen offset:0
    buffer_load_dwordx4 a[20:23], v4, s[8:11], s26 offen offset:1024
    buffer_load_dwordx4 a[24:27], v4, s[8:11], s26 offen offset:2048
    buffer_load_dwordx4 a[28:31], v4, s[8:11], s26 offen offset:3072
    s_waitcnt vmcnt(7)
    s_add_u32 s26, s27, 51200
    buffer_load_dwordx4 a[32:35], v4, s[8:11], s26 offen offset:0
    s_waitcnt vmcnt(7)
    buffer_load_dwordx4 a[36:39], v4, s[8:11], s26 offen offset:1024
    s_waitcnt vmcnt(7)
    buffer_load_dwordx4 a[40:43], v4, s[8:11], s26 offen offset:2048
    s_waitcnt vmcnt(7)
    buffer_load_dwordx4 a[44:47], v4, s[8:11], s26 offen offset:3072
    s_waitcnt vmcnt(7)
    s_add_u32 s26, s27, 55296
    buffer_load_dwordx4 a[48:51], v4, s[8:11], s26 offen offset:0
    s_waitcnt vmcnt(7)
    buffer_load_dwordx4 a[52:55], v4, s[8:11], s26 offen offset:1024
    s_waitcnt vmcnt(7)
    s_add_u32 s26, s27, 100352
    buffer_load_dwordx4 a[56:59], v4, s[8:11], s26 offen offset:0
    s_waitcnt vmcnt(7)
    buffer_load_dwordx4 a[60:63], v4, s[8:11], s26 offen offset:1024
    s_waitcnt vmcnt(7)
    buffer_load_dwordx4 a[64:67], v4, s[8:11], s26 offen offset:2048
    s_waitcnt vmcnt(7)
    buffer_load_dwordx4 a[68:71], v4, s[8:11], s26 offen offset:3072
    s_waitcnt vmcnt(7)
    s_add_u32 s26, s27, 104448
    buffer_load_dwordx4 a[72:75], v4, s[8:11], s26 offen offset:0
    s_waitcnt vmcnt(7)
    buffer_load_dwordx4 a[76:79], v4, s[8:11], s26 offen offset:1024
    s_waitcnt vmcnt(7)
    buffer_load_dwordx4 a[80:83], v4, s[8:11], s26 offen offset:2048
    s_waitcnt vmcnt(7)
    buffer_load_dwordx4 a[84:87], v4, s[8:11], s26 offen offset:3072
    s_waitcnt vmcnt(7)
    s_add_u32 s26, s27, 108544
    buffer_load_dwordx4 a[88:91], v4, s[8:11], s26 offen offset:0
    s_waitcnt vmcnt(7)
    buffer_load_dwordx4 a[92:95], v4, s[8:11], s26 offen offset:1024
    s_waitcnt vmcnt(7)
    buffer_load_dwordx4 a[96:99], v4, s[8:11], s26 offen offset:2048
    s_waitcnt vmcnt(7)
    buffer_load_dwordx4 a[100:103], v4, s[8:11], s26 offen offset:3072
    s_waitcnt vmcnt(7)
    s_add_u32 s26, s27, 112640
    buffer_load_dwordx4 a[104:107], v4, s[8:11], s26 offen offset:0
    s_waitcnt vmcnt(7)
    buffer_load_dwordx4 a[108:111], v4, s[8:11], s26 offen offset:1024
    s_waitcnt vmcnt(7)
    s_add_u32 s26, s27, 157696
    buffer_load_dwordx4 a[112:115], v4, s[8:11], s26 offen offset:0
    s_waitcnt vmcnt(7)
    buffer_load_dwordx4 a[116:119], v4, s[8:11], s26 offen offset:1024
    s_waitcnt vmcnt(7)
    buffer_load_dwordx4 a[120:123], v4, s[8:11], s26 offen offset:2048
    s_waitcnt vmcnt(7)
    buffer_load_dwordx4 a[124:127], v4, s[8:11], s26 offen offset:3072
    s_waitcnt vmcnt(7)
    s_add_u32 s26, s27, 161792
    buffer_load_dwordx4 a[128:131], v4, s[8:11], s26 offen offset:0
    s_waitcnt vmcnt(7)
    buffer_load_dwordx4 a[132:135], v4, s[8:11], s26 offen offset:1024
    s_waitcnt vmcnt(7)
    buffer_load_dwordx4 a[136:139], v4, s[8:11], s26 offen offset:2048
    s_waitcnt vmcnt(7)
    buffer_load_dwordx4 a[140:143], v4, s[8:11], s26 offen offset:3072
    s_waitcnt vmcnt(7)
    s_add_u32 s26, s27, 165888
    buffer_load_dwordx4 a[144:147], v4, s[8:11], s26 offen offset:0
    s_waitcnt vmcnt(7)
    buffer_load_dwordx4 a[148:151], v4, s[8:11], s26 offen offset:1024
    s_waitcnt vmcnt(7)
    buffer_load_dwordx4 a[152:155], v4, s[8:11], s26 offen offset:2048
    s_waitcnt vmcnt(7)
    buffer_load_dwordx4 a[156:159], v4, s[8:11], s26 offen offset:3072
    s_waitcnt vmcnt(7)
    s_add_u32 s26, s27, 169984
    buffer_load_dwordx4 a[160:163], v4, s[8:11], s26 offen offset:0
    s_waitcnt vmcnt(7)
    buffer_load_dwordx4 a[164:167], v4, s[8:11], s26 offen offset:1024
    s_waitcnt vmcnt(7)
    s_add_u32 s26, s27, 215040
    buffer_load_dwordx4 a[168:171], v4, s[8:11], s26 offen offset:0
    s_waitcnt vmcnt(7)
    buffer_load_dwordx4 a[172:175], v4, s[8:11], s26 offen offset:1024
    s_waitcnt vmcnt(7)
    buffer_load_dwordx4 a[176:179], v4, s[8:11], s26 offen offset:2048
    s_waitcnt vmcnt(7)
    buffer_load_dwordx4 a[180:183], v4, s[8:11], s26 offen offset:3072
    s_waitcnt vmcnt(7)
    s_add_u32 s26, s27, 219136
    buffer_load_dwordx4 a[184:187], v4, s[8:11], s26 offen offset:0
    s_waitcnt vmcnt(7)
    buffer_load_dwordx4 a[188:191], v4, s[8:11], s26 offen offset:1024
    s_waitcnt vmcnt(7)
    buffer_load_dwordx4 a[192:195], v4, s[8:11], s26 offen offset:2048
    s_waitcnt vmcnt(7)
    buffer_load_dwordx4 a[196:199], v4, s[8:11], s26 offen offset:3072
    s_waitcnt vmcnt(7)
    s_add_u32 s26, s27, 223232
    buffer_load_dwordx4 a[200:203], v4, s[8:11], s26 offen offset:0
    s_waitcnt vmcnt(7)
    buffer_load_dwordx4 a[204:207], v4, s[8:11], s26 offen offset:1024
    s_waitcnt vmcnt(7)
    buffer_load_dwordx4 a[208:211], v4, s[8:11], s26 offen offset:2048
    s_waitcnt vmcnt(7)
    buffer_load_dwordx4 a[212:215], v4, s[8:11], s26 offen offset:3072
    s_waitcnt vmcnt(7)
    s_add_u32 s26, s27, 227328
    buffer_load_dwordx4 a[216:219], v4, s[8:11], s26 offen offset:0
    s_waitcnt vmcnt(7)
    buffer_load_dwordx4 a[220:223], v4, s[8:11], s26 offen offset:1024
    s_waitcnt vmcnt(7)
    s_add_u32 s26, s27, 272384
    buffer_load_dwordx4 a[224:227], v4, s[8:11], s26 offen offset:0
    s_waitcnt vmcnt(7)
    buffer_load_dwordx4 a[228:231], v4, s[8:11], s26 offen offset:1024
    s_waitcnt vmcnt(7)
    buffer_load_dwordx4 a[232:235], v4, s[8:11], s26 offen offset:2048
    s_waitcnt vmcnt(7)
    buffer_load_dwordx4 a[236:239], v4, s[8:11], s26 offen offset:3072
    s_waitcnt vmcnt(7)
    s_add_u32 s26, s27, 276480
    buffer_load_dwordx4 a[240:243], v4, s[8:11], s26 offen offset:0
    s_waitcnt vmcnt(7)
    buffer_load_dwordx4 a[244:247], v4, s[8:11], s26 offen offset:1024
    s_waitcnt vmcnt(7)
    buffer_load_dwordx4 a[248:251], v4, s[8:11], s26 offen offset:2048
    s_waitcnt vmcnt(7)
    buffer_load_dwordx4 a[252:255], v4, s[8:11], s26 offen offset:3072
    s_waitcnt vmcnt(7)
    s_add_u32 s26, s27, 280576
    buffer_load_dwordx4 v[64:67], v4, s[8:11], s26 offen offset:0
    s_waitcnt vmcnt(7)
    buffer_load_dwordx4 v[68:71], v4, s[8:11], s26 offen offset:1024
    s_waitcnt vmcnt(7)
    buffer_load_dwordx4 v[72:75], v4, s[8:11], s26 offen offset:2048
    s_waitcnt vmcnt(7)
    buffer_load_dwordx4 v[76:79], v4, s[8:11], s26 offen offset:3072
    s_waitcnt vmcnt(7)
    s_add_u32 s26, s27, 284672
    buffer_load_dwordx4 v[80:83], v4, s[8:11], s26 offen offset:0
    s_waitcnt vmcnt(7)
    buffer_load_dwordx4 v[84:87], v4, s[8:11], s26 offen offset:1024
    s_waitcnt vmcnt(7)
L_sw_17:
    v_mov_b32 v12, 64
    buffer_load_dword v13, v12, s[12:15], 0 offen sc1
    s_mov_b32 s19, 0
    s_mov_b32 s21, 19922944
    s_mov_b32 s22, 20971520
    s_mov_b32 s24, 0
    s_lshl_b32 s32, s16, 2
    s_add_u32 s32, s32, s17
    s_lshl_b32 s32, s32, 12
    s_add_u32 s32, s32, 23068672
    s_cmp_lg_u32 s17, 3
    s_cbranch_scc1 L_nx0_22
    s_waitcnt vmcnt(30)
    s_mov_b32 s26, s24
    buffer_load_dwordx4 v[88:91], v4, s[8:11], s26 offen offset:0
    buffer_load_dwordx4 v[92:95], v4, s[8:11], s26 offen offset:1024
    buffer_load_dwordx4 v[96:99], v4, s[8:11], s26 offen offset:2048
    buffer_load_dwordx4 v[100:103], v4, s[8:11], s26 offen offset:3072
    s_add_u32 s26, s26, 4096
    buffer_load_dwordx4 v[104:107], v4, s[8:11], s26 offen offset:0
    buffer_load_dwordx4 v[108:111], v4, s[8:11], s26 offen offset:1024
    buffer_load_dwordx4 v[112:115], v4, s[8:11], s26 offen offset:2048
    buffer_load_dwordx4 v[116:119], v4, s[8:11], s26 offen offset:3072
    s_add_u32 s26, s26, 4096
    buffer_load_dwordx4 v[120:123], v4, s[8:11], s26 offen offset:0
    buffer_load_dwordx4 v[124:127], v4, s[8:11], s26 offen offset:1024
    buffer_load_dwordx4 v[128:131], v4, s[8:11], s26 offen offset:2048
    buffer_load_dwordx4 v[132:135], v4, s[8:11], s26 offen offset:3072
    s_add_u32 s26, s26, 4096
    buffer_load_dwordx4 v[136:139], v4, s[8:11], s26 offen offset:0
    buffer_load_dwordx4 v[140:143], v4, s[8:11], s26 offen offset:1024
    buffer_load_dwordx4 v[144:147], v4, s[8:11], s26 offen offset:2048
    buffer_load_dwordx4 v[148:151], v4, s[8:11], s26 offen offset:3072
    s_add_u32 s26, s26, 4096
    buffer_load_dwordx4 v[152:155], v4, s[8:11], s26 offen offset:0
    buffer_load_dwordx4 v[156:159], v4, s[8:11], s26 offen offset:1024
    buffer_load_dwordx4 v[160:163], v4, s[8:11], s26 offen offset:2048
    buffer_load_dwordx4 v[164:167], v4, s[8:11], s26 offen offset:3072
    s_add_u32 s26, s26, 4096
    buffer_load_dwordx4 v[168:171], v4, s[8:11], s26 offen offset:0
    buffer_load_dwordx4 v[172:175], v4, s[8:11], s26 offen offset:1024
    buffer_load_dwordx4 v[176:179], v4, s[8:11], s26 offen offset:2048
    buffer_load_dwordx4 v[180:183], v4, s[8:11], s26 offen offset:3072
    s_add_u32 s26, s26, 4096
    buffer_load_dwordx4 v[184:187], v4, s[8:11], s26 offen offset:0
    buffer_load_dwordx4 v[188:191], v4, s[8:11], s26 offen offset:1024
    buffer_load_dwordx4 v[192:195], v4, s[8:11], s26 offen offset:2048
    buffer_load_dwordx4 v[196:199], v4, s[8:11], s26 offen offset:3072
L_nx0_22:
    s_mov_b32 s28, 0
    s_waitcnt vmcnt(0)
    s_branch L_modep_25
L_mode_23:
    v_mov_b32 v12, 64
    buffer_load_dword v13, v12, s[12:15], 0 offen sc1
    s_waitcnt vmcnt(0)
L_modep_25:
    s_nop 0
    v_readfirstlane_b32 s26, v13
    s_nop 0
    s_and_b32 s27, s26, 0xffff
    s_cmp_ge_u32 s27, 32
    s_nop 0
    s_cbranch_scc1 L_moded_24
    s_sleep 2
    s_add_u32 s28, s28, 1
    s_cmp_lt_u32 s28, 20000
    s_cbranch_scc1 L_mode_23
    s_mov_b32 s26, 0x10000
L_moded_24:
    s_lshr_b32 s26, s26, 16
    s_cmp_eq_u32 s26, 0
    s_cselect_b32 s20, 1, 0
    s_mov_b32 s29, 20000
    s_mov_b64 s[34:35], 0
    s_cmp_lg_u32 s20, 1
    s_cbranch_scc1 L_sc_next1
    s_cmp_lg_u32 s17, 0
    s_cbranch_scc1 L_sc1_n0
    v_lshrrev_b32 v11, 1, v0
    v_min_u32 v11, 220, v11
    s_and_b32 s26, s16, 3
    s_lshl_b32 s26, s26, 8
    s_add_u32 s26, s26, 7168
    v_add_u32 v11, s26, v11
    v_add_u32 v8, 14336, v4
    v_mov_b32 v9, 0
    ds_write_b32 v8, v9 offset:0
    ds_write_b32 v8, v9 offset:1024
    ds_write_b32 v8, v9 offset:2048
    ds_write_b32 v8, v9 offset:3072
    ds_write_b32 v8, v9 offset:4096
    v_and_b32 v4, 248, v0
    v_lshlrev_b32 v4, 3, v4
    v_add_u32 v4, 0, v4
    s_and_b32 s26, s19, 1
    s_xor_b32 s26, s26, 1
    s_mul_i32 s26, s26, 28672
    s_add_u32 s26, s26, 20480
    s_add_u32 s27, s24, 28672
    s_mov_b32 m0, s26
    s_nop 0
    buffer_load_dwordx4 v1, s[8:11], s27 offen offset:0  lds
    buffer_load_dwordx4 v1, s[8:11], s27 offen offset:1024  lds
    buffer_load_dwordx4 v1, s[8:11], s27 offen offset:2048  lds
    buffer_load_dwordx4 v1, s[8:11], s27 offen offset:3072  lds
    s_add_u32 s26, s26, 4096
    s_add_u32 s27, s27, 4096
    s_mov_b32 m0, s26
    s_nop 0
    buffer_load_dwordx4 v1, s[8:11], s27 offen offset:0  lds
    buffer_load_dwordx4 v1, s[8:11], s27 offen offset:1024  lds
    buffer_load_dwordx4 v1, s[8:11], s27 offen offset:2048  lds
    buffer_load_dwordx4 v1, s[8:11], s27 offen offset:3072  lds
    s_add_u32 s26, s26, 4096
    s_add_u32 s27, s27, 4096
    s_mov_b32 m0, s26
    s_nop 0
    buffer_load_dwordx4 v1, s[8:11], s27 offen offset:0  lds
    v_mov_b64 v[40:41], 0
    v_mov_b64 v[42:43], 0
    v_mov_b64 v[44:45], 0
    v_mov_b64 v[46:47], 0
    v_mov_b64 v[48:49], 0
    v_mov_b64 v[50:51], 0
    v_mov_b64 v[52:53], 0
    v_mov_b64 v[54:55], 0
    v_mov_b64 v[56:57], 0
    v_mov_b64 v[58:59], 0
    v_mov_b64 v[60:61], 0
    v_mov_b64 v[62:63], 0
    s_branch L_sc0_first_27
    .p2align 6
L_sc0_top_26:
    v_mov_b64 v[40:41], 0
    v_mov_b64 v[42:43], 0
    v_mov_b64 v[44:45], 0
    v_mov_b64 v[46:47], 0
    v_mov_b64 v[48:49], 0
    v_mov_b64 v[50:51], 0
    v_mov_b64 v[52:53], 0
    v_mov_b64 v[54:55], 0
    v_mov_b64 v[56:57], 0
    v_mov_b64 v[58:59], 0
    v_mov_b64 v[60:61], 0
    v_mov_b64 v[62:63], 0
    s_mov_b32 m0, 0
    s_sub_u32 s26, s21, 0
    s_add_u32 s27, s26, 4096
    s_mov_b32 s28, 0
    buffer_load_dword v5, v11, s[8:11], s21 offen offset:0 sc1
    s_nop 12
    buffer_load_dword v6, v11, s[8:11], s21 offen offset:0 sc1
    s_nop 12
    buffer_load_dword v7, v11, s[8:11], s21 offen offset:0 sc1
    s_nop 12
L_h_29:
    buffer_load_dword v10, v11, s[8:11], s21 offen offset:0 sc1
    s_waitcnt vmcnt(3)
    v_cmp_eq_u32 vcc, -1, v5
    s_cbranch_vccz L_hd_30
    s_nop 2
    buffer_load_dword v5, v11, s[8:11], s21 offen offset:0 sc1
    s_waitcnt vmcnt(3)
    v_cmp_eq_u32 vcc, -1, v6
    s_cbranch_vccz L_hd_30
    s_nop 2
    buffer_load_dword v6, v11, s[8:11], s21 offen offset:0 sc1
    s_waitcnt vmcnt(3)
    v_cmp_eq_u32 vcc, -1, v7
    s_cbranch_vccz L_hd_30
    s_nop 2
    buffer_load_dword v7, v11, s[8:11], s21 offen offset:0 sc1
    s_waitcnt vmcnt(3)
    v_cmp_eq_u32 vcc, -1, v10
    s_cbranch_vccz L_hd_30
    s_nop 2
    s_add_u32 s28, s28, 1
    s_cmp_lt_u32 s28, s29
    s_cbranch_scc1 L_h_29
L_hd_30:
    s_nop 4
    s_barrier
    buffer_load_dwordx4 v1, s[8:11], s26 offen sc1 lds
    v_add_u32 v9, 1, v9
    s_mov_b32 s36, 0
    s_mov_b32 s28, 1
    s_mov_b32 m0, 4096
    s_nop 4
    buffer_load_dwordx4 v1, s[8:11], s27 offen sc1 lds
    s_waitcnt vmcnt(1) lgkmcnt(0)
    s_barrier
L_got_31:
    ds_read_b64_tr_b16 v[12:13], v0 offset:0
    ds_read_b64_tr_b16 v[14:15], v0 offset:512
    ds_read_b64_tr_b16 v[16:17], v0 offset:1024
    ds_read_b64_tr_b16 v[18:19], v0 offset:1536
    ds_read_b64_tr_b16 v[20:21], v0 offset:2048
    s_waitcnt vmcnt(0)
    s_barrier
L_dry_28:
    s_waitcnt lgkmcnt(3)
    v_smfmac_f32_16x16x64_bf16 v[40:43], v[12:15], a[0:7], v2
    ds_read_b64_tr_b16 v[22:23], v0 offset:2560
    v_smfmac_f32_16x16x64_bf16 v[44:47], v[12:15], a[56:63], v2
    ds_read_b64_tr_b16 v[24:25], v0 offset:3072
    s_waitcnt lgkmcnt(3)
    v_smfmac_f32_16x16x64_bf16 v[40:43], v[16:19], a[8:15], v2
    ds_read_b64_tr_b16 v[26:27], v0 offset:3584
    v_smfmac_f32_16x16x64_bf16 v[44:47], v[16:19], a[64:71], v2
    ds_read_b64_tr_b16 v[28:29], v0 offset:4096
    s_waitcnt lgkmcnt(3)
    v_smfmac_f32_16x16x64_bf16 v[40:43], v[20:23], a[16:23], v2
    ds_read_b64_tr_b16 v[30:31], v0 offset:4608
    v_smfmac_f32_16x16x64_bf16 v[44:47], v[20:23], a[72:79], v2
    ds_read_b64_tr_b16 v[32:33], v0 offset:5120
    s_waitcnt lgkmcnt(3)
    v_smfmac_f32_16x16x64_bf16 v[40:43], v[24:27], a[24:31], v2
    ds_read_b64_tr_b16 v[34:35], v0 offset:5632
    v_smfmac_f32_16x16x64_bf16 v[44:47], v[24:27], a[80:87], v2
    ds_read_b64_tr_b16 v[36:37], v0 offset:6144
    s_waitcnt lgkmcnt(3)
    v_smfmac_f32_16x16x64_bf16 v[40:43], v[28:31], a[32:39], v2
    ds_read_b64_tr_b16 v[38:39], v0 offset:6656
    v_smfmac_f32_16x16x64_bf16 v[44:47], v[28:31], a[88:95], v2
    s_waitcnt lgkmcnt(2)
    v_smfmac_f32_16x16x64_bf16 v[40:43], v[32:35], a[40:47], v2
    v_smfmac_f32_16x16x64_bf16 v[44:47], v[32:35], a[96:103], v2
    s_waitcnt lgkmcnt(0)
    v_smfmac_f32_16x16x64_bf16 v[40:43], v[36:39], a[48:55], v2
    v_smfmac_f32_16x16x64_bf16 v[44:47], v[36:39], a[104:111], v2
    v_smfmac_f32_16x16x64_bf16 v[48:51], v[12:15], a[112:119], v2
    v_smfmac_f32_16x16x64_bf16 v[48:51], v[16:19], a[120:127], v2
    v_add_f32 v40, v40, v42
    v_smfmac_f32_16x16x64_bf16 v[48:51], v[20:23], a[128:135], v2
    v_add_f32 v41, v41, v43
    v_smfmac_f32_16x16x64_bf16 v[48:51], v[24:27], a[136:143], v2
    v_cvt_pk_bf16_f32 v40, v40, v41
    v_smfmac_f32_16x16x64_bf16 v[48:51], v[28:31], a[144:151], v2
    ds_write_b32 v3, v40 offset:7168
    v_smfmac_f32_16x16x64_bf16 v[48:51], v[32:35], a[152:159], v2
    v_add_f32 v44, v44, v46
    v_smfmac_f32_16x16x64_bf16 v[48:51], v[36:39], a[160:167], v2
    v_add_f32 v45, v45, v47
    v_smfmac_f32_16x16x64_bf16 v[52:55], v[12:15], a[168:175], v2
    v_cvt_pk_bf16_f32 v44, v44, v45
    v_smfmac_f32_16x16x64_bf16 v[52:55], v[16:19], a[176:183], v2
    ds_write_b32 v3, v44 offset:8192
    v_smfmac_f32_16x16x64_bf16 v[52:55], v[20:23], a[184:191], v2
    v_add_f32 v48, v48, v50
    v_smfmac_f32_16x16x64_bf16 v[52:55], v[24:27], a[192:199], v2
    v_add_f32 v49, v49, v51
    v_smfmac_f32_16x16x64_bf16 v[52:55], v[28:31], a[200:207], v2
    v_cvt_pk_bf16_f32 v48, v48, v49
    v_smfmac_f32_16x16x64_bf16 v[52:55], v[32:35], a[208:215], v2
    ds_write_b32 v3, v48 offset:9216
    v_smfmac_f32_16x16x64_bf16 v[52:55], v[36:39], a[216:223], v2
    ds_write_b32 v8, v9 offset:0
    v_smfmac_f32_16x16x64_bf16 v[56:59], v[12:15], a[224:231], v2
    v_mov_b64 v[40:41], 0
    v_smfmac_f32_16x16x64_bf16 v[56:59], v[16:19], a[232:239], v2
    v_mov_b64 v[42:43], 0
    v_smfmac_f32_16x16x64_bf16 v[56:59], v[20:23], a[240:247], v2
    v_add_f32 v52, v52, v54
    v_smfmac_f32_16x16x64_bf16 v[56:59], v[24:27], a[248:255], v2
    v_add_f32 v53, v53, v55
    v_smfmac_f32_16x16x64_bf16 v[56:59], v[28:31], v[64:71], v2
    v_cvt_pk_bf16_f32 v52, v52, v53
    v_smfmac_f32_16x16x64_bf16 v[56:59], v[32:35], v[72:79], v2
    ds_write_b32 v3, v52 offset:10240
    v_smfmac_f32_16x16x64_bf16 v[56:59], v[36:39], v[80:87], v2
    v_mov_b64 v[44:45], 0
    v_smfmac_f32_16x16x64_bf16 v[60:63], v[12:15], v[88:95], v2
    v_mov_b64 v[46:47], 0
    v_smfmac_f32_16x16x64_bf16 v[60:63], v[16:19], v[96:103], v2
    v_smfmac_f32_16x16x64_bf16 v[60:63], v[20:23], v[104:111], v2
    v_add_f32 v56, v56, v58
    v_smfmac_f32_16x16x64_bf16 v[60:63], v[24:27], v[112:119], v2
    v_add_f32 v57, v57, v59
    v_smfmac_f32_16x16x64_bf16 v[60:63], v[28:31], v[120:127], v2
    v_cvt_pk_bf16_f32 v56, v56, v57
    v_smfmac_f32_16x16x64_bf16 v[60:63], v[32:35], v[128:135], v2
    ds_write_b32 v3, v56 offset:11264
    v_smfmac_f32_16x16x64_bf16 v[60:63], v[36:39], v[136:143], v2
    ds_write_b32 v8, v9 offset:1024
    v_smfmac_f32_16x16x64_bf16 v[40:43], v[12:15], v[144:151], v2
    v_smfmac_f32_16x16x64_bf16 v[40:43], v[16:19], v[152:159], v2
    v_smfmac_f32_16x16x64_bf16 v[40:43], v[20:23], v[160:167], v2
    v_add_f32 v60, v60, v62
    v_smfmac_f32_16x16x64_bf16 v[40:43], v[24:27], v[168:175], v2
    v_add_f32 v61, v61, v63
    v_smfmac_f32_16x16x64_bf16 v[40:43], v[28:31], v[176:183], v2
    v_cvt_pk_bf16_f32 v60, v60, v61
    v_smfmac_f32_16x16x64_bf16 v[40:43], v[32:35], v[184:191], v2
    ds_write_b32 v3, v60 offset:12288
    v_smfmac_f32_16x16x64_bf16 v[40:43], v[36:39], v[192:199], v2
    ds_write_b32 v8, v9 offset:2048
    v_smfmac_f32_16x16x64_bf16 v[44:47], v[12:15], v[200:207], v2
    v_smfmac_f32_16x16x64_bf16 v[44:47], v[16:19], v[208:215], v2
    v_smfmac_f32_16x16x64_bf16 v[44:47], v[20:23], v[216:223], v2
    v_add_f32 v40, v40, v42
    v_smfmac_f32_16x16x64_bf16 v[44:47], v[24:27], v[224:231], v2
    v_add_f32 v41, v41, v43
    v_smfmac_f32_16x16x64_bf16 v[44:47], v[28:31], v[232:239], v2
    v_cvt_pk_bf16_f32 v40, v40, v41
    v_smfmac_f32_16x16x64_bf16 v[44:47], v[32:35], v[240:247], v2
    ds_write_b32 v3, v40 offset:13312
    v_smfmac_f32_16x16x64_bf16 v[44:47], v[36:39], v[248:255], v2
    s_nop 7
    v_pk_add_f32 v[44:45], v[44:45], v[46:47]
    v_cvt_pk_bf16_f32 v44, v44, v45
    ds_write_b32 v3, v44 offset:13568
    s_waitcnt lgkmcnt(0)
    s_barrier
    s_barrier
    v_mov_b32 v12, 18432
    ds_read_b32 v12, v12
    s_waitcnt lgkmcnt(0)
    v_and_b32 v13, 0x3fffffff, v12
    v_cmp_eq_u32 vcc, v13, v9
    s_cbranch_vccnz L_again_32
    s_add_u32 s19, s19, 1
    s_add_u32 s21, s21, 8192
    s_add_u32 s22, s22, 16384
    s_add_u32 s24, s24, 28672
    s_add_u32 s25, s25, 458752
    s_add_u32 s32, s32, 64
    s_cmp_ge_u32 s19, 63
    s_cbranch_scc1 L_exit
    s_sleep 4
    s_sleep 2
    s_branch L_sc0_top_26
L_sc0_first_27:
    v_add_u32 v9, 1, v9
    s_mov_b32 s36, 1
    s_mov_b32 s28, 0
L_pm_33:
    buffer_load_dwordx4 v[12:15], v1, s[8:11], s21 offen sc1
    buffer_load_dwordx4 v[16:19], v1, s[8:11], s21 offen offset:768 sc1
    s_add_u32 s28, s28, 1
    s_waitcnt vmcnt(1)
    ds_write_b128 v1, v[12:15]
    v_max3_u32 v20, v12, v13, v14
    s_waitcnt vmcnt(0)
    ds_write_b128 v1, v[16:19] offset:768
    v_max3_u32 v20, v20, v15, v16
    v_max3_u32 v20, v20, v17, v18
    v_max_u32 v20, v20, v19
    v_cmp_eq_u32 vcc, -1, v20
    s_cbranch_vccz L_pmd_34
    s_cmp_lt_u32 s28, s29
    s_cbranch_scc1 L_pm_33
    s_mov_b32 s29, 1
L_pmd_34:
    s_waitcnt lgkmcnt(0)
    s_barrier
    s_branch L_got_31
L_again_32:
    v_mov_b64 v[40:41], 0
    v_mov_b64 v[42:43], 0
    v_mov_b64 v[44:45], 0
    v_mov_b64 v[46:47], 0
    v_mov_b64 v[48:49], 0
    v_mov_b64 v[50:51], 0
    v_mov_b64 v[52:53], 0
    v_mov_b64 v[54:55], 0
    v_mov_b64 v[56:57], 0
    v_mov_b64 v[58:59], 0
    v_mov_b64 v[60:61], 0
    v_mov_b64 v[62:63], 0
    v_cmp_eq_u32 vcc, v12, v9
    s_cbranch_vccnz L_sc0_first_27
    v_add_u32 v9, 1, v9
    s_branch L_got_31
L_sc1_n0:
    s_cmp_lg_u32 s17, 1
    s_cbranch_scc1 L_sc1_n1
    v_lshrrev_b32 v11, 1, v0
    v_min_u32 v11, 220, v11
    s_and_b32 s26, s16, 3
    s_lshl_b32 s26, s26, 8
    s_add_u32 s26, s26, 7168
    v_add_u32 v11, s26, v11
    v_add_u32 v8, 14340, v4
    v_mov_b32 v9, 0
    ds_write_b32 v8, v9 offset:0
    ds_write_b32 v8, v9 offset:1024
    ds_write_b32 v8, v9 offset:2048
    ds_write_b32 v8, v9 offset:3072
    ds_write_b32 v8, v9 offset:4096
    v_and_b32 v4, 248, v0
    v_lshlrev_b32 v4, 3, v4
    v_add_u32 v4, 2048, v4
    s_and_b32 s26, s19, 1
    s_xor_b32 s26, s26, 1
    s_mul_i32 s26, s26, 28672
    s_add_u32 s26, s26, 29696
    s_add_u32 s27, s24, 36096
    s_mov_b32 m0, s26
    s_nop 0
    buffer_load_dwordx4 v1, s[8:11], s27 offen offset:0  lds
    buffer_load_dwordx4 v1, s[8:11], s27 offen offset:1024  lds
    buffer_load_dwordx4 v1, s[8:11], s27 offen offset:2048  lds
    buffer_load_dwordx4 v1, s[8:11], s27 offen offset:3072  lds
    s_add_u32 s26, s26, 4096
    s_add_u32 s27, s27, 4096
    s_mov_b32 m0, s26
    s_nop 0
    buffer_load_dwordx4 v1, s[8:11], s27 offen offset:0  lds
    buffer_load_dwordx4 v1, s[8:11], s27 offen offset:1024  lds
    buffer_load_dwordx4 v1, s[8:11], s27 offen offset:2048  lds
    buffer_load_dwordx4 v1, s[8:11], s27 offen offset:3072  lds
    s_add_u32 s26, s26, 4096
    s_add_u32 s27, s27, 4096
    s_mov_b32 m0, s26
    s_nop 0
    buffer_load_dwordx4 v1, s[8:11], s27 offen offset:0  lds
    v_mov_b64 v[40:41], 0
    v_mov_b64 v[42:43], 0
    v_mov_b64 v[44:45], 0
    v_mov_b64 v[46:47], 0
    v_mov_b64 v[48:49], 0
    v_mov_b64 v[50:51], 0
    v_mov_b64 v[52:53], 0
    v_mov_b64 v[54:55], 0
    v_mov_b64 v[56:57], 0
    v_mov_b64 v[58:59], 0
    v_mov_b64 v[60:61], 0
    v_mov_b64 v[62:63], 0
    s_branch L_sc1_first_36
    .p2align 6
L_sc1_top_35:
    v_mov_b64 v[40:41], 0
    v_mov_b64 v[42:43], 0
    v_mov_b64 v[44:45], 0
    v_mov_b64 v[46:47], 0
    v_mov_b64 v[48:49], 0
    v_mov_b64 v[50:51], 0
    v_mov_b64 v[52:53], 0
    v_mov_b64 v[54:55], 0
    v_mov_b64 v[56:57], 0
    v_mov_b64 v[58:59], 0
    v_mov_b64 v[60:61], 0
    v_mov_b64 v[62:63], 0
    s_mov_b32 m0, 1024
    s_sub_u32 s26, s21, 768
    s_add_u32 s27, s26, 4096
    s_barrier
    buffer_load_dwordx4 v1, s[8:11], s26 offen sc1 lds
    v_add_u32 v9, 1, v9
    s_mov_b32 s36, 0
    s_mov_b32 s28, 1
    s_mov_b32 m0, 5120
    s_nop 4
    buffer_load_dwordx4 v1, s[8:11], s27 offen sc1 lds
    s_waitcnt vmcnt(1) lgkmcnt(0)
    s_barrier
L_got_38:
    ds_read_b64_tr_b16 v[12:13], v0 offset:0
    ds_read_b64_tr_b16 v[14:15], v0 offset:512
    ds_read_b64_tr_b16 v[16:17], v0 offset:1024
    ds_read_b64_tr_b16 v[18:19], v0 offset:1536
    ds_read_b64_tr_b16 v[20:21], v0 offset:2048
    s_waitcnt vmcnt(0)
    s_barrier
L_dry_37:
    s_waitcnt lgkmcnt(3)
    v_smfmac_f32_16x16x64_bf16 v[40:43], v[12:15], a[0:7], v2
    ds_read_b64_tr_b16 v[22:23], v0 offset:2560
    v_smfmac_f32_16x16x64_bf16 v[44:47], v[12:15], a[56:63], v2
    ds_read_b64_tr_b16 v[24:25], v0 offset:3072
    s_waitcnt lgkmcnt(3)
    v_smfmac_f32_16x16x64_bf16 v[40:43], v[16:19], a[8:15], v2
    ds_read_b64_tr_b16 v[26:27], v0 offset:3584
    v_smfmac_f32_16x16x64_bf16 v[44:47], v[16:19], a[64:71], v2
    ds_read_b64_tr_b16 v[28:29], v0 offset:4096
    s_waitcnt lgkmcnt(3)
    v_smfmac_f32_16x16x64_bf16 v[40:43], v[20:23], a[16:23], v2
    ds_read_b64_tr_b16 v[30:31], v0 offset:4608
    v_smfmac_f32_16x16x64_bf16 v[44:47], v[20:23], a[72:79], v2
    ds_read_b64_tr_b16 v[32:33], v0 offset:5120
    s_waitcnt lgkmcnt(3)
    v_smfmac_f32_16x16x64_bf16 v[40:43], v[24:27], a[24:31], v2
    ds_read_b64_tr_b16 v[34:35], v0 offset:5632
    v_smfmac_f32_16x16x64_bf16 v[44:47], v[24:27], a[80:87], v2
    ds_read_b64_tr_b16 v[36:37], v0 offset:6144
    s_waitcnt lgkmcnt(3)
    v_smfmac_f32_16x16x64_bf16 v[40:43], v[28:31], a[32:39], v2
    ds_read_b64_tr_b16 v[38:39], v0 offset:6656
    v_smfmac_f32_16x16x64_bf16 v[44:47], v[28:31], a[88:95], v2
    s_waitcnt lgkmcnt(2)
    v_smfmac_f32_16x16x64_bf16 v[40:43], v[32:35], a[40:47], v2
    v_smfmac_f32_16x16x64_bf16 v[44:47], v[32:35], a[96:103], v2
    s_waitcnt lgkmcnt(0)
    v_smfmac_f32_16x16x64_bf16 v[40:43], v[36:39], a[48:55], v2
    v_smfmac_f32_16x16x64_bf16 v[44:47], v[36:39], a[104:111], v2
    v_smfmac_f32_16x16x64_bf16 v[48:51], v[12:15], a[112:119], v2
    v_smfmac_f32_16x16x64_bf16 v[48:51], v[16:19], a[120:127], v2
    v_add_f32 v40, v40, v42
    v_smfmac_f32_16x16x64_bf16 v[48:51], v[20:23], a[128:135], v2
    v_add_f32 v41, v41, v43
    v_smfmac_f32_16x16x64_bf16 v[48:51], v[24:27], a[136:143], v2
    v_cvt_pk_bf16_f32 v40, v40, v41
    v_smfmac_f32_16x16x64_bf16 v[48:51], v[28:31], a[144:151], v2
    ds_write_b32 v3, v40 offset:7296
    v_smfmac_f32_16x16x64_bf16 v[48:51], v[32:35], a[152:159], v2
    v_add_f32 v44, v44, v46
    v_smfmac_f32_16x16x64_bf16 v[48:51], v[36:39], a[160:167], v2
    v_add_f32 v45, v45, v47
    v_smfmac_f32_16x16x64_bf16 v[52:55], v[12:15], a[168:175], v2
    v_cvt_pk_bf16_f32 v44, v44, v45
    v_smfmac_f32_16x16x64_bf16 v[52:55], v[16:19], a[176:183], v2
    ds_write_b32 v3, v44 offset:8320
    v_smfmac_f32_16x16x64_bf16 v[52:55], v[20:23], a[184:191], v2
    v_add_f32 v48, v48, v50
    v_smfmac_f32_16x16x64_bf16 v[52:55], v[24:27], a[192:199], v2
    v_add_f32 v49, v49, v51
    v_smfmac_f32_16x16x64_bf16 v[52:55], v[28:31], a[200:207], v2
    v_cvt_pk_bf16_f32 v48, v48, v49
    v_smfmac_f32_16x16x64_bf16 v[52:55], v[32:35], a[208:215], v2
    ds_write_b32 v3, v48 offset:9344
    v_smfmac_f32_16x16x64_bf16 v[52:55], v[36:39], a[216:223], v2
    ds_write_b32 v8, v9 offset:0
    v_smfmac_f32_16x16x64_bf16 v[56:59], v[12:15], a[224:231], v2
    v_mov_b64 v[40:41], 0
    v_smfmac_f32_16x16x64_bf16 v[56:59], v[16:19], a[232:239], v2
    v_mov_b64 v[42:43], 0
    v_smfmac_f32_16x16x64_bf16 v[56:59], v[20:23], a[240:247], v2
    v_add_f32 v52, v52, v54
    v_smfmac_f32_16x16x64_bf16 v[56:59], v[24:27], a[248:255], v2
    v_add_f32 v53, v53, v55
    v_smfmac_f32_16x16x64_bf16 v[56:59], v[28:31], v[64:71], v2
    v_cvt_pk_bf16_f32 v52, v52, v53
    v_smfmac_f32_16x16x64_bf16 v[56:59], v[32:35], v[72:79], v2
    ds_write_b32 v3, v52 offset:10368
    v_smfmac_f32_16x16x64_bf16 v[56:59], v[36:39], v[80:87], v2
    v_mov_b64 v[44:45], 0
    v_smfmac_f32_16x16x64_bf16 v[60:63], v[12:15], v[88:95], v2
    v_mov_b64 v[46:47], 0
    v_smfmac_f32_16x16x64_bf16 v[60:63], v[16:19], v[96:103], v2
    v_smfmac_f32_16x16x64_bf16 v[60:63], v[20:23], v[104:111], v2
    v_add_f32 v56, v56, v58
    v_smfmac_f32_16x16x64_bf16 v[60:63], v[24:27], v[112:119], v2
    v_add_f32 v57, v57, v59
    v_smfmac_f32_16x16x64_bf16 v[60:63], v[28:31], v[120:127], v2
    v_cvt_pk_bf16_f32 v56, v56, v57
    v_smfmac_f32_16x16x64_bf16 v[60:63], v[32:35], v[128:135], v2
    ds_write_b32 v3, v56 offset:11392
    v_smfmac_f32_16x16x64_bf16 v[60:63], v[36:39], v[136:143], v2
    ds_write_b32 v8, v9 offset:1024
    v_smfmac_f32_16x16x64_bf16 v[40:43], v[12:15], v[144:151], v2
    v_smfmac_f32_16x16x64_bf16 v[40:43], v[16:19], v[152:159], v2
    v_smfmac_f32_16x16x64_bf16 v[40:43], v[20:23], v[160:167], v2
    v_add_f32 v60, v60, v62
    v_smfmac_f32_16x16x64_bf16 v[40:43], v[24:27], v[168:175], v2
    v_add_f32 v61, v61, v63
    v_smfmac_f32_16x16x64_bf16 v[40:43], v[28:31], v[176:183], v2
    v_cvt_pk_bf16_f32 v60, v60, v61
    v_smfmac_f32_16x16x64_bf16 v[40:43], v[32:35], v[184:191], v2
    ds_write_b32 v3, v60 offset:12416
    v_smfmac_f32_16x16x64_bf16 v[40:43], v[36:39], v[192:199], v2
    ds_write_b32 v8, v9 offset:2048
    v_smfmac_f32_16x16x64_bf16 v[44:47], v[12:15], v[200:207], v2
    v_smfmac_f32_16x16x64_bf16 v[44:47], v[16:19], v[208:215], v2
    v_smfmac_f32_16x16x64_bf16 v[44:47], v[20:23], v[216:223], v2
    v_add_f32 v40, v40, v42
    v_smfmac_f32_16x16x64_bf16 v[44:47], v[24:27], v[224:231], v2
    v_add_f32 v41, v41, v43
    v_smfmac_f32_16x16x64_bf16 v[44:47], v[28:31], v[232:239], v2
    v_cvt_pk_bf16_f32 v40, v40, v41
    v_smfmac_f32_16x16x64_bf16 v[44:47], v[32:35], v[240:247], v2
    ds_write_b32 v3, v40 offset:13440
    v_smfmac_f32_16x16x64_bf16 v[44:47], v[36:39], v[248:255], v2
    s_nop 7
    v_pk_add_f32 v[44:45], v[44:45], v[46:47]
    v_cvt_pk_bf16_f32 v44, v44, v45
    ds_write_b32 v3, v44 offset:13696
    s_waitcnt lgkmcnt(0)
    s_barrier
    s_barrier
    v_mov_b32 v12, 18432
    ds_read_b32 v12, v12
    s_waitcnt lgkmcnt(0)
    v_and_b32 v13, 0x3fffffff, v12
    v_cmp_eq_u32 vcc, v13, v9
    s_cbranch_vccnz L_again_39
    s_add_u32 s19, s19, 1
    s_add_u32 s21, s21, 8192
    s_add_u32 s22, s22, 16384
    s_add_u32 s24, s24, 28672
    s_add_u32 s25, s25, 458752
    s_add_u32 s32, s32, 64
    s_cmp_ge_u32 s19, 63
    s_cbranch_scc1 L_exit
    s_sleep 4
    s_and_b32 s26, s19, 1
    s_xor_b32 s26, s26, 1
    s_mul_i32 s26, s26, 28672
    s_add_u32 s26, s26, 40960
    s_add_u32 s27, s24, 47360
    s_mov_b32 m0, s26
    s_nop 0
    buffer_load_dwordx4 v1, s[8:11], s27 offen offset:0  lds
    buffer_load_dwordx4 v1, s[8:11], s27 offen offset:1024  lds
    buffer_load_dwordx4 v1, s[8:11], s27 offen offset:2048  lds
    buffer_load_dwordx4 v1, s[8:11], s27 offen offset:3072  lds
    s_sleep 2
    s_branch L_sc1_top_35
L_sc1_first_36:
    v_add_u32 v9, 1, v9
    s_mov_b32 s36, 1
    s_mov_b32 s28, 0
L_pm_40:
    buffer_load_dwordx4 v[12:15], v1, s[8:11], s21 offen sc1
    buffer_load_dwordx4 v[16:19], v1, s[8:11], s21 offen offset:768 sc1
    s_add_u32 s28, s28, 1
    s_waitcnt vmcnt(1)
    ds_write_b128 v1, v[12:15]
    v_max3_u32 v20, v12, v13, v14
    s_waitcnt vmcnt(0)
    ds_write_b128 v1, v[16:19] offset:768
    v_max3_u32 v20, v20, v15, v16
    v_max3_u32 v20, v20, v17, v18
    v_max_u32 v20, v20, v19
    v_cmp_eq_u32 vcc, -1, v20
    s_cbranch_vccz L_pmd_41
    s_cmp_lt_u32 s28, s29
    s_cbranch_scc1 L_pm_40
    s_mov_b32 s29, 1
L_pmd_41:
    s_waitcnt lgkmcnt(0)
    s_barrier
    s_branch L_got_38
L_again_39:
    v_mov_b64 v[40:41], 0
    v_mov_b64 v[42:43], 0
    v_mov_b64 v[44:45], 0
    v_mov_b64 v[46:47], 0
    v_mov_b64 v[48:49], 0
    v_mov_b64 v[50:51], 0
    v_mov_b64 v[52:53], 0
    v_mov_b64 v[54:55], 0
    v_mov_b64 v[56:57], 0
    v_mov_b64 v[58:59], 0
    v_mov_b64 v[60:61], 0
    v_mov_b64 v[62:63], 0
    v_cmp_eq_u32 vcc, v12, v9
    s_cbranch_vccnz L_sc1_first_36
    v_add_u32 v9, 1, v9
    s_branch L_got_38
L_sc1_n1:
    s_cmp_lg_u32 s17, 2
    s_cbranch_scc1 L_sc1_n2
    v_lshrrev_b32 v11, 1, v0
    v_min_u32 v11, 220, v11
    s_and_b32 s26, s16, 3
    s_lshl_b32 s26, s26, 8
    s_add_u32 s26, s26, 7168
    v_add_u32 v11, s26, v11
    v_add_u32 v8, 14344, v4
    v_mov_b32 v9, 0
    ds_write_b32 v8, v9 offset:0
    ds_write_b32 v8, v9 offset:1024
    ds_write_b32 v8, v9 offset:2048
    ds_write_b32 v8, v9 offset:3072
    ds_write_b32 v8, v9 offset:4096
    v_and_b32 v4, 248, v0
    v_lshlrev_b32 v4, 3, v4
    v_add_u32 v4, 4096, v4
    s_and_b32 s26, s19, 1
    s_xor_b32 s26, s26, 1
    s_mul_i32 s26, s26, 28672
    s_add_u32 s26, s26, 38912
    s_add_u32 s27, s24, 43520
    s_mov_b32 m0, s26
    s_nop 0
    buffer_load_dwordx4 v1, s[8:11], s27 offen offset:0  lds
    buffer_load_dwordx4 v1, s[8:11], s27 offen offset:1024  lds
    buffer_load_dwordx4 v1, s[8:11], s27 offen offset:2048  lds
    buffer_load_dwordx4 v1, s[8:11], s27 offen offset:3072  lds
    s_add_u32 s26, s26, 4096
    s_add_u32 s27, s27, 4096
    s_mov_b32 m0, s26
    s_nop 0
    buffer_load_dwordx4 v1, s[8:11], s27 offen offset:0  lds
    buffer_load_dwordx4 v1, s[8:11], s27 offen offset:1024  lds
    buffer_load_dwordx4 v1, s[8:11], s27 offen offset:2048  lds
    buffer_load_dwordx4 v1, s[8:11], s27 offen offset:3072  lds
    s_add_u32 s26, s26, 4096
    s_add_u32 s27, s27, 4096
    s_mov_b32 m0, s26
    s_nop 0
    buffer_load_dwordx4 v1, s[8:11], s27 offen offset:0  lds
    buffer_load_dwordx4 v1, s[8:11], s27 offen offset:1024  lds
    v_mov_b64 v[40:41], 0
    v_mov_b64 v[42:43], 0
    v_mov_b64 v[44:45], 0
    v_mov_b64 v[46:47], 0
    v_mov_b64 v[48:49], 0
    v_mov_b64 v[50:51], 0
    v_mov_b64 v[52:53], 0
    v_mov_b64 v[54:55], 0
    v_mov_b64 v[56:57], 0
    v_mov_b64 v[58:59], 0
    v_mov_b64 v[60:61], 0
    v_mov_b64 v[62:63], 0
    s_branch L_sc2_first_43
    .p2align 6
L_sc2_top_42:
    v_mov_b64 v[40:41], 0
    v_mov_b64 v[42:43], 0
    v_mov_b64 v[44:45], 0
    v_mov_b64 v[46:47], 0
    v_mov_b64 v[48:49], 0
    v_mov_b64 v[50:51], 0
    v_mov_b64 v[52:53], 0
    v_mov_b64 v[54:55], 0
    v_mov_b64 v[56:57], 0
    v_mov_b64 v[58:59], 0
    v_mov_b64 v[60:61], 0
    v_mov_b64 v[62:63], 0
    s_mov_b32 m0, 2048
    s_sub_u32 s26, s21, 1536
    s_add_u32 s27, s26, 4096
    s_barrier
    buffer_load_dwordx4 v1, s[8:11], s26 offen sc1 lds
    v_add_u32 v9, 1, v9
    s_mov_b32 s36, 0
    s_mov_b32 s28, 1
    s_mov_b32 m0, 6144
    s_nop 4
    buffer_load_dwordx4 v1, s[8:11], s27 offen sc1 lds
    s_waitcnt vmcnt(1) lgkmcnt(0)
    s_barrier
L_got_45:
    ds_read_b64_tr_b16 v[12:13], v0 offset:0
    ds_read_b64_tr_b16 v[14:15], v0 offset:512
    ds_read_b64_tr_b16 v[16:17], v0 offset:1024
    ds_read_b64_tr_b16 v[18:19], v0 offset:1536
    ds_read_b64_tr_b16 v[20:21], v0 offset:2048
    s_waitcnt vmcnt(0)
    s_barrier
L_dry_44:
    s_waitcnt lgkmcnt(3)
    v_smfmac_f32_16x16x64_bf16 v[40:43], v[12:15], a[0:7], v2
    ds_read_b64_tr_b16 v[22:23], v0 offset:2560
    v_smfmac_f32_16x16x64_bf16 v[44:47], v[12:15], a[56:63], v2
    ds_read_b64_tr_b16 v[24:25], v0 offset:3072
    s_waitcnt lgkmcnt(3)
    v_smfmac_f32_16x16x64_bf16 v[40:43], v[16:19], a[8:15], v2
    ds_read_b64_tr_b16 v[26:27], v0 offset:3584
    v_smfmac_f32_16x16x64_bf16 v[44:47], v[16:19], a[64:71], v2
    ds_read_b64_tr_b16 v[28:29], v0 offset:4096
    s_waitcnt lgkmcnt(3)
    v_smfmac_f32_16x16x64_bf16 v[40:43], v[20:23], a[16:23], v2
    ds_read_b64_tr_b16 v[30:31], v0 offset:4608
    v_smfmac_f32_16x16x64_bf16 v[44:47], v[20:23], a[72:79], v2
    ds_read_b64_tr_b16 v[32:33], v0 offset:5120
    s_waitcnt lgkmcnt(3)
    v_smfmac_f32_16x16x64_bf16 v[40:43], v[24:27], a[24:31], v2
    ds_read_b64_tr_b16 v[34:35], v0 offset:5632
    v_smfmac_f32_16x16x64_bf16 v[44:47], v[24:27], a[80:87], v2
    ds_read_b64_tr_b16 v[36:37], v0 offset:6144
    s_waitcnt lgkmcnt(3)
    v_smfmac_f32_16x16x64_bf16 v[40:43], v[28:31], a[32:39], v2
    ds_read_b64_tr_b16 v[38:39], v0 offset:6656
    v_smfmac_f32_16x16x64_bf16 v[44:47], v[28:31], a[88:95], v2
    s_waitcnt lgkmcnt(2)
    v_smfmac_f32_16x16x64_bf16 v[40:43], v[32:35], a[40:47], v2
    v_smfmac_f32_16x16x64_bf16 v[44:47], v[32:35], a[96:103], v2
    s_waitcnt lgkmcnt(0)
    v_smfmac_f32_16x16x64_bf16 v[40:43], v[36:39], a[48:55], v2
    v_smfmac_f32_16x16x64_bf16 v[44:47], v[36:39], a[104:111], v2
    v_smfmac_f32_16x16x64_bf16 v[48:51], v[12:15], a[112:119], v2
    v_smfmac_f32_16x16x64_bf16 v[48:51], v[16:19], a[120:127], v2
    v_add_f32 v40, v40, v42
    v_smfmac_f32_16x16x64_bf16 v[48:51], v[20:23], a[128:135], v2
    v_add_f32 v41, v41, v43
    v_smfmac_f32_16x16x64_bf16 v[48:51], v[24:27], a[136:143], v2
    v_cvt_pk_bf16_f32 v40, v40, v41
    v_smfmac_f32_16x16x64_bf16 v[48:51], v[28:31], a[144:151], v2
    ds_write_b32 v3, v40 offset:7424
    v_smfmac_f32_16x16x64_bf16 v[48:51], v[32:35], a[152:159], v2
    v_add_f32 v44, v44, v46
    v_smfmac_f32_16x16x64_bf16 v[48:51], v[36:39], a[160:167], v2
    v_add_f32 v45, v45, v47
    v_smfmac_f32_16x16x64_bf16 v[52:55], v[12:15], a[168:175], v2
    v_cvt_pk_bf16_f32 v44, v44, v45
    v_smfmac_f32_16x16x64_bf16 v[52:55], v[16:19], a[176:183], v2
    ds_write_b32 v3, v44 offset:8448
    v_smfmac_f32_16x16x64_bf16 v[52:55], v[20:23], a[184:191], v2
    v_add_f32 v48, v48, v50
    v_smfmac_f32_16x16x64_bf16 v[52:55], v[24:27], a[192:199], v2
    v_add_f32 v49, v49, v51
    v_smfmac_f32_16x16x64_bf16 v[52:55], v[28:31], a[200:207], v2
    v_cvt_pk_bf16_f32 v48, v48, v49
    v_smfmac_f32_16x16x64_bf16 v[52:55], v[32:35], a[208:215], v2
    ds_write_b32 v3, v48 offset:9472
    v_smfmac_f32_16x16x64_bf16 v[52:55], v[36:39], a[216:223], v2
    ds_write_b32 v8, v9 offset:0
    v_smfmac_f32_16x16x64_bf16 v[56:59], v[12:15], a[224:231], v2
    v_mov_b64 v[40:41], 0
    v_smfmac_f32_16x16x64_bf16 v[56:59], v[16:19], a[232:239], v2
    v_mov_b64 v[42:43], 0
    v_smfmac_f32_16x16x64_bf16 v[56:59], v[20:23], a[240:247], v2
    v_add_f32 v52, v52, v54
    v_smfmac_f32_16x16x64_bf16 v[56:59], v[24:27], a[248:255], v2
    v_add_f32 v53, v53, v55
    v_smfmac_f32_16x16x64_bf16 v[56:59], v[28:31], v[64:71], v2
    v_cvt_pk_bf16_f32 v52, v52, v53
    v_smfmac_f32_16x16x64_bf16 v[56:59], v[32:35], v[72:79], v2
    ds_write_b32 v3, v52 offset:10496
    v_smfmac_f32_16x16x64_bf16 v[56:59], v[36:39], v[80:87], v2
    v_smfmac_f32_16x16x64_bf16 v[60:63], v[12:15], v[88:95], v2
    v_smfmac_f32_16x16x64_bf16 v[60:63], v[16:19], v[96:103], v2
    v_smfmac_f32_16x16x64_bf16 v[60:63], v[20:23], v[104:111], v2
    v_add_f32 v56, v56, v58
    v_smfmac_f32_16x16x64_bf16 v[60:63], v[24:27], v[112:119], v2
    v_add_f32 v57, v57, v59
    v_smfmac_f32_16x16x64_bf16 v[60:63], v[28:31], v[120:127], v2
    v_cvt_pk_bf16_f32 v56, v56, v57
    v_smfmac_f32_16x16x64_bf16 v[60:63], v[32:35], v[128:135], v2
    ds_write_b32 v3, v56 offset:11520
    v_smfmac_f32_16x16x64_bf16 v[60:63], v[36:39], v[136:143], v2
    ds_write_b32 v8, v9 offset:1024
    v_smfmac_f32_16x16x64_bf16 v[40:43], v[12:15], v[144:151], v2
    v_smfmac_f32_16x16x64_bf16 v[40:43], v[16:19], v[152:159], v2
    v_smfmac_f32_16x16x64_bf16 v[40:43], v[20:23], v[160:167], v2
    v_add_f32 v60, v60, v62
    v_smfmac_f32_16x16x64_bf16 v[40:43], v[24:27], v[168:175], v2
    v_add_f32 v61, v61, v63
    v_smfmac_f32_16x16x64_bf16 v[40:43], v[28:31], v[176:183], v2
    v_cvt_pk_bf16_f32 v60, v60, v61
    v_smfmac_f32_16x16x64_bf16 v[40:43], v[32:35], v[184:191], v2
    ds_write_b32 v3, v60 offset:12544
    v_smfmac_f32_16x16x64_bf16 v[40:43], v[36:39], v[192:199], v2
    s_nop 7
    v_pk_add_f32 v[40:41], v[40:41], v[42:43]
    v_cvt_pk_bf16_f32 v40, v40, v41
    ds_write_b32 v3, v40 offset:12672
    ds_write_b32 v8, v9 offset:2048
    s_and_b32 s26, s19, 1
    s_xor_b32 s26, s26, 0
    s_mul_i32 s26, s26, 28672
    s_add_u32 s26, s26, 20480
    s_add_u32 s27, s24, 53760
    s_mov_b32 m0, s26
    s_nop 0
    buffer_load_dwordx4 v1, s[8:11], s27 offen offset:0  lds
    buffer_load_dwordx4 v1, s[8:11], s27 offen offset:1024  lds
    buffer_load_dwordx4 v1, s[8:11], s27 offen offset:2048  lds
    buffer_load_dwordx4 v1, s[8:11], s27 offen offset:3072  lds
    s_waitcnt lgkmcnt(0)
    s_barrier
    s_and_b32 s26, s19, 1
    s_xor_b32 s26, s26, 0
    s_mul_i32 s26, s26, 28672
    s_add_u32 s26, s26, 24576
    s_add_u32 s27, s24, 57856
    s_mov_b32 m0, s26
    s_nop 0
    buffer_load_dwordx4 v1, s[8:11], s27 offen offset:0  lds
    buffer_load_dwordx4 v1, s[8:11], s27 offen offset:1024  lds
    buffer_load_dwordx4 v1, s[8:11], s27 offen offset:2048  lds
    buffer_load_dwordx4 v1, s[8:11], s27 offen offset:3072  lds
    s_add_u32 s26, s26, 4096
    s_add_u32 s27, s27, 4096
    s_mov_b32 m0, s26
    s_nop 0
    buffer_load_dwordx4 v1, s[8:11], s27 offen offset:0  lds
    buffer_load_dwordx4 v1, s[8:11], s27 offen offset:1024  lds
    buffer_load_dwordx4 v1, s[8:11], s27 offen offset:2048  lds
    buffer_load_dwordx4 v1, s[8:11], s27 offen offset:3072  lds
    s_add_u32 s26, s26, 4096
    s_add_u32 s27, s27, 4096
    s_mov_b32 m0, s26
    s_nop 0
    buffer_load_dwordx4 v1, s[8:11], s27 offen offset:0  lds
    buffer_load_dwordx4 v1, s[8:11], s27 offen offset:1024  lds
    buffer_load_dwordx4 v1, s[8:11], s27 offen offset:2048  lds
    buffer_load_dwordx4 v1, s[8:11], s27 offen offset:3072  lds
    s_add_u32 s26, s26, 4096
    s_add_u32 s27, s27, 4096
    s_mov_b32 m0, s26
    s_nop 0
    buffer_load_dwordx4 v1, s[8:11], s27 offen offset:0  lds
    buffer_load_dwordx4 v1, s[8:11], s27 offen offset:1024  lds
    buffer_load_dwordx4 v1, s[8:11], s27 offen offset:2048  lds
    buffer_load_dwordx4 v1, s[8:11], s27 offen offset:3072  lds
    s_barrier
    v_mov_b32 v12, 18432
    ds_read_b32 v12, v12
    s_waitcnt lgkmcnt(0)
    v_and_b32 v13, 0x3fffffff, v12
    v_cmp_eq_u32 vcc, v13, v9
    s_cbranch_vccnz L_again_46
    s_add_u32 s19, s19, 1
    s_add_u32 s21, s21, 8192
    s_add_u32 s22, s22, 16384
    s_add_u32 s24, s24, 28672
    s_add_u32 s25, s25, 458752
    s_add_u32 s32, s32, 64
    s_cmp_ge_u32 s19, 63
    s_cbranch_scc1 L_exit
    s_sleep 4
    s_and_b32 s26, s19, 1
    s_xor_b32 s26, s26, 1
    s_mul_i32 s26, s26, 28672
    s_add_u32 s26, s26, 45056
    s_add_u32 s27, s24, 49664
    s_mov_b32 m0, s26
    s_nop 0
    buffer_load_dwordx4 v1, s[8:11], s27 offen offset:0  lds
    buffer_load_dwordx4 v1, s[8:11], s27 offen offset:1024  lds
    buffer_load_dwordx4 v1, s[8:11], s27 offen offset:2048  lds
    buffer_load_dwordx4 v1, s[8:11], s27 offen offset:3072  lds
    s_sleep 2
    s_branch L_sc2_top_42
L_sc2_first_43:
    v_add_u32 v9, 1, v9
    s_mov_b32 s36, 1
    s_mov_b32 s28, 0
L_pm_47:
    buffer_load_dwordx4 v[12:15], v1, s[8:11], s21 offen sc1
    buffer_load_dwordx4 v[16:19], v1, s[8:11], s21 offen offset:768 sc1
    s_add_u32 s28, s28, 1
    s_waitcnt vmcnt(1)
    ds_write_b128 v1, v[12:15]
    v_max3_u32 v20, v12, v13, v14
    s_waitcnt vmcnt(0)
    ds_write_b128 v1, v[16:19] offset:768
    v_max3_u32 v20, v20, v15, v16
    v_max3_u32 v20, v20, v17, v18
    v_max_u32 v20, v20, v19
    v_cmp_eq_u32 vcc, -1, v20
    s_cbranch_vccz L_pmd_48
    s_cmp_lt_u32 s28, s29
    s_cbranch_scc1 L_pm_47
    s_mov_b32 s29, 1
L_pmd_48:
    s_waitcnt lgkmcnt(0)
    s_barrier
    s_branch L_got_45
L_again_46:
    v_mov_b64 v[40:41], 0
    v_mov_b64 v[42:43], 0
    v_mov_b64 v[44:45], 0
    v_mov_b64 v[46:47], 0
    v_mov_b64 v[48:49], 0
    v_mov_b64 v[50:51], 0
    v_mov_b64 v[52:53], 0
    v_mov_b64 v[54:55], 0
    v_mov_b64 v[56:57], 0
    v_mov_b64 v[58:59], 0
    v_mov_b64 v[60:61], 0
    v_mov_b64 v[62:63], 0
    v_cmp_eq_u32 vcc, v12, v9
    s_cbranch_vccnz L_sc2_first_43
    v_add_u32 v9, 1, v9
    s_branch L_got_45
L_sc1_n2:
    v_lshrrev_b32 v11, 1, v0
    v_min_u32 v11, 220, v11
    s_and_b32 s26, s16, 3
    s_lshl_b32 s26, s26, 8
    s_add_u32 s26, s26, 7168
    v_add_u32 v11, s26, v11
    v_and_b32 v252, 120, v0
    v_lshlrev_b32 v252, 3, v252
    v_add_u32 v252, 6144, v252
    s_mov_b32 s23, 0
    s_lshl_b32 s26, s16, 2
    s_add_u32 s26, s26, 12288
    v_lshlrev_b32 v254, 4, v0
    v_add_u32 v254, s26, v254
    v_mov_b32 v255, 0
    v_mov_b64 v[40:41], 0
    v_mov_b64 v[42:43], 0
    v_mov_b64 v[44:45], 0
    v_mov_b64 v[46:47], 0
    v_mov_b64 v[48:49], 0
    v_mov_b64 v[50:51], 0
    v_mov_b64 v[52:53], 0
    v_mov_b64 v[54:55], 0
    v_mov_b64 v[56:57], 0
    v_mov_b64 v[58:59], 0
    v_mov_b64 v[228:229], 0
    v_mov_b64 v[230:231], 0
    v_mov_b64 v[232:233], 0
    v_mov_b64 v[234:235], 0
    v_mov_b32 v236, v10
    v_mov_b32 v237, v10
    v_mov_b64 v[238:239], 0
    s_branch L_sc3_first_50
    .p2align 6
    s_nop 0
    s_nop 0
    s_nop 0
    s_nop 0
    s_nop 0
L_sc3_top_49:
    v_mov_b64 v[40:41], 0
    v_mov_b64 v[42:43], 0
    v_mov_b64 v[44:45], 0
    v_mov_b64 v[46:47], 0
    v_mov_b64 v[48:49], 0
    v_mov_b64 v[50:51], 0
    v_mov_b64 v[52:53], 0
    v_mov_b64 v[54:55], 0
    v_mov_b64 v[56:57], 0
    v_mov_b64 v[58:59], 0
    v_mov_b64 v[228:229], 0
    v_mov_b64 v[230:231], 0
    v_mov_b64 v[232:233], 0
    v_mov_b64 v[234:235], 0
    v_mov_b32 v236, v10
    v_mov_b32 v237, v10
    v_mov_b64 v[238:239], 0
    s_mov_b32 m0, 3072
    s_sub_u32 s26, s21, 2304
    s_add_u32 s27, s26, 4096
    s_barrier
    buffer_load_dwordx4 v1, s[8:11], s26 offen sc1 lds
    s_add_u32 s23, s23, 1
    s_mov_b32 s36, 0
    s_mov_b32 s28, 1
    s_mov_b32 m0, 7168
    s_waitcnt vmcnt(0) lgkmcnt(0)
    s_barrier
L_got_52:
    ds_read_b64_tr_b16 v[12:13], v0 offset:0
    ds_read_b64_tr_b16 v[14:15], v0 offset:512
    ds_read_b64_tr_b16 v[16:17], v0 offset:1024
    ds_read_b64_tr_b16 v[18:19], v0 offset:1536
    ds_read_b64_tr_b16 v[20:21], v0 offset:2048
    s_waitcnt vmcnt(0)
    s_barrier
L_dry_51:
    s_waitcnt lgkmcnt(3)
    v_smfmac_f32_16x16x64_bf16 v[40:43], v[12:15], a[0:7], v2
    ds_read_b64_tr_b16 v[22:23], v0 offset:2560
    v_smfmac_f32_16x16x64_bf16 v[44:47], v[12:15], a[56:63], v2
    ds_read_b64_tr_b16 v[24:25], v0 offset:3072
    s_waitcnt lgkmcnt(3)
    v_smfmac_f32_16x16x64_bf16 v[40:43], v[16:19], a[8:15], v2
    ds_read_b64_tr_b16 v[26:27], v0 offset:3584
    v_smfmac_f32_16x16x64_bf16 v[44:47], v[16:19], a[64:71], v2
    ds_read_b64_tr_b16 v[28:29], v0 offset:4096
    s_waitcnt lgkmcnt(3)
    v_smfmac_f32_16x16x64_bf16 v[40:43], v[20:23], a[16:23], v2
    ds_read_b64_tr_b16 v[30:31], v0 offset:4608
    v_smfmac_f32_16x16x64_bf16 v[44:47], v[20:23], a[72:79], v2
    ds_read_b64_tr_b16 v[32:33], v0 offset:5120
    s_waitcnt lgkmcnt(3)
    v_smfmac_f32_16x16x64_bf16 v[40:43], v[24:27], a[24:31], v2
    ds_read_b64_tr_b16 v[34:35], v0 offset:5632
    v_smfmac_f32_16x16x64_bf16 v[44:47], v[24:27], a[80:87], v2
    ds_read_b64_tr_b16 v[36:37], v0 offset:6144
    s_waitcnt lgkmcnt(3)
    v_smfmac_f32_16x16x64_bf16 v[40:43], v[28:31], a[32:39], v2
    ds_read_b64_tr_b16 v[38:39], v0 offset:6656
    v_smfmac_f32_16x16x64_bf16 v[44:47], v[28:31], a[88:95], v2
    s_waitcnt lgkmcnt(2)
    v_smfmac_f32_16x16x64_bf16 v[40:43], v[32:35], a[40:47], v2
    v_smfmac_f32_16x16x64_bf16 v[44:47], v[32:35], a[96:103], v2
    s_waitcnt lgkmcnt(0)
    v_smfmac_f32_16x16x64_bf16 v[40:43], v[36:39], a[48:55], v2
    v_smfmac_f32_16x16x64_bf16 v[44:47], v[36:39], a[104:111], v2
    v_smfmac_f32_16x16x64_bf16 v[48:51], v[12:15], a[112:119], v2
    v_smfmac_f32_16x16x64_bf16 v[48:51], v[16:19], a[120:127], v2
    v_add_f32 v40, v40, v42
    v_smfmac_f32_16x16x64_bf16 v[48:51], v[20:23], a[128:135], v2
    v_add_f32 v41, v41, v43
    v_smfmac_f32_16x16x64_bf16 v[48:51], v[24:27], a[136:143], v2
    v_cvt_pk_bf16_f32 v40, v40, v41
    v_smfmac_f32_16x16x64_bf16 v[48:51], v[28:31], a[144:151], v2
    ds_write_b32 v3, v40 offset:7552
    v_smfmac_f32_16x16x64_bf16 v[48:51], v[32:35], a[152:159], v2
    v_add_f32 v44, v44, v46
    v_smfmac_f32_16x16x64_bf16 v[48:51], v[36:39], a[160:167], v2
    v_add_f32 v45, v45, v47
    v_smfmac_f32_16x16x64_bf16 v[52:55], v[12:15], a[168:175], v2
    v_cvt_pk_bf16_f32 v44, v44, v45
    v_smfmac_f32_16x16x64_bf16 v[52:55], v[16:19], a[176:183], v2
    ds_write_b32 v3, v44 offset:8576
    v_smfmac_f32_16x16x64_bf16 v[52:55], v[20:23], a[184:191], v2
    v_add_f32 v48, v48, v50
    v_smfmac_f32_16x16x64_bf16 v[52:55], v[24:27], a[192:199], v2
    v_add_f32 v49, v49, v51
    v_smfmac_f32_16x16x64_bf16 v[52:55], v[28:31], a[200:207], v2
    v_cvt_pk_bf16_f32 v48, v48, v49
    v_smfmac_f32_16x16x64_bf16 v[52:55], v[32:35], a[208:215], v2
    ds_write_b32 v3, v48 offset:9600
    v_smfmac_f32_16x16x64_bf16 v[52:55], v[36:39], a[216:223], v2
    v_cmp_u_f32 vcc, v41, v42
    v_smfmac_f32_16x16x64_bf16 v[56:59], v[12:15], a[224:231], v2
    s_cbranch_vccnz L_eb_53
L_ec_54:
    v_smfmac_f32_16x16x64_bf16 v[56:59], v[16:19], a[232:239], v2
    v_smfmac_f32_16x16x64_bf16 v[56:59], v[20:23], a[240:247], v2
    v_add_f32 v52, v52, v54
    v_smfmac_f32_16x16x64_bf16 v[56:59], v[24:27], a[248:255], v2
    ds_read_b128 v[240:243], v4 offset:14336
    ds_read_b64_tr_b16 v[200:201], v0 offset:7168
    v_add_f32 v53, v53, v55
    v_smfmac_f32_16x16x64_bf16 v[56:59], v[28:31], v[64:71], v2
    ds_read_b64_tr_b16 v[202:203], v0 offset:7680
    ds_read_b64_tr_b16 v[204:205], v0 offset:8192
    v_cvt_pk_bf16_f32 v52, v52, v53
    v_smfmac_f32_16x16x64_bf16 v[56:59], v[32:35], v[72:79], v2
    ds_write_b32 v3, v52 offset:10624
    ds_read_b64_tr_b16 v[206:207], v0 offset:8704
    ds_read_b64_tr_b16 v[208:209], v0 offset:9216
    v_smfmac_f32_16x16x64_bf16 v[56:59], v[36:39], v[80:87], v2
    ds_read_b64_tr_b16 v[210:211], v0 offset:9728
    s_waitcnt lgkmcnt(5)
    v_mfma_f32_16x16x32_bf16 v[236:239], v[200:203], v[12:15], v[236:239]
    v_min3_u32 v251, v240, v241, v242
    v_smfmac_f32_16x16x64_bf16 v[228:231], v[200:203], v[88:95], v2
    v_smfmac_f32_16x16x64_bf16 v[232:235], v[200:203], v[144:151], v2
    v_add_f32 v56, v56, v58
    s_waitcnt lgkmcnt(2)
    v_mfma_f32_16x16x32_bf16 v[236:239], v[204:207], v[16:19], v[236:239]
    v_add_f32 v57, v57, v59
    v_smfmac_f32_16x16x64_bf16 v[228:231], v[204:207], v[96:103], v2
    v_cvt_pk_bf16_f32 v56, v56, v57
    v_smfmac_f32_16x16x64_bf16 v[232:235], v[204:207], v[152:159], v2
    ds_write_b32 v3, v56 offset:11648
    s_waitcnt lgkmcnt(1)
    v_mfma_f32_16x16x32_bf16 v[236:239], v[208:211], v[20:23], v[236:239]
    v_smfmac_f32_16x16x64_bf16 v[228:231], v[208:211], v[104:111], v2
    v_smfmac_f32_16x16x64_bf16 v[232:235], v[208:211], v[160:167], v2
    s_nop 7
    ds_read_b128 v[240:243], v4 offset:15360
    ds_read_b64_tr_b16 v[212:213], v0 offset:10240
    ds_read_b64_tr_b16 v[214:215], v0 offset:10752
    ds_read_b64_tr_b16 v[216:217], v0 offset:11264
    ds_read_b64_tr_b16 v[218:219], v0 offset:11776
    s_waitcnt lgkmcnt(2)
    v_mfma_f32_16x16x32_bf16 v[236:239], v[212:215], v[24:27], v[236:239]
    v_min3_u32 v240, v240, v241, v242
    v_min_u32 v251, v251, v240
    v_smfmac_f32_16x16x64_bf16 v[228:231], v[212:215], v[112:119], v2
    v_smfmac_f32_16x16x64_bf16 v[232:235], v[212:215], v[168:175], v2
    s_waitcnt lgkmcnt(0)
    v_mfma_f32_16x16x32_bf16 v[236:239], v[216:219], v[28:31], v[236:239]
    v_smfmac_f32_16x16x64_bf16 v[228:231], v[216:219], v[120:127], v2
    v_smfmac_f32_16x16x64_bf16 v[232:235], v[216:219], v[176:183], v2
    v_mov_b64 v[206:207], 0
    v_mov_b64 v[208:209], 0
    v_mov_b32 v211, 0
    v_mov_b32 v203, 0
    s_nop 3
    s_nop 3
    ds_read_b128 v[240:243], v4 offset:16384
    ds_read_b64_tr_b16 v[220:221], v0 offset:12288
    ds_read_b64_tr_b16 v[222:223], v0 offset:12800
    s_barrier
    ds_read_b64_tr_b16 v[224:225], v0 offset:13312
    ds_read_b64_tr_b16 v[226:227], v0 offset:13824
    s_waitcnt lgkmcnt(2)
    v_mfma_f32_16x16x32_bf16 v[236:239], v[220:223], v[32:35], v[236:239]
    v_min3_u32 v240, v240, v241, v242
    v_smfmac_f32_16x16x64_bf16 v[228:231], v[220:223], v[128:135], v2
    v_min_u32 v251, v251, v240
    v_smfmac_f32_16x16x64_bf16 v[232:235], v[220:223], v[184:191], v2
    v_subrev_u32 v251, s23, v251
    s_waitcnt lgkmcnt(0)
    v_mfma_f32_16x16x32_bf16 v[236:239], v[224:227], v[36:39], v[236:239]
    v_smfmac_f32_16x16x64_bf16 v[228:231], v[224:227], v[136:143], v2
    v_smfmac_f32_16x16x64_bf16 v[232:235], v[224:227], v[192:199], v2
    s_mov_b32 s27, 1006632960
    s_mov_b32 s28, 0
    v_add_f32_dpp v244, v238, v236 quad_perm:[2,3,0,1] row_mask:0xf bank_mask:0xf
    v_add_f32_dpp v245, v239, v237 quad_perm:[2,3,0,1] row_mask:0xf bank_mask:0xf
    s_nop 0
    v_pk_add_f32 v[240:241], v[228:229], v[230:231]
    v_exp_f32 v236, v244
    v_exp_f32 v237, v245
    v_pk_add_f32 v[242:243], v[232:233], v[234:235]
    v_exp_f32 v228, v240
    v_exp_f32 v229, v241
    v_exp_f32 v230, v242
    v_exp_f32 v231, v243
L_smr_55:
    v_pk_add_f32 v[248:249], v[228:229], v[236:237]
    v_cvt_pk_bf16_f32 v202, v236, v237
    v_pk_add_f32 v[248:249], v[248:249], v[230:231]
    v_cvt_pk_bf16_f32 v200, v228, v229
    s_nop 0
    v_add_f32_dpp v248, v248, v248 row_ror:8 row_mask:0xf bank_mask:0xf
    v_add_f32_dpp v249, v249, v249 row_ror:8 row_mask:0xf bank_mask:0xf
    v_cvt_pk_bf16_f32 v201, v230, v231
    v_add_f32_dpp v248, v248, v248 row_ror:4 row_mask:0xf bank_mask:0xf
    v_add_f32_dpp v249, v249, v249 row_ror:4 row_mask:0xf bank_mask:0xf
    s_nop 0
    v_add_f32_dpp v248, v248, v248 row_ror:2 row_mask:0xf bank_mask:0xf
    v_add_f32_dpp v249, v249, v249 row_ror:2 row_mask:0xf bank_mask:0xf
    s_nop 0
    v_add_f32_dpp v248, v248, v248 row_ror:1 row_mask:0xf bank_mask:0xf
    v_add_f32_dpp v249, v249, v249 row_ror:1 row_mask:0xf bank_mask:0xf
    v_rcp_f32 v246, v248
    v_rcp_f32 v247, v249
    v_subrev_u32 v248, 562036736, v248
    v_cvt_pk_bf16_f32 v250, v246, v247
    v_and_b32 v204, v250, v7
    v_and_b32 v205, v250, v8
    v_and_b32 v210, v250, v9
    v_subrev_u32 v249, 562036736, v249
    v_mfma_f32_16x16x32_bf16 v[212:215], v[200:203], v[204:207], 0
    v_mfma_f32_16x16x32_bf16 v[216:219], v[200:203], v[208:211], 0
    v_max3_u32 v248, v248, v249, v251
    v_cmp_lt_u32 vcc, s27, v248
    s_or_b64 vcc, vcc, s[34:35]
    s_cselect_b64 exec, 0, -1
    s_nop 0
    v_cvt_pk_bf16_f32 v212, v212, v213
    v_cvt_pk_bf16_f32 v213, v214, v215
    buffer_store_dwordx2 v[212:213], v5, s[8:11], s22 offen
    v_cvt_pk_bf16_f32 v216, v216, v217
    buffer_store_dword v216, v6, s[8:11], s22 offen
    s_mov_b64 exec, -1
    s_cbranch_scc1 L_sms_56
    s_barrier
    s_add_u32 s19, s19, 1
    s_add_u32 s21, s21, 8192
    s_add_u32 s22, s22, 16384
    s_add_u32 s24, s24, 28672
    s_add_u32 s25, s25, 458752
    s_add_u32 s32, s32, 64
    s_cmp_ge_u32 s19, 63
    s_cbranch_scc1 L_exit
    s_and_b32 s26, s19, 1
    s_mul_i32 s26, s26, 28672
    v_add_u32 v240, s26, v4
    ds_read_b128 v[88:91], v240 offset:20480
    ds_read_b128 v[92:95], v240 offset:21504
    ds_read_b128 v[96:99], v240 offset:22528
    ds_read_b128 v[100:103], v240 offset:23552
    ds_read_b128 v[104:107], v240 offset:24576
    ds_read_b128 v[108:111], v240 offset:25600
    ds_read_b128 v[112:115], v240 offset:26624
    ds_read_b128 v[116:119], v240 offset:27648
    ds_read_b128 v[120:123], v240 offset:28672
    ds_read_b128 v[124:127], v240 offset:29696
    ds_read_b128 v[128:131], v240 offset:30720
    ds_read_b128 v[132:135], v240 offset:31744
    ds_read_b128 v[136:139], v240 offset:32768
    ds_read_b128 v[140:143], v240 offset:33792
    ds_read_b128 v[144:147], v240 offset:34816
    ds_read_b128 v[148:151], v240 offset:35840
    ds_read_b128 v[152:155], v240 offset:36864
    ds_read_b128 v[156:159], v240 offset:37888
    ds_read_b128 v[160:163], v240 offset:38912
    ds_read_b128 v[164:167], v240 offset:39936
    ds_read_b128 v[168:171], v240 offset:40960
    ds_read_b128 v[172:175], v240 offset:41984
    ds_read_b128 v[176:179], v240 offset:43008
    ds_read_b128 v[180:183], v240 offset:44032
    ds_read_b128 v[184:187], v240 offset:45056
    ds_read_b128 v[188:191], v240 offset:46080
    ds_read_b128 v[192:195], v240 offset:47104
    ds_read_b128 v[196:199], v240 offset:48128
    s_branch L_sc3_top_49
L_sc3_first_50:
    s_add_u32 s23, s23, 1
    s_mov_b32 s36, 1
    s_mov_b32 s28, 0
L_pm_58:
    buffer_load_dwordx4 v[12:15], v1, s[8:11], s21 offen sc1
    buffer_load_dwordx4 v[16:19], v1, s[8:11], s21 offen offset:768 sc1
    s_add_u32 s28, s28, 1
    s_waitcnt vmcnt(1)
    ds_write_b128 v1, v[12:15]
    v_max3_u32 v20, v12, v13, v14
    s_waitcnt vmcnt(0)
    ds_write_b128 v1, v[16:19] offset:768
    v_max3_u32 v20, v20, v15, v16
    v_max3_u32 v20, v20, v17, v18
    v_max_u32 v20, v20, v19
    v_cmp_eq_u32 vcc, -1, v20
    s_cbranch_vccz L_pmd_59
    s_cmp_lt_u32 s28, s29
    s_cbranch_scc1 L_pm_58
    s_mov_b32 s29, 1
L_pmd_59:
    s_waitcnt lgkmcnt(0)
    s_barrier
    s_branch L_got_52
L_eb_53:
    s_cmp_lg_u32 s36, 0
    s_cbranch_scc1 L_ec_54
    s_mov_b32 s28, 0
L_el_60:
    s_mov_b32 s26, s21
    buffer_load_dwordx4 v[200:203], v4, s[8:11], s26 offen offset:0 sc1
    buffer_load_dwordx4 v[204:207], v4, s[8:11], s26 offen offset:1024 sc1
    buffer_load_dwordx4 v[208:211], v4, s[8:11], s26 offen offset:2048 sc1
    buffer_load_dwordx4 v[212:215], v4, s[8:11], s26 offen offset:3072 sc1
    s_add_u32 s26, s26, 4096
    buffer_load_dwordx4 v[216:219], v4, s[8:11], s26 offen offset:0 sc1
    buffer_load_dwordx4 v[220:223], v4, s[8:11], s26 offen offset:1024 sc1
    buffer_load_dwordx4 v[224:227], v4, s[8:11], s26 offen offset:2048 sc1
    s_add_u32 s28, s28, 1
    s_waitcnt vmcnt(0)
    v_max_u32 v240, v200, v201
    v_max3_u32 v240, v240, v202, v203
    v_max3_u32 v240, v240, v204, v205
    v_max3_u32 v240, v240, v206, v207
    v_max3_u32 v240, v240, v208, v209
    v_max3_u32 v240, v240, v210, v211
    v_max3_u32 v240, v240, v212, v213
    v_max3_u32 v240, v240, v214, v215
    v_max3_u32 v240, v240, v216, v217
    v_max3_u32 v240, v240, v218, v219
    v_max3_u32 v240, v240, v220, v221
    v_max3_u32 v240, v240, v222, v223
    v_max3_u32 v240, v240, v224, v225
    v_max3_u32 v240, v240, v226, v227
    v_cmp_eq_u32 vcc, -1, v240
    s_cbranch_vccz L_ed_61
    s_cmp_lt_u32 s28, s29
    s_cbranch_scc1 L_el_60
    s_mov_b32 s29, 1
L_ed_61:
    ds_write_b128 v4, v[200:203] offset:0
    ds_write_b128 v4, v[204:207] offset:1024
    ds_write_b128 v4, v[208:211] offset:2048
    ds_write_b128 v4, v[212:215] offset:3072
    ds_write_b128 v4, v[216:219] offset:4096
    ds_write_b128 v4, v[220:223] offset:5120
    ds_write_b128 v4, v[224:227] offset:6144
    s_or_b32 s26, s23, 0x40000000
    v_mov_b32 v240, 18432
    v_mov_b32 v241, s26
    ds_write_b32 v240, v241
    v_mov_b64 v[40:41], 0
    v_mov_b64 v[42:43], 0
    v_mov_b64 v[44:45], 0
    v_mov_b64 v[46:47], 0
    v_mov_b64 v[48:49], 0
    v_mov_b64 v[50:51], 0
    v_mov_b64 v[52:53], 0
    v_mov_b64 v[54:55], 0
    v_mov_b64 v[56:57], 0
    v_mov_b64 v[58:59], 0
    v_mov_b64 v[228:229], 0
    v_mov_b64 v[230:231], 0
    v_mov_b64 v[232:233], 0
    v_mov_b64 v[234:235], 0
    v_mov_b32 v236, v10
    v_mov_b32 v237, v10
    v_mov_b64 v[238:239], 0
    s_add_u32 s23, s23, 1
    s_mov_b32 s36, 1
    s_waitcnt lgkmcnt(0)
    s_barrier
    s_barrier
    s_branch L_got_52
L_sms_56:
    s_cmp_lg_u32 s34, 0
    s_mov_b64 s[34:35], 0
    s_cbranch_scc1 L_vd_64
    s_cmp_eq_u32 s28, 0
    s_cbranch_scc1 L_loc_62
    s_cmp_lg_u32 s36, 0
    s_cbranch_scc1 L_safe_63
L_vd_64:
    v_mov_b32 v240, 18432
    s_nop 0
    v_mov_b32 v241, s23
    ds_write_b32 v240, v241
    s_waitcnt lgkmcnt(0)
    s_barrier
    v_mov_b64 v[40:41], 0
    v_mov_b64 v[42:43], 0
    v_mov_b64 v[44:45], 0
    v_mov_b64 v[46:47], 0
    v_mov_b64 v[48:49], 0
    v_mov_b64 v[50:51], 0
    v_mov_b64 v[52:53], 0
    v_mov_b64 v[54:55], 0
    v_mov_b64 v[56:57], 0
    v_mov_b64 v[58:59], 0
    v_mov_b64 v[228:229], 0
    v_mov_b64 v[230:231], 0
    v_mov_b64 v[232:233], 0
    v_mov_b64 v[234:235], 0
    v_mov_b32 v236, v10
    v_mov_b32 v237, v10
    v_mov_b64 v[238:239], 0
    s_branch L_sc3_first_50
L_safe_63:
    s_mov_b32 s27, -1
    s_branch L_smr_55
L_loc_62:
    s_mov_b32 s28, 1
    v_mov_b32 v251, 0
    v_mov_b64 v[228:229], 0
    v_mov_b64 v[230:231], 0
    v_mov_b64 v[232:233], 0
    v_mov_b64 v[234:235], 0
    v_mov_b32 v236, v10
    v_mov_b32 v237, v10
    v_mov_b64 v[238:239], 0
    s_mov_b32 s26, 0
L_rl_65:
    ds_read_b128 v[240:243], v4 offset:17408
    ds_read_b64_tr_b16 v[200:201], v0 offset:7168
    ds_read_b64_tr_b16 v[202:203], v0 offset:7680
    ds_read_b64_tr_b16 v[204:205], v0 offset:8192
    ds_read_b64_tr_b16 v[206:207], v0 offset:8704
    ds_read_b64_tr_b16 v[208:209], v0 offset:9216
    ds_read_b64_tr_b16 v[210:211], v0 offset:9728
    ds_read_b64_tr_b16 v[212:213], v0 offset:10240
    ds_read_b64_tr_b16 v[214:215], v0 offset:10752
    ds_read_b64_tr_b16 v[216:217], v0 offset:11264
    ds_read_b64_tr_b16 v[218:219], v0 offset:11776
    ds_read_b64_tr_b16 v[220:221], v0 offset:12288
    ds_read_b64_tr_b16 v[222:223], v0 offset:12800
    ds_read_b64_tr_b16 v[224:225], v0 offset:13312
    ds_read_b64_tr_b16 v[226:227], v0 offset:13824
    s_waitcnt lgkmcnt(0)
    v_mfma_f32_16x16x32_bf16 v[236:239], v[200:203], v[12:15], v[236:239]
    v_smfmac_f32_16x16x64_bf16 v[228:231], v[200:203], v[88:95], v2
    v_smfmac_f32_16x16x64_bf16 v[232:235], v[200:203], v[144:151], v2
    v_mfma_f32_16x16x32_bf16 v[236:239], v[204:207], v[16:19], v[236:239]
    v_smfmac_f32_16x16x64_bf16 v[228:231], v[204:207], v[96:103], v2
    v_smfmac_f32_16x16x64_bf16 v[232:235], v[204:207], v[152:159], v2
    v_mfma_f32_16x16x32_bf16 v[236:239], v[208:211], v[20:23], v[236:239]
    v_smfmac_f32_16x16x64_bf16 v[228:231], v[208:211], v[104:111], v2
    v_smfmac_f32_16x16x64_bf16 v[232:235], v[208:211], v[160:167], v2
    v_mfma_f32_16x16x32_bf16 v[236:239], v[212:215], v[24:27], v[236:239]
    v_smfmac_f32_16x16x64_bf16 v[228:231], v[212:215], v[112:119], v2
    v_smfmac_f32_16x16x64_bf16 v[232:235], v[212:215], v[168:175], v2
    v_mfma_f32_16x16x32_bf16 v[236:239], v[216:219], v[28:31], v[236:239]
    v_smfmac_f32_16x16x64_bf16 v[228:231], v[216:219], v[120:127], v2
    v_smfmac_f32_16x16x64_bf16 v[232:235], v[216:219], v[176:183], v2
    v_mfma_f32_16x16x32_bf16 v[236:239], v[220:223], v[32:35], v[236:239]
    v_smfmac_f32_16x16x64_bf16 v[228:231], v[220:223], v[128:135], v2
    v_smfmac_f32_16x16x64_bf16 v[232:235], v[220:223], v[184:191], v2
    v_mfma_f32_16x16x32_bf16 v[236:239], v[224:227], v[36:39], v[236:239]
    v_smfmac_f32_16x16x64_bf16 v[228:231], v[224:227], v[136:143], v2
    v_smfmac_f32_16x16x64_bf16 v[232:235], v[224:227], v[192:199], v2
    v_mov_b64 v[206:207], 0
    v_mov_b64 v[208:209], 0
    v_mov_b32 v211, 0
    v_mov_b32 v203, 0
    v_add_f32_dpp v244, v238, v236 quad_perm:[2,3,0,1] row_mask:0xf bank_mask:0xf
    v_add_f32_dpp v245, v239, v237 quad_perm:[2,3,0,1] row_mask:0xf bank_mask:0xf
    v_pk_add_f32 v[240:241], v[228:229], v[230:231]
    s_nop 0
    v_pk_add_f32 v[242:243], v[232:233], v[234:235]
    v_max3_f32 v246, v240, v244, v242
    v_max3_f32 v247, v241, v245, v243
    s_nop 0
    v_max_f32_dpp v246, v246, v246 row_ror:8 row_mask:0xf bank_mask:0xf
    v_max_f32_dpp v247, v247, v247 row_ror:8 row_mask:0xf bank_mask:0xf
    s_nop 0
    v_max_f32_dpp v246, v246, v246 row_ror:4 row_mask:0xf bank_mask:0xf
    v_max_f32_dpp v247, v247, v247 row_ror:4 row_mask:0xf bank_mask:0xf
    s_nop 0
    v_max_f32_dpp v246, v246, v246 row_ror:2 row_mask:0xf bank_mask:0xf
    v_max_f32_dpp v247, v247, v247 row_ror:2 row_mask:0xf bank_mask:0xf
    s_nop 0
    v_max_f32_dpp v246, v246, v246 row_ror:1 row_mask:0xf bank_mask:0xf
    v_max_f32_dpp v247, v247, v247 row_ror:1 row_mask:0xf bank_mask:0xf
    v_pk_add_f32 v[240:241], v[240:241], v[246:247] neg_lo:[0,1] neg_hi:[0,1]
    v_pk_add_f32 v[242:243], v[242:243], v[246:247] neg_lo:[0,1] neg_hi:[0,1]
    v_pk_add_f32 v[244:245], v[244:245], v[246:247] neg_lo:[0,1] neg_hi:[0,1]
    v_exp_f32 v228, v240
    v_exp_f32 v229, v241
    v_exp_f32 v230, v242
    v_exp_f32 v231, v243
    v_exp_f32 v236, v244
    v_exp_f32 v237, v245
    s_nop 1
    s_branch L_smr_55
L_sc_next1:
    s_cmp_lg_u32 s20, 0
    s_cbranch_scc1 L_sc_next0
    s_cmp_lg_u32 s17, 0
    s_cbranch_scc1 L_sc0_n0
    v_lshrrev_b32 v11, 1, v0
    v_min_u32 v11, 220, v11
    s_and_b32 s26, s16, 3
    s_lshl_b32 s26, s26, 8
    s_add_u32 s26, s26, 7168
    v_add_u32 v11, s26, v11
    v_add_u32 v8, 14336, v4
    v_mov_b32 v9, 0
    ds_write_b32 v8, v9 offset:0
    ds_write_b32 v8, v9 offset:1024
    ds_write_b32 v8, v9 offset:2048
    ds_write_b32 v8, v9 offset:3072
    ds_write_b32 v8, v9 offset:4096
    v_and_b32 v4, 248, v0
    v_lshlrev_b32 v4, 3, v4
    v_add_u32 v4, 0, v4
    s_and_b32 s26, s19, 1
    s_xor_b32 s26, s26, 1
    s_mul_i32 s26, s26, 28672
    s_add_u32 s26, s26, 20480
    s_add_u32 s27, s24, 28672
    s_mov_b32 m0, s26
    s_nop 0
    buffer_load_dwordx4 v1, s[8:11], s27 offen offset:0  lds
    buffer_load_dwordx4 v1, s[8:11], s27 offen offset:1024  lds
    buffer_load_dwordx4 v1, s[8:11], s27 offen offset:2048  lds
    buffer_load_dwordx4 v1, s[8:11], s27 offen offset:3072  lds
    s_add_u32 s26, s26, 4096
    s_add_u32 s27, s27, 4096
    s_mov_b32 m0, s26
    s_nop 0
    buffer_load_dwordx4 v1, s[8:11], s27 offen offset:0  lds
    buffer_load_dwordx4 v1, s[8:11], s27 offen offset:1024  lds
    buffer_load_dwordx4 v1, s[8:11], s27 offen offset:2048  lds
    buffer_load_dwordx4 v1, s[8:11], s27 offen offset:3072  lds
    s_add_u32 s26, s26, 4096
    s_add_u32 s27, s27, 4096
    s_mov_b32 m0, s26
    s_nop 0
    buffer_load_dwordx4 v1, s[8:11], s27 offen offset:0  lds
    v_mov_b64 v[40:41], 0
    v_mov_b64 v[42:43], 0
    v_mov_b64 v[44:45], 0
    v_mov_b64 v[46:47], 0
    v_mov_b64 v[48:49], 0
    v_mov_b64 v[50:51], 0
    v_mov_b64 v[52:53], 0
    v_mov_b64 v[54:55], 0
    v_mov_b64 v[56:57], 0
    v_mov_b64 v[58:59], 0
    v_mov_b64 v[60:61], 0
    v_mov_b64 v[62:63], 0
    s_branch L_sc0_first_68
    .p2align 6
L_sc0_top_67:
    v_mov_b64 v[40:41], 0
    v_mov_b64 v[42:43], 0
    v_mov_b64 v[44:45], 0
    v_mov_b64 v[46:47], 0
    v_mov_b64 v[48:49], 0
    v_mov_b64 v[50:51], 0
    v_mov_b64 v[52:53], 0
    v_mov_b64 v[54:55], 0
    v_mov_b64 v[56:57], 0
    v_mov_b64 v[58:59], 0
    v_mov_b64 v[60:61], 0
    v_mov_b64 v[62:63], 0
    s_mov_b32 m0, 0
    s_sub_u32 s26, s21, 0
    s_add_u32 s27, s26, 4096
    s_mov_b32 s28, 0
    buffer_load_dword v5, v11, s[8:11], s21 offen offset:0 sc1
    s_nop 12
    buffer_load_dword v6, v11, s[8:11], s21 offen offset:0 sc1
    s_nop 12
    buffer_load_dword v7, v11, s[8:11], s21 offen offset:0 sc1
    s_nop 12
L_h_70:
    buffer_load_dword v10, v11, s[8:11], s21 offen offset:0 sc1
    s_waitcnt vmcnt(3)
    v_cmp_eq_u32 vcc, -1, v5
    s_cbranch_vccz L_hd_71
    s_nop 2
    buffer_load_dword v5, v11, s[8:11], s21 offen offset:0 sc1
    s_waitcnt vmcnt(3)
    v_cmp_eq_u32 vcc, -1, v6
    s_cbranch_vccz L_hd_71
    s_nop 2
    buffer_load_dword v6, v11, s[8:11], s21 offen offset:0 sc1
    s_waitcnt vmcnt(3)
    v_cmp_eq_u32 vcc, -1, v7
    s_cbranch_vccz L_hd_71
    s_nop 2
    buffer_load_dword v7, v11, s[8:11], s21 offen offset:0 sc1
    s_waitcnt vmcnt(3)
    v_cmp_eq_u32 vcc, -1, v10
    s_cbranch_vccz L_hd_71
    s_nop 2
    s_add_u32 s28, s28, 1
    s_cmp_lt_u32 s28, s29
    s_cbranch_scc1 L_h_70
L_hd_71:
    s_nop 4
    s_barrier
    buffer_load_dwordx4 v1, s[8:11], s26 offen sc1 lds
    v_add_u32 v9, 1, v9
    s_mov_b32 s36, 0
    s_mov_b32 s28, 1
    s_mov_b32 m0, 4096
    s_nop 4
    buffer_load_dwordx4 v1, s[8:11], s27 offen sc1 lds
    s_waitcnt vmcnt(1) lgkmcnt(0)
    s_barrier
L_got_72:
    ds_read_b64_tr_b16 v[12:13], v0 offset:0
    ds_read_b64_tr_b16 v[14:15], v0 offset:512
    ds_read_b64_tr_b16 v[16:17], v0 offset:1024
    ds_read_b64_tr_b16 v[18:19], v0 offset:1536
    ds_read_b64_tr_b16 v[20:21], v0 offset:2048
    s_waitcnt vmcnt(0)
    s_barrier
L_dry_69:
    s_waitcnt lgkmcnt(3)
    v_smfmac_f32_16x16x64_bf16 v[40:43], v[12:15], a[0:7], v2
    ds_read_b64_tr_b16 v[22:23], v0 offset:2560
    v_smfmac_f32_16x16x64_bf16 v[44:47], v[12:15], a[56:63], v2
    ds_read_b64_tr_b16 v[24:25], v0 offset:3072
    s_waitcnt lgkmcnt(3)
    v_smfmac_f32_16x16x64_bf16 v[40:43], v[16:19], a[8:15], v2
    ds_read_b64_tr_b16 v[26:27], v0 offset:3584
    v_smfmac_f32_16x16x64_bf16 v[44:47], v[16:19], a[64:71], v2
    ds_read_b64_tr_b16 v[28:29], v0 offset:4096
    s_waitcnt lgkmcnt(3)
    v_smfmac_f32_16x16x64_bf16 v[40:43], v[20:23], a[16:23], v2
    ds_read_b64_tr_b16 v[30:31], v0 offset:4608
    v_smfmac_f32_16x16x64_bf16 v[44:47], v[20:23], a[72:79], v2
    ds_read_b64_tr_b16 v[32:33], v0 offset:5120
    s_waitcnt lgkmcnt(3)
    v_smfmac_f32_16x16x64_bf16 v[40:43], v[24:27], a[24:31], v2
    ds_read_b64_tr_b16 v[34:35], v0 offset:5632
    v_smfmac_f32_16x16x64_bf16 v[44:47], v[24:27], a[80:87], v2
    ds_read_b64_tr_b16 v[36:37], v0 offset:6144
    s_waitcnt lgkmcnt(3)
    v_smfmac_f32_16x16x64_bf16 v[40:43], v[28:31], a[32:39], v2
    ds_read_b64_tr_b16 v[38:39], v0 offset:6656
    v_smfmac_f32_16x16x64_bf16 v[44:47], v[28:31], a[88:95], v2
    s_waitcnt lgkmcnt(2)
    v_smfmac_f32_16x16x64_bf16 v[40:43], v[32:35], a[40:47], v2
    v_smfmac_f32_16x16x64_bf16 v[44:47], v[32:35], a[96:103], v2
    s_waitcnt lgkmcnt(0)
    v_smfmac_f32_16x16x64_bf16 v[40:43], v[36:39], a[48:55], v2
    v_smfmac_f32_16x16x64_bf16 v[44:47], v[36:39], a[104:111], v2
    v_smfmac_f32_16x16x64_bf16 v[48:51], v[12:15], a[112:119], v2
    v_smfmac_f32_16x16x64_bf16 v[48:51], v[16:19], a[120:127], v2
    v_add_f32 v40, v40, v42
    v_smfmac_f32_16x16x64_bf16 v[48:51], v[20:23], a[128:135], v2
    v_add_f32 v41, v41, v43
    v_smfmac_f32_16x16x64_bf16 v[48:51], v[24:27], a[136:143], v2
    v_cvt_pk_bf16_f32 v40, v40, v41
    v_smfmac_f32_16x16x64_bf16 v[48:51], v[28:31], a[144:151], v2
    ds_write_b32 v3, v40 offset:7168
    v_smfmac_f32_16x16x64_bf16 v[48:51], v[32:35], a[152:159], v2
    v_add_f32 v44, v44, v46
    v_smfmac_f32_16x16x64_bf16 v[48:51], v[36:39], a[160:167], v2
    v_add_f32 v45, v45, v47
    v_smfmac_f32_16x16x64_bf16 v[52:55], v[12:15], a[168:175], v2
    v_cvt_pk_bf16_f32 v44, v44, v45
    v_smfmac_f32_16x16x64_bf16 v[52:55], v[16:19], a[176:183], v2
    ds_write_b32 v3, v44 offset:8192
    v_smfmac_f32_16x16x64_bf16 v[52:55], v[20:23], a[184:191], v2
    v_add_f32 v48, v48, v50
    v_smfmac_f32_16x16x64_bf16 v[52:55], v[24:27], a[192:199], v2
    v_add_f32 v49, v49, v51
    v_smfmac_f32_16x16x64_bf16 v[52:55], v[28:31], a[200:207], v2
    v_cvt_pk_bf16_f32 v48, v48, v49
    v_smfmac_f32_16x16x64_bf16 v[52:55], v[32:35], a[208:215], v2
    ds_write_b32 v3, v48 offset:9216
    v_smfmac_f32_16x16x64_bf16 v[52:55], v[36:39], a[216:223], v2
    ds_write_b32 v8, v9 offset:0
    v_smfmac_f32_16x16x64_bf16 v[56:59], v[12:15], a[224:231], v2
    v_mov_b64 v[40:41], 0
    v_smfmac_f32_16x16x64_bf16 v[56:59], v[16:19], a[232:239], v2
    v_mov_b64 v[42:43], 0
    v_smfmac_f32_16x16x64_bf16 v[56:59], v[20:23], a[240:247], v2
    v_add_f32 v52, v52, v54
    v_smfmac_f32_16x16x64_bf16 v[56:59], v[24:27], a[248:255], v2
    v_add_f32 v53, v53, v55
    v_smfmac_f32_16x16x64_bf16 v[56:59], v[28:31], v[64:71], v2
    v_cvt_pk_bf16_f32 v52, v52, v53
    v_smfmac_f32_16x16x64_bf16 v[56:59], v[32:35], v[72:79], v2
    ds_write_b32 v3, v52 offset:10240
    v_smfmac_f32_16x16x64_bf16 v[56:59], v[36:39], v[80:87], v2
    v_mov_b64 v[44:45], 0
    v_smfmac_f32_16x16x64_bf16 v[60:63], v[12:15], v[88:95], v2
    v_mov_b64 v[46:47], 0
    v_smfmac_f32_16x16x64_bf16 v[60:63], v[16:19], v[96:103], v2
    v_smfmac_f32_16x16x64_bf16 v[60:63], v[20:23], v[104:111], v2
    v_add_f32 v56, v56, v58
    v_smfmac_f32_16x16x64_bf16 v[60:63], v[24:27], v[112:119], v2
    v_add_f32 v57, v57, v59
    v_smfmac_f32_16x16x64_bf16 v[60:63], v[28:31], v[120:127], v2
    v_cvt_pk_bf16_f32 v56, v56, v57
    v_smfmac_f32_16x16x64_bf16 v[60:63], v[32:35], v[128:135], v2
    ds_write_b32 v3, v56 offset:11264
    v_smfmac_f32_16x16x64_bf16 v[60:63], v[36:39], v[136:143], v2
    ds_write_b32 v8, v9 offset:1024
    v_smfmac_f32_16x16x64_bf16 v[40:43], v[12:15], v[144:151], v2
    v_smfmac_f32_16x16x64_bf16 v[40:43], v[16:19], v[152:159], v2
    v_smfmac_f32_16x16x64_bf16 v[40:43], v[20:23], v[160:167], v2
    v_add_f32 v60, v60, v62
    v_smfmac_f32_16x16x64_bf16 v[40:43], v[24:27], v[168:175], v2
    v_add_f32 v61, v61, v63
    v_smfmac_f32_16x16x64_bf16 v[40:43], v[28:31], v[176:183], v2
    v_cvt_pk_bf16_f32 v60, v60, v61
    v_smfmac_f32_16x16x64_bf16 v[40:43], v[32:35], v[184:191], v2
    ds_write_b32 v3, v60 offset:12288
    v_smfmac_f32_16x16x64_bf16 v[40:43], v[36:39], v[192:199], v2
    ds_write_b32 v8, v9 offset:2048
    v_smfmac_f32_16x16x64_bf16 v[44:47], v[12:15], v[200:207], v2
    v_smfmac_f32_16x16x64_bf16 v[44:47], v[16:19], v[208:215], v2
    v_smfmac_f32_16x16x64_bf16 v[44:47], v[20:23], v[216:223], v2
    v_add_f32 v40, v40, v42
    v_smfmac_f32_16x16x64_bf16 v[44:47], v[24:27], v[224:231], v2
    v_add_f32 v41, v41, v43
    v_smfmac_f32_16x16x64_bf16 v[44:47], v[28:31], v[232:239], v2
    v_cvt_pk_bf16_f32 v40, v40, v41
    v_smfmac_f32_16x16x64_bf16 v[44:47], v[32:35], v[240:247], v2
    ds_write_b32 v3, v40 offset:13312
    v_smfmac_f32_16x16x64_bf16 v[44:47], v[36:39], v[248:255], v2
    s_nop 7
    v_pk_add_f32 v[44:45], v[44:45], v[46:47]
    v_cvt_pk_bf16_f32 v44, v44, v45
    ds_write_b32 v3, v44 offset:13568
    s_waitcnt lgkmcnt(0)
    s_barrier
    s_barrier
    v_mov_b32 v12, 18432
    ds_read_b32 v12, v12
    s_waitcnt lgkmcnt(0)
    v_and_b32 v13, 0x3fffffff, v12
    v_cmp_eq_u32 vcc, v13, v9
    s_cbranch_vccnz L_again_73
    s_add_u32 s19, s19, 1
    s_add_u32 s21, s21, 8192
    s_add_u32 s22, s22, 16384
    s_add_u32 s24, s24, 28672
    s_add_u32 s25, s25, 458752
    s_add_u32 s32, s32, 64
    s_cmp_ge_u32 s19, 63
    s_cbranch_scc1 L_exit
    s_sleep 4
    s_sleep 2
    s_branch L_sc0_top_67
L_sc0_first_68:
    v_add_u32 v9, 1, v9
    s_mov_b32 s36, 1
    s_mov_b32 s28, 0
L_pm_74:
    buffer_load_dwordx4 v[12:15], v1, s[8:11], s21 offen sc1
    buffer_load_dwordx4 v[16:19], v1, s[8:11], s21 offen offset:768 sc1
    s_add_u32 s28, s28, 1
    s_waitcnt vmcnt(1)
    ds_write_b128 v1, v[12:15]
    v_max3_u32 v20, v12, v13, v14
    s_waitcnt vmcnt(0)
    ds_write_b128 v1, v[16:19] offset:768
    v_max3_u32 v20, v20, v15, v16
    v_max3_u32 v20, v20, v17, v18
    v_max_u32 v20, v20, v19
    v_cmp_eq_u32 vcc, -1, v20
    s_cbranch_vccz L_pmd_75
    s_cmp_lt_u32 s28, s29
    s_cbranch_scc1 L_pm_74
    s_mov_b32 s29, 1
L_pmd_75:
    s_waitcnt lgkmcnt(0)
    s_barrier
    s_branch L_got_72
L_again_73:
    v_mov_b64 v[40:41], 0
    v_mov_b64 v[42:43], 0
    v_mov_b64 v[44:45], 0
    v_mov_b64 v[46:47], 0
    v_mov_b64 v[48:49], 0
    v_mov_b64 v[50:51], 0
    v_mov_b64 v[52:53], 0
    v_mov_b64 v[54:55], 0
    v_mov_b64 v[56:57], 0
    v_mov_b64 v[58:59], 0
    v_mov_b64 v[60:61], 0
    v_mov_b64 v[62:63], 0
    v_cmp_eq_u32 vcc, v12, v9
    s_cbranch_vccnz L_sc0_first_68
    v_add_u32 v9, 1, v9
    s_branch L_got_72
L_sc0_n0:
    s_cmp_lg_u32 s17, 1
    s_cbranch_scc1 L_sc0_n1
    v_lshrrev_b32 v11, 1, v0
    v_min_u32 v11, 220, v11
    s_and_b32 s26, s16, 3
    s_lshl_b32 s26, s26, 8
    s_add_u32 s26, s26, 7168
    v_add_u32 v11, s26, v11
    v_add_u32 v8, 14340, v4
    v_mov_b32 v9, 0
    ds_write_b32 v8, v9 offset:0
    ds_write_b32 v8, v9 offset:1024
    ds_write_b32 v8, v9 offset:2048
    ds_write_b32 v8, v9 offset:3072
    ds_write_b32 v8, v9 offset:4096
    v_and_b32 v4, 248, v0
    v_lshlrev_b32 v4, 3, v4
    v_add_u32 v4, 2048, v4
    s_and_b32 s26, s19, 1
    s_xor_b32 s26, s26, 1
    s_mul_i32 s26, s26, 28672
    s_add_u32 s26, s26, 29696
    s_add_u32 s27, s24, 36096
    s_mov_b32 m0, s26
    s_nop 0
    buffer_load_dwordx4 v1, s[8:11], s27 offen offset:0  lds
    buffer_load_dwordx4 v1, s[8:11], s27 offen offset:1024  lds
    buffer_load_dwordx4 v1, s[8:11], s27 offen offset:2048  lds
    buffer_load_dwordx4 v1, s[8:11], s27 offen offset:3072  lds
    s_add_u32 s26, s26, 4096
    s_add_u32 s27, s27, 4096
    s_mov_b32 m0, s26
    s_nop 0
    buffer_load_dwordx4 v1, s[8:11], s27 offen offset:0  lds
    buffer_load_dwordx4 v1, s[8:11], s27 offen offset:1024  lds
    buffer_load_dwordx4 v1, s[8:11], s27 offen offset:2048  lds
    buffer_load_dwordx4 v1, s[8:11], s27 offen offset:3072  lds
    s_add_u32 s26, s26, 4096
    s_add_u32 s27, s27, 4096
    s_mov_b32 m0, s26
    s_nop 0
    buffer_load_dwordx4 v1, s[8:11], s27 offen offset:0  lds
    v_mov_b64 v[40:41], 0
    v_mov_b64 v[42:43], 0
    v_mov_b64 v[44:45], 0
    v_mov_b64 v[46:47], 0
    v_mov_b64 v[48:49], 0
    v_mov_b64 v[50:51], 0
    v_mov_b64 v[52:53], 0
    v_mov_b64 v[54:55], 0
    v_mov_b64 v[56:57], 0
    v_mov_b64 v[58:59], 0
    v_mov_b64 v[60:61], 0
    v_mov_b64 v[62:63], 0
    s_branch L_sc1_first_77
    .p2align 6
L_sc1_top_76:
    v_mov_b64 v[40:41], 0
    v_mov_b64 v[42:43], 0
    v_mov_b64 v[44:45], 0
    v_mov_b64 v[46:47], 0
    v_mov_b64 v[48:49], 0
    v_mov_b64 v[50:51], 0
    v_mov_b64 v[52:53], 0
    v_mov_b64 v[54:55], 0
    v_mov_b64 v[56:57], 0
    v_mov_b64 v[58:59], 0
    v_mov_b64 v[60:61], 0
    v_mov_b64 v[62:63], 0
    s_mov_b32 m0, 1024
    s_sub_u32 s26, s21, 768
    s_add_u32 s27, s26, 4096
    s_barrier
    buffer_load_dwordx4 v1, s[8:11], s26 offen sc1 lds
    v_add_u32 v9, 1, v9
    s_mov_b32 s36, 0
    s_mov_b32 s28, 1
    s_mov_b32 m0, 5120
    s_nop 4
    buffer_load_dwordx4 v1, s[8:11], s27 offen sc1 lds
    s_waitcnt vmcnt(1) lgkmcnt(0)
    s_barrier
L_got_79:
    ds_read_b64_tr_b16 v[12:13], v0 offset:0
    ds_read_b64_tr_b16 v[14:15], v0 offset:512
    ds_read_b64_tr_b16 v[16:17], v0 offset:1024
    ds_read_b64_tr_b16 v[18:19], v0 offset:1536
    ds_read_b64_tr_b16 v[20:21], v0 offset:2048
    s_waitcnt vmcnt(0)
    s_barrier
L_dry_78:
    s_waitcnt lgkmcnt(3)
    v_smfmac_f32_16x16x64_bf16 v[40:43], v[12:15], a[0:7], v2
    ds_read_b64_tr_b16 v[22:23], v0 offset:2560
    v_smfmac_f32_16x16x64_bf16 v[44:47], v[12:15], a[56:63], v2
    ds_read_b64_tr_b16 v[24:25], v0 offset:3072
    s_waitcnt lgkmcnt(3)
    v_smfmac_f32_16x16x64_bf16 v[40:43], v[16:19], a[8:15], v2
    ds_read_b64_tr_b16 v[26:27], v0 offset:3584
    v_smfmac_f32_16x16x64_bf16 v[44:47], v[16:19], a[64:71], v2
    ds_read_b64_tr_b16 v[28:29], v0 offset:4096
    s_waitcnt lgkmcnt(3)
    v_smfmac_f32_16x16x64_bf16 v[40:43], v[20:23], a[16:23], v2
    ds_read_b64_tr_b16 v[30:31], v0 offset:4608
    v_smfmac_f32_16x16x64_bf16 v[44:47], v[20:23], a[72:79], v2
    ds_read_b64_tr_b16 v[32:33], v0 offset:5120
    s_waitcnt lgkmcnt(3)
    v_smfmac_f32_16x16x64_bf16 v[40:43], v[24:27], a[24:31], v2
    ds_read_b64_tr_b16 v[34:35], v0 offset:5632
    v_smfmac_f32_16x16x64_bf16 v[44:47], v[24:27], a[80:87], v2
    ds_read_b64_tr_b16 v[36:37], v0 offset:6144
    s_waitcnt lgkmcnt(3)
    v_smfmac_f32_16x16x64_bf16 v[40:43], v[28:31], a[32:39], v2
    ds_read_b64_tr_b16 v[38:39], v0 offset:6656
    v_smfmac_f32_16x16x64_bf16 v[44:47], v[28:31], a[88:95], v2
    s_waitcnt lgkmcnt(2)
    v_smfmac_f32_16x16x64_bf16 v[40:43], v[32:35], a[40:47], v2
    v_smfmac_f32_16x16x64_bf16 v[44:47], v[32:35], a[96:103], v2
    s_waitcnt lgkmcnt(0)
    v_smfmac_f32_16x16x64_bf16 v[40:43], v[36:39], a[48:55], v2
    v_smfmac_f32_16x16x64_bf16 v[44:47], v[36:39], a[104:111], v2
    v_smfmac_f32_16x16x64_bf16 v[48:51], v[12:15], a[112:119], v2
    v_smfmac_f32_16x16x64_bf16 v[48:51], v[16:19], a[120:127], v2
    v_add_f32 v40, v40, v42
    v_smfmac_f32_16x16x64_bf16 v[48:51], v[20:23], a[128:135], v2
    v_add_f32 v41, v41, v43
    v_smfmac_f32_16x16x64_bf16 v[48:51], v[24:27], a[136:143], v2
    v_cvt_pk_bf16_f32 v40, v40, v41
    v_smfmac_f32_16x16x64_bf16 v[48:51], v[28:31], a[144:151], v2
    ds_write_b32 v3, v40 offset:7296
    v_smfmac_f32_16x16x64_bf16 v[48:51], v[32:35], a[152:159], v2
    v_add_f32 v44, v44, v46
    v_smfmac_f32_16x16x64_bf16 v[48:51], v[36:39], a[160:167], v2
    v_add_f32 v45, v45, v47
    v_smfmac_f32_16x16x64_bf16 v[52:55], v[12:15], a[168:175], v2
    v_cvt_pk_bf16_f32 v44, v44, v45
    v_smfmac_f32_16x16x64_bf16 v[52:55], v[16:19], a[176:183], v2
    ds_write_b32 v3, v44 offset:8320
    v_smfmac_f32_16x16x64_bf16 v[52:55], v[20:23], a[184:191], v2
    v_add_f32 v48, v48, v50
    v_smfmac_f32_16x16x64_bf16 v[52:55], v[24:27], a[192:199], v2
    v_add_f32 v49, v49, v51
    v_smfmac_f32_16x16x64_bf16 v[52:55], v[28:31], a[200:207], v2
    v_cvt_pk_bf16_f32 v48, v48, v49
    v_smfmac_f32_16x16x64_bf16 v[52:55], v[32:35], a[208:215], v2
    ds_write_b32 v3, v48 offset:9344
    v_smfmac_f32_16x16x64_bf16 v[52:55], v[36:39], a[216:223], v2
    ds_write_b32 v8, v9 offset:0
    v_smfmac_f32_16x16x64_bf16 v[56:59], v[12:15], a[224:231], v2
    v_mov_b64 v[40:41], 0
    v_smfmac_f32_16x16x64_bf16 v[56:59], v[16:19], a[232:239], v2
    v_mov_b64 v[42:43], 0
    v_smfmac_f32_16x16x64_bf16 v[56:59], v[20:23], a[240:247], v2
    v_add_f32 v52, v52, v54
    v_smfmac_f32_16x16x64_bf16 v[56:59], v[24:27], a[248:255], v2
    v_add_f32 v53, v53, v55
    v_smfmac_f32_16x16x64_bf16 v[56:59], v[28:31], v[64:71], v2
    v_cvt_pk_bf16_f32 v52, v52, v53
    v_smfmac_f32_16x16x64_bf16 v[56:59], v[32:35], v[72:79], v2
    ds_write_b32 v3, v52 offset:10368
    v_smfmac_f32_16x16x64_bf16 v[56:59], v[36:39], v[80:87], v2
    v_mov_b64 v[44:45], 0
    v_smfmac_f32_16x16x64_bf16 v[60:63], v[12:15], v[88:95], v2
    v_mov_b64 v[46:47], 0
    v_smfmac_f32_16x16x64_bf16 v[60:63], v[16:19], v[96:103], v2
    v_smfmac_f32_16x16x64_bf16 v[60:63], v[20:23], v[104:111], v2
    v_add_f32 v56, v56, v58
    v_smfmac_f32_16x16x64_bf16 v[60:63], v[24:27], v[112:119], v2
    v_add_f32 v57, v57, v59
    v_smfmac_f32_16x16x64_bf16 v[60:63], v[28:31], v[120:127], v2
    v_cvt_pk_bf16_f32 v56, v56, v57
    v_smfmac_f32_16x16x64_bf16 v[60:63], v[32:35], v[128:135], v2
    ds_write_b32 v3, v56 offset:11392
    v_smfmac_f32_16x16x64_bf16 v[60:63], v[36:39], v[136:143], v2
    ds_write_b32 v8, v9 offset:1024
    v_smfmac_f32_16x16x64_bf16 v[40:43], v[12:15], v[144:151], v2
    v_smfmac_f32_16x16x64_bf16 v[40:43], v[16:19], v[152:159], v2
    v_smfmac_f32_16x16x64_bf16 v[40:43], v[20:23], v[160:167], v2
    v_add_f32 v60, v60, v62
    v_smfmac_f32_16x16x64_bf16 v[40:43], v[24:27], v[168:175], v2
    v_add_f32 v61, v61, v63
    v_smfmac_f32_16x16x64_bf16 v[40:43], v[28:31], v[176:183], v2
    v_cvt_pk_bf16_f32 v60, v60, v61
    v_smfmac_f32_16x16x64_bf16 v[40:43], v[32:35], v[184:191], v2
    ds_write_b32 v3, v60 offset:12416
    v_smfmac_f32_16x16x64_bf16 v[40:43], v[36:39], v[192:199], v2
    ds_write_b32 v8, v9 offset:2048
    v_smfmac_f32_16x16x64_bf16 v[44:47], v[12:15], v[200:207], v2
    v_smfmac_f32_16x16x64_bf16 v[44:47], v[16:19], v[208:215], v2
    v_smfmac_f32_16x16x64_bf16 v[44:47], v[20:23], v[216:223], v2
    v_add_f32 v40, v40, v42
    v_smfmac_f32_16x16x64_bf16 v[44:47], v[24:27], v[224:231], v2
    v_add_f32 v41, v41, v43
    v_smfmac_f32_16x16x64_bf16 v[44:47], v[28:31], v[232:239], v2
    v_cvt_pk_bf16_f32 v40, v40, v41
    v_smfmac_f32_16x16x64_bf16 v[44:47], v[32:35], v[240:247], v2
    ds_write_b32 v3, v40 offset:13440
    v_smfmac_f32_16x16x64_bf16 v[44:47], v[36:39], v[248:255], v2
    s_nop 7
    v_pk_add_f32 v[44:45], v[44:45], v[46:47]
    v_cvt_pk_bf16_f32 v44, v44, v45
    ds_write_b32 v3, v44 offset:13696
    s_waitcnt lgkmcnt(0)
    s_barrier
    s_barrier
    v_mov_b32 v12, 18432
    ds_read_b32 v12, v12
    s_waitcnt lgkmcnt(0)
    v_and_b32 v13, 0x3fffffff, v12
    v_cmp_eq_u32 vcc, v13, v9
    s_cbranch_vccnz L_again_80
    s_add_u32 s19, s19, 1
    s_add_u32 s21, s21, 8192
    s_add_u32 s22, s22, 16384
    s_add_u32 s24, s24, 28672
    s_add_u32 s25, s25, 458752
    s_add_u32 s32, s32, 64
    s_cmp_ge_u32 s19, 63
    s_cbranch_scc1 L_exit
    s_sleep 4
    s_and_b32 s26, s19, 1
    s_xor_b32 s26, s26, 1
    s_mul_i32 s26, s26, 28672
    s_add_u32 s26, s26, 40960
    s_add_u32 s27, s24, 47360
    s_mov_b32 m0, s26
    s_nop 0
    buffer_load_dwordx4 v1, s[8:11], s27 offen offset:0  lds
    buffer_load_dwordx4 v1, s[8:11], s27 offen offset:1024  lds
    buffer_load_dwordx4 v1, s[8:11], s27 offen offset:2048  lds
    buffer_load_dwordx4 v1, s[8:11], s27 offen offset:3072  lds
    s_sleep 2
    s_branch L_sc1_top_76
L_sc1_first_77:
    v_add_u32 v9, 1, v9
    s_mov_b32 s36, 1
    s_mov_b32 s28, 0
L_pm_81:
    buffer_load_dwordx4 v[12:15], v1, s[8:11], s21 offen sc1
    buffer_load_dwordx4 v[16:19], v1, s[8:11], s21 offen offset:768 sc1
    s_add_u32 s28, s28, 1
    s_waitcnt vmcnt(1)
    ds_write_b128 v1, v[12:15]
    v_max3_u32 v20, v12, v13, v14
    s_waitcnt vmcnt(0)
    ds_write_b128 v1, v[16:19] offset:768
    v_max3_u32 v20, v20, v15, v16
    v_max3_u32 v20, v20, v17, v18
    v_max_u32 v20, v20, v19
    v_cmp_eq_u32 vcc, -1, v20
    s_cbranch_vccz L_pmd_82
    s_cmp_lt_u32 s28, s29
    s_cbranch_scc1 L_pm_81
    s_mov_b32 s29, 1
L_pmd_82:
    s_waitcnt lgkmcnt(0)
    s_barrier
    s_branch L_got_79
L_again_80:
    v_mov_b64 v[40:41], 0
    v_mov_b64 v[42:43], 0
    v_mov_b64 v[44:45], 0
    v_mov_b64 v[46:47], 0
    v_mov_b64 v[48:49], 0
    v_mov_b64 v[50:51], 0
    v_mov_b64 v[52:53], 0
    v_mov_b64 v[54:55], 0
    v_mov_b64 v[56:57], 0
    v_mov_b64 v[58:59], 0
    v_mov_b64 v[60:61], 0
    v_mov_b64 v[62:63], 0
    v_cmp_eq_u32 vcc, v12, v9
    s_cbranch_vccnz L_sc1_first_77
    v_add_u32 v9, 1, v9
    s_branch L_got_79
L_sc0_n1:
    s_cmp_lg_u32 s17, 2
    s_cbranch_scc1 L_sc0_n2
    v_lshrrev_b32 v11, 1, v0
    v_min_u32 v11, 220, v11
    s_and_b32 s26, s16, 3
    s_lshl_b32 s26, s26, 8
    s_add_u32 s26, s26, 7168
    v_add_u32 v11, s26, v11
    v_add_u32 v8, 14344, v4
    v_mov_b32 v9, 0
    ds_write_b32 v8, v9 offset:0
    ds_write_b32 v8, v9 offset:1024
    ds_write_b32 v8, v9 offset:2048
    ds_write_b32 v8, v9 offset:3072
    ds_write_b32 v8, v9 offset:4096
    v_and_b32 v4, 248, v0
    v_lshlrev_b32 v4, 3, v4
    v_add_u32 v4, 4096, v4
    s_and_b32 s26, s19, 1
    s_xor_b32 s26, s26, 1
    s_mul_i32 s26, s26, 28672
    s_add_u32 s26, s26, 38912
    s_add_u32 s27, s24, 43520
    s_mov_b32 m0, s26
    s_nop 0
    buffer_load_dwordx4 v1, s[8:11], s27 offen offset:0  lds
    buffer_load_dwordx4 v1, s[8:11], s27 offen offset:1024  lds
    buffer_load_dwordx4 v1, s[8:11], s27 offen offset:2048  lds
    buffer_load_dwordx4 v1, s[8:11], s27 offen offset:3072  lds
    s_add_u32 s26, s26, 4096
    s_add_u32 s27, s27, 4096
    s_mov_b32 m0, s26
    s_nop 0
    buffer_load_dwordx4 v1, s[8:11], s27 offen offset:0  lds
    buffer_load_dwordx4 v1, s[8:11], s27 offen offset:1024  lds
    buffer_load_dwordx4 v1, s[8:11], s27 offen offset:2048  lds
    buffer_load_dwordx4 v1, s[8:11], s27 offen offset:3072  lds
    s_add_u32 s26, s26, 4096
    s_add_u32 s27, s27, 4096
    s_mov_b32 m0, s26
    s_nop 0
    buffer_load_dwordx4 v1, s[8:11], s27 offen offset:0  lds
    buffer_load_dwordx4 v1, s[8:11], s27 offen offset:1024  lds
    v_mov_b64 v[40:41], 0
    v_mov_b64 v[42:43], 0
    v_mov_b64 v[44:45], 0
    v_mov_b64 v[46:47], 0
    v_mov_b64 v[48:49], 0
    v_mov_b64 v[50:51], 0
    v_mov_b64 v[52:53], 0
    v_mov_b64 v[54:55], 0
    v_mov_b64 v[56:57], 0
    v_mov_b64 v[58:59], 0
    v_mov_b64 v[60:61], 0
    v_mov_b64 v[62:63], 0
    s_branch L_sc2_first_84
    .p2align 6
L_sc2_top_83:
    v_mov_b64 v[40:41], 0
    v_mov_b64 v[42:43], 0
    v_mov_b64 v[44:45], 0
    v_mov_b64 v[46:47], 0
    v_mov_b64 v[48:49], 0
    v_mov_b64 v[50:51], 0
    v_mov_b64 v[52:53], 0
    v_mov_b64 v[54:55], 0
    v_mov_b64 v[56:57], 0
    v_mov_b64 v[58:59], 0
    v_mov_b64 v[60:61], 0
    v_mov_b64 v[62:63], 0
    s_mov_b32 m0, 2048
    s_sub_u32 s26, s21, 1536
    s_add_u32 s27, s26, 4096
    s_barrier
    buffer_load_dwordx4 v1, s[8:11], s26 offen sc1 lds
    v_add_u32 v9, 1, v9
    s_mov_b32 s36, 0
    s_mov_b32 s28, 1
    s_mov_b32 m0, 6144
    s_nop 4
    buffer_load_dwordx4 v1, s[8:11], s27 offen sc1 lds
    s_waitcnt vmcnt(1) lgkmcnt(0)
    s_barrier
L_got_86:
    ds_read_b64_tr_b16 v[12:13], v0 offset:0
    ds_read_b64_tr_b16 v[14:15], v0 offset:512
    ds_read_b64_tr_b16 v[16:17], v0 offset:1024
    ds_read_b64_tr_b16 v[18:19], v0 offset:1536
    ds_read_b64_tr_b16 v[20:21], v0 offset:2048
    s_waitcnt vmcnt(0)
    s_barrier
L_dry_85:
    s_waitcnt lgkmcnt(3)
    v_smfmac_f32_16x16x64_bf16 v[40:43], v[12:15], a[0:7], v2
    ds_read_b64_tr_b16 v[22:23], v0 offset:2560
    v_smfmac_f32_16x16x64_bf16 v[44:47], v[12:15], a[56:63], v2
    ds_read_b64_tr_b16 v[24:25], v0 offset:3072
    s_waitcnt lgkmcnt(3)
    v_smfmac_f32_16x16x64_bf16 v[40:43], v[16:19], a[8:15], v2
    ds_read_b64_tr_b16 v[26:27], v0 offset:3584
    v_smfmac_f32_16x16x64_bf16 v[44:47], v[16:19], a[64:71], v2
    ds_read_b64_tr_b16 v[28:29], v0 offset:4096
    s_waitcnt lgkmcnt(3)
    v_smfmac_f32_16x16x64_bf16 v[40:43], v[20:23], a[16:23], v2
    ds_read_b64_tr_b16 v[30:31], v0 offset:4608
    v_smfmac_f32_16x16x64_bf16 v[44:47], v[20:23], a[72:79], v2
    ds_read_b64_tr_b16 v[32:33], v0 offset:5120
    s_waitcnt lgkmcnt(3)
    v_smfmac_f32_16x16x64_bf16 v[40:43], v[24:27], a[24:31], v2
    ds_read_b64_tr_b16 v[34:35], v0 offset:5632
    v_smfmac_f32_16x16x64_bf16 v[44:47], v[24:27], a[80:87], v2
    ds_read_b64_tr_b16 v[36:37], v0 offset:6144
    s_waitcnt lgkmcnt(3)
    v_smfmac_f32_16x16x64_bf16 v[40:43], v[28:31], a[32:39], v2
    ds_read_b64_tr_b16 v[38:39], v0 offset:6656
    v_smfmac_f32_16x16x64_bf16 v[44:47], v[28:31], a[88:95], v2
    s_waitcnt lgkmcnt(2)
    v_smfmac_f32_16x16x64_bf16 v[40:43], v[32:35], a[40:47], v2
    v_smfmac_f32_16x16x64_bf16 v[44:47], v[32:35], a[96:103], v2
    s_waitcnt lgkmcnt(0)
    v_smfmac_f32_16x16x64_bf16 v[40:43], v[36:39], a[48:55], v2
    v_smfmac_f32_16x16x64_bf16 v[44:47], v[36:39], a[104:111], v2
    v_smfmac_f32_16x16x64_bf16 v[48:51], v[12:15], a[112:119], v2
    v_smfmac_f32_16x16x64_bf16 v[48:51], v[16:19], a[120:127], v2
    v_add_f32 v40, v40, v42
    v_smfmac_f32_16x16x64_bf16 v[48:51], v[20:23], a[128:135], v2
    v_add_f32 v41, v41, v43
    v_smfmac_f32_16x16x64_bf16 v[48:51], v[24:27], a[136:143], v2
    v_cvt_pk_bf16_f32 v40, v40, v41
    v_smfmac_f32_16x16x64_bf16 v[48:51], v[28:31], a[144:151], v2
    ds_write_b32 v3, v40 offset:7424
    v_smfmac_f32_16x16x64_bf16 v[48:51], v[32:35], a[152:159], v2
    v_add_f32 v44, v44, v46
    v_smfmac_f32_16x16x64_bf16 v[48:51], v[36:39], a[160:167], v2
    v_add_f32 v45, v45, v47
    v_smfmac_f32_16x16x64_bf16 v[52:55], v[12:15], a[168:175], v2
    v_cvt_pk_bf16_f32 v44, v44, v45
    v_smfmac_f32_16x16x64_bf16 v[52:55], v[16:19], a[176:183], v2
    ds_write_b32 v3, v44 offset:8448
    v_smfmac_f32_16x16x64_bf16 v[52:55], v[20:23], a[184:191], v2
    v_add_f32 v48, v48, v50
    v_smfmac_f32_16x16x64_bf16 v[52:55], v[24:27], a[192:199], v2
    v_add_f32 v49, v49, v51
    v_smfmac_f32_16x16x64_bf16 v[52:55], v[28:31], a[200:207], v2
    v_cvt_pk_bf16_f32 v48, v48, v49
    v_smfmac_f32_16x16x64_bf16 v[52:55], v[32:35], a[208:215], v2
    ds_write_b32 v3, v48 offset:9472
    v_smfmac_f32_16x16x64_bf16 v[52:55], v[36:39], a[216:223], v2
    ds_write_b32 v8, v9 offset:0
    v_smfmac_f32_16x16x64_bf16 v[56:59], v[12:15], a[224:231], v2
    v_mov_b64 v[40:41], 0
    v_smfmac_f32_16x16x64_bf16 v[56:59], v[16:19], a[232:239], v2
    v_mov_b64 v[42:43], 0
    v_smfmac_f32_16x16x64_bf16 v[56:59], v[20:23], a[240:247], v2
    v_add_f32 v52, v52, v54
    v_smfmac_f32_16x16x64_bf16 v[56:59], v[24:27], a[248:255], v2
    v_add_f32 v53, v53, v55
    v_smfmac_f32_16x16x64_bf16 v[56:59], v[28:31], v[64:71], v2
    v_cvt_pk_bf16_f32 v52, v52, v53
    v_smfmac_f32_16x16x64_bf16 v[56:59], v[32:35], v[72:79], v2
    ds_write_b32 v3, v52 offset:10496
    v_smfmac_f32_16x16x64_bf16 v[56:59], v[36:39], v[80:87], v2
    v_smfmac_f32_16x16x64_bf16 v[60:63], v[12:15], v[88:95], v2
    v_smfmac_f32_16x16x64_bf16 v[60:63], v[16:19], v[96:103], v2
    v_smfmac_f32_16x16x64_bf16 v[60:63], v[20:23], v[104:111], v2
    v_add_f32 v56, v56, v58
    v_smfmac_f32_16x16x64_bf16 v[60:63], v[24:27], v[112:119], v2
    v_add_f32 v57, v57, v59
    v_smfmac_f32_16x16x64_bf16 v[60:63], v[28:31], v[120:127], v2
    v_cvt_pk_bf16_f32 v56, v56, v57
    v_smfmac_f32_16x16x64_bf16 v[60:63], v[32:35], v[128:135], v2
    ds_write_b32 v3, v56 offset:11520
    v_smfmac_f32_16x16x64_bf16 v[60:63], v[36:39], v[136:143], v2
    ds_write_b32 v8, v9 offset:1024
    v_smfmac_f32_16x16x64_bf16 v[40:43], v[12:15], v[144:151], v2
    v_smfmac_f32_16x16x64_bf16 v[40:43], v[16:19], v[152:159], v2
    v_smfmac_f32_16x16x64_bf16 v[40:43], v[20:23], v[160:167], v2
    v_add_f32 v60, v60, v62
    v_smfmac_f32_16x16x64_bf16 v[40:43], v[24:27], v[168:175], v2
    v_add_f32 v61, v61, v63
    v_smfmac_f32_16x16x64_bf16 v[40:43], v[28:31], v[176:183], v2
    v_cvt_pk_bf16_f32 v60, v60, v61
    v_smfmac_f32_16x16x64_bf16 v[40:43], v[32:35], v[184:191], v2
    ds_write_b32 v3, v60 offset:12544
    v_smfmac_f32_16x16x64_bf16 v[40:43], v[36:39], v[192:199], v2
    s_nop 7
    v_pk_add_f32 v[40:41], v[40:41], v[42:43]
    v_cvt_pk_bf16_f32 v40, v40, v41
    ds_write_b32 v3, v40 offset:12672
    ds_write_b32 v8, v9 offset:2048
    s_and_b32 s26, s19, 1
    s_xor_b32 s26, s26, 0
    s_mul_i32 s26, s26, 28672
    s_add_u32 s26, s26, 20480
    s_add_u32 s27, s24, 53760
    s_mov_b32 m0, s26
    s_nop 0
    buffer_load_dwordx4 v1, s[8:11], s27 offen offset:0  lds
    buffer_load_dwordx4 v1, s[8:11], s27 offen offset:1024  lds
    buffer_load_dwordx4 v1, s[8:11], s27 offen offset:2048  lds
    buffer_load_dwordx4 v1, s[8:11], s27 offen offset:3072  lds
    s_waitcnt lgkmcnt(0)
    s_barrier
    s_and_b32 s26, s19, 1
    s_xor_b32 s26, s26, 0
    s_mul_i32 s26, s26, 28672
    s_add_u32 s26, s26, 24576
    s_add_u32 s27, s24, 57856
    s_mov_b32 m0, s26
    s_nop 0
    buffer_load_dwordx4 v1, s[8:11], s27 offen offset:0  lds
    buffer_load_dwordx4 v1, s[8:11], s27 offen offset:1024  lds
    buffer_load_dwordx4 v1, s[8:11], s27 offen offset:2048  lds
    buffer_load_dwordx4 v1, s[8:11], s27 offen offset:3072  lds
    s_add_u32 s26, s26, 4096
    s_add_u32 s27, s27, 4096
    s_mov_b32 m0, s26
    s_nop 0
    buffer_load_dwordx4 v1, s[8:11], s27 offen offset:0  lds
    buffer_load_dwordx4 v1, s[8:11], s27 offen offset:1024  lds
    buffer_load_dwordx4 v1, s[8:11], s27 offen offset:2048  lds
    buffer_load_dwordx4 v1, s[8:11], s27 offen offset:3072  lds
    s_add_u32 s26, s26, 4096
    s_add_u32 s27, s27, 4096
    s_mov_b32 m0, s26
    s_nop 0
    buffer_load_dwordx4 v1, s[8:11], s27 offen offset:0  lds
    buffer_load_dwordx4 v1, s[8:11], s27 offen offset:1024  lds
    buffer_load_dwordx4 v1, s[8:11], s27 offen offset:2048  lds
    buffer_load_dwordx4 v1, s[8:11], s27 offen offset:3072  lds
    s_add_u32 s26, s26, 4096
    s_add_u32 s27, s27, 4096
    s_mov_b32 m0, s26
    s_nop 0
    buffer_load_dwordx4 v1, s[8:11], s27 offen offset:0  lds
    buffer_load_dwordx4 v1, s[8:11], s27 offen offset:1024  lds
    buffer_load_dwordx4 v1, s[8:11], s27 offen offset:2048  lds
    buffer_load_dwordx4 v1, s[8:11], s27 offen offset:3072  lds
    s_barrier
    v_mov_b32 v12, 18432
    ds_read_b32 v12, v12
    s_waitcnt lgkmcnt(0)
    v_and_b32 v13, 0x3fffffff, v12
    v_cmp_eq_u32 vcc, v13, v9
    s_cbranch_vccnz L_again_87
    s_add_u32 s19, s19, 1
    s_add_u32 s21, s21, 8192
    s_add_u32 s22, s22, 16384
    s_add_u32 s24, s24, 28672
    s_add_u32 s25, s25, 458752
    s_add_u32 s32, s32, 64
    s_cmp_ge_u32 s19, 63
    s_cbranch_scc1 L_exit
    s_sleep 4
    s_and_b32 s26, s19, 1
    s_xor_b32 s26, s26, 1
    s_mul_i32 s26, s26, 28672
    s_add_u32 s26, s26, 45056
    s_add_u32 s27, s24, 49664
    s_mov_b32 m0, s26
    s_nop 0
    buffer_load_dwordx4 v1, s[8:11], s27 offen offset:0  lds
    buffer_load_dwordx4 v1, s[8:11], s27 offen offset:1024  lds
    buffer_load_dwordx4 v1, s[8:11], s27 offen offset:2048  lds
    buffer_load_dwordx4 v1, s[8:11], s27 offen offset:3072  lds
    s_sleep 2
    s_branch L_sc2_top_83
L_sc2_first_84:
    v_add_u32 v9, 1, v9
    s_mov_b32 s36, 1
    s_mov_b32 s28, 0
L_pm_88:
    buffer_load_dwordx4 v[12:15], v1, s[8:11], s21 offen sc1
    buffer_load_dwordx4 v[16:19], v1, s[8:11], s21 offen offset:768 sc1
    s_add_u32 s28, s28, 1
    s_waitcnt vmcnt(1)
    ds_write_b128 v1, v[12:15]
    v_max3_u32 v20, v12, v13, v14
    s_waitcnt vmcnt(0)
    ds_write_b128 v1, v[16:19] offset:768
    v_max3_u32 v20, v20, v15, v16
    v_max3_u32 v20, v20, v17, v18
    v_max_u32 v20, v20, v19
    v_cmp_eq_u32 vcc, -1, v20
    s_cbranch_vccz L_pmd_89
    s_cmp_lt_u32 s28, s29
    s_cbranch_scc1 L_pm_88
    s_mov_b32 s29, 1
L_pmd_89:
    s_waitcnt lgkmcnt(0)
    s_barrier
    s_branch L_got_86
L_again_87:
    v_mov_b64 v[40:41], 0
    v_mov_b64 v[42:43], 0
    v_mov_b64 v[44:45], 0
    v_mov_b64 v[46:47], 0
    v_mov_b64 v[48:49], 0
    v_mov_b64 v[50:51], 0
    v_mov_b64 v[52:53], 0
    v_mov_b64 v[54:55], 0
    v_mov_b64 v[56:57], 0
    v_mov_b64 v[58:59], 0
    v_mov_b64 v[60:61], 0
    v_mov_b64 v[62:63], 0
    v_cmp_eq_u32 vcc, v12, v9
    s_cbranch_vccnz L_sc2_first_84
    v_add_u32 v9, 1, v9
    s_branch L_got_86
L_sc0_n2:
    v_lshrrev_b32 v11, 1, v0
    v_min_u32 v11, 220, v11
    s_and_b32 s26, s16, 3
    s_lshl_b32 s26, s26, 8
    s_add_u32 s26, s26, 7168
    v_add_u32 v11, s26, v11
    v_and_b32 v252, 120, v0
    v_lshlrev_b32 v252, 3, v252
    v_add_u32 v252, 6144, v252
    s_mov_b32 s23, 0
    s_lshl_b32 s26, s16, 2
    s_add_u32 s26, s26, 12288
    v_lshlrev_b32 v254, 4, v0
    v_add_u32 v254, s26, v254
    v_mov_b32 v255, 0
    v_mov_b64 v[40:41], 0
    v_mov_b64 v[42:43], 0
    v_mov_b64 v[44:45], 0
    v_mov_b64 v[46:47], 0
    v_mov_b64 v[48:49], 0
    v_mov_b64 v[50:51], 0
    v_mov_b64 v[52:53], 0
    v_mov_b64 v[54:55], 0
    v_mov_b64 v[56:57], 0
    v_mov_b64 v[58:59], 0
    v_mov_b64 v[228:229], 0
    v_mov_b64 v[230:231], 0
    v_mov_b64 v[232:233], 0
    v_mov_b64 v[234:235], 0
    v_mov_b32 v236, v10
    v_mov_b32 v237, v10
    v_mov_b64 v[238:239], 0
    s_branch L_sc3_first_91
    .p2align 6
    s_nop 0
    s_nop 0
    s_nop 0
    s_nop 0
    s_nop 0
L_sc3_top_90:
    v_mov_b64 v[40:41], 0
    v_mov_b64 v[42:43], 0
    v_mov_b64 v[44:45], 0
    v_mov_b64 v[46:47], 0
    v_mov_b64 v[48:49], 0
    v_mov_b64 v[50:51], 0
    v_mov_b64 v[52:53], 0
    v_mov_b64 v[54:55], 0
    v_mov_b64 v[56:57], 0
    v_mov_b64 v[58:59], 0
    v_mov_b64 v[228:229], 0
    v_mov_b64 v[230:231], 0
    v_mov_b64 v[232:233], 0
    v_mov_b64 v[234:235], 0
    v_mov_b32 v236, v10
    v_mov_b32 v237, v10
    v_mov_b64 v[238:239], 0
    s_mov_b32 m0, 3072
    s_sub_u32 s26, s21, 2304
    s_add_u32 s27, s26, 4096
    s_barrier
    buffer_load_dwordx4 v1, s[8:11], s26 offen sc1 lds
    s_add_u32 s23, s23, 1
    s_mov_b32 s36, 0
    s_mov_b32 s28, 1
    s_mov_b32 m0, 7168
    s_waitcnt vmcnt(0) lgkmcnt(0)
    s_barrier
L_got_93:
    ds_read_b64_tr_b16 v[12:13], v0 offset:0
    ds_read_b64_tr_b16 v[14:15], v0 offset:512
    ds_read_b64_tr_b16 v[16:17], v0 offset:1024
    ds_read_b64_tr_b16 v[18:19], v0 offset:1536
    ds_read_b64_tr_b16 v[20:21], v0 offset:2048
    s_waitcnt vmcnt(0)
    s_barrier
L_dry_92:
    s_waitcnt lgkmcnt(3)
    v_smfmac_f32_16x16x64_bf16 v[40:43], v[12:15], a[0:7], v2
    ds_read_b64_tr_b16 v[22:23], v0 offset:2560
    v_smfmac_f32_16x16x64_bf16 v[44:47], v[12:15], a[56:63], v2
    ds_read_b64_tr_b16 v[24:25], v0 offset:3072
    s_waitcnt lgkmcnt(3)
    v_smfmac_f32_16x16x64_bf16 v[40:43], v[16:19], a[8:15], v2
    ds_read_b64_tr_b16 v[26:27], v0 offset:3584
    v_smfmac_f32_16x16x64_bf16 v[44:47], v[16:19], a[64:71], v2
    ds_read_b64_tr_b16 v[28:29], v0 offset:4096
    s_waitcnt lgkmcnt(3)
    v_smfmac_f32_16x16x64_bf16 v[40:43], v[20:23], a[16:23], v2
    ds_read_b64_tr_b16 v[30:31], v0 offset:4608
    v_smfmac_f32_16x16x64_bf16 v[44:47], v[20:23], a[72:79], v2
    ds_read_b64_tr_b16 v[32:33], v0 offset:5120
    s_waitcnt lgkmcnt(3)
    v_smfmac_f32_16x16x64_bf16 v[40:43], v[24:27], a[24:31], v2
    ds_read_b64_tr_b16 v[34:35], v0 offset:5632
    v_smfmac_f32_16x16x64_bf16 v[44:47], v[24:27], a[80:87], v2
    ds_read_b64_tr_b16 v[36:37], v0 offset:6144
    s_waitcnt lgkmcnt(3)
    v_smfmac_f32_16x16x64_bf16 v[40:43], v[28:31], a[32:39], v2
    ds_read_b64_tr_b16 v[38:39], v0 offset:6656
    v_smfmac_f32_16x16x64_bf16 v[44:47], v[28:31], a[88:95], v2
    s_waitcnt lgkmcnt(2)
    v_smfmac_f32_16x16x64_bf16 v[40:43], v[32:35], a[40:47], v2
    v_smfmac_f32_16x16x64_bf16 v[44:47], v[32:35], a[96:103], v2
    s_waitcnt lgkmcnt(0)
    v_smfmac_f32_16x16x64_bf16 v[40:43], v[36:39], a[48:55], v2
    v_smfmac_f32_16x16x64_bf16 v[44:47], v[36:39], a[104:111], v2
    v_smfmac_f32_16x16x64_bf16 v[48:51], v[12:15], a[112:119], v2
    v_smfmac_f32_16x16x64_bf16 v[48:51], v[16:19], a[120:127], v2
    v_add_f32 v40, v40, v42
    v_smfmac_f32_16x16x64_bf16 v[48:51], v[20:23], a[128:135], v2
    v_add_f32 v41, v41, v43
    v_smfmac_f32_16x16x64_bf16 v[48:51], v[24:27], a[136:143], v2
    v_cvt_pk_bf16_f32 v40, v40, v41
    v_smfmac_f32_16x16x64_bf16 v[48:51], v[28:31], a[144:151], v2
    ds_write_b32 v3, v40 offset:7552
    v_smfmac_f32_16x16x64_bf16 v[48:51], v[32:35], a[152:159], v2
    v_add_f32 v44, v44, v46
    v_smfmac_f32_16x16x64_bf16 v[48:51], v[36:39], a[160:167], v2
    v_add_f32 v45, v45, v47
    v_smfmac_f32_16x16x64_bf16 v[52:55], v[12:15], a[168:175], v2
    v_cvt_pk_bf16_f32 v44, v44, v45
    v_smfmac_f32_16x16x64_bf16 v[52:55], v[16:19], a[176:183], v2
    ds_write_b32 v3, v44 offset:8576
    v_smfmac_f32_16x16x64_bf16 v[52:55], v[20:23], a[184:191], v2
    v_add_f32 v48, v48, v50
    v_smfmac_f32_16x16x64_bf16 v[52:55], v[24:27], a[192:199], v2
    v_add_f32 v49, v49, v51
    v_smfmac_f32_16x16x64_bf16 v[52:55], v[28:31], a[200:207], v2
    v_cvt_pk_bf16_f32 v48, v48, v49
    v_smfmac_f32_16x16x64_bf16 v[52:55], v[32:35], a[208:215], v2
    ds_write_b32 v3, v48 offset:9600
    v_smfmac_f32_16x16x64_bf16 v[52:55], v[36:39], a[216:223], v2
    v_cmp_u_f32 vcc, v41, v42
    v_smfmac_f32_16x16x64_bf16 v[56:59], v[12:15], a[224:231], v2
    s_cbranch_vccnz L_eb_94
L_ec_95:
    v_smfmac_f32_16x16x64_bf16 v[56:59], v[16:19], a[232:239], v2
    v_smfmac_f32_16x16x64_bf16 v[56:59], v[20:23], a[240:247], v2
    v_add_f32 v52, v52, v54
    v_smfmac_f32_16x16x64_bf16 v[56:59], v[24:27], a[248:255], v2
    ds_read_b128 v[240:243], v4 offset:14336
    ds_read_b64_tr_b16 v[200:201], v0 offset:7168
    v_add_f32 v53, v53, v55
    v_smfmac_f32_16x16x64_bf16 v[56:59], v[28:31], v[64:71], v2
    ds_read_b64_tr_b16 v[202:203], v0 offset:7680
    ds_read_b64_tr_b16 v[204:205], v0 offset:8192
    v_cvt_pk_bf16_f32 v52, v52, v53
    v_smfmac_f32_16x16x64_bf16 v[56:59], v[32:35], v[72:79], v2
    ds_write_b32 v3, v52 offset:10624
    ds_read_b64_tr_b16 v[206:207], v0 offset:8704
    ds_read_b64_tr_b16 v[208:209], v0 offset:9216
    v_smfmac_f32_16x16x64_bf16 v[56:59], v[36:39], v[80:87], v2
    ds_read_b64_tr_b16 v[210:211], v0 offset:9728
    s_waitcnt lgkmcnt(5)
    v_mfma_f32_16x16x32_bf16 v[236:239], v[200:203], v[12:15], v[236:239]
    v_min3_u32 v251, v240, v241, v242
    v_smfmac_f32_16x16x64_bf16 v[228:231], v[200:203], v[88:95], v2
    v_smfmac_f32_16x16x64_bf16 v[232:235], v[200:203], v[144:151], v2
    v_add_f32 v56, v56, v58
    s_waitcnt lgkmcnt(2)
    v_mfma_f32_16x16x32_bf16 v[236:239], v[204:207], v[16:19], v[236:239]
    v_add_f32 v57, v57, v59
    v_smfmac_f32_16x16x64_bf16 v[228:231], v[204:207], v[96:103], v2
    v_cvt_pk_bf16_f32 v56, v56, v57
    v_smfmac_f32_16x16x64_bf16 v[232:235], v[204:207], v[152:159], v2
    ds_write_b32 v3, v56 offset:11648
    s_waitcnt lgkmcnt(1)
    v_mfma_f32_16x16x32_bf16 v[236:239], v[208:211], v[20:23], v[236:239]
    v_smfmac_f32_16x16x64_bf16 v[228:231], v[208:211], v[104:111], v2
    v_smfmac_f32_16x16x64_bf16 v[232:235], v[208:211], v[160:167], v2
    s_nop 7
    ds_read_b128 v[240:243], v4 offset:15360
    ds_read_b64_tr_b16 v[212:213], v0 offset:10240
    ds_read_b64_tr_b16 v[214:215], v0 offset:10752
    ds_read_b64_tr_b16 v[216:217], v0 offset:11264
    ds_read_b64_tr_b16 v[218:219], v0 offset:11776
    s_waitcnt lgkmcnt(2)
    v_mfma_f32_16x16x32_bf16 v[236:239], v[212:215], v[24:27], v[236:239]
    v_min3_u32 v240, v240, v241, v242
    v_min_u32 v251, v251, v240
    v_smfmac_f32_16x16x64_bf16 v[228:231], v[212:215], v[112:119], v2
    v_smfmac_f32_16x16x64_bf16 v[232:235], v[212:215], v[168:175], v2
    s_waitcnt lgkmcnt(0)
    v_mfma_f32_16x16x32_bf16 v[236:239], v[216:219], v[28:31], v[236:239]
    v_smfmac_f32_16x16x64_bf16 v[228:231], v[216:219], v[120:127], v2
    v_smfmac_f32_16x16x64_bf16 v[232:235], v[216:219], v[176:183], v2
    v_mov_b64 v[206:207], 0
    v_mov_b64 v[208:209], 0
    v_mov_b32 v211, 0
    v_mov_b32 v203, 0
    s_nop 3
    s_nop 3
    ds_read_b128 v[240:243], v4 offset:16384
    ds_read_b64_tr_b16 v[220:221], v0 offset:12288
    ds_read_b64_tr_b16 v[222:223], v0 offset:12800
    s_barrier
    ds_read_b64_tr_b16 v[224:225], v0 offset:13312
    ds_read_b64_tr_b16 v[226:227], v0 offset:13824
    s_waitcnt lgkmcnt(2)
    v_mfma_f32_16x16x32_bf16 v[236:239], v[220:223], v[32:35], v[236:239]
    v_min3_u32 v240, v240, v241, v242
    v_smfmac_f32_16x16x64_bf16 v[228:231], v[220:223], v[128:135], v2
    v_min_u32 v251, v251, v240
    v_smfmac_f32_16x16x64_bf16 v[232:235], v[220:223], v[184:191], v2
    v_subrev_u32 v251, s23, v251
    s_waitcnt lgkmcnt(0)
    v_mfma_f32_16x16x32_bf16 v[236:239], v[224:227], v[36:39], v[236:239]
    v_smfmac_f32_16x16x64_bf16 v[228:231], v[224:227], v[136:143], v2
    v_smfmac_f32_16x16x64_bf16 v[232:235], v[224:227], v[192:199], v2
    s_mov_b32 s27, 1006632960
    s_mov_b32 s28, 0
    v_add_f32_dpp v244, v238, v236 quad_perm:[2,3,0,1] row_mask:0xf bank_mask:0xf
    v_add_f32_dpp v245, v239, v237 quad_perm:[2,3,0,1] row_mask:0xf bank_mask:0xf
    s_nop 0
    v_pk_add_f32 v[240:241], v[228:229], v[230:231]
    v_exp_f32 v236, v244
    v_exp_f32 v237, v245
    v_pk_add_f32 v[242:243], v[232:233], v[234:235]
    v_exp_f32 v228, v240
    v_exp_f32 v229, v241
    v_exp_f32 v230, v242
    v_exp_f32 v231, v243
L_smr_96:
    v_pk_add_f32 v[248:249], v[228:229], v[236:237]
    v_cvt_pk_bf16_f32 v202, v236, v237
    v_pk_add_f32 v[248:249], v[248:249], v[230:231]
    v_cvt_pk_bf16_f32 v200, v228, v229
    s_nop 0
    v_add_f32_dpp v248, v248, v248 row_ror:8 row_mask:0xf bank_mask:0xf
    v_add_f32_dpp v249, v249, v249 row_ror:8 row_mask:0xf bank_mask:0xf
    v_cvt_pk_bf16_f32 v201, v230, v231
    v_add_f32_dpp v248, v248, v248 row_ror:4 row_mask:0xf bank_mask:0xf
    v_add_f32_dpp v249, v249, v249 row_ror:4 row_mask:0xf bank_mask:0xf
    s_nop 0
    v_add_f32_dpp v248, v248, v248 row_ror:2 row_mask:0xf bank_mask:0xf
    v_add_f32_dpp v249, v249, v249 row_ror:2 row_mask:0xf bank_mask:0xf
    s_nop 0
    v_add_f32_dpp v248, v248, v248 row_ror:1 row_mask:0xf bank_mask:0xf
    v_add_f32_dpp v249, v249, v249 row_ror:1 row_mask:0xf bank_mask:0xf
    v_rcp_f32 v246, v248
    v_rcp_f32 v247, v249
    v_subrev_u32 v248, 562036736, v248
    v_cvt_pk_bf16_f32 v250, v246, v247
    v_and_b32 v204, v250, v7
    v_and_b32 v205, v250, v8
    v_and_b32 v210, v250, v9
    v_subrev_u32 v249, 562036736, v249
    v_mfma_f32_16x16x32_bf16 v[212:215], v[200:203], v[204:207], 0
    v_mfma_f32_16x16x32_bf16 v[216:219], v[200:203], v[208:211], 0
    v_max3_u32 v248, v248, v249, v251
    v_cmp_lt_u32 vcc, s27, v248
    s_or_b64 vcc, vcc, s[34:35]
    s_cselect_b64 exec, 0, -1
    s_nop 0
    v_cvt_pk_bf16_f32 v212, v212, v213
    v_cvt_pk_bf16_f32 v213, v214, v215
    buffer_store_dwordx2 v[212:213], v5, s[8:11], s22 offen sc1
    v_cvt_pk_bf16_f32 v216, v216, v217
    buffer_store_dword v216, v6, s[8:11], s22 offen sc1
    s_mov_b64 exec, -1
    s_cbranch_scc1 L_sms_97
    s_barrier
    s_add_u32 s19, s19, 1
    s_add_u32 s21, s21, 8192
    s_add_u32 s22, s22, 16384
    s_add_u32 s24, s24, 28672
    s_add_u32 s25, s25, 458752
    s_add_u32 s32, s32, 64
    s_cmp_ge_u32 s19, 63
    s_cbranch_scc1 L_exit
    s_and_b32 s26, s19, 1
    s_mul_i32 s26, s26, 28672
    v_add_u32 v240, s26, v4
    ds_read_b128 v[88:91], v240 offset:20480
    ds_read_b128 v[92:95], v240 offset:21504
    ds_read_b128 v[96:99], v240 offset:22528
    ds_read_b128 v[100:103], v240 offset:23552
    ds_read_b128 v[104:107], v240 offset:24576
    ds_read_b128 v[108:111], v240 offset:25600
    ds_read_b128 v[112:115], v240 offset:26624
    ds_read_b128 v[116:119], v240 offset:27648
    ds_read_b128 v[120:123], v240 offset:28672
    ds_read_b128 v[124:127], v240 offset:29696
    ds_read_b128 v[128:131], v240 offset:30720
    ds_read_b128 v[132:135], v240 offset:31744
    ds_read_b128 v[136:139], v240 offset:32768
    ds_read_b128 v[140:143], v240 offset:33792
    ds_read_b128 v[144:147], v240 offset:34816
    ds_read_b128 v[148:151], v240 offset:35840
    ds_read_b128 v[152:155], v240 offset:36864
    ds_read_b128 v[156:159], v240 offset:37888
    ds_read_b128 v[160:163], v240 offset:38912
    ds_read_b128 v[164:167], v240 offset:39936
    ds_read_b128 v[168:171], v240 offset:40960
    ds_read_b128 v[172:175], v240 offset:41984
    ds_read_b128 v[176:179], v240 offset:43008
    ds_read_b128 v[180:183], v240 offset:44032
    ds_read_b128 v[184:187], v240 offset:45056
    ds_read_b128 v[188:191], v240 offset:46080
    ds_read_b128 v[192:195], v240 offset:47104
    ds_read_b128 v[196:199], v240 offset:48128
    s_branch L_sc3_top_90
L_sc3_first_91:
    s_add_u32 s23, s23, 1
    s_mov_b32 s36, 1
    s_mov_b32 s28, 0
L_pm_99:
    buffer_load_dwordx4 v[12:15], v1, s[8:11], s21 offen sc1
    buffer_load_dwordx4 v[16:19], v1, s[8:11], s21 offen offset:768 sc1
    s_add_u32 s28, s28, 1
    s_waitcnt vmcnt(1)
    ds_write_b128 v1, v[12:15]
    v_max3_u32 v20, v12, v13, v14
    s_waitcnt vmcnt(0)
    ds_write_b128 v1, v[16:19] offset:768
    v_max3_u32 v20, v20, v15, v16
    v_max3_u32 v20, v20, v17, v18
    v_max_u32 v20, v20, v19
    v_cmp_eq_u32 vcc, -1, v20
    s_cbranch_vccz L_pmd_100
    s_cmp_lt_u32 s28, s29
    s_cbranch_scc1 L_pm_99
    s_mov_b32 s29, 1
L_pmd_100:
    s_waitcnt lgkmcnt(0)
    s_barrier
    s_branch L_got_93
L_eb_94:
    s_cmp_lg_u32 s36, 0
    s_cbranch_scc1 L_ec_95
    s_mov_b32 s28, 0
L_el_101:
    s_mov_b32 s26, s21
    buffer_load_dwordx4 v[200:203], v4, s[8:11], s26 offen offset:0 sc1
    buffer_load_dwordx4 v[204:207], v4, s[8:11], s26 offen offset:1024 sc1
    buffer_load_dwordx4 v[208:211], v4, s[8:11], s26 offen offset:2048 sc1
    buffer_load_dwordx4 v[212:215], v4, s[8:11], s26 offen offset:3072 sc1
    s_add_u32 s26, s26, 4096
    buffer_load_dwordx4 v[216:219], v4, s[8:11], s26 offen offset:0 sc1
    buffer_load_dwordx4 v[220:223], v4, s[8:11], s26 offen offset:1024 sc1
    buffer_load_dwordx4 v[224:227], v4, s[8:11], s26 offen offset:2048 sc1
    s_add_u32 s28, s28, 1
    s_waitcnt vmcnt(0)
    v_max_u32 v240, v200, v201
    v_max3_u32 v240, v240, v202, v203
    v_max3_u32 v240, v240, v204, v205
    v_max3_u32 v240, v240, v206, v207
    v_max3_u32 v240, v240, v208, v209
    v_max3_u32 v240, v240, v210, v211
    v_max3_u32 v240, v240, v212, v213
    v_max3_u32 v240, v240, v214, v215
    v_max3_u32 v240, v240, v216, v217
    v_max3_u32 v240, v240, v218, v219
    v_max3_u32 v240, v240, v220, v221
    v_max3_u32 v240, v240, v222, v223
    v_max3_u32 v240, v240, v224, v225
    v_max3_u32 v240, v240, v226, v227
    v_cmp_eq_u32 vcc, -1, v240
    s_cbranch_vccz L_ed_102
    s_cmp_lt_u32 s28, s29
    s_cbranch_scc1 L_el_101
    s_mov_b32 s29, 1
L_ed_102:
    ds_write_b128 v4, v[200:203] offset:0
    ds_write_b128 v4, v[204:207] offset:1024
    ds_write_b128 v4, v[208:211] offset:2048
    ds_write_b128 v4, v[212:215] offset:3072
    ds_write_b128 v4, v[216:219] offset:4096
    ds_write_b128 v4, v[220:223] offset:5120
    ds_write_b128 v4, v[224:227] offset:6144
    s_or_b32 s26, s23, 0x40000000
    v_mov_b32 v240, 18432
    v_mov_b32 v241, s26
    ds_write_b32 v240, v241
    v_mov_b64 v[40:41], 0
    v_mov_b64 v[42:43], 0
    v_mov_b64 v[44:45], 0
    v_mov_b64 v[46:47], 0
    v_mov_b64 v[48:49], 0
    v_mov_b64 v[50:51], 0
    v_mov_b64 v[52:53], 0
    v_mov_b64 v[54:55], 0
    v_mov_b64 v[56:57], 0
    v_mov_b64 v[58:59], 0
    v_mov_b64 v[228:229], 0
    v_mov_b64 v[230:231], 0
    v_mov_b64 v[232:233], 0
    v_mov_b64 v[234:235], 0
    v_mov_b32 v236, v10
    v_mov_b32 v237, v10
    v_mov_b64 v[238:239], 0
    s_add_u32 s23, s23, 1
    s_mov_b32 s36, 1
    s_waitcnt lgkmcnt(0)
    s_barrier
    s_barrier
    s_branch L_got_93
L_sms_97:
    s_cmp_lg_u32 s34, 0
    s_mov_b64 s[34:35], 0
    s_cbranch_scc1 L_vd_105
    s_cmp_eq_u32 s28, 0
    s_cbranch_scc1 L_loc_103
    s_cmp_lg_u32 s36, 0
    s_cbranch_scc1 L_safe_104
L_vd_105:
    v_mov_b32 v240, 18432
    s_nop 0
    v_mov_b32 v241, s23
    ds_write_b32 v240, v241
    s_waitcnt lgkmcnt(0)
    s_barrier
    v_mov_b64 v[40:41], 0
    v_mov_b64 v[42:43], 0
    v_mov_b64 v[44:45], 0
    v_mov_b64 v[46:47], 0
    v_mov_b64 v[48:49], 0
    v_mov_b64 v[50:51], 0
    v_mov_b64 v[52:53], 0
    v_mov_b64 v[54:55], 0
    v_mov_b64 v[56:57], 0
    v_mov_b64 v[58:59], 0
    v_mov_b64 v[228:229], 0
    v_mov_b64 v[230:231], 0
    v_mov_b64 v[232:233], 0
    v_mov_b64 v[234:235], 0
    v_mov_b32 v236, v10
    v_mov_b32 v237, v10
    v_mov_b64 v[238:239], 0
    s_branch L_sc3_first_91
L_safe_104:
    s_mov_b32 s27, -1
    s_branch L_smr_96
L_loc_103:
    s_mov_b32 s28, 1
    v_mov_b32 v251, 0
    v_mov_b64 v[228:229], 0
    v_mov_b64 v[230:231], 0
    v_mov_b64 v[232:233], 0
    v_mov_b64 v[234:235], 0
    v_mov_b32 v236, v10
    v_mov_b32 v237, v10
    v_mov_b64 v[238:239], 0
    s_mov_b32 s26, 0
L_rl_106:
    ds_read_b128 v[240:243], v4 offset:17408
    ds_read_b64_tr_b16 v[200:201], v0 offset:7168
    ds_read_b64_tr_b16 v[202:203], v0 offset:7680
    ds_read_b64_tr_b16 v[204:205], v0 offset:8192
    ds_read_b64_tr_b16 v[206:207], v0 offset:8704
    ds_read_b64_tr_b16 v[208:209], v0 offset:9216
    ds_read_b64_tr_b16 v[210:211], v0 offset:9728
    ds_read_b64_tr_b16 v[212:213], v0 offset:10240
    ds_read_b64_tr_b16 v[214:215], v0 offset:10752
    ds_read_b64_tr_b16 v[216:217], v0 offset:11264
    ds_read_b64_tr_b16 v[218:219], v0 offset:11776
    ds_read_b64_tr_b16 v[220:221], v0 offset:12288
    ds_read_b64_tr_b16 v[222:223], v0 offset:12800
    ds_read_b64_tr_b16 v[224:225], v0 offset:13312
    ds_read_b64_tr_b16 v[226:227], v0 offset:13824
    s_waitcnt lgkmcnt(0)
    v_mfma_f32_16x16x32_bf16 v[236:239], v[200:203], v[12:15], v[236:239]
    v_smfmac_f32_16x16x64_bf16 v[228:231], v[200:203], v[88:95], v2
    v_smfmac_f32_16x16x64_bf16 v[232:235], v[200:203], v[144:151], v2
    v_mfma_f32_16x16x32_bf16 v[236:239], v[204:207], v[16:19], v[236:239]
    v_smfmac_f32_16x16x64_bf16 v[228:231], v[204:207], v[96:103], v2
    v_smfmac_f32_16x16x64_bf16 v[232:235], v[204:207], v[152:159], v2
    v_mfma_f32_16x16x32_bf16 v[236:239], v[208:211], v[20:23], v[236:239]
    v_smfmac_f32_16x16x64_bf16 v[228:231], v[208:211], v[104:111], v2
    v_smfmac_f32_16x16x64_bf16 v[232:235], v[208:211], v[160:167], v2
    v_mfma_f32_16x16x32_bf16 v[236:239], v[212:215], v[24:27], v[236:239]
    v_smfmac_f32_16x16x64_bf16 v[228:231], v[212:215], v[112:119], v2
    v_smfmac_f32_16x16x64_bf16 v[232:235], v[212:215], v[168:175], v2
    v_mfma_f32_16x16x32_bf16 v[236:239], v[216:219], v[28:31], v[236:239]
    v_smfmac_f32_16x16x64_bf16 v[228:231], v[216:219], v[120:127], v2
    v_smfmac_f32_16x16x64_bf16 v[232:235], v[216:219], v[176:183], v2
    v_mfma_f32_16x16x32_bf16 v[236:239], v[220:223], v[32:35], v[236:239]
    v_smfmac_f32_16x16x64_bf16 v[228:231], v[220:223], v[128:135], v2
    v_smfmac_f32_16x16x64_bf16 v[232:235], v[220:223], v[184:191], v2
    v_mfma_f32_16x16x32_bf16 v[236:239], v[224:227], v[36:39], v[236:239]
    v_smfmac_f32_16x16x64_bf16 v[228:231], v[224:227], v[136:143], v2
    v_smfmac_f32_16x16x64_bf16 v[232:235], v[224:227], v[192:199], v2
    v_mov_b64 v[206:207], 0
    v_mov_b64 v[208:209], 0
    v_mov_b32 v211, 0
    v_mov_b32 v203, 0
    v_add_f32_dpp v244, v238, v236 quad_perm:[2,3,0,1] row_mask:0xf bank_mask:0xf
    v_add_f32_dpp v245, v239, v237 quad_perm:[2,3,0,1] row_mask:0xf bank_mask:0xf
    v_pk_add_f32 v[240:241], v[228:229], v[230:231]
    s_nop 0
    v_pk_add_f32 v[242:243], v[232:233], v[234:235]
    v_max3_f32 v246, v240, v244, v242
    v_max3_f32 v247, v241, v245, v243
    s_nop 0
    v_max_f32_dpp v246, v246, v246 row_ror:8 row_mask:0xf bank_mask:0xf
    v_max_f32_dpp v247, v247, v247 row_ror:8 row_mask:0xf bank_mask:0xf
    s_nop 0
    v_max_f32_dpp v246, v246, v246 row_ror:4 row_mask:0xf bank_mask:0xf
    v_max_f32_dpp v247, v247, v247 row_ror:4 row_mask:0xf bank_mask:0xf
    s_nop 0
    v_max_f32_dpp v246, v246, v246 row_ror:2 row_mask:0xf bank_mask:0xf
    v_max_f32_dpp v247, v247, v247 row_ror:2 row_mask:0xf bank_mask:0xf
    s_nop 0
    v_max_f32_dpp v246, v246, v246 row_ror:1 row_mask:0xf bank_mask:0xf
    v_max_f32_dpp v247, v247, v247 row_ror:1 row_mask:0xf bank_mask:0xf
    v_pk_add_f32 v[240:241], v[240:241], v[246:247] neg_lo:[0,1] neg_hi:[0,1]
    v_pk_add_f32 v[242:243], v[242:243], v[246:247] neg_lo:[0,1] neg_hi:[0,1]
    v_pk_add_f32 v[244:245], v[244:245], v[246:247] neg_lo:[0,1] neg_hi:[0,1]
    v_exp_f32 v228, v240
    v_exp_f32 v229, v241
    v_exp_f32 v230, v242
    v_exp_f32 v231, v243
    v_exp_f32 v236, v244
    v_exp_f32 v237, v245
    s_nop 1
    s_branch L_smr_96
L_sc_next0:
    s_branch L_exit
L_comb:
    v_mov_b32 v112, v1
    s_cmp_lg_u32 s17, 0
    s_cbranch_scc1 L_reg_108
    s_cmp_eq_u32 s18, 0
    s_cselect_b32 s26, 1, 0x10001
    s_mov_b64 exec, 1
    v_mov_b32 v2, 64
    v_mov_b32 v3, s26
    buffer_atomic_add v3, v2, s[12:15], 0 offen
    s_mov_b64 exec, -1
L_reg_108:
    v_lshlrev_b32 v0, 3, v112
    s_mul_i32 s26, s17, 1792
    v_lshlrev_b32 v1, 4, v112
    v_add_u32 v1, s26, v1
    v_and_b32 v113, 2, v112
    v_cmp_ne_u32 vcc, 0, v113
    v_mov_b32 v113, 0x4444
    v_mov_b32 v114, 0xeeee
    v_cndmask_b32 v2, v113, v114, vcc
    v_bfe_u32 v6, v112, 3, 1
    v_lshlrev_b32 v6, 9, v6
    v_bfe_u32 v113, v112, 2, 1
    v_lshl_add_u32 v6, v113, 6, v6
    v_and_b32 v113, 1, v112
    v_lshl_add_u32 v6, v113, 5, v6
    v_lshrrev_b32 v113, 4, v112
    v_lshl_add_u32 v6, v113, 3, v6
    v_bfe_u32 v113, v112, 1, 1
    v_lshl_add_u32 v6, v113, 2, v6
    s_sub_u32 s16, s16, 16
    s_lshl_b32 s16, s16, 1
    s_and_b32 s26, s17, 1
    s_add_u32 s27, s16, s26
    s_lshr_b32 s26, s27, 2
    s_lshl_b32 s26, s26, 10
    s_and_b32 s27, s27, 3
    s_lshl_b32 s27, s27, 7
    s_add_u32 s26, s26, s27
    s_add_u32 s26, s26, 8192
    v_add_u32 v6, s26, v6
    v_lshlrev_b32 v3, 4, v112
    s_mul_i32 s26, s17, 28672
    s_add_u32 s26, s26, 16384
    v_add_u32 v7, s26, v3
    s_lshl_b32 s26, s17, 10
    v_add_u32 v8, s26, v3
    v_add_u32 v4, s26, v8
    s_and_b32 s26, s17, 1
    s_lshl_b32 s26, s26, 3
    v_add_u32 v5, s26, v3
    s_mul_i32 s27, s17, 112
    s_add_u32 s27, s27, s16
    s_add_u32 s27, s27, 448
    s_mul_i32 s27, s27, 14336
    s_add_u32 s27, s27, 2097152
    s_add_u32 s26, s27, 1204224
    buffer_load_dwordx4 v[12:15], v3, s[8:11], s26 offen offset:0
    buffer_load_dwordx4 v[16:19], v3, s[8:11], s26 offen offset:1024
    buffer_load_dwordx4 v[20:23], v3, s[8:11], s26 offen offset:2048
    buffer_load_dwordx4 v[24:27], v3, s[8:11], s26 offen offset:3072
    s_add_u32 s26, s27, 1208320
    buffer_load_dwordx4 v[28:31], v3, s[8:11], s26 offen offset:0
    buffer_load_dwordx4 v[32:35], v3, s[8:11], s26 offen offset:1024
    buffer_load_dwordx4 v[36:39], v3, s[8:11], s26 offen offset:2048
    buffer_load_dwordx4 v[40:43], v3, s[8:11], s26 offen offset:3072
    s_add_u32 s26, s27, 1212416
    buffer_load_dwordx4 v[44:47], v3, s[8:11], s26 offen offset:0
    buffer_load_dwordx4 v[48:51], v3, s[8:11], s26 offen offset:1024
    buffer_load_dwordx4 v[52:55], v3, s[8:11], s26 offen offset:2048
    buffer_load_dwordx4 v[56:59], v3, s[8:11], s26 offen offset:3072
    s_add_u32 s26, s27, 1216512
    buffer_load_dwordx4 v[60:63], v3, s[8:11], s26 offen offset:0
    buffer_load_dwordx4 v[64:67], v3, s[8:11], s26 offen offset:1024
    s_add_u32 s26, s27, 1218560
    buffer_load_dwordx4 v[120:123], v3, s[8:11], s26 offen offset:0
    buffer_load_dwordx4 v[124:127], v3, s[8:11], s26 offen offset:1024
    buffer_load_dwordx4 v[128:131], v3, s[8:11], s26 offen offset:2048
    buffer_load_dwordx4 v[132:135], v3, s[8:11], s26 offen offset:3072
    s_add_u32 s26, s27, 1222656
    buffer_load_dwordx4 v[136:139], v3, s[8:11], s26 offen offset:0
    buffer_load_dwordx4 v[140:143], v3, s[8:11], s26 offen offset:1024
    buffer_load_dwordx4 v[144:147], v3, s[8:11], s26 offen offset:2048
    buffer_load_dwordx4 v[148:151], v3, s[8:11], s26 offen offset:3072
    s_add_u32 s26, s27, 1226752
    buffer_load_dwordx4 v[152:155], v3, s[8:11], s26 offen offset:0
    buffer_load_dwordx4 v[156:159], v3, s[8:11], s26 offen offset:1024
    buffer_load_dwordx4 v[160:163], v3, s[8:11], s26 offen offset:2048
    buffer_load_dwordx4 v[164:167], v3, s[8:11], s26 offen offset:3072
    s_add_u32 s26, s27, 1230848
    buffer_load_dwordx4 v[168:171], v3, s[8:11], s26 offen offset:0
    buffer_load_dwordx4 v[172:175], v3, s[8:11], s26 offen offset:1024
    s_add_u32 s26, s27, 0
    buffer_load_dwordx4 a[0:3], v3, s[8:11], s26 offen offset:0
    buffer_load_dwordx4 a[4:7], v3, s[8:11], s26 offen offset:1024
    buffer_load_dwordx4 a[8:11], v3, s[8:11], s26 offen offset:2048
    buffer_load_dwordx4 a[12:15], v3, s[8:11], s26 offen offset:3072
    s_add_u32 s26, s27, 4096
    buffer_load_dwordx4 a[16:19], v3, s[8:11], s26 offen offset:0
    buffer_load_dwordx4 a[20:23], v3, s[8:11], s26 offen offset:1024
    buffer_load_dwordx4 a[24:27], v3, s[8:11], s26 offen offset:2048
    buffer_load_dwordx4 a[28:31], v3, s[8:11], s26 offen offset:3072
    s_add_u32 s26, s27, 8192
    buffer_load_dwordx4 a[32:35], v3, s[8:11], s26 offen offset:0
    buffer_load_dwordx4 a[36:39], v3, s[8:11], s26 offen offset:1024
    buffer_load_dwordx4 a[40:43], v3, s[8:11], s26 offen offset:2048
    buffer_load_dwordx4 a[44:47], v3, s[8:11], s26 offen offset:3072
    s_add_u32 s26, s27, 12288
    buffer_load_dwordx4 a[48:51], v3, s[8:11], s26 offen offset:0
    buffer_load_dwordx4 a[52:55], v3, s[8:11], s26 offen offset:1024
    s_add_u32 s26, s27, 14336
    buffer_load_dwordx4 a[56:59], v3, s[8:11], s26 offen offset:0
    buffer_load_dwordx4 a[60:63], v3, s[8:11], s26 offen offset:1024
    buffer_load_dwordx4 a[64:67], v3, s[8:11], s26 offen offset:2048
    buffer_load_dwordx4 a[68:71], v3, s[8:11], s26 offen offset:3072
    s_add_u32 s26, s27, 18432
    buffer_load_dwordx4 a[72:75], v3, s[8:11], s26 offen offset:0
    buffer_load_dwordx4 a[76:79], v3, s[8:11], s26 offen offset:1024
    buffer_load_dwordx4 a[80:83], v3, s[8:11], s26 offen offset:2048
    buffer_load_dwordx4 a[84:87], v3, s[8:11], s26 offen offset:3072
    s_add_u32 s26, s27, 22528
    buffer_load_dwordx4 a[88:91], v3, s[8:11], s26 offen offset:0
    buffer_load_dwordx4 a[92:95], v3, s[8:11], s26 offen offset:1024
    buffer_load_dwordx4 a[96:99], v3, s[8:11], s26 offen offset:2048
    buffer_load_dwordx4 a[100:103], v3, s[8:11], s26 offen offset:3072
    s_add_u32 s26, s27, 26624
    buffer_load_dwordx4 a[104:107], v3, s[8:11], s26 offen offset:0
    buffer_load_dwordx4 a[108:111], v3, s[8:11], s26 offen offset:1024
    s_waitcnt vmcnt(28)
    s_add_u32 s26, s27, 401408
    buffer_load_dwordx4 a[112:115], v3, s[8:11], s26 offen offset:0
    buffer_load_dwordx4 a[116:119], v3, s[8:11], s26 offen offset:1024
    buffer_load_dwordx4 a[120:123], v3, s[8:11], s26 offen offset:2048
    buffer_load_dwordx4 a[124:127], v3, s[8:11], s26 offen offset:3072
    s_add_u32 s26, s27, 405504
    buffer_load_dwordx4 a[128:131], v3, s[8:11], s26 offen offset:0
    buffer_load_dwordx4 a[132:135], v3, s[8:11], s26 offen offset:1024
    buffer_load_dwordx4 a[136:139], v3, s[8:11], s26 offen offset:2048
    buffer_load_dwordx4 a[140:143], v3, s[8:11], s26 offen offset:3072
    s_add_u32 s26, s27, 409600
    buffer_load_dwordx4 a[144:147], v3, s[8:11], s26 offen offset:0
    buffer_load_dwordx4 a[148:151], v3, s[8:11], s26 offen offset:1024
    buffer_load_dwordx4 a[152:155], v3, s[8:11], s26 offen offset:2048
    buffer_load_dwordx4 a[156:159], v3, s[8:11], s26 offen offset:3072
    s_add_u32 s26, s27, 413696
    buffer_load_dwordx4 a[160:163], v3, s[8:11], s26 offen offset:0
    buffer_load_dwordx4 a[164:167], v3, s[8:11], s26 offen offset:1024
    s_add_u32 s26, s27, 415744
    buffer_load_dwordx4 a[168:171], v3, s[8:11], s26 offen offset:0
    buffer_load_dwordx4 a[172:175], v3, s[8:11], s26 offen offset:1024
    buffer_load_dwordx4 a[176:179], v3, s[8:11], s26 offen offset:2048
    buffer_load_dwordx4 a[180:183], v3, s[8:11], s26 offen offset:3072
    s_add_u32 s26, s27, 419840
    buffer_load_dwordx4 a[184:187], v3, s[8:11], s26 offen offset:0
    buffer_load_dwordx4 a[188:191], v3, s[8:11], s26 offen offset:1024
    buffer_load_dwordx4 a[192:195], v3, s[8:11], s26 offen offset:2048
    buffer_load_dwordx4 a[196:199], v3, s[8:11], s26 offen offset:3072
    s_add_u32 s26, s27, 423936
    buffer_load_dwordx4 a[200:203], v3, s[8:11], s26 offen offset:0
    buffer_load_dwordx4 a[204:207], v3, s[8:11], s26 offen offset:1024
    buffer_load_dwordx4 a[208:211], v3, s[8:11], s26 offen offset:2048
    buffer_load_dwordx4 a[212:215], v3, s[8:11], s26 offen offset:3072
    s_add_u32 s26, s27, 428032
    buffer_load_dwordx4 a[216:219], v3, s[8:11], s26 offen offset:0
    buffer_load_dwordx4 a[220:223], v3, s[8:11], s26 offen offset:1024
    s_waitcnt vmcnt(28)
    s_add_u32 s26, s27, 802816
    buffer_load_dwordx4 a[224:227], v3, s[8:11], s26 offen offset:0
    buffer_load_dwordx4 a[228:231], v3, s[8:11], s26 offen offset:1024
    buffer_load_dwordx4 a[232:235], v3, s[8:11], s26 offen offset:2048
    buffer_load_dwordx4 a[236:239], v3, s[8:11], s26 offen offset:3072
    s_add_u32 s26, s27, 806912
    buffer_load_dwordx4 a[240:243], v3, s[8:11], s26 offen offset:0
    buffer_load_dwordx4 a[244:247], v3, s[8:11], s26 offen offset:1024
    buffer_load_dwordx4 a[248:251], v3, s[8:11], s26 offen offset:2048
    buffer_load_dwordx4 a[252:255], v3, s[8:11], s26 offen offset:3072
    s_add_u32 s26, s27, 811008
    buffer_load_dwordx4 v[176:179], v3, s[8:11], s26 offen offset:0
    buffer_load_dwordx4 v[180:183], v3, s[8:11], s26 offen offset:1024
    buffer_load_dwordx4 v[184:187], v3, s[8:11], s26 offen offset:2048
    buffer_load_dwordx4 v[188:191], v3, s[8:11], s26 offen offset:3072
    s_add_u32 s26, s27, 815104
    buffer_load_dwordx4 v[192:195], v3, s[8:11], s26 offen offset:0
    buffer_load_dwordx4 v[196:199], v3, s[8:11], s26 offen offset:1024
    s_add_u32 s26, s27, 817152
    buffer_load_dwordx4 v[200:203], v3, s[8:11], s26 offen offset:0
    buffer_load_dwordx4 v[204:207], v3, s[8:11], s26 offen offset:1024
    buffer_load_dwordx4 v[208:211], v3, s[8:11], s26 offen offset:2048
    buffer_load_dwordx4 v[212:215], v3, s[8:11], s26 offen offset:3072
    s_add_u32 s26, s27, 821248
    buffer_load_dwordx4 v[216:219], v3, s[8:11], s26 offen offset:0
    buffer_load_dwordx4 v[220:223], v3, s[8:11], s26 offen offset:1024
    buffer_load_dwordx4 v[224:227], v3, s[8:11], s26 offen offset:2048
    buffer_load_dwordx4 v[228:231], v3, s[8:11], s26 offen offset:3072
    s_add_u32 s26, s27, 825344
    buffer_load_dwordx4 v[232:235], v3, s[8:11], s26 offen offset:0
    buffer_load_dwordx4 v[236:239], v3, s[8:11], s26 offen offset:1024
    buffer_load_dwordx4 v[240:243], v3, s[8:11], s26 offen offset:2048
    buffer_load_dwordx4 v[244:247], v3, s[8:11], s26 offen offset:3072
    s_add_u32 s26, s27, 829440
    buffer_load_dwordx4 v[248:251], v3, s[8:11], s26 offen offset:0
    buffer_load_dwordx4 v[252:255], v3, s[8:11], s26 offen offset:1024
    s_waitcnt vmcnt(28)
    v_mov_b32 v104, 64
    buffer_load_dword v105, v104, s[12:15], 0 offen sc1
    v_mov_b32 v106, 0
    s_mov_b32 s38, 23003136
    s_mov_b32 s37, 23061760
    buffer_load_dword v107, v106, s[8:11], s38 offen sc1
    buffer_load_dword v109, v106, s[8:11], s37 offen sc1
    s_waitcnt vmcnt(28)
    ds_write_b128 v7, v[12:15] offset:0
    ds_write_b128 v7, v[16:19] offset:1024
    ds_write_b128 v7, v[20:23] offset:2048
    ds_write_b128 v7, v[24:27] offset:3072
    ds_write_b128 v7, v[28:31] offset:4096
    ds_write_b128 v7, v[32:35] offset:5120
    ds_write_b128 v7, v[36:39] offset:6144
    ds_write_b128 v7, v[40:43] offset:7168
    ds_write_b128 v7, v[44:47] offset:8192
    ds_write_b128 v7, v[48:51] offset:9216
    ds_write_b128 v7, v[52:55] offset:10240
    ds_write_b128 v7, v[56:59] offset:11264
    ds_write_b128 v7, v[60:63] offset:12288
    ds_write_b128 v7, v[64:67] offset:13312
    ds_write_b128 v7, v[120:123] offset:14336
    ds_write_b128 v7, v[124:127] offset:15360
    ds_write_b128 v7, v[128:131] offset:16384
    ds_write_b128 v7, v[132:135] offset:17408
    ds_write_b128 v7, v[136:139] offset:18432
    ds_write_b128 v7, v[140:143] offset:19456
    ds_write_b128 v7, v[144:147] offset:20480
    ds_write_b128 v7, v[148:151] offset:21504
    ds_write_b128 v7, v[152:155] offset:22528
    ds_write_b128 v7, v[156:159] offset:23552
    ds_write_b128 v7, v[160:163] offset:24576
    ds_write_b128 v7, v[164:167] offset:25600
    ds_write_b128 v7, v[168:171] offset:26624
    ds_write_b128 v7, v[172:175] offset:27648
    s_waitcnt lgkmcnt(0)
    s_mov_b32 s19, 0
    s_mov_b32 s21, 19922944
    s_mov_b32 s22, 20971520
    s_lshl_b32 s24, s16, 14
    s_lshl_b32 s26, s17, 12
    s_add_u32 s24, s24, s26
    s_add_u32 s24, s24, 67108864
    s_lshl_b32 s25, s16, 12
    s_add_u32 s25, s25, 29360128
    s_lshr_b32 s32, s16, 1
    s_add_u32 s32, s32, 16
    s_lshl_b32 s32, s32, 2
    s_add_u32 s32, s32, s17
    s_lshl_b32 s32, s32, 12
    s_add_u32 s32, s32, 23068672
    v_mov_b32 v161, 1
    v_mov_b32 v162, 0
    v_mov_b32 v163, 0
    v_and_b32 v160, 120, v0
    v_lshrrev_b32 v160, 1, v160
    s_lshl_b32 s26, s17, 4
    s_mul_i32 s26, s26, 0
    s_and_b32 s27, s16, 6
    s_lshl_b32 s27, s27, 6
    s_add_u32 s26, s26, s27
    s_add_u32 s26, s26, 12288
    v_add_u32 v160, s26, v160
    s_lshl_b32 s26, s16, 1
    s_add_u32 s26, s26, s17
    s_lshl_b32 s26, s26, 2
    s_add_u32 s26, s26, 15360
    v_lshlrev_b32 v164, 5, v0
    v_add_u32 v164, s26, v164
    s_add_u32 s33, s25, 0x8000000
    v_lshrrev_b32 v165, 1, v0
    v_min_u32 v165, 220, v165
    v_add_u32 v165, 7168, v165
    s_mov_b32 s56, 0
    v_lshrrev_b32 v101, 3, v0
    v_bfe_u32 v100, v101, 1, 2
    v_mul_u32_u24 v5, 192, v100
    v_bfe_u32 v100, v101, 4, 2
    v_lshl_add_u32 v5, v100, 5, v5
    v_and_b32 v100, 1, v101
    v_lshl_add_u32 v5, v100, 4, v5
    v_bfe_u32 v100, v101, 3, 1
    v_lshl_add_u32 v5, v100, 3, v5
    v_lshrrev_b32 v100, 4, v101
    v_mul_u32_u24 v75, 192, v100
    v_and_b32 v100, 15, v101
    v_lshl_add_u32 v75, v100, 3, v75
    s_mul_i32 s26, s17, 1536
    v_add_u32 v75, s26, v75
    s_and_b32 s26, s17, 1
    s_mul_i32 s27, s26, 768
    v_add_u32 v5, s27, v5
    s_add_u32 s27, s16, s26
    s_lshr_b32 s26, s27, 2
    s_lshl_b32 s26, s26, 10
    s_and_b32 s27, s27, 3
    s_lshl_b32 s27, s27, 7
    s_add_u32 s26, s26, s27
    s_add_u32 s26, s26, 8192
    v_and_b32 v100, 31, v101
    v_lshlrev_b32 v6, 2, v100
    v_lshrrev_b32 v100, 5, v101
    v_lshl_add_u32 v6, v100, 9, v6
    v_add_u32 v6, s26, v6
    v_lshrrev_b32 v172, 2, v8
    v_lshrrev_b32 v173, 1, v0
    s_lshl_b32 s39, s17, 11
    s_min_u32 s39, s39, 5120
    s_mov_b32 s38, 23003136
    v_mov_b32 v88, 0
    v_mov_b32 v89, 0
    v_mov_b32 v90, 0
    v_mov_b32 v91, 0
    v_mov_b32 v92, 0
    v_mov_b32 v93, 0
    v_mov_b32 v94, 0
    v_mov_b32 v95, 0
    v_lshrrev_b32 v72, 1, v8
    s_lshl_b32 s26, s17, 2
    s_add_u32 s26, s26, 14336
    v_add_u32 v73, s26, v3
    v_mov_b32 v74, 0
    ds_write_b32 v73, v74
    s_mov_b32 s28, 0
    s_waitcnt vmcnt(0)
    s_branch L_modep_111
L_mode_109:
    v_mov_b32 v104, 64
    buffer_load_dword v105, v104, s[12:15], 0 offen sc1
    s_waitcnt vmcnt(0)
L_modep_111:
    s_nop 0
    v_readfirstlane_b32 s26, v105
    s_nop 0
    s_and_b32 s27, s26, 0xffff
    s_cmp_ge_u32 s27, 32
    s_nop 0
    s_cbranch_scc1 L_moded_110
    s_sleep 2
    s_add_u32 s28, s28, 1
    s_cmp_lt_u32 s28, 20000
    s_cbranch_scc1 L_mode_109
    s_mov_b32 s26, 0x10000
L_moded_110:
    s_lshr_b32 s26, s26, 16
    s_cmp_eq_u32 s26, 0
    s_cselect_b32 s20, 1, 0
    s_mov_b32 s29, 20000
    s_mov_b32 s28, 0
    v_mov_b32 v106, 0
    s_branch L_wcp_114
L_wc_112:
    buffer_load_dword v107, v106, s[8:11], s38 offen sc1
L_wcp_114:
    s_add_u32 s28, s28, 1
    s_waitcnt vmcnt(0)
    v_readfirstlane_b32 s26, v107
    s_nop 0
    s_cmp_ge_u32 s26, 28
    s_nop 1
    s_cbranch_scc1 L_wcd_113
    s_sleep 4
    s_cmp_lt_u32 s28, s29
    s_cbranch_scc1 L_wc_112
    s_mov_b32 s29, 1
L_wcd_113:
    s_mov_b32 s37, 23061760
    s_mov_b32 s28, 0
    v_mov_b32 v108, 0
    s_branch L_wcp_117
L_wc_115:
    buffer_load_dword v109, v108, s[8:11], s37 offen sc1
L_wcp_117:
    s_add_u32 s28, s28, 1
    s_waitcnt vmcnt(0)
    v_readfirstlane_b32 s26, v109
    s_nop 0
    s_cmp_ge_u32 s26, 98
    s_nop 1
    s_cbranch_scc1 L_wcd_116
    s_sleep 4
    s_cmp_lt_u32 s28, s29
    s_cbranch_scc1 L_wc_115
    s_mov_b32 s29, 1
L_wcd_116:
    s_cmp_lg_u32 s20, 1
    s_cbranch_scc1 L_cb_next1
    v_mov_b64 v[40:41], 0
    v_mov_b64 v[42:43], 0
    v_mov_b64 v[44:45], 0
    v_mov_b64 v[46:47], 0
    v_mov_b64 v[48:49], 0
    v_mov_b64 v[50:51], 0
    v_mov_b64 v[52:53], 0
    v_mov_b64 v[54:55], 0
    v_mov_b64 v[56:57], 0
    v_mov_b64 v[58:59], 0
    v_mov_b64 v[60:61], 0
    v_mov_b64 v[62:63], 0
    v_mov_b64 v[64:65], 0
    v_mov_b64 v[66:67], 0
    v_mov_b64 v[68:69], 0
    v_mov_b64 v[70:71], 0
    ds_read_b128 v[128:131], v7 offset:0
    ds_read_b128 v[132:135], v7 offset:1024
    ds_read_b128 v[136:139], v7 offset:2048
    ds_read_b128 v[140:143], v7 offset:3072
    ds_read_b128 v[144:147], v7 offset:4096
    ds_read_b128 v[148:151], v7 offset:5120
    ds_read_b128 v[152:155], v7 offset:6144
    ds_read_b128 v[156:159], v7 offset:7168
    s_mov_b64 s[34:35], 0
    s_add_u32 s23, s24, 16384
    s_lshl_b32 s38, s19, 7
    s_add_u32 s38, s38, 23003264
    s_add_u32 s26, s21, s39
    s_mov_b32 m0, s39
    s_branch L_cb_top_118
    .p2align 6
    s_nop 0
L_nh_119:
    s_barrier
L_cb_top_118:
    buffer_load_dwordx4 v3, s[8:11], s26 offen sc1 lds
    buffer_load_dwordx4 v3, s[8:11], s26 offen offset:1024 sc1 lds
    s_mov_b32 s36, 0
    s_barrier
    buffer_load_dwordx4 v[112:115], v3, s[8:11], s23 offen offset:0 sc1
    buffer_load_dwordx4 v[116:119], v3, s[8:11], s23 offen offset:1024 sc1
    buffer_load_dwordx4 v[120:123], v3, s[8:11], s23 offen offset:2048 sc1
    buffer_load_dwordx4 v[124:127], v3, s[8:11], s23 offen offset:3072 sc1
    s_waitcnt vmcnt(4) lgkmcnt(0)
    s_barrier
L_cmb_121:
    ds_read_b64_tr_b16 v[12:13], v0 offset:0
    ds_read_b64_tr_b16 v[14:15], v0 offset:512
    ds_read_b64_tr_b16 v[16:17], v0 offset:1024
    ds_read_b64_tr_b16 v[18:19], v0 offset:1536
    ds_read_b64_tr_b16 v[20:21], v0 offset:2048
    ds_read_b64_tr_b16 v[22:23], v0 offset:2560
    s_waitcnt lgkmcnt(4)
    v_smfmac_f32_16x16x64_bf16 v[40:43], v[12:15], a[0:7], v2
    ds_read_b64_tr_b16 v[24:25], v0 offset:3072
    buffer_load_dwordx4 v[96:99], v3, s[8:11], s24 offen offset:0 sc1
    v_smfmac_f32_16x16x64_bf16 v[44:47], v[12:15], a[56:63], v2
    ds_read_b64_tr_b16 v[26:27], v0 offset:3584
    s_waitcnt lgkmcnt(4)
    v_smfmac_f32_16x16x64_bf16 v[40:43], v[16:19], a[8:15], v2
    ds_read_b64_tr_b16 v[28:29], v0 offset:4096
    v_smfmac_f32_16x16x64_bf16 v[64:67], v[12:15], v[128:135], v2
    ds_read_b64_tr_b16 v[30:31], v0 offset:4608
    buffer_load_dwordx4 v[100:103], v3, s[8:11], s24 offen offset:1024 sc1
    v_smfmac_f32_16x16x64_bf16 v[44:47], v[16:19], a[64:71], v2
    ds_read_b64_tr_b16 v[32:33], v0 offset:5120
    s_waitcnt lgkmcnt(5)
    v_smfmac_f32_16x16x64_bf16 v[40:43], v[20:23], a[16:23], v2
    ds_read_b64_tr_b16 v[34:35], v0 offset:5632
    v_smfmac_f32_16x16x64_bf16 v[44:47], v[20:23], a[72:79], v2
    ds_read_b64_tr_b16 v[36:37], v0 offset:6144
    buffer_load_dwordx4 v[104:107], v3, s[8:11], s24 offen offset:2048 sc1
    v_smfmac_f32_16x16x64_bf16 v[64:67], v[16:19], v[136:143], v2
    ds_read_b64_tr_b16 v[38:39], v0 offset:6656
    s_waitcnt lgkmcnt(6)
    v_smfmac_f32_16x16x64_bf16 v[40:43], v[24:27], a[24:31], v2
    ds_read_b128 v[128:131], v7 offset:8192
    v_smfmac_f32_16x16x64_bf16 v[44:47], v[24:27], a[80:87], v2
    ds_read_b128 v[132:135], v7 offset:9216
    buffer_load_dwordx4 v[108:111], v3, s[8:11], s24 offen offset:3072 sc1
    s_waitcnt lgkmcnt(6)
    v_smfmac_f32_16x16x64_bf16 v[40:43], v[28:31], a[32:39], v2
    ds_read_b128 v[136:139], v7 offset:10240
    v_smfmac_f32_16x16x64_bf16 v[64:67], v[20:23], v[144:151], v2
    ds_read_b128 v[140:143], v7 offset:11264
    v_smfmac_f32_16x16x64_bf16 v[44:47], v[28:31], a[88:95], v2
    ds_read_b128 v[144:147], v7 offset:12288
    buffer_load_dword v163, v162, s[8:11], s38 offen sc1
    s_waitcnt lgkmcnt(7)
    v_smfmac_f32_16x16x64_bf16 v[40:43], v[32:35], a[40:47], v2
    ds_read_b128 v[148:151], v7 offset:13312
    buffer_store_dwordx4 v[88:91], v8, s[8:11], s33 offen sc1
    v_smfmac_f32_16x16x64_bf16 v[44:47], v[32:35], a[96:103], v2
    v_smfmac_f32_16x16x64_bf16 v[64:67], v[24:27], v[152:159], v2
    ds_read_b128 v[152:155], v7 offset:14336
    s_waitcnt lgkmcnt(7)
    v_smfmac_f32_16x16x64_bf16 v[40:43], v[36:39], a[48:55], v2
    ds_read_b128 v[156:159], v7 offset:15360
    s_add_u32 s27, s33, 4096
    buffer_store_dwordx4 v[92:95], v8, s[8:11], s27 offen sc1
    v_smfmac_f32_16x16x64_bf16 v[44:47], v[36:39], a[104:111], v2
    v_smfmac_f32_16x16x64_bf16 v[48:51], v[12:15], a[112:119], v2
    s_waitcnt lgkmcnt(6)
    v_smfmac_f32_16x16x64_bf16 v[64:67], v[28:31], v[128:135], v2
    ds_read_b128 v[128:131], v7 offset:16384
    v_add_f32 v40, v40, v42
    v_smfmac_f32_16x16x64_bf16 v[48:51], v[16:19], a[120:127], v2
    ds_read_b128 v[132:135], v7 offset:17408
    v_add_f32 v41, v41, v43
    v_smfmac_f32_16x16x64_bf16 v[48:51], v[20:23], a[128:135], v2
    v_cvt_pk_bf16_f32 v88, v40, v41
    v_smfmac_f32_16x16x64_bf16 v[48:51], v[24:27], a[136:143], v2
    v_add_f32 v44, v44, v46
    s_waitcnt lgkmcnt(6)
    v_smfmac_f32_16x16x64_bf16 v[64:67], v[32:35], v[136:143], v2
    ds_read_b128 v[136:139], v7 offset:18432
    v_add_f32 v45, v45, v47
    v_smfmac_f32_16x16x64_bf16 v[48:51], v[28:31], a[144:151], v2
    ds_read_b128 v[140:143], v7 offset:19456
    v_cvt_pk_bf16_f32 v92, v44, v45
    v_smfmac_f32_16x16x64_bf16 v[48:51], v[32:35], a[152:159], v2
    v_add_f32 v9, v40, v41
    v_smfmac_f32_16x16x64_bf16 v[48:51], v[36:39], a[160:167], v2
    ds_write_b32 v172, v9 offset:13312
    s_waitcnt lgkmcnt(7)
    v_smfmac_f32_16x16x64_bf16 v[64:67], v[36:39], v[144:151], v2
    ds_read_b128 v[144:147], v7 offset:20480
    v_smfmac_f32_16x16x64_bf16 v[52:55], v[12:15], a[168:175], v2
    ds_read_b128 v[148:151], v7 offset:21504
    v_smfmac_f32_16x16x64_bf16 v[52:55], v[16:19], a[176:183], v2
    v_add_f32 v48, v48, v50
    v_smfmac_f32_16x16x64_bf16 v[52:55], v[20:23], a[184:191], v2
    s_waitcnt lgkmcnt(2)
    s_barrier
    v_add_f32 v49, v49, v51
    v_smfmac_f32_16x16x64_bf16 v[68:71], v[12:15], v[152:159], v2
    ds_read_b128 v[152:155], v7 offset:22528
    v_cvt_pk_bf16_f32 v89, v48, v49
    v_smfmac_f32_16x16x64_bf16 v[52:55], v[24:27], a[192:199], v2
    ds_read_b128 v[156:159], v7 offset:23552
    v_add_f32 v64, v64, v66
    v_smfmac_f32_16x16x64_bf16 v[52:55], v[28:31], a[200:207], v2
    ds_read2st64_b32 v[168:169], v173 offset0:52 offset1:53
    v_add_f32 v65, v65, v67
    v_smfmac_f32_16x16x64_bf16 v[52:55], v[32:35], a[208:215], v2
    ds_read2st64_b32 v[170:171], v173 offset0:54 offset1:55
    v_cvt_pk_bf16_f32 v91, v64, v65
    v_smfmac_f32_16x16x64_bf16 v[68:71], v[16:19], v[128:135], v2
    ds_read_b128 v[128:131], v7 offset:24576
    v_smfmac_f32_16x16x64_bf16 v[52:55], v[36:39], a[216:223], v2
    ds_read_b128 v[132:135], v7 offset:25600
    v_smfmac_f32_16x16x64_bf16 v[56:59], v[12:15], a[224:231], v2
    v_smfmac_f32_16x16x64_bf16 v[56:59], v[16:19], a[232:239], v2
    s_waitcnt lgkmcnt(2)
    v_add_f32 v168, v168, v170
    v_smfmac_f32_16x16x64_bf16 v[68:71], v[20:23], v[136:143], v2
    ds_read_b128 v[136:139], v7 offset:26624
    v_add_f32 v52, v52, v54
    v_smfmac_f32_16x16x64_bf16 v[56:59], v[20:23], a[240:247], v2
    ds_read_b128 v[140:143], v7 offset:27648
    v_add_f32 v53, v53, v55
    v_smfmac_f32_16x16x64_bf16 v[56:59], v[24:27], a[248:255], v2
    v_cvt_pk_bf16_f32 v93, v52, v53
    v_smfmac_f32_16x16x64_bf16 v[56:59], v[28:31], v[176:183], v2
    v_add_f32 v169, v169, v171
    v_smfmac_f32_16x16x64_bf16 v[68:71], v[24:27], v[144:151], v2
    v_cmp_u_f32 vcc, v168, v169
    v_smfmac_f32_16x16x64_bf16 v[56:59], v[32:35], v[184:191], v2
    v_smfmac_f32_16x16x64_bf16 v[56:59], v[36:39], v[192:199], v2
    v_smfmac_f32_16x16x64_bf16 v[60:63], v[12:15], v[200:207], v2
    v_smfmac_f32_16x16x64_bf16 v[68:71], v[28:31], v[152:159], v2
    v_smfmac_f32_16x16x64_bf16 v[60:63], v[16:19], v[208:215], v2
    v_add_f32 v56, v56, v58
    v_smfmac_f32_16x16x64_bf16 v[60:63], v[20:23], v[216:223], v2
    v_add_f32 v57, v57, v59
    v_smfmac_f32_16x16x64_bf16 v[60:63], v[24:27], v[224:231], v2
    v_cvt_pk_bf16_f32 v90, v56, v57
    s_waitcnt lgkmcnt(2)
    v_smfmac_f32_16x16x64_bf16 v[68:71], v[32:35], v[128:135], v2
    v_smfmac_f32_16x16x64_bf16 v[60:63], v[28:31], v[232:239], v2
    v_smfmac_f32_16x16x64_bf16 v[60:63], v[32:35], v[240:247], v2
    v_smfmac_f32_16x16x64_bf16 v[60:63], v[36:39], v[248:255], v2
    s_waitcnt lgkmcnt(0)
    v_smfmac_f32_16x16x64_bf16 v[68:71], v[36:39], v[136:143], v2
    s_cbranch_vccnz L_cnb_124
L_cnx_125:
    s_nop 3
    v_add_f32 v60, v60, v62
    v_add_f32 v61, v61, v63
    v_cvt_pk_bf16_f32 v94, v60, v61
    v_add_f32 v68, v68, v70
    v_add_f32 v69, v69, v71
    v_cvt_pk_bf16_f32 v95, v68, v69
    s_cmp_ge_u32 s19, 63
    s_cbranch_scc1 L_cbl_126
    s_add_u32 s26, s22, 8192
    s_mov_b32 s33, s25
    ds_read_b128 v[128:131], v7 offset:0
    ds_read_b128 v[132:135], v7 offset:1024
    ds_read_b128 v[136:139], v7 offset:2048
    ds_read_b128 v[140:143], v7 offset:3072
    ds_read_b128 v[144:147], v7 offset:4096
    ds_read_b128 v[148:151], v7 offset:5120
    ds_read_b128 v[152:155], v7 offset:6144
    ds_read_b128 v[156:159], v7 offset:7168
    .p2align 5
    s_nop 2
    s_nop 2
    s_nop 2
    s_nop 3
    s_nop 3
    s_nop 3
    s_barrier
    s_mov_b32 s28, 0
    buffer_load_dwordx4 v[12:15], v4, s[8:11], s22 offen sc1
    buffer_load_dwordx4 v[16:19], v4, s[8:11], s22 offen offset:1024 sc1
    buffer_load_dwordx2 v[20:21], v72, s[8:11], s26 offen sc1
    v_mov_b64 v[76:77], 0
    v_mov_b64 v[78:79], 0
    v_mov_b64 v[80:81], 0
    v_mov_b64 v[82:83], 0
    v_add_u32 v74, 1, v74
    v_mov_b64 v[40:41], 0
    v_mov_b64 v[42:43], 0
    v_mov_b64 v[44:45], 0
    v_mov_b64 v[46:47], 0
    v_mov_b64 v[48:49], 0
    v_mov_b64 v[50:51], 0
    v_mov_b64 v[52:53], 0
    v_mov_b64 v[54:55], 0
    v_mov_b64 v[56:57], 0
    v_mov_b64 v[58:59], 0
    v_mov_b64 v[60:61], 0
    v_mov_b64 v[62:63], 0
    v_mov_b64 v[64:65], 0
    v_mov_b64 v[66:67], 0
    v_mov_b64 v[68:69], 0
    v_mov_b64 v[70:71], 0
    s_nop 15
    buffer_load_dwordx4 v[24:27], v4, s[8:11], s22 offen sc1
    buffer_load_dwordx4 v[28:31], v4, s[8:11], s22 offen offset:1024 sc1
    buffer_load_dwordx2 v[32:33], v72, s[8:11], s26 offen sc1
    s_add_u32 s28, s28, 1
    s_waitcnt vmcnt(5)
    v_smfmac_f32_16x16x64_bf16 v[76:79], v[12:15], v[96:103], v2
    v_max_u32 v9, v12, v14
    v_smfmac_f32_16x16x64_bf16 v[80:83], v[12:15], v[112:119], v2
    s_waitcnt vmcnt(4)
    v_smfmac_f32_16x16x64_bf16 v[76:79], v[16:19], v[104:111], v2
    v_max3_u32 v9, v9, v16, v18
    v_smfmac_f32_16x16x64_bf16 v[80:83], v[16:19], v[120:127], v2
    s_waitcnt vmcnt(3)
    v_smfmac_f32_16x16x32_bf16 v[76:79], v[20:21], v[88:91], v2
    v_max3_u32 v9, v9, v20, v21
    v_smfmac_f32_16x16x32_bf16 v[80:83], v[20:21], v[92:95], v2
    v_cmp_eq_u32 vcc, -1, v9
    s_cbranch_vccnz L_ppr_129
L_ppd_128:
    s_mov_b64 exec, 15
    buffer_store_dword v162, v164, s[8:11], s21 offen
    s_mov_b64 exec, -1
    v_readfirstlane_b32 s37, v163
    v_pk_add_f32 v[76:77], v[76:77], v[78:79]
    ds_write_b64 v75, v[76:77] offset:7168
    v_pk_add_f32 v[80:81], v[80:81], v[82:83]
    ds_write_b64 v75, v[80:81] offset:7936
    s_cmp_ge_u32 s17, 2
    s_cbranch_scc1 L_cbh_130
    s_waitcnt lgkmcnt(0)
    s_barrier
    ds_read_b64 v[76:77], v5 offset:7168
    ds_read_b64 v[78:79], v5 offset:8704
    ds_read_b64 v[80:81], v5 offset:10240
    ds_read_b64 v[82:83], v5 offset:11776
    s_waitcnt lgkmcnt(2)
    v_pk_add_f32 v[76:77], v[76:77], v[78:79]
    s_waitcnt lgkmcnt(0)
    v_pk_add_f32 v[80:81], v[80:81], v[82:83]
    v_pk_add_f32 v[76:77], v[76:77], v[80:81]
    v_cvt_pk_bf16_f32 v9, v76, v77
    buffer_store_dword v9, v6, s[8:11], s21 offen
    s_cmp_lt_u32 s19, 62
    s_cbranch_scc1 L_cny_133
    s_add_u32 s26, s21, 2228224
    buffer_store_dword v9, v6, s[8:11], s26 offen sc1
L_cny_133:
    s_cmp_lt_u32 s37, 28
    s_cbranch_scc1 L_us_134
L_ub_135:
    s_add_u32 s19, s19, 1
    s_add_u32 s21, s21, 8192
    s_add_u32 s22, s22, 16384
    s_add_u32 s24, s24, 458752
    s_add_u32 s25, s25, 114688
    s_add_u32 s32, s32, 64
    s_add_u32 s23, s24, 16384
    s_lshl_b32 s38, s19, 7
    s_add_u32 s38, s38, 23003264
    s_add_u32 s26, s21, s39
    s_mov_b32 m0, s39
    s_branch L_nh_119
L_cmr_122:
    s_barrier
    s_mov_b32 s36, 1
    s_add_u32 s33, s25, 0x8000000
    v_mov_b64 v[40:41], 0
    v_mov_b64 v[42:43], 0
    v_mov_b64 v[44:45], 0
    v_mov_b64 v[46:47], 0
    v_mov_b64 v[48:49], 0
    v_mov_b64 v[50:51], 0
    v_mov_b64 v[52:53], 0
    v_mov_b64 v[54:55], 0
    v_mov_b64 v[56:57], 0
    v_mov_b64 v[58:59], 0
    v_mov_b64 v[60:61], 0
    v_mov_b64 v[62:63], 0
    v_mov_b64 v[64:65], 0
    v_mov_b64 v[66:67], 0
    v_mov_b64 v[68:69], 0
    v_mov_b64 v[70:71], 0
    ds_read_b128 v[128:131], v7 offset:0
    ds_read_b128 v[132:135], v7 offset:1024
    ds_read_b128 v[136:139], v7 offset:2048
    ds_read_b128 v[140:143], v7 offset:3072
    ds_read_b128 v[144:147], v7 offset:4096
    ds_read_b128 v[148:151], v7 offset:5120
    ds_read_b128 v[152:155], v7 offset:6144
    ds_read_b128 v[156:159], v7 offset:7168
    s_mov_b32 s28, 0
L_pm_136:
    buffer_load_dwordx4 v[12:15], v1, s[8:11], s21 offen sc1
    buffer_load_dwordx4 v[16:19], v1, s[8:11], s21 offen offset:768 sc1
    s_add_u32 s28, s28, 1
    s_waitcnt vmcnt(1)
    ds_write_b128 v1, v[12:15]
    v_max3_u32 v20, v12, v13, v14
    s_waitcnt vmcnt(0)
    ds_write_b128 v1, v[16:19] offset:768
    v_max3_u32 v20, v20, v15, v16
    v_max3_u32 v20, v20, v17, v18
    v_max_u32 v20, v20, v19
    v_cmp_eq_u32 vcc, -1, v20
    s_cbranch_vccz L_pmd_137
    s_cmp_lt_u32 s28, s29
    s_cbranch_scc1 L_pm_136
    s_mov_b32 s29, 1
L_pmd_137:
    s_waitcnt lgkmcnt(0)
    s_barrier
    s_branch L_cmb_121
L_cnb_124:
    s_nop 7
    s_cmp_eq_u32 s36, 0
    s_cbranch_scc1 L_cmr_122
    s_branch L_cnx_125
L_cbl_126:
    buffer_store_dwordx4 v[88:91], v8, s[8:11], s25 offen sc1
    s_add_u32 s27, s25, 4096
    buffer_store_dwordx4 v[92:95], v8, s[8:11], s27 offen sc1
    s_nop 0
    s_branch L_exit
L_ppr_129:
    s_nop 7
L_pp_127:
    buffer_load_dwordx4 v[12:15], v4, s[8:11], s22 offen sc1
    buffer_load_dwordx4 v[16:19], v4, s[8:11], s22 offen offset:1024 sc1
    buffer_load_dwordx2 v[20:21], v72, s[8:11], s26 offen sc1
    v_mov_b64 v[76:77], 0
    v_mov_b64 v[78:79], 0
    v_mov_b64 v[80:81], 0
    v_mov_b64 v[82:83], 0
    s_add_u32 s28, s28, 1
    s_waitcnt vmcnt(5)
    v_smfmac_f32_16x16x64_bf16 v[76:79], v[24:27], v[96:103], v2
    v_max_u32 v9, v24, v26
    v_smfmac_f32_16x16x64_bf16 v[80:83], v[24:27], v[112:119], v2
    s_waitcnt vmcnt(4)
    v_smfmac_f32_16x16x64_bf16 v[76:79], v[28:31], v[104:111], v2
    v_max3_u32 v9, v9, v28, v30
    v_smfmac_f32_16x16x64_bf16 v[80:83], v[28:31], v[120:127], v2
    s_waitcnt vmcnt(3)
    v_smfmac_f32_16x16x32_bf16 v[76:79], v[32:33], v[88:91], v2
    v_max3_u32 v9, v9, v32, v33
    v_smfmac_f32_16x16x32_bf16 v[80:83], v[32:33], v[92:95], v2
    v_cmp_eq_u32 vcc, -1, v9
    s_nop 5
    s_cbranch_vccz L_ppd_128
    buffer_load_dwordx4 v[24:27], v4, s[8:11], s22 offen sc1
    buffer_load_dwordx4 v[28:31], v4, s[8:11], s22 offen offset:1024 sc1
    buffer_load_dwordx2 v[32:33], v72, s[8:11], s26 offen sc1
    v_mov_b64 v[76:77], 0
    v_mov_b64 v[78:79], 0
    v_mov_b64 v[80:81], 0
    v_mov_b64 v[82:83], 0
    s_add_u32 s28, s28, 1
    s_waitcnt vmcnt(5)
    v_smfmac_f32_16x16x64_bf16 v[76:79], v[12:15], v[96:103], v2
    v_max_u32 v9, v12, v14
    v_smfmac_f32_16x16x64_bf16 v[80:83], v[12:15], v[112:119], v2
    s_waitcnt vmcnt(4)
    v_smfmac_f32_16x16x64_bf16 v[76:79], v[16:19], v[104:111], v2
    v_max3_u32 v9, v9, v16, v18
    v_smfmac_f32_16x16x64_bf16 v[80:83], v[16:19], v[120:127], v2
    s_waitcnt vmcnt(3)
    v_smfmac_f32_16x16x32_bf16 v[76:79], v[20:21], v[88:91], v2
    v_max3_u32 v9, v9, v20, v21
    v_smfmac_f32_16x16x32_bf16 v[80:83], v[20:21], v[92:95], v2
    v_cmp_eq_u32 vcc, -1, v9
    s_nop 5
    s_cbranch_vccz L_ppd_128
    s_cmp_lt_u32 s28, s29
    s_cbranch_scc1 L_pp_127
    s_mov_b32 s29, 1
    s_mov_b64 vcc, 0
    s_branch L_ppd_128
L_cbh_130:
    s_add_u32 s19, s19, 1
    s_add_u32 s21, s21, 8192
    s_add_u32 s22, s22, 16384
    s_add_u32 s24, s24, 458752
    s_add_u32 s25, s25, 114688
    s_add_u32 s32, s32, 64
    s_cmp_eq_u32 s17, 2
    s_waitcnt lgkmcnt(0)
    s_barrier
    s_cbranch_scc1 L_cw2_138
    buffer_load_dword v10, v165, s[8:11], s21 offen sc1
    s_cmp_lt_u32 s37, 28
    s_cbranch_scc1 L_us_139
L_ub_140:
    s_add_u32 s23, s24, 16384
    s_lshl_b32 s38, s19, 7
    s_add_u32 s38, s38, 23003264
    s_add_u32 s26, s21, s39
    s_mov_b32 m0, s39
    s_nop 4
    buffer_load_dword v11, v165, s[8:11], s21 offen sc1
    s_nop 12
    buffer_load_dword v166, v165, s[8:11], s21 offen sc1
    s_nop 12
    s_mov_b32 s28, 0
L_h_141:
    buffer_load_dword v167, v165, s[8:11], s21 offen offset:0 sc1
    s_waitcnt vmcnt(3)
    v_cmp_eq_u32 vcc, -1, v10
    s_cbranch_vccz L_hd_142
    s_nop 2
    buffer_load_dword v10, v165, s[8:11], s21 offen offset:0 sc1
    s_waitcnt vmcnt(3)
    v_cmp_eq_u32 vcc, -1, v11
    s_cbranch_vccz L_hd_142
    s_nop 2
    buffer_load_dword v11, v165, s[8:11], s21 offen offset:0 sc1
    s_waitcnt vmcnt(3)
    v_cmp_eq_u32 vcc, -1, v166
    s_cbranch_vccz L_hd_142
    s_nop 2
    buffer_load_dword v166, v165, s[8:11], s21 offen offset:0 sc1
    s_waitcnt vmcnt(3)
    v_cmp_eq_u32 vcc, -1, v167
    s_cbranch_vccz L_hd_142
    s_nop 2
    s_add_u32 s28, s28, 1
    s_cmp_lt_u32 s28, s29
    s_cbranch_scc1 L_h_141
L_hd_142:
    s_nop 15
    s_nop 2
    s_branch L_nh_119
L_cw2_138:
    s_sleep 1
    s_cmp_lt_u32 s37, 28
    s_cbranch_scc1 L_us_143
L_ub_144:
    s_add_u32 s23, s24, 16384
    s_lshl_b32 s38, s19, 7
    s_add_u32 s38, s38, 23003264
    s_add_u32 s26, s21, s39
    s_mov_b32 m0, s39
    s_branch L_nh_119
L_us_134:
    s_mov_b32 s28, 0
    v_mov_b32 v174, 0
L_wc_145:
    buffer_load_dword v175, v174, s[8:11], s38 offen sc1
L_wcp_147:
    s_add_u32 s28, s28, 1
    s_waitcnt vmcnt(0)
    v_readfirstlane_b32 s26, v175
    s_nop 0
    s_cmp_ge_u32 s26, 28
    s_nop 1
    s_cbranch_scc1 L_wcd_146
    s_sleep 4
    s_cmp_lt_u32 s28, s29
    s_cbranch_scc1 L_wc_145
    s_mov_b32 s29, 1
L_wcd_146:
    s_branch L_ub_135
L_us_139:
    s_mov_b32 s28, 0
    v_mov_b32 v174, 0
L_wc_148:
    buffer_load_dword v175, v174, s[8:11], s38 offen sc1
L_wcp_150:
    s_add_u32 s28, s28, 1
    s_waitcnt vmcnt(0)
    v_readfirstlane_b32 s26, v175
    s_nop 0
    s_cmp_ge_u32 s26, 28
    s_nop 1
    s_cbranch_scc1 L_wcd_149
    s_sleep 4
    s_cmp_lt_u32 s28, s29
    s_cbranch_scc1 L_wc_148
    s_mov_b32 s29, 1
L_wcd_149:
    s_branch L_ub_140
L_us_143:
    s_mov_b32 s28, 0
    v_mov_b32 v174, 0
L_wc_151:
    buffer_load_dword v175, v174, s[8:11], s38 offen sc1
L_wcp_153:
    s_add_u32 s28, s28, 1
    s_waitcnt vmcnt(0)
    v_readfirstlane_b32 s26, v175
    s_nop 0
    s_cmp_ge_u32 s26, 28
    s_nop 1
    s_cbranch_scc1 L_wcd_152
    s_sleep 4
    s_cmp_lt_u32 s28, s29
    s_cbranch_scc1 L_wc_151
    s_mov_b32 s29, 1
L_wcd_152:
    s_branch L_ub_144
L_cb_next1:
    s_cmp_lg_u32 s20, 0
    s_cbranch_scc1 L_cb_next0
    v_mov_b64 v[40:41], 0
    v_mov_b64 v[42:43], 0
    v_mov_b64 v[44:45], 0
    v_mov_b64 v[46:47], 0
    v_mov_b64 v[48:49], 0
    v_mov_b64 v[50:51], 0
    v_mov_b64 v[52:53], 0
    v_mov_b64 v[54:55], 0
    v_mov_b64 v[56:57], 0
    v_mov_b64 v[58:59], 0
    v_mov_b64 v[60:61], 0
    v_mov_b64 v[62:63], 0
    v_mov_b64 v[64:65], 0
    v_mov_b64 v[66:67], 0
    v_mov_b64 v[68:69], 0
    v_mov_b64 v[70:71], 0
    ds_read_b128 v[128:131], v7 offset:0
    ds_read_b128 v[132:135], v7 offset:1024
    ds_read_b128 v[136:139], v7 offset:2048
    ds_read_b128 v[140:143], v7 offset:3072
    ds_read_b128 v[144:147], v7 offset:4096
    ds_read_b128 v[148:151], v7 offset:5120
    ds_read_b128 v[152:155], v7 offset:6144
    ds_read_b128 v[156:159], v7 offset:7168
    s_mov_b64 s[34:35], 0
    s_add_u32 s23, s24, 16384
    s_lshl_b32 s38, s19, 7
    s_add_u32 s38, s38, 23003264
    s_add_u32 s26, s21, s39
    s_mov_b32 m0, s39
    s_branch L_cb_top_154
    .p2align 6
    s_nop 0
L_nh_155:
    s_barrier
L_cb_top_154:
    buffer_load_dwordx4 v3, s[8:11], s26 offen sc1 lds
    buffer_load_dwordx4 v3, s[8:11], s26 offen offset:1024 sc1 lds
    s_mov_b32 s36, 0
    s_barrier
    buffer_load_dwordx4 v[112:115], v3, s[8:11], s23 offen offset:0 sc1
    buffer_load_dwordx4 v[116:119], v3, s[8:11], s23 offen offset:1024 sc1
    buffer_load_dwordx4 v[120:123], v3, s[8:11], s23 offen offset:2048 sc1
    buffer_load_dwordx4 v[124:127], v3, s[8:11], s23 offen offset:3072 sc1
    s_waitcnt vmcnt(4) lgkmcnt(0)
    s_barrier
L_cmb_157:
    ds_read_b64_tr_b16 v[12:13], v0 offset:0
    ds_read_b64_tr_b16 v[14:15], v0 offset:512
    ds_read_b64_tr_b16 v[16:17], v0 offset:1024
    ds_read_b64_tr_b16 v[18:19], v0 offset:1536
    ds_read_b64_tr_b16 v[20:21], v0 offset:2048
    ds_read_b64_tr_b16 v[22:23], v0 offset:2560
    s_waitcnt lgkmcnt(4)
    v_smfmac_f32_16x16x64_bf16 v[40:43], v[12:15], a[0:7], v2
    ds_read_b64_tr_b16 v[24:25], v0 offset:3072
    buffer_load_dwordx4 v[96:99], v3, s[8:11], s24 offen offset:0 sc1
    v_smfmac_f32_16x16x64_bf16 v[44:47], v[12:15], a[56:63], v2
    ds_read_b64_tr_b16 v[26:27], v0 offset:3584
    s_waitcnt lgkmcnt(4)
    v_smfmac_f32_16x16x64_bf16 v[40:43], v[16:19], a[8:15], v2
    ds_read_b64_tr_b16 v[28:29], v0 offset:4096
    v_smfmac_f32_16x16x64_bf16 v[64:67], v[12:15], v[128:135], v2
    ds_read_b64_tr_b16 v[30:31], v0 offset:4608
    buffer_load_dwordx4 v[100:103], v3, s[8:11], s24 offen offset:1024 sc1
    v_smfmac_f32_16x16x64_bf16 v[44:47], v[16:19], a[64:71], v2
    ds_read_b64_tr_b16 v[32:33], v0 offset:5120
    s_waitcnt lgkmcnt(5)
    v_smfmac_f32_16x16x64_bf16 v[40:43], v[20:23], a[16:23], v2
    ds_read_b64_tr_b16 v[34:35], v0 offset:5632
    v_smfmac_f32_16x16x64_bf16 v[44:47], v[20:23], a[72:79], v2
    ds_read_b64_tr_b16 v[36:37], v0 offset:6144
    buffer_load_dwordx4 v[104:107], v3, s[8:11], s24 offen offset:2048 sc1
    v_smfmac_f32_16x16x64_bf16 v[64:67], v[16:19], v[136:143], v2
    ds_read_b64_tr_b16 v[38:39], v0 offset:6656
    s_waitcnt lgkmcnt(6)
    v_smfmac_f32_16x16x64_bf16 v[40:43], v[24:27], a[24:31], v2
    ds_read_b128 v[128:131], v7 offset:8192
    v_smfmac_f32_16x16x64_bf16 v[44:47], v[24:27], a[80:87], v2
    ds_read_b128 v[132:135], v7 offset:9216
    buffer_load_dwordx4 v[108:111], v3, s[8:11], s24 offen offset:3072 sc1
    s_waitcnt lgkmcnt(6)
    v_smfmac_f32_16x16x64_bf16 v[40:43], v[28:31], a[32:39], v2
    ds_read_b128 v[136:139], v7 offset:10240
    v_smfmac_f32_16x16x64_bf16 v[64:67], v[20:23], v[144:151], v2
    ds_read_b128 v[140:143], v7 offset:11264
    v_smfmac_f32_16x16x64_bf16 v[44:47], v[28:31], a[88:95], v2
    ds_read_b128 v[144:147], v7 offset:12288
    buffer_load_dword v163, v162, s[8:11], s38 offen sc1
    s_waitcnt lgkmcnt(7)
    v_smfmac_f32_16x16x64_bf16 v[40:43], v[32:35], a[40:47], v2
    ds_read_b128 v[148:151], v7 offset:13312
    buffer_store_dwordx4 v[88:91], v8, s[8:11], s33 offen sc1
    v_smfmac_f32_16x16x64_bf16 v[44:47], v[32:35], a[96:103], v2
    v_smfmac_f32_16x16x64_bf16 v[64:67], v[24:27], v[152:159], v2
    ds_read_b128 v[152:155], v7 offset:14336
    s_waitcnt lgkmcnt(7)
    v_smfmac_f32_16x16x64_bf16 v[40:43], v[36:39], a[48:55], v2
    ds_read_b128 v[156:159], v7 offset:15360
    s_add_u32 s27, s33, 4096
    buffer_store_dwordx4 v[92:95], v8, s[8:11], s27 offen sc1
    v_smfmac_f32_16x16x64_bf16 v[44:47], v[36:39], a[104:111], v2
    v_smfmac_f32_16x16x64_bf16 v[48:51], v[12:15], a[112:119], v2
    s_waitcnt lgkmcnt(6)
    v_smfmac_f32_16x16x64_bf16 v[64:67], v[28:31], v[128:135], v2
    ds_read_b128 v[128:131], v7 offset:16384
    v_add_f32 v40, v40, v42
    v_smfmac_f32_16x16x64_bf16 v[48:51], v[16:19], a[120:127], v2
    ds_read_b128 v[132:135], v7 offset:17408
    v_add_f32 v41, v41, v43
    v_smfmac_f32_16x16x64_bf16 v[48:51], v[20:23], a[128:135], v2
    v_cvt_pk_bf16_f32 v88, v40, v41
    v_smfmac_f32_16x16x64_bf16 v[48:51], v[24:27], a[136:143], v2
    v_add_f32 v44, v44, v46
    s_waitcnt lgkmcnt(6)
    v_smfmac_f32_16x16x64_bf16 v[64:67], v[32:35], v[136:143], v2
    ds_read_b128 v[136:139], v7 offset:18432
    v_add_f32 v45, v45, v47
    v_smfmac_f32_16x16x64_bf16 v[48:51], v[28:31], a[144:151], v2
    ds_read_b128 v[140:143], v7 offset:19456
    v_cvt_pk_bf16_f32 v92, v44, v45
    v_smfmac_f32_16x16x64_bf16 v[48:51], v[32:35], a[152:159], v2
    v_add_f32 v9, v40, v41
    v_smfmac_f32_16x16x64_bf16 v[48:51], v[36:39], a[160:167], v2
    ds_write_b32 v172, v9 offset:13312
    s_waitcnt lgkmcnt(7)
    v_smfmac_f32_16x16x64_bf16 v[64:67], v[36:39], v[144:151], v2
    ds_read_b128 v[144:147], v7 offset:20480
    v_smfmac_f32_16x16x64_bf16 v[52:55], v[12:15], a[168:175], v2
    ds_read_b128 v[148:151], v7 offset:21504
    v_smfmac_f32_16x16x64_bf16 v[52:55], v[16:19], a[176:183], v2
    v_add_f32 v48, v48, v50
    v_smfmac_f32_16x16x64_bf16 v[52:55], v[20:23], a[184:191], v2
    s_waitcnt lgkmcnt(2)
    s_barrier
    v_add_f32 v49, v49, v51
    v_smfmac_f32_16x16x64_bf16 v[68:71], v[12:15], v[152:159], v2
    ds_read_b128 v[152:155], v7 offset:22528
    v_cvt_pk_bf16_f32 v89, v48, v49
    v_smfmac_f32_16x16x64_bf16 v[52:55], v[24:27], a[192:199], v2
    ds_read_b128 v[156:159], v7 offset:23552
    v_add_f32 v64, v64, v66
    v_smfmac_f32_16x16x64_bf16 v[52:55], v[28:31], a[200:207], v2
    ds_read2st64_b32 v[168:169], v173 offset0:52 offset1:53
    v_add_f32 v65, v65, v67
    v_smfmac_f32_16x16x64_bf16 v[52:55], v[32:35], a[208:215], v2
    ds_read2st64_b32 v[170:171], v173 offset0:54 offset1:55
    v_cvt_pk_bf16_f32 v91, v64, v65
    v_smfmac_f32_16x16x64_bf16 v[68:71], v[16:19], v[128:135], v2
    ds_read_b128 v[128:131], v7 offset:24576
    v_smfmac_f32_16x16x64_bf16 v[52:55], v[36:39], a[216:223], v2
    ds_read_b128 v[132:135], v7 offset:25600
    v_smfmac_f32_16x16x64_bf16 v[56:59], v[12:15], a[224:231], v2
    v_smfmac_f32_16x16x64_bf16 v[56:59], v[16:19], a[232:239], v2
    s_waitcnt lgkmcnt(2)
    v_add_f32 v168, v168, v170
    v_smfmac_f32_16x16x64_bf16 v[68:71], v[20:23], v[136:143], v2
    ds_read_b128 v[136:139], v7 offset:26624
    v_add_f32 v52, v52, v54
    v_smfmac_f32_16x16x64_bf16 v[56:59], v[20:23], a[240:247], v2
    ds_read_b128 v[140:143], v7 offset:27648
    v_add_f32 v53, v53, v55
    v_smfmac_f32_16x16x64_bf16 v[56:59], v[24:27], a[248:255], v2
    v_cvt_pk_bf16_f32 v93, v52, v53
    v_smfmac_f32_16x16x64_bf16 v[56:59], v[28:31], v[176:183], v2
    v_add_f32 v169, v169, v171
    v_smfmac_f32_16x16x64_bf16 v[68:71], v[24:27], v[144:151], v2
    v_cmp_u_f32 vcc, v168, v169
    v_smfmac_f32_16x16x64_bf16 v[56:59], v[32:35], v[184:191], v2
    v_smfmac_f32_16x16x64_bf16 v[56:59], v[36:39], v[192:199], v2
    v_smfmac_f32_16x16x64_bf16 v[60:63], v[12:15], v[200:207], v2
    v_smfmac_f32_16x16x64_bf16 v[68:71], v[28:31], v[152:159], v2
    v_smfmac_f32_16x16x64_bf16 v[60:63], v[16:19], v[208:215], v2
    v_add_f32 v56, v56, v58
    v_smfmac_f32_16x16x64_bf16 v[60:63], v[20:23], v[216:223], v2
    v_add_f32 v57, v57, v59
    v_smfmac_f32_16x16x64_bf16 v[60:63], v[24:27], v[224:231], v2
    v_cvt_pk_bf16_f32 v90, v56, v57
    s_waitcnt lgkmcnt(2)
    v_smfmac_f32_16x16x64_bf16 v[68:71], v[32:35], v[128:135], v2
    v_smfmac_f32_16x16x64_bf16 v[60:63], v[28:31], v[232:239], v2
    v_smfmac_f32_16x16x64_bf16 v[60:63], v[32:35], v[240:247], v2
    v_smfmac_f32_16x16x64_bf16 v[60:63], v[36:39], v[248:255], v2
    s_waitcnt lgkmcnt(0)
    v_smfmac_f32_16x16x64_bf16 v[68:71], v[36:39], v[136:143], v2
    s_cbranch_vccnz L_cnb_160
L_cnx_161:
    s_nop 3
    v_add_f32 v60, v60, v62
    v_add_f32 v61, v61, v63
    v_cvt_pk_bf16_f32 v94, v60, v61
    v_add_f32 v68, v68, v70
    v_add_f32 v69, v69, v71
    v_cvt_pk_bf16_f32 v95, v68, v69
    s_cmp_ge_u32 s19, 63
    s_cbranch_scc1 L_cbl_162
    s_add_u32 s26, s22, 8192
    s_mov_b32 s33, s25
    ds_read_b128 v[128:131], v7 offset:0
    ds_read_b128 v[132:135], v7 offset:1024
    ds_read_b128 v[136:139], v7 offset:2048
    ds_read_b128 v[140:143], v7 offset:3072
    ds_read_b128 v[144:147], v7 offset:4096
    ds_read_b128 v[148:151], v7 offset:5120
    ds_read_b128 v[152:155], v7 offset:6144
    ds_read_b128 v[156:159], v7 offset:7168
    .p2align 5
    s_nop 2
    s_nop 2
    s_nop 2
    s_nop 3
    s_nop 3
    s_nop 3
    s_barrier
    s_mov_b32 s28, 0
    buffer_load_dwordx4 v[12:15], v4, s[8:11], s22 offen sc1
    buffer_load_dwordx4 v[16:19], v4, s[8:11], s22 offen offset:1024 sc1
    buffer_load_dwordx2 v[20:21], v72, s[8:11], s26 offen sc1
    v_mov_b64 v[76:77], 0
    v_mov_b64 v[78:79], 0
    v_mov_b64 v[80:81], 0
    v_mov_b64 v[82:83], 0
    v_add_u32 v74, 1, v74
    v_mov_b64 v[40:41], 0
    v_mov_b64 v[42:43], 0
    v_mov_b64 v[44:45], 0
    v_mov_b64 v[46:47], 0
    v_mov_b64 v[48:49], 0
    v_mov_b64 v[50:51], 0
    v_mov_b64 v[52:53], 0
    v_mov_b64 v[54:55], 0
    v_mov_b64 v[56:57], 0
    v_mov_b64 v[58:59], 0
    v_mov_b64 v[60:61], 0
    v_mov_b64 v[62:63], 0
    v_mov_b64 v[64:65], 0
    v_mov_b64 v[66:67], 0
    v_mov_b64 v[68:69], 0
    v_mov_b64 v[70:71], 0
    s_nop 15
    buffer_load_dwordx4 v[24:27], v4, s[8:11], s22 offen sc1
    buffer_load_dwordx4 v[28:31], v4, s[8:11], s22 offen offset:1024 sc1
    buffer_load_dwordx2 v[32:33], v72, s[8:11], s26 offen sc1
    s_add_u32 s28, s28, 1
    s_waitcnt vmcnt(5)
    v_smfmac_f32_16x16x64_bf16 v[76:79], v[12:15], v[96:103], v2
    v_max_u32 v9, v12, v14
    v_smfmac_f32_16x16x64_bf16 v[80:83], v[12:15], v[112:119], v2
    s_waitcnt vmcnt(4)
    v_smfmac_f32_16x16x64_bf16 v[76:79], v[16:19], v[104:111], v2
    v_max3_u32 v9, v9, v16, v18
    v_smfmac_f32_16x16x64_bf16 v[80:83], v[16:19], v[120:127], v2
    s_waitcnt vmcnt(3)
    v_smfmac_f32_16x16x32_bf16 v[76:79], v[20:21], v[88:91], v2
    v_max3_u32 v9, v9, v20, v21
    v_smfmac_f32_16x16x32_bf16 v[80:83], v[20:21], v[92:95], v2
    v_cmp_eq_u32 vcc, -1, v9
    s_cbranch_vccnz L_ppr_165
L_ppd_164:
    s_mov_b64 exec, 15
    buffer_store_dword v162, v164, s[8:11], s21 offen sc1
    s_mov_b64 exec, -1
    v_readfirstlane_b32 s37, v163
    v_pk_add_f32 v[76:77], v[76:77], v[78:79]
    ds_write_b64 v75, v[76:77] offset:7168
    v_pk_add_f32 v[80:81], v[80:81], v[82:83]
    ds_write_b64 v75, v[80:81] offset:7936
    s_cmp_ge_u32 s17, 2
    s_cbranch_scc1 L_cbh_166
    s_waitcnt lgkmcnt(0)
    s_barrier
    ds_read_b64 v[76:77], v5 offset:7168
    ds_read_b64 v[78:79], v5 offset:8704
    ds_read_b64 v[80:81], v5 offset:10240
    ds_read_b64 v[82:83], v5 offset:11776
    s_waitcnt lgkmcnt(2)
    v_pk_add_f32 v[76:77], v[76:77], v[78:79]
    s_waitcnt lgkmcnt(0)
    v_pk_add_f32 v[80:81], v[80:81], v[82:83]
    v_pk_add_f32 v[76:77], v[76:77], v[80:81]
    v_cvt_pk_bf16_f32 v9, v76, v77
    buffer_store_dword v9, v6, s[8:11], s21 offen sc1
    s_cmp_lt_u32 s19, 62
    s_cbranch_scc1 L_cny_169
    s_add_u32 s26, s21, 2228224
    buffer_store_dword v9, v6, s[8:11], s26 offen sc1
L_cny_169:
    s_cmp_lt_u32 s37, 28
    s_cbranch_scc1 L_us_170
L_ub_171:
    s_add_u32 s19, s19, 1
    s_add_u32 s21, s21, 8192
    s_add_u32 s22, s22, 16384
    s_add_u32 s24, s24, 458752
    s_add_u32 s25, s25, 114688
    s_add_u32 s32, s32, 64
    s_add_u32 s23, s24, 16384
    s_lshl_b32 s38, s19, 7
    s_add_u32 s38, s38, 23003264
    s_add_u32 s26, s21, s39
    s_mov_b32 m0, s39
    s_branch L_nh_155
L_cmr_158:
    s_barrier
    s_mov_b32 s36, 1
    s_add_u32 s33, s25, 0x8000000
    v_mov_b64 v[40:41], 0
    v_mov_b64 v[42:43], 0
    v_mov_b64 v[44:45], 0
    v_mov_b64 v[46:47], 0
    v_mov_b64 v[48:49], 0
    v_mov_b64 v[50:51], 0
    v_mov_b64 v[52:53], 0
    v_mov_b64 v[54:55], 0
    v_mov_b64 v[56:57], 0
    v_mov_b64 v[58:59], 0
    v_mov_b64 v[60:61], 0
    v_mov_b64 v[62:63], 0
    v_mov_b64 v[64:65], 0
    v_mov_b64 v[66:67], 0
    v_mov_b64 v[68:69], 0
    v_mov_b64 v[70:71], 0
    ds_read_b128 v[128:131], v7 offset:0
    ds_read_b128 v[132:135], v7 offset:1024
    ds_read_b128 v[136:139], v7 offset:2048
    ds_read_b128 v[140:143], v7 offset:3072
    ds_read_b128 v[144:147], v7 offset:4096
    ds_read_b128 v[148:151], v7 offset:5120
    ds_read_b128 v[152:155], v7 offset:6144
    ds_read_b128 v[156:159], v7 offset:7168
    s_mov_b32 s28, 0
L_pm_172:
    buffer_load_dwordx4 v[12:15], v1, s[8:11], s21 offen sc1
    buffer_load_dwordx4 v[16:19], v1, s[8:11], s21 offen offset:768 sc1
    s_add_u32 s28, s28, 1
    s_waitcnt vmcnt(1)
    ds_write_b128 v1, v[12:15]
    v_max3_u32 v20, v12, v13, v14
    s_waitcnt vmcnt(0)
    ds_write_b128 v1, v[16:19] offset:768
    v_max3_u32 v20, v20, v15, v16
    v_max3_u32 v20, v20, v17, v18
    v_max_u32 v20, v20, v19
    v_cmp_eq_u32 vcc, -1, v20
    s_cbranch_vccz L_pmd_173
    s_cmp_lt_u32 s28, s29
    s_cbranch_scc1 L_pm_172
    s_mov_b32 s29, 1
L_pmd_173:
    s_waitcnt lgkmcnt(0)
    s_barrier
    s_branch L_cmb_157
L_cnb_160:
    s_nop 7
    s_cmp_eq_u32 s36, 0
    s_cbranch_scc1 L_cmr_158
    s_branch L_cnx_161
L_cbl_162:
    buffer_store_dwordx4 v[88:91], v8, s[8:11], s25 offen sc1
    s_add_u32 s27, s25, 4096
    buffer_store_dwordx4 v[92:95], v8, s[8:11], s27 offen sc1
    s_nop 0
    s_branch L_exit
L_ppr_165:
    s_nop 7
L_pp_163:
    buffer_load_dwordx4 v[12:15], v4, s[8:11], s22 offen sc1
    buffer_load_dwordx4 v[16:19], v4, s[8:11], s22 offen offset:1024 sc1
    buffer_load_dwordx2 v[20:21], v72, s[8:11], s26 offen sc1
    v_mov_b64 v[76:77], 0
    v_mov_b64 v[78:79], 0
    v_mov_b64 v[80:81], 0
    v_mov_b64 v[82:83], 0
    s_add_u32 s28, s28, 1
    s_waitcnt vmcnt(5)
    v_smfmac_f32_16x16x64_bf16 v[76:79], v[24:27], v[96:103], v2
    v_max_u32 v9, v24, v26
    v_smfmac_f32_16x16x64_bf16 v[80:83], v[24:27], v[112:119], v2
    s_waitcnt vmcnt(4)
    v_smfmac_f32_16x16x64_bf16 v[76:79], v[28:31], v[104:111], v2
    v_max3_u32 v9, v9, v28, v30
    v_smfmac_f32_16x16x64_bf16 v[80:83], v[28:31], v[120:127], v2
    s_waitcnt vmcnt(3)
    v_smfmac_f32_16x16x32_bf16 v[76:79], v[32:33], v[88:91], v2
    v_max3_u32 v9, v9, v32, v33
    v_smfmac_f32_16x16x32_bf16 v[80:83], v[32:33], v[92:95], v2
    v_cmp_eq_u32 vcc, -1, v9
    s_nop 5
    s_cbranch_vccz L_ppd_164
    buffer_load_dwordx4 v[24:27], v4, s[8:11], s22 offen sc1
    buffer_load_dwordx4 v[28:31], v4, s[8:11], s22 offen offset:1024 sc1
    buffer_load_dwordx2 v[32:33], v72, s[8:11], s26 offen sc1
    v_mov_b64 v[76:77], 0
    v_mov_b64 v[78:79], 0
    v_mov_b64 v[80:81], 0
    v_mov_b64 v[82:83], 0
    s_add_u32 s28, s28, 1
    s_waitcnt vmcnt(5)
    v_smfmac_f32_16x16x64_bf16 v[76:79], v[12:15], v[96:103], v2
    v_max_u32 v9, v12, v14
    v_smfmac_f32_16x16x64_bf16 v[80:83], v[12:15], v[112:119], v2
    s_waitcnt vmcnt(4)
    v_smfmac_f32_16x16x64_bf16 v[76:79], v[16:19], v[104:111], v2
    v_max3_u32 v9, v9, v16, v18
    v_smfmac_f32_16x16x64_bf16 v[80:83], v[16:19], v[120:127], v2
    s_waitcnt vmcnt(3)
    v_smfmac_f32_16x16x32_bf16 v[76:79], v[20:21], v[88:91], v2
    v_max3_u32 v9, v9, v20, v21
    v_smfmac_f32_16x16x32_bf16 v[80:83], v[20:21], v[92:95], v2
    v_cmp_eq_u32 vcc, -1, v9
    s_nop 5
    s_cbranch_vccz L_ppd_164
    s_cmp_lt_u32 s28, s29
    s_cbranch_scc1 L_pp_163
    s_mov_b32 s29, 1
    s_mov_b64 vcc, 0
    s_branch L_ppd_164
L_cbh_166:
    s_add_u32 s19, s19, 1
    s_add_u32 s21, s21, 8192
    s_add_u32 s22, s22, 16384
    s_add_u32 s24, s24, 458752
    s_add_u32 s25, s25, 114688
    s_add_u32 s32, s32, 64
    s_cmp_eq_u32 s17, 2
    s_waitcnt lgkmcnt(0)
    s_barrier
    s_cbranch_scc1 L_cw2_174
    buffer_load_dword v10, v165, s[8:11], s21 offen sc1
    s_cmp_lt_u32 s37, 28
    s_cbranch_scc1 L_us_175
L_ub_176:
    s_add_u32 s23, s24, 16384
    s_lshl_b32 s38, s19, 7
    s_add_u32 s38, s38, 23003264
    s_add_u32 s26, s21, s39
    s_mov_b32 m0, s39
    s_nop 4
    buffer_load_dword v11, v165, s[8:11], s21 offen sc1
    s_nop 12
    buffer_load_dword v166, v165, s[8:11], s21 offen sc1
    s_nop 12
    s_mov_b32 s28, 0
L_h_177:
    buffer_load_dword v167, v165, s[8:11], s21 offen offset:0 sc1
    s_waitcnt vmcnt(3)
    v_cmp_eq_u32 vcc, -1, v10
    s_cbranch_vccz L_hd_178
    s_nop 2
    buffer_load_dword v10, v165, s[8:11], s21 offen offset:0 sc1
    s_waitcnt vmcnt(3)
    v_cmp_eq_u32 vcc, -1, v11
    s_cbranch_vccz L_hd_178
    s_nop 2
    buffer_load_dword v11, v165, s[8:11], s21 offen offset:0 sc1
    s_waitcnt vmcnt(3)
    v_cmp_eq_u32 vcc, -1, v166
    s_cbranch_vccz L_hd_178
    s_nop 2
    buffer_load_dword v166, v165, s[8:11], s21 offen offset:0 sc1
    s_waitcnt vmcnt(3)
    v_cmp_eq_u32 vcc, -1, v167
    s_cbranch_vccz L_hd_178
    s_nop 2
    s_add_u32 s28, s28, 1
    s_cmp_lt_u32 s28, s29
    s_cbranch_scc1 L_h_177
L_hd_178:
    s_nop 15
    s_nop 2
    s_branch L_nh_155
L_cw2_174:
    s_sleep 1
    s_cmp_lt_u32 s37, 28
    s_cbranch_scc1 L_us_179
L_ub_180:
    s_add_u32 s23, s24, 16384
    s_lshl_b32 s38, s19, 7
    s_add_u32 s38, s38, 23003264
    s_add_u32 s26, s21, s39
    s_mov_b32 m0, s39
    s_branch L_nh_155
L_us_170:
    s_mov_b32 s28, 0
    v_mov_b32 v174, 0
L_wc_181:
    buffer_load_dword v175, v174, s[8:11], s38 offen sc1
L_wcp_183:
    s_add_u32 s28, s28, 1
    s_waitcnt vmcnt(0)
    v_readfirstlane_b32 s26, v175
    s_nop 0
    s_cmp_ge_u32 s26, 28
    s_nop 1
    s_cbranch_scc1 L_wcd_182
    s_sleep 4
    s_cmp_lt_u32 s28, s29
    s_cbranch_scc1 L_wc_181
    s_mov_b32 s29, 1
L_wcd_182:
    s_branch L_ub_171
L_us_175:
    s_mov_b32 s28, 0
    v_mov_b32 v174, 0
L_wc_184:
    buffer_load_dword v175, v174, s[8:11], s38 offen sc1
L_wcp_186:
    s_add_u32 s28, s28, 1
    s_waitcnt vmcnt(0)
    v_readfirstlane_b32 s26, v175
    s_nop 0
    s_cmp_ge_u32 s26, 28
    s_nop 1
    s_cbranch_scc1 L_wcd_185
    s_sleep 4
    s_cmp_lt_u32 s28, s29
    s_cbranch_scc1 L_wc_184
    s_mov_b32 s29, 1
L_wcd_185:
    s_branch L_ub_176
L_us_179:
    s_mov_b32 s28, 0
    v_mov_b32 v174, 0
L_wc_187:
    buffer_load_dword v175, v174, s[8:11], s38 offen sc1
L_wcp_189:
    s_add_u32 s28, s28, 1
    s_waitcnt vmcnt(0)
    v_readfirstlane_b32 s26, v175
    s_nop 0
    s_cmp_ge_u32 s26, 28
    s_nop 1
    s_cbranch_scc1 L_wcd_188
    s_sleep 4
    s_cmp_lt_u32 s28, s29
    s_cbranch_scc1 L_wc_187
    s_mov_b32 s29, 1
L_wcd_188:
    s_branch L_ub_180
L_cb_next0:
    s_branch L_exit
M_worker:
    s_lshr_b32 s26, s16, 5
    s_sub_u32 s26, s26, 1
    s_mov_b32 s78, s26
    s_and_b32 s27, s16, 31
    s_cmp_ge_u32 s27, 30
    s_cbranch_scc1 M_attn
    s_cmp_ge_u32 s27, 16
    s_cbranch_scc1 M_ffn
    s_cmp_ge_u32 s27, 8
    s_cselect_b32 s79, 62, 0
    s_cselect_b32 s47, 1, 31
    s_and_b32 s27, s27, 7
    s_lshl_b32 s16, s26, 3
    s_add_u32 s16, s16, s27
    s_lshr_b32 s26, s16, 0
    s_and_b32 s36, s16, 0
    s_mov_b32 s36, s79
    s_lshl_b32 s26, s26, 2
    s_add_u32 s26, s26, s17
    v_lshlrev_b32 v2, 4, v1
    s_mul_i32 s39, s17, 7168
    s_mul_i32 s37, s36, 28672
    s_add_u32 s37, s37, s39
    s_add_u32 s37, s37, 0
    s_add_u32 m0, s39, 0
    s_nop 0
    buffer_load_dwordx4 v2, s[8:11], s37 offen offset:0  lds
    buffer_load_dwordx4 v2, s[8:11], s37 offen offset:1024  lds
    buffer_load_dwordx4 v2, s[8:11], s37 offen offset:2048  lds
    buffer_load_dwordx4 v2, s[8:11], s37 offen offset:3072  lds
    s_add_u32 m0, m0, 4096
    s_add_u32 s37, s37, 4096
    buffer_load_dwordx4 v2, s[8:11], s37 offen offset:0  lds
    buffer_load_dwordx4 v2, s[8:11], s37 offen offset:1024  lds
    buffer_load_dwordx4 v2, s[8:11], s37 offen offset:2048  lds
    s_add_u32 s37, s37, 24576
    s_add_u32 m0, s39, 28672
    s_nop 0
    buffer_load_dwordx4 v2, s[8:11], s37 offen offset:0  lds
    buffer_load_dwordx4 v2, s[8:11], s37 offen offset:1024  lds
    buffer_load_dwordx4 v2, s[8:11], s37 offen offset:2048  lds
    buffer_load_dwordx4 v2, s[8:11], s37 offen offset:3072  lds
    s_add_u32 m0, m0, 4096
    s_add_u32 s37, s37, 4096
    buffer_load_dwordx4 v2, s[8:11], s37 offen offset:0  lds
    buffer_load_dwordx4 v2, s[8:11], s37 offen offset:1024  lds
    buffer_load_dwordx4 v2, s[8:11], s37 offen offset:2048  lds
    s_add_u32 s37, s37, 24576
    s_add_u32 m0, s39, 57344
    s_nop 0
    buffer_load_dwordx4 v2, s[8:11], s37 offen offset:0  lds
    buffer_load_dwordx4 v2, s[8:11], s37 offen offset:1024  lds
    buffer_load_dwordx4 v2, s[8:11], s37 offen offset:2048  lds
    buffer_load_dwordx4 v2, s[8:11], s37 offen offset:3072  lds
    s_add_u32 m0, m0, 4096
    s_add_u32 s37, s37, 4096
    buffer_load_dwordx4 v2, s[8:11], s37 offen offset:0  lds
    buffer_load_dwordx4 v2, s[8:11], s37 offen offset:1024  lds
    buffer_load_dwordx4 v2, s[8:11], s37 offen offset:2048  lds
    s_add_u32 s37, s37, 24576
    s_mul_i32 s27, s26, 57344
    s_add_u32 s27, s27, 2097152
    s_lshl_b32 s41, s16, 2
    s_add_u32 s41, s41, s17
    s_lshl_b32 s41, s41, 7
    s_add_u32 s41, s41, 135266304
    s_lshl_b32 s43, s36, 12
    s_add_u32 s41, s41, s43
    s_mov_b32 s43, 0
    s_mul_i32 s38, s36, 458752
    s_cmp_ge_u32 s26, 112
    s_cbranch_scc1 G_type1
    s_mul_i32 s40, s26, 37
    s_lshr_b32 s40, s40, 8
    s_mul_i32 s46, s40, 7
    s_cmp_gt_u32 s46, s26
    s_cselect_b32 s46, 1, 0
    s_sub_u32 s40, s40, s46
    s_mul_i32 s46, s40, 7
    s_sub_u32 s46, s26, s46
    s_mul_i32 s40, s40, 28672
    s_lshl_b32 s46, s46, 11
    s_add_u32 s38, s38, s40
    s_add_u32 s38, s38, s46
    s_add_u32 s38, s38, 37748736
    v_bfe_u32 v3, v1, 3, 1
    v_mul_u32_u24 v3, 14336, v3
    v_lshrrev_b32 v4, 4, v1
    v_lshl_add_u32 v3, v4, 8, v3
    v_bfe_u32 v4, v1, 2, 1
    v_lshl_add_u32 v3, v4, 7, v3
    v_and_b32 v4, 3, v1
    v_lshl_add_u32 v3, v4, 4, v3
    s_add_u32 s26, s27, 0
    buffer_load_dwordx4 a[0:3], v3, s[8:11], s26 offen offset:0
    buffer_load_dwordx4 a[4:7], v3, s[8:11], s26 offen offset:1024
    buffer_load_dwordx4 a[8:11], v3, s[8:11], s26 offen offset:2048
    s_add_u32 s26, s27, 3072
    buffer_load_dwordx4 a[12:15], v3, s[8:11], s26 offen offset:0
    buffer_load_dwordx4 a[16:19], v3, s[8:11], s26 offen offset:1024
    buffer_load_dwordx4 a[20:23], v3, s[8:11], s26 offen offset:2048
    s_add_u32 s26, s27, 6144
    buffer_load_dwordx4 a[24:27], v3, s[8:11], s26 offen offset:0
    buffer_load_dwordx4 a[28:31], v3, s[8:11], s26 offen offset:1024
    buffer_load_dwordx4 a[32:35], v3, s[8:11], s26 offen offset:2048
    s_add_u32 s26, s27, 9216
    buffer_load_dwordx4 a[36:39], v3, s[8:11], s26 offen offset:0
    buffer_load_dwordx4 a[40:43], v3, s[8:11], s26 offen offset:1024
    buffer_load_dwordx4 a[44:47], v3, s[8:11], s26 offen offset:2048
    s_add_u32 s26, s27, 12288
    buffer_load_dwordx4 a[48:51], v3, s[8:11], s26 offen offset:0
    buffer_load_dwordx4 a[52:55], v3, s[8:11], s26 offen offset:1024
    s_add_u32 s26, s27, 64
    buffer_load_dwordx4 a[56:59], v3, s[8:11], s26 offen offset:0
    buffer_load_dwordx4 a[60:63], v3, s[8:11], s26 offen offset:1024
    buffer_load_dwordx4 a[64:67], v3, s[8:11], s26 offen offset:2048
    s_add_u32 s26, s27, 3136
    buffer_load_dwordx4 a[68:71], v3, s[8:11], s26 offen offset:0
    buffer_load_dwordx4 a[72:75], v3, s[8:11], s26 offen offset:1024
    buffer_load_dwordx4 a[76:79], v3, s[8:11], s26 offen offset:2048
    s_add_u32 s26, s27, 6208
    buffer_load_dwordx4 a[80:83], v3, s[8:11], s26 offen offset:0
    buffer_load_dwordx4 a[84:87], v3, s[8:11], s26 offen offset:1024
    buffer_load_dwordx4 a[88:91], v3, s[8:11], s26 offen offset:2048
    s_add_u32 s26, s27, 9280
    buffer_load_dwordx4 a[92:95], v3, s[8:11], s26 offen offset:0
    buffer_load_dwordx4 a[96:99], v3, s[8:11], s26 offen offset:1024
    buffer_load_dwordx4 a[100:103], v3, s[8:11], s26 offen offset:2048
    s_add_u32 s26, s27, 12352
    buffer_load_dwordx4 a[104:107], v3, s[8:11], s26 offen offset:0
    buffer_load_dwordx4 a[108:111], v3, s[8:11], s26 offen offset:1024
    s_add_u32 s26, s27, 28672
    buffer_load_dwordx4 a[112:115], v3, s[8:11], s26 offen offset:0
    buffer_load_dwordx4 a[116:119], v3, s[8:11], s26 offen offset:1024
    buffer_load_dwordx4 a[120:123], v3, s[8:11], s26 offen offset:2048
    s_add_u32 s26, s27, 31744
    buffer_load_dwordx4 a[124:127], v3, s[8:11], s26 offen offset:0
    buffer_load_dwordx4 a[128:131], v3, s[8:11], s26 offen offset:1024
    buffer_load_dwordx4 a[132:135], v3, s[8:11], s26 offen offset:2048
    s_add_u32 s26, s27, 34816
    buffer_load_dwordx4 a[136:139], v3, s[8:11], s26 offen offset:0
    buffer_load_dwordx4 a[140:143], v3, s[8:11], s26 offen offset:1024
    buffer_load_dwordx4 a[144:147], v3, s[8:11], s26 offen offset:2048
    s_add_u32 s26, s27, 37888
    buffer_load_dwordx4 a[148:151], v3, s[8:11], s26 offen offset:0
    buffer_load_dwordx4 a[152:155], v3, s[8:11], s26 offen offset:1024
    s_waitcnt vmcnt(30)
    buffer_load_dwordx4 a[156:159], v3, s[8:11], s26 offen offset:2048
    s_add_u32 s26, s27, 40960
    buffer_load_dwordx4 a[160:163], v3, s[8:11], s26 offen offset:0
    buffer_load_dwordx4 a[164:167], v3, s[8:11], s26 offen offset:1024
    s_add_u32 s26, s27, 28736
    buffer_load_dwordx4 a[168:171], v3, s[8:11], s26 offen offset:0
    buffer_load_dwordx4 a[172:175], v3, s[8:11], s26 offen offset:1024
    buffer_load_dwordx4 a[176:179], v3, s[8:11], s26 offen offset:2048
    s_add_u32 s26, s27, 31808
    buffer_load_dwordx4 a[180:183], v3, s[8:11], s26 offen offset:0
    buffer_load_dwordx4 a[184:187], v3, s[8:11], s26 offen offset:1024
    buffer_load_dwordx4 a[188:191], v3, s[8:11], s26 offen offset:2048
    s_add_u32 s26, s27, 34880
    buffer_load_dwordx4 a[192:195], v3, s[8:11], s26 offen offset:0
    buffer_load_dwordx4 a[196:199], v3, s[8:11], s26 offen offset:1024
    buffer_load_dwordx4 a[200:203], v3, s[8:11], s26 offen offset:2048
    s_add_u32 s26, s27, 37952
    buffer_load_dwordx4 a[204:207], v3, s[8:11], s26 offen offset:0
    buffer_load_dwordx4 a[208:211], v3, s[8:11], s26 offen offset:1024
    buffer_load_dwordx4 a[212:215], v3, s[8:11], s26 offen offset:2048
    s_add_u32 s26, s27, 41024
    buffer_load_dwordx4 a[216:219], v3, s[8:11], s26 offen offset:0
    buffer_load_dwordx4 a[220:223], v3, s[8:11], s26 offen offset:1024
    s_lshl_b32 s44, s36, 7
    s_add_u32 s44, s44, 23011328
    s_cmp_eq_u32 s17, 0
    s_cselect_b32 s44, s44, s41
    s_cselect_b32 s42, 128, 0
    s_mov_b32 s27, 4160749568
    s_add_u32 s38, s38, 0x8000000
    v_mov_b32 v4, v2
    v_mov_b32 v6, 0
    v_mov_b32 v7, 1
    s_mov_b32 s40, 0
    s_mov_b32 s46, 86016
    s_waitcnt vmcnt(0)
    s_barrier
    ds_read_b128 v[16:19], v4 offset:0
    ds_read_b128 v[20:23], v4 offset:14336
    ds_read_b128 v[24:27], v4 offset:1024
    ds_read_b128 v[28:31], v4 offset:15360
G_top0:
    s_waitcnt lgkmcnt(2)
    s_nop 0
    v_mfma_f32_16x16x32_bf16 v[48:51], a[0:3], v[16:19], 0
    v_mfma_f32_16x16x32_bf16 v[52:55], a[0:3], v[20:23], 0
    ds_read_b128 v[32:35], v4 offset:2048
    v_mfma_f32_16x16x32_bf16 v[56:59], a[56:59], v[16:19], 0
    v_mfma_f32_16x16x32_bf16 v[60:63], a[56:59], v[20:23], 0
    ds_read_b128 v[36:39], v4 offset:16384
    v_mfma_f32_16x16x32_bf16 v[64:67], a[112:115], v[16:19], 0
    v_cvt_pk_bf16_f32 v112, v80, v81
    v_mfma_f32_16x16x32_bf16 v[68:71], a[112:115], v[20:23], 0
    v_cvt_pk_bf16_f32 v113, v82, v83
    v_mfma_f32_16x16x32_bf16 v[72:75], a[168:171], v[16:19], 0
    v_cvt_pk_bf16_f32 v114, v88, v89
    v_mfma_f32_16x16x32_bf16 v[76:79], a[168:171], v[20:23], 0
    v_cvt_pk_bf16_f32 v115, v90, v91
    s_waitcnt lgkmcnt(2)
    v_mfma_f32_16x16x32_bf16 v[48:51], a[4:7], v[24:27], v[48:51]
    v_mfma_f32_16x16x32_bf16 v[52:55], a[4:7], v[28:31], v[52:55]
    ds_read_b128 v[40:43], v4 offset:3072
    v_mfma_f32_16x16x32_bf16 v[56:59], a[60:63], v[24:27], v[56:59]
    s_add_u32 s26, s38, 0
    buffer_store_dwordx4 v[112:115], v2, s[8:11], s26 offen sc1
    v_mfma_f32_16x16x32_bf16 v[60:63], a[60:63], v[28:31], v[60:63]
    ds_read_b128 v[44:47], v4 offset:17408
    v_cvt_pk_bf16_f32 v116, v96, v97
    v_mfma_f32_16x16x32_bf16 v[64:67], a[116:119], v[24:27], v[64:67]
    v_cvt_pk_bf16_f32 v117, v98, v99
    v_mfma_f32_16x16x32_bf16 v[68:71], a[116:119], v[28:31], v[68:71]
    v_cvt_pk_bf16_f32 v118, v104, v105
    v_mfma_f32_16x16x32_bf16 v[72:75], a[172:175], v[24:27], v[72:75]
    v_cvt_pk_bf16_f32 v119, v106, v107
    v_mfma_f32_16x16x32_bf16 v[76:79], a[172:175], v[28:31], v[76:79]
    s_waitcnt lgkmcnt(2)
    v_mfma_f32_16x16x32_bf16 v[48:51], a[8:11], v[32:35], v[48:51]
    s_add_u32 s26, s38, 1024
    buffer_store_dwordx4 v[116:119], v2, s[8:11], s26 offen sc1
    v_mfma_f32_16x16x32_bf16 v[52:55], a[8:11], v[36:39], v[52:55]
    ds_read_b128 v[16:19], v4 offset:4096
    v_cvt_pk_bf16_f32 v120, v84, v85
    v_mfma_f32_16x16x32_bf16 v[56:59], a[64:67], v[32:35], v[56:59]
    v_cvt_pk_bf16_f32 v121, v86, v87
    v_mfma_f32_16x16x32_bf16 v[60:63], a[64:67], v[36:39], v[60:63]
    ds_read_b128 v[20:23], v4 offset:18432
    v_cvt_pk_bf16_f32 v122, v92, v93
    v_mfma_f32_16x16x32_bf16 v[64:67], a[120:123], v[32:35], v[64:67]
    v_cvt_pk_bf16_f32 v123, v94, v95
    v_mfma_f32_16x16x32_bf16 v[68:71], a[120:123], v[36:39], v[68:71]
    v_mfma_f32_16x16x32_bf16 v[72:75], a[176:179], v[32:35], v[72:75]
    s_add_u32 s26, s38, 14336
    buffer_store_dwordx4 v[120:123], v2, s[8:11], s26 offen sc1
    v_mfma_f32_16x16x32_bf16 v[76:79], a[176:179], v[36:39], v[76:79]
    v_cvt_pk_bf16_f32 v124, v100, v101
    s_waitcnt lgkmcnt(2)
    v_mfma_f32_16x16x32_bf16 v[48:51], a[12:15], v[40:43], v[48:51]
    v_cvt_pk_bf16_f32 v125, v102, v103
    v_mfma_f32_16x16x32_bf16 v[52:55], a[12:15], v[44:47], v[52:55]
    ds_read_b128 v[24:27], v4 offset:5120
    v_cvt_pk_bf16_f32 v126, v108, v109
    v_mfma_f32_16x16x32_bf16 v[56:59], a[68:71], v[40:43], v[56:59]
    v_cvt_pk_bf16_f32 v127, v110, v111
    v_mfma_f32_16x16x32_bf16 v[60:63], a[68:71], v[44:47], v[60:63]
    ds_read_b128 v[28:31], v4 offset:19456
    v_mfma_f32_16x16x32_bf16 v[64:67], a[124:127], v[40:43], v[64:67]
    s_add_u32 s26, s38, 15360
    buffer_store_dwordx4 v[124:127], v2, s[8:11], s26 offen sc1
    v_mfma_f32_16x16x32_bf16 v[68:71], a[124:127], v[44:47], v[68:71]
    v_mfma_f32_16x16x32_bf16 v[72:75], a[180:183], v[40:43], v[72:75]
    s_add_u32 s38, s38, s27
    s_mov_b32 s27, 458752
    v_mfma_f32_16x16x32_bf16 v[76:79], a[180:183], v[44:47], v[76:79]
    s_waitcnt lgkmcnt(2)
    v_mfma_f32_16x16x32_bf16 v[48:51], a[16:19], v[16:19], v[48:51]
    v_mfma_f32_16x16x32_bf16 v[52:55], a[16:19], v[20:23], v[52:55]
    ds_read_b128 v[32:35], v4 offset:6144
    v_mfma_f32_16x16x32_bf16 v[56:59], a[72:75], v[16:19], v[56:59]
    v_mfma_f32_16x16x32_bf16 v[60:63], a[72:75], v[20:23], v[60:63]
    ds_read_b128 v[36:39], v4 offset:20480
    v_mfma_f32_16x16x32_bf16 v[64:67], a[128:131], v[16:19], v[64:67]
    v_mfma_f32_16x16x32_bf16 v[68:71], a[128:131], v[20:23], v[68:71]
    v_mfma_f32_16x16x32_bf16 v[72:75], a[184:187], v[16:19], v[72:75]
    v_mfma_f32_16x16x32_bf16 v[76:79], a[184:187], v[20:23], v[76:79]
    s_waitcnt lgkmcnt(2)
    v_mfma_f32_16x16x32_bf16 v[48:51], a[20:23], v[24:27], v[48:51]
    v_mfma_f32_16x16x32_bf16 v[52:55], a[20:23], v[28:31], v[52:55]
    ds_read_b128 v[40:43], v4 offset:7168
    v_mfma_f32_16x16x32_bf16 v[56:59], a[76:79], v[24:27], v[56:59]
    v_mfma_f32_16x16x32_bf16 v[60:63], a[76:79], v[28:31], v[60:63]
    ds_read_b128 v[44:47], v4 offset:21504
    v_mfma_f32_16x16x32_bf16 v[64:67], a[132:135], v[24:27], v[64:67]
    v_mfma_f32_16x16x32_bf16 v[68:71], a[132:135], v[28:31], v[68:71]
    v_mfma_f32_16x16x32_bf16 v[72:75], a[188:191], v[24:27], v[72:75]
    v_mfma_f32_16x16x32_bf16 v[76:79], a[188:191], v[28:31], v[76:79]
    s_waitcnt lgkmcnt(2)
    v_mfma_f32_16x16x32_bf16 v[48:51], a[24:27], v[32:35], v[48:51]
    v_mfma_f32_16x16x32_bf16 v[52:55], a[24:27], v[36:39], v[52:55]
    ds_read_b128 v[16:19], v4 offset:8192
    v_mfma_f32_16x16x32_bf16 v[56:59], a[80:83], v[32:35], v[56:59]
    v_mfma_f32_16x16x32_bf16 v[60:63], a[80:83], v[36:39], v[60:63]
    ds_read_b128 v[20:23], v4 offset:22528
    v_mfma_f32_16x16x32_bf16 v[64:67], a[136:139], v[32:35], v[64:67]
    v_mfma_f32_16x16x32_bf16 v[68:71], a[136:139], v[36:39], v[68:71]
    v_mfma_f32_16x16x32_bf16 v[72:75], a[192:195], v[32:35], v[72:75]
    v_mfma_f32_16x16x32_bf16 v[76:79], a[192:195], v[36:39], v[76:79]
    s_waitcnt lgkmcnt(2)
    v_mfma_f32_16x16x32_bf16 v[48:51], a[28:31], v[40:43], v[48:51]
    v_mfma_f32_16x16x32_bf16 v[52:55], a[28:31], v[44:47], v[52:55]
    ds_read_b128 v[24:27], v4 offset:9216
    v_mfma_f32_16x16x32_bf16 v[56:59], a[84:87], v[40:43], v[56:59]
    v_mfma_f32_16x16x32_bf16 v[60:63], a[84:87], v[44:47], v[60:63]
    ds_read_b128 v[28:31], v4 offset:23552
    v_mfma_f32_16x16x32_bf16 v[64:67], a[140:143], v[40:43], v[64:67]
    v_add_u32 v5, 28672, v4
    v_subrev_u32 v8, 114688, v5
    v_min_u32 v5, v5, v8
    v_mfma_f32_16x16x32_bf16 v[68:71], a[140:143], v[44:47], v[68:71]
    v_mfma_f32_16x16x32_bf16 v[72:75], a[196:199], v[40:43], v[72:75]
    v_mfma_f32_16x16x32_bf16 v[76:79], a[196:199], v[44:47], v[76:79]
    s_waitcnt lgkmcnt(2)
    v_mfma_f32_16x16x32_bf16 v[48:51], a[32:35], v[16:19], v[48:51]
    v_mfma_f32_16x16x32_bf16 v[52:55], a[32:35], v[20:23], v[52:55]
    ds_read_b128 v[32:35], v4 offset:10240
    v_mfma_f32_16x16x32_bf16 v[56:59], a[88:91], v[16:19], v[56:59]
    v_mfma_f32_16x16x32_bf16 v[60:63], a[88:91], v[20:23], v[60:63]
    ds_read_b128 v[36:39], v4 offset:24576
    v_mfma_f32_16x16x32_bf16 v[64:67], a[144:147], v[16:19], v[64:67]
    v_mfma_f32_16x16x32_bf16 v[68:71], a[144:147], v[20:23], v[68:71]
    v_mfma_f32_16x16x32_bf16 v[72:75], a[200:203], v[16:19], v[72:75]
    v_mfma_f32_16x16x32_bf16 v[76:79], a[200:203], v[20:23], v[76:79]
    s_waitcnt lgkmcnt(2)
    v_mfma_f32_16x16x32_bf16 v[48:51], a[36:39], v[24:27], v[48:51]
    v_mfma_f32_16x16x32_bf16 v[52:55], a[36:39], v[28:31], v[52:55]
    ds_read_b128 v[40:43], v4 offset:11264
    v_mfma_f32_16x16x32_bf16 v[56:59], a[92:95], v[24:27], v[56:59]
    v_mfma_f32_16x16x32_bf16 v[60:63], a[92:95], v[28:31], v[60:63]
    ds_read_b128 v[44:47], v4 offset:25600
    v_mfma_f32_16x16x32_bf16 v[64:67], a[148:151], v[24:27], v[64:67]
    v_mfma_f32_16x16x32_bf16 v[68:71], a[148:151], v[28:31], v[68:71]
    v_mfma_f32_16x16x32_bf16 v[72:75], a[204:207], v[24:27], v[72:75]
    v_mfma_f32_16x16x32_bf16 v[76:79], a[204:207], v[28:31], v[76:79]
    s_waitcnt lgkmcnt(2)
    v_mfma_f32_16x16x32_bf16 v[48:51], a[40:43], v[32:35], v[48:51]
    s_waitcnt vmcnt(11)
    s_barrier
    s_mov_b64 exec, 1
    buffer_atomic_add v7, v6, s[8:11], s41 offen
    s_mov_b64 exec, -1
    s_add_u32 s43, s43, 1
    s_cmp_ge_u32 s43, 2
    s_cselect_b32 s41, s44, s41
    s_cselect_b32 s45, s42, 0
    s_add_u32 s44, s44, s45
    v_mfma_f32_16x16x32_bf16 v[52:55], a[40:43], v[36:39], v[52:55]
    ds_read_b128 v[16:19], v4 offset:12288
    v_mfma_f32_16x16x32_bf16 v[56:59], a[96:99], v[32:35], v[56:59]
    s_add_u32 m0, s39, s46
    v_mfma_f32_16x16x32_bf16 v[60:63], a[96:99], v[36:39], v[60:63]
    ds_read_b128 v[20:23], v4 offset:26624
    v_mfma_f32_16x16x32_bf16 v[64:67], a[152:155], v[32:35], v[64:67]
    buffer_load_dwordx4 v2, s[8:11], s37 offen offset:0  lds
    v_mfma_f32_16x16x32_bf16 v[68:71], a[152:155], v[36:39], v[68:71]
    v_mfma_f32_16x16x32_bf16 v[72:75], a[208:211], v[32:35], v[72:75]
    buffer_load_dwordx4 v2, s[8:11], s37 offen offset:1024  lds
    v_mfma_f32_16x16x32_bf16 v[76:79], a[208:211], v[36:39], v[76:79]
    s_waitcnt lgkmcnt(2)
    v_mfma_f32_16x16x32_bf16 v[48:51], a[44:47], v[40:43], v[48:51]
    buffer_load_dwordx4 v2, s[8:11], s37 offen offset:2048  lds
    v_mfma_f32_16x16x32_bf16 v[52:55], a[44:47], v[44:47], v[52:55]
    ds_read_b128 v[24:27], v4 offset:13312
    v_mfma_f32_16x16x32_bf16 v[56:59], a[100:103], v[40:43], v[56:59]
    buffer_load_dwordx4 v2, s[8:11], s37 offen offset:3072  lds
    v_mfma_f32_16x16x32_bf16 v[60:63], a[100:103], v[44:47], v[60:63]
    ds_read_b128 v[28:31], v4 offset:27648
    v_mfma_f32_16x16x32_bf16 v[64:67], a[156:159], v[40:43], v[64:67]
    s_add_u32 m0, m0, 4096
    s_add_u32 s37, s37, 4096
    v_mfma_f32_16x16x32_bf16 v[68:71], a[156:159], v[44:47], v[68:71]
    v_mfma_f32_16x16x32_bf16 v[72:75], a[212:215], v[40:43], v[72:75]
    buffer_load_dwordx4 v2, s[8:11], s37 offen offset:0  lds
    v_mfma_f32_16x16x32_bf16 v[76:79], a[212:215], v[44:47], v[76:79]
    s_waitcnt lgkmcnt(2)
    v_mfma_f32_16x16x32_bf16 v[48:51], a[48:51], v[16:19], v[48:51]
    buffer_load_dwordx4 v2, s[8:11], s37 offen offset:1024  lds
    v_mfma_f32_16x16x32_bf16 v[52:55], a[48:51], v[20:23], v[52:55]
    ds_read_b128 v[32:35], v5 offset:0
    v_mfma_f32_16x16x32_bf16 v[56:59], a[104:107], v[16:19], v[56:59]
    buffer_load_dwordx4 v2, s[8:11], s37 offen offset:2048  lds
    v_mfma_f32_16x16x32_bf16 v[60:63], a[104:107], v[20:23], v[60:63]
    ds_read_b128 v[36:39], v5 offset:14336
    v_mfma_f32_16x16x32_bf16 v[64:67], a[160:163], v[16:19], v[64:67]
    s_add_u32 s37, s37, 24576
    v_mfma_f32_16x16x32_bf16 v[68:71], a[160:163], v[20:23], v[68:71]
    v_mfma_f32_16x16x32_bf16 v[72:75], a[216:219], v[16:19], v[72:75]
    s_add_u32 s46, s46, 28672
    s_cmp_ge_u32 s46, 114688
    s_cselect_b32 s46, 0, s46
    v_mfma_f32_16x16x32_bf16 v[76:79], a[216:219], v[20:23], v[76:79]
    s_waitcnt lgkmcnt(2)
    v_mfma_f32_16x16x32_bf16 v[48:51], a[52:55], v[24:27], v[48:51]
    v_mfma_f32_16x16x32_bf16 v[52:55], a[52:55], v[28:31], v[52:55]
    ds_read_b128 v[40:43], v5 offset:1024
    v_mfma_f32_16x16x32_bf16 v[56:59], a[108:111], v[24:27], v[56:59]
    v_mfma_f32_16x16x32_bf16 v[60:63], a[108:111], v[28:31], v[60:63]
    ds_read_b128 v[44:47], v5 offset:15360
    v_mfma_f32_16x16x32_bf16 v[64:67], a[164:167], v[24:27], v[64:67]
    v_mfma_f32_16x16x32_bf16 v[68:71], a[164:167], v[28:31], v[68:71]
    v_mfma_f32_16x16x32_bf16 v[72:75], a[220:223], v[24:27], v[72:75]
    v_mfma_f32_16x16x32_bf16 v[76:79], a[220:223], v[28:31], v[76:79]
    s_waitcnt lgkmcnt(2)
    v_mfma_f32_16x16x32_bf16 v[80:83], a[0:3], v[32:35], 0
    v_mfma_f32_16x16x32_bf16 v[84:87], a[0:3], v[36:39], 0
    ds_read_b128 v[16:19], v5 offset:2048
    v_mfma_f32_16x16x32_bf16 v[88:91], a[56:59], v[32:35], 0
    v_mfma_f32_16x16x32_bf16 v[92:95], a[56:59], v[36:39], 0
    ds_read_b128 v[20:23], v5 offset:16384
    v_mfma_f32_16x16x32_bf16 v[96:99], a[112:115], v[32:35], 0
    v_cvt_pk_bf16_f32 v112, v48, v49
    v_mfma_f32_16x16x32_bf16 v[100:103], a[112:115], v[36:39], 0
    v_cvt_pk_bf16_f32 v113, v50, v51
    v_mfma_f32_16x16x32_bf16 v[104:107], a[168:171], v[32:35], 0
    v_cvt_pk_bf16_f32 v114, v56, v57
    v_mfma_f32_16x16x32_bf16 v[108:111], a[168:171], v[36:39], 0
    v_cvt_pk_bf16_f32 v115, v58, v59
    s_waitcnt lgkmcnt(2)
    v_mfma_f32_16x16x32_bf16 v[80:83], a[4:7], v[40:43], v[80:83]
    v_mfma_f32_16x16x32_bf16 v[84:87], a[4:7], v[44:47], v[84:87]
    ds_read_b128 v[24:27], v5 offset:3072
    v_mfma_f32_16x16x32_bf16 v[88:91], a[60:63], v[40:43], v[88:91]
    s_add_u32 s26, s38, 0
    buffer_store_dwordx4 v[112:115], v2, s[8:11], s26 offen sc1
    v_mfma_f32_16x16x32_bf16 v[92:95], a[60:63], v[44:47], v[92:95]
    ds_read_b128 v[28:31], v5 offset:17408
    v_cvt_pk_bf16_f32 v116, v64, v65
    v_mfma_f32_16x16x32_bf16 v[96:99], a[116:119], v[40:43], v[96:99]
    v_cvt_pk_bf16_f32 v117, v66, v67
    v_mfma_f32_16x16x32_bf16 v[100:103], a[116:119], v[44:47], v[100:103]
    v_cvt_pk_bf16_f32 v118, v72, v73
    v_mfma_f32_16x16x32_bf16 v[104:107], a[172:175], v[40:43], v[104:107]
    v_cvt_pk_bf16_f32 v119, v74, v75
    v_mfma_f32_16x16x32_bf16 v[108:111], a[172:175], v[44:47], v[108:111]
    s_waitcnt lgkmcnt(2)
    v_mfma_f32_16x16x32_bf16 v[80:83], a[8:11], v[16:19], v[80:83]
    s_add_u32 s26, s38, 1024
    buffer_store_dwordx4 v[116:119], v2, s[8:11], s26 offen sc1
    v_mfma_f32_16x16x32_bf16 v[84:87], a[8:11], v[20:23], v[84:87]
    ds_read_b128 v[32:35], v5 offset:4096
    v_cvt_pk_bf16_f32 v120, v52, v53
    v_mfma_f32_16x16x32_bf16 v[88:91], a[64:67], v[16:19], v[88:91]
    v_cvt_pk_bf16_f32 v121, v54, v55
    v_mfma_f32_16x16x32_bf16 v[92:95], a[64:67], v[20:23], v[92:95]
    ds_read_b128 v[36:39], v5 offset:18432
    v_cvt_pk_bf16_f32 v122, v60, v61
    v_mfma_f32_16x16x32_bf16 v[96:99], a[120:123], v[16:19], v[96:99]
    v_cvt_pk_bf16_f32 v123, v62, v63
    v_mfma_f32_16x16x32_bf16 v[100:103], a[120:123], v[20:23], v[100:103]
    v_mfma_f32_16x16x32_bf16 v[104:107], a[176:179], v[16:19], v[104:107]
    s_add_u32 s26, s38, 14336
    buffer_store_dwordx4 v[120:123], v2, s[8:11], s26 offen sc1
    v_mfma_f32_16x16x32_bf16 v[108:111], a[176:179], v[20:23], v[108:111]
    v_cvt_pk_bf16_f32 v124, v68, v69
    s_waitcnt lgkmcnt(2)
    v_mfma_f32_16x16x32_bf16 v[80:83], a[12:15], v[24:27], v[80:83]
    v_cvt_pk_bf16_f32 v125, v70, v71
    v_mfma_f32_16x16x32_bf16 v[84:87], a[12:15], v[28:31], v[84:87]
    ds_read_b128 v[40:43], v5 offset:5120
    v_cvt_pk_bf16_f32 v126, v76, v77
    v_mfma_f32_16x16x32_bf16 v[88:91], a[68:71], v[24:27], v[88:91]
    v_cvt_pk_bf16_f32 v127, v78, v79
    v_mfma_f32_16x16x32_bf16 v[92:95], a[68:71], v[28:31], v[92:95]
    ds_read_b128 v[44:47], v5 offset:19456
    v_mfma_f32_16x16x32_bf16 v[96:99], a[124:127], v[24:27], v[96:99]
    s_add_u32 s26, s38, 15360
    buffer_store_dwordx4 v[124:127], v2, s[8:11], s26 offen sc1
    v_mfma_f32_16x16x32_bf16 v[100:103], a[124:127], v[28:31], v[100:103]
    v_mfma_f32_16x16x32_bf16 v[104:107], a[180:183], v[24:27], v[104:107]
    s_add_u32 s38, s38, s27
    s_mov_b32 s27, 458752
    v_mfma_f32_16x16x32_bf16 v[108:111], a[180:183], v[28:31], v[108:111]
    s_waitcnt lgkmcnt(2)
    v_mfma_f32_16x16x32_bf16 v[80:83], a[16:19], v[32:35], v[80:83]
    v_mfma_f32_16x16x32_bf16 v[84:87], a[16:19], v[36:39], v[84:87]
    ds_read_b128 v[16:19], v5 offset:6144
    v_mfma_f32_16x16x32_bf16 v[88:91], a[72:75], v[32:35], v[88:91]
    v_mfma_f32_16x16x32_bf16 v[92:95], a[72:75], v[36:39], v[92:95]
    ds_read_b128 v[20:23], v5 offset:20480
    v_mfma_f32_16x16x32_bf16 v[96:99], a[128:131], v[32:35], v[96:99]
    v_mfma_f32_16x16x32_bf16 v[100:103], a[128:131], v[36:39], v[100:103]
    v_mfma_f32_16x16x32_bf16 v[104:107], a[184:187], v[32:35], v[104:107]
    v_mfma_f32_16x16x32_bf16 v[108:111], a[184:187], v[36:39], v[108:111]
    s_waitcnt lgkmcnt(2)
    v_mfma_f32_16x16x32_bf16 v[80:83], a[20:23], v[40:43], v[80:83]
    v_mfma_f32_16x16x32_bf16 v[84:87], a[20:23], v[44:47], v[84:87]
    ds_read_b128 v[24:27], v5 offset:7168
    v_mfma_f32_16x16x32_bf16 v[88:91], a[76:79], v[40:43], v[88:91]
    v_mfma_f32_16x16x32_bf16 v[92:95], a[76:79], v[44:47], v[92:95]
    ds_read_b128 v[28:31], v5 offset:21504
    v_mfma_f32_16x16x32_bf16 v[96:99], a[132:135], v[40:43], v[96:99]
    v_mfma_f32_16x16x32_bf16 v[100:103], a[132:135], v[44:47], v[100:103]
    v_mfma_f32_16x16x32_bf16 v[104:107], a[188:191], v[40:43], v[104:107]
    v_mfma_f32_16x16x32_bf16 v[108:111], a[188:191], v[44:47], v[108:111]
    s_waitcnt lgkmcnt(2)
    v_mfma_f32_16x16x32_bf16 v[80:83], a[24:27], v[16:19], v[80:83]
    v_mfma_f32_16x16x32_bf16 v[84:87], a[24:27], v[20:23], v[84:87]
    ds_read_b128 v[32:35], v5 offset:8192
    v_mfma_f32_16x16x32_bf16 v[88:91], a[80:83], v[16:19], v[88:91]
    v_mfma_f32_16x16x32_bf16 v[92:95], a[80:83], v[20:23], v[92:95]
    ds_read_b128 v[36:39], v5 offset:22528
    v_mfma_f32_16x16x32_bf16 v[96:99], a[136:139], v[16:19], v[96:99]
    v_mfma_f32_16x16x32_bf16 v[100:103], a[136:139], v[20:23], v[100:103]
    v_mfma_f32_16x16x32_bf16 v[104:107], a[192:195], v[16:19], v[104:107]
    v_mfma_f32_16x16x32_bf16 v[108:111], a[192:195], v[20:23], v[108:111]
    s_waitcnt lgkmcnt(2)
    v_mfma_f32_16x16x32_bf16 v[80:83], a[28:31], v[24:27], v[80:83]
    v_mfma_f32_16x16x32_bf16 v[84:87], a[28:31], v[28:31], v[84:87]
    ds_read_b128 v[40:43], v5 offset:9216
    v_mfma_f32_16x16x32_bf16 v[88:91], a[84:87], v[24:27], v[88:91]
    v_mfma_f32_16x16x32_bf16 v[92:95], a[84:87], v[28:31], v[92:95]
    ds_read_b128 v[44:47], v5 offset:23552
    v_mfma_f32_16x16x32_bf16 v[96:99], a[140:143], v[24:27], v[96:99]
    v_add_u32 v4, 28672, v5
    v_subrev_u32 v8, 114688, v4
    v_min_u32 v4, v4, v8
    v_mfma_f32_16x16x32_bf16 v[100:103], a[140:143], v[28:31], v[100:103]
    v_mfma_f32_16x16x32_bf16 v[104:107], a[196:199], v[24:27], v[104:107]
    v_mfma_f32_16x16x32_bf16 v[108:111], a[196:199], v[28:31], v[108:111]
    s_waitcnt lgkmcnt(2)
    v_mfma_f32_16x16x32_bf16 v[80:83], a[32:35], v[32:35], v[80:83]
    v_mfma_f32_16x16x32_bf16 v[84:87], a[32:35], v[36:39], v[84:87]
    ds_read_b128 v[16:19], v5 offset:10240
    v_mfma_f32_16x16x32_bf16 v[88:91], a[88:91], v[32:35], v[88:91]
    v_mfma_f32_16x16x32_bf16 v[92:95], a[88:91], v[36:39], v[92:95]
    ds_read_b128 v[20:23], v5 offset:24576
    v_mfma_f32_16x16x32_bf16 v[96:99], a[144:147], v[32:35], v[96:99]
    v_mfma_f32_16x16x32_bf16 v[100:103], a[144:147], v[36:39], v[100:103]
    v_mfma_f32_16x16x32_bf16 v[104:107], a[200:203], v[32:35], v[104:107]
    v_mfma_f32_16x16x32_bf16 v[108:111], a[200:203], v[36:39], v[108:111]
    s_waitcnt lgkmcnt(2)
    v_mfma_f32_16x16x32_bf16 v[80:83], a[36:39], v[40:43], v[80:83]
    v_mfma_f32_16x16x32_bf16 v[84:87], a[36:39], v[44:47], v[84:87]
    ds_read_b128 v[24:27], v5 offset:11264
    v_mfma_f32_16x16x32_bf16 v[88:91], a[92:95], v[40:43], v[88:91]
    v_mfma_f32_16x16x32_bf16 v[92:95], a[92:95], v[44:47], v[92:95]
    ds_read_b128 v[28:31], v5 offset:25600
    v_mfma_f32_16x16x32_bf16 v[96:99], a[148:151], v[40:43], v[96:99]
    v_mfma_f32_16x16x32_bf16 v[100:103], a[148:151], v[44:47], v[100:103]
    v_mfma_f32_16x16x32_bf16 v[104:107], a[204:207], v[40:43], v[104:107]
    v_mfma_f32_16x16x32_bf16 v[108:111], a[204:207], v[44:47], v[108:111]
    s_waitcnt lgkmcnt(2)
    v_mfma_f32_16x16x32_bf16 v[80:83], a[40:43], v[16:19], v[80:83]
    s_waitcnt vmcnt(11)
    s_barrier
    s_mov_b64 exec, 1
    buffer_atomic_add v7, v6, s[8:11], s41 offen
    s_mov_b64 exec, -1
    s_add_u32 s43, s43, 1
    s_cmp_ge_u32 s43, 2
    s_cselect_b32 s41, s44, s41
    s_cselect_b32 s45, s42, 0
    s_add_u32 s44, s44, s45
    v_mfma_f32_16x16x32_bf16 v[84:87], a[40:43], v[20:23], v[84:87]
    ds_read_b128 v[32:35], v5 offset:12288
    v_mfma_f32_16x16x32_bf16 v[88:91], a[96:99], v[16:19], v[88:91]
    s_add_u32 m0, s39, s46
    v_mfma_f32_16x16x32_bf16 v[92:95], a[96:99], v[20:23], v[92:95]
    ds_read_b128 v[36:39], v5 offset:26624
    v_mfma_f32_16x16x32_bf16 v[96:99], a[152:155], v[16:19], v[96:99]
    buffer_load_dwordx4 v2, s[8:11], s37 offen offset:0  lds
    v_mfma_f32_16x16x32_bf16 v[100:103], a[152:155], v[20:23], v[100:103]
    v_mfma_f32_16x16x32_bf16 v[104:107], a[208:211], v[16:19], v[104:107]
    buffer_load_dwordx4 v2, s[8:11], s37 offen offset:1024  lds
    v_mfma_f32_16x16x32_bf16 v[108:111], a[208:211], v[20:23], v[108:111]
    s_waitcnt lgkmcnt(2)
    v_mfma_f32_16x16x32_bf16 v[80:83], a[44:47], v[24:27], v[80:83]
    buffer_load_dwordx4 v2, s[8:11], s37 offen offset:2048  lds
    v_mfma_f32_16x16x32_bf16 v[84:87], a[44:47], v[28:31], v[84:87]
    ds_read_b128 v[40:43], v5 offset:13312
    v_mfma_f32_16x16x32_bf16 v[88:91], a[100:103], v[24:27], v[88:91]
    buffer_load_dwordx4 v2, s[8:11], s37 offen offset:3072  lds
    v_mfma_f32_16x16x32_bf16 v[92:95], a[100:103], v[28:31], v[92:95]
    ds_read_b128 v[44:47], v5 offset:27648
    v_mfma_f32_16x16x32_bf16 v[96:99], a[156:159], v[24:27], v[96:99]
    s_add_u32 m0, m0, 4096
    s_add_u32 s37, s37, 4096
    v_mfma_f32_16x16x32_bf16 v[100:103], a[156:159], v[28:31], v[100:103]
    v_mfma_f32_16x16x32_bf16 v[104:107], a[212:215], v[24:27], v[104:107]
    buffer_load_dwordx4 v2, s[8:11], s37 offen offset:0  lds
    v_mfma_f32_16x16x32_bf16 v[108:111], a[212:215], v[28:31], v[108:111]
    s_waitcnt lgkmcnt(2)
    v_mfma_f32_16x16x32_bf16 v[80:83], a[48:51], v[32:35], v[80:83]
    buffer_load_dwordx4 v2, s[8:11], s37 offen offset:1024  lds
    v_mfma_f32_16x16x32_bf16 v[84:87], a[48:51], v[36:39], v[84:87]
    ds_read_b128 v[16:19], v4 offset:0
    v_mfma_f32_16x16x32_bf16 v[88:91], a[104:107], v[32:35], v[88:91]
    buffer_load_dwordx4 v2, s[8:11], s37 offen offset:2048  lds
    v_mfma_f32_16x16x32_bf16 v[92:95], a[104:107], v[36:39], v[92:95]
    ds_read_b128 v[20:23], v4 offset:14336
    v_mfma_f32_16x16x32_bf16 v[96:99], a[160:163], v[32:35], v[96:99]
    s_add_u32 s37, s37, 24576
    v_mfma_f32_16x16x32_bf16 v[100:103], a[160:163], v[36:39], v[100:103]
    v_mfma_f32_16x16x32_bf16 v[104:107], a[216:219], v[32:35], v[104:107]
    s_add_u32 s46, s46, 28672
    s_cmp_ge_u32 s46, 114688
    s_cselect_b32 s46, 0, s46
    v_mfma_f32_16x16x32_bf16 v[108:111], a[216:219], v[36:39], v[108:111]
    s_waitcnt lgkmcnt(2)
    v_mfma_f32_16x16x32_bf16 v[80:83], a[52:55], v[40:43], v[80:83]
    v_mfma_f32_16x16x32_bf16 v[84:87], a[52:55], v[44:47], v[84:87]
    ds_read_b128 v[24:27], v4 offset:1024
    v_mfma_f32_16x16x32_bf16 v[88:91], a[108:111], v[40:43], v[88:91]
    v_mfma_f32_16x16x32_bf16 v[92:95], a[108:111], v[44:47], v[92:95]
    ds_read_b128 v[28:31], v4 offset:15360
    v_mfma_f32_16x16x32_bf16 v[96:99], a[164:167], v[40:43], v[96:99]
    v_mfma_f32_16x16x32_bf16 v[100:103], a[164:167], v[44:47], v[100:103]
    v_mfma_f32_16x16x32_bf16 v[104:107], a[220:223], v[40:43], v[104:107]
    v_mfma_f32_16x16x32_bf16 v[108:111], a[220:223], v[44:47], v[108:111]
    s_add_u32 s40, s40, 1
    s_cmp_lt_u32 s40, s47
    s_nop 4
    s_cbranch_scc1 G_top0
    v_cvt_pk_bf16_f32 v112, v80, v81
    v_cvt_pk_bf16_f32 v113, v82, v83
    v_cvt_pk_bf16_f32 v114, v88, v89
    v_cvt_pk_bf16_f32 v115, v90, v91
    s_add_u32 s26, s38, 0
    buffer_store_dwordx4 v[112:115], v2, s[8:11], s26 offen sc1
    v_cvt_pk_bf16_f32 v116, v96, v97
    v_cvt_pk_bf16_f32 v117, v98, v99
    v_cvt_pk_bf16_f32 v118, v104, v105
    v_cvt_pk_bf16_f32 v119, v106, v107
    s_add_u32 s26, s38, 1024
    buffer_store_dwordx4 v[116:119], v2, s[8:11], s26 offen sc1
    v_cvt_pk_bf16_f32 v120, v84, v85
    v_cvt_pk_bf16_f32 v121, v86, v87
    v_cvt_pk_bf16_f32 v122, v92, v93
    v_cvt_pk_bf16_f32 v123, v94, v95
    s_add_u32 s26, s38, 14336
    buffer_store_dwordx4 v[120:123], v2, s[8:11], s26 offen sc1
    v_cvt_pk_bf16_f32 v124, v100, v101
    v_cvt_pk_bf16_f32 v125, v102, v103
    v_cvt_pk_bf16_f32 v126, v108, v109
    v_cvt_pk_bf16_f32 v127, v110, v111
    s_add_u32 s26, s38, 15360
    buffer_store_dwordx4 v[124:127], v2, s[8:11], s26 offen sc1
    s_waitcnt vmcnt(0) lgkmcnt(0)
    s_barrier
    s_mov_b64 exec, 1
    buffer_atomic_add v7, v6, s[8:11], s41 offen
    s_mov_b64 exec, -1
    s_add_u32 s43, s43, 1
    s_cmp_ge_u32 s43, 2
    s_cselect_b32 s41, s44, s41
    s_cselect_b32 s45, s42, 0
    s_add_u32 s44, s44, s45
    s_mov_b64 exec, 1
    buffer_atomic_add v7, v6, s[8:11], s41 offen
    s_mov_b64 exec, -1
    s_add_u32 s43, s43, 1
    s_cmp_ge_u32 s43, 2
    s_cselect_b32 s41, s44, s41
    s_cselect_b32 s45, s42, 0
    s_add_u32 s44, s44, s45
    s_branch G_done
G_type1:
    s_sub_u32 s26, s26, 112
    s_mul_i32 s40, s26, 37
    s_lshr_b32 s40, s40, 8
    s_mul_i32 s46, s40, 7
    s_cmp_gt_u32 s46, s26
    s_cselect_b32 s46, 1, 0
    s_sub_u32 s40, s40, s46
    s_mul_i32 s46, s40, 7
    s_sub_u32 s46, s26, s46
    s_lshl_b32 s40, s40, 10
    s_lshl_b32 s46, s46, 16
    s_add_u32 s38, s38, s40
    s_add_u32 s38, s38, s46
    s_add_u32 s38, s38, 67108864
    v_mov_b32 v3, v2
    s_add_u32 s26, s27, 0
    buffer_load_dwordx4 a[0:3], v3, s[8:11], s26 offen offset:0
    buffer_load_dwordx4 a[4:7], v3, s[8:11], s26 offen offset:1024
    buffer_load_dwordx4 a[8:11], v3, s[8:11], s26 offen offset:2048
    s_add_u32 s26, s27, 3072
    buffer_load_dwordx4 a[12:15], v3, s[8:11], s26 offen offset:0
    buffer_load_dwordx4 a[16:19], v3, s[8:11], s26 offen offset:1024
    buffer_load_dwordx4 a[20:23], v3, s[8:11], s26 offen offset:2048
    s_add_u32 s26, s27, 6144
    buffer_load_dwordx4 a[24:27], v3, s[8:11], s26 offen offset:0
    buffer_load_dwordx4 a[28:31], v3, s[8:11], s26 offen offset:1024
    buffer_load_dwordx4 a[32:35], v3, s[8:11], s26 offen offset:2048
    s_add_u32 s26, s27, 9216
    buffer_load_dwordx4 a[36:39], v3, s[8:11], s26 offen offset:0
    buffer_load_dwordx4 a[40:43], v3, s[8:11], s26 offen offset:1024
    buffer_load_dwordx4 a[44:47], v3, s[8:11], s26 offen offset:2048
    s_add_u32 s26, s27, 12288
    buffer_load_dwordx4 a[48:51], v3, s[8:11], s26 offen offset:0
    buffer_load_dwordx4 a[52:55], v3, s[8:11], s26 offen offset:1024
    s_add_u32 s26, s27, 14336
    buffer_load_dwordx4 a[56:59], v3, s[8:11], s26 offen offset:0
    buffer_load_dwordx4 a[60:63], v3, s[8:11], s26 offen offset:1024
    buffer_load_dwordx4 a[64:67], v3, s[8:11], s26 offen offset:2048
    s_add_u32 s26, s27, 17408
    buffer_load_dwordx4 a[68:71], v3, s[8:11], s26 offen offset:0
    buffer_load_dwordx4 a[72:75], v3, s[8:11], s26 offen offset:1024
    buffer_load_dwordx4 a[76:79], v3, s[8:11], s26 offen offset:2048
    s_add_u32 s26, s27, 20480
    buffer_load_dwordx4 a[80:83], v3, s[8:11], s26 offen offset:0
    buffer_load_dwordx4 a[84:87], v3, s[8:11], s26 offen offset:1024
    buffer_load_dwordx4 a[88:91], v3, s[8:11], s26 offen offset:2048
    s_add_u32 s26, s27, 23552
    buffer_load_dwordx4 a[92:95], v3, s[8:11], s26 offen offset:0
    buffer_load_dwordx4 a[96:99], v3, s[8:11], s26 offen offset:1024
    buffer_load_dwordx4 a[100:103], v3, s[8:11], s26 offen offset:2048
    s_add_u32 s26, s27, 26624
    buffer_load_dwordx4 a[104:107], v3, s[8:11], s26 offen offset:0
    buffer_load_dwordx4 a[108:111], v3, s[8:11], s26 offen offset:1024
    s_add_u32 s26, s27, 28672
    buffer_load_dwordx4 a[112:115], v3, s[8:11], s26 offen offset:0
    buffer_load_dwordx4 a[116:119], v3, s[8:11], s26 offen offset:1024
    buffer_load_dwordx4 a[120:123], v3, s[8:11], s26 offen offset:2048
    s_add_u32 s26, s27, 31744
    buffer_load_dwordx4 a[124:127], v3, s[8:11], s26 offen offset:0
    buffer_load_dwordx4 a[128:131], v3, s[8:11], s26 offen offset:1024
    buffer_load_dwordx4 a[132:135], v3, s[8:11], s26 offen offset:2048
    s_add_u32 s26, s27, 34816
    buffer_load_dwordx4 a[136:139], v3, s[8:11], s26 offen offset:0
    buffer_load_dwordx4 a[140:143], v3, s[8:11], s26 offen offset:1024
    buffer_load_dwordx4 a[144:147], v3, s[8:11], s26 offen offset:2048
    s_add_u32 s26, s27, 37888
    buffer_load_dwordx4 a[148:151], v3, s[8:11], s26 offen offset:0
    buffer_load_dwordx4 a[152:155], v3, s[8:11], s26 offen offset:1024
    s_waitcnt vmcnt(30)
    buffer_load_dwordx4 a[156:159], v3, s[8:11], s26 offen offset:2048
    s_add_u32 s26, s27, 40960
    buffer_load_dwordx4 a[160:163], v3, s[8:11], s26 offen offset:0
    buffer_load_dwordx4 a[164:167], v3, s[8:11], s26 offen offset:1024
    s_add_u32 s26, s27, 43008
    buffer_load_dwordx4 a[168:171], v3, s[8:11], s26 offen offset:0
    buffer_load_dwordx4 a[172:175], v3, s[8:11], s26 offen offset:1024
    buffer_load_dwordx4 a[176:179], v3, s[8:11], s26 offen offset:2048
    s_add_u32 s26, s27, 46080
    buffer_load_dwordx4 a[180:183], v3, s[8:11], s26 offen offset:0
    buffer_load_dwordx4 a[184:187], v3, s[8:11], s26 offen offset:1024
    buffer_load_dwordx4 a[188:191], v3, s[8:11], s26 offen offset:2048
    s_add_u32 s26, s27, 49152
    buffer_load_dwordx4 a[192:195], v3, s[8:11], s26 offen offset:0
    buffer_load_dwordx4 a[196:199], v3, s[8:11], s26 offen offset:1024
    buffer_load_dwordx4 a[200:203], v3, s[8:11], s26 offen offset:2048
    s_add_u32 s26, s27, 52224
    buffer_load_dwordx4 a[204:207], v3, s[8:11], s26 offen offset:0
    buffer_load_dwordx4 a[208:211], v3, s[8:11], s26 offen offset:1024
    buffer_load_dwordx4 a[212:215], v3, s[8:11], s26 offen offset:2048
    s_add_u32 s26, s27, 55296
    buffer_load_dwordx4 a[216:219], v3, s[8:11], s26 offen offset:0
    buffer_load_dwordx4 a[220:223], v3, s[8:11], s26 offen offset:1024
    s_lshl_b32 s44, s36, 7
    s_add_u32 s44, s44, 23003136
    s_cmp_eq_u32 s17, 0
    s_cselect_b32 s44, s44, s41
    s_cselect_b32 s42, 128, 0
    s_mov_b32 s27, 4160749568
    s_add_u32 s38, s38, 0x8000000
    v_mov_b32 v4, v2
    v_mov_b32 v6, 0
    v_mov_b32 v7, 1
    s_mov_b32 s40, 0
    s_mov_b32 s46, 86016
    s_waitcnt vmcnt(0)
    s_barrier
    ds_read_b128 v[16:19], v4 offset:0
    ds_read_b128 v[20:23], v4 offset:14336
    ds_read_b128 v[24:27], v4 offset:1024
    ds_read_b128 v[28:31], v4 offset:15360
G_top1:
    s_waitcnt lgkmcnt(2)
    s_nop 0
    v_mfma_f32_16x16x32_bf16 v[48:51], v[16:19], a[0:3], 0
    v_mfma_f32_16x16x32_bf16 v[52:55], v[20:23], a[0:3], 0
    ds_read_b128 v[32:35], v4 offset:2048
    v_mfma_f32_16x16x32_bf16 v[56:59], v[16:19], a[56:59], 0
    v_mfma_f32_16x16x32_bf16 v[60:63], v[20:23], a[56:59], 0
    ds_read_b128 v[36:39], v4 offset:16384
    v_mfma_f32_16x16x32_bf16 v[64:67], v[16:19], a[112:115], 0
    v_cvt_pk_bf16_f32 v112, v80, v81
    v_mfma_f32_16x16x32_bf16 v[68:71], v[20:23], a[112:115], 0
    v_cvt_pk_bf16_f32 v114, v82, v83
    v_mfma_f32_16x16x32_bf16 v[72:75], v[16:19], a[168:171], 0
    v_cvt_pk_bf16_f32 v113, v84, v85
    v_mfma_f32_16x16x32_bf16 v[76:79], v[20:23], a[168:171], 0
    v_cvt_pk_bf16_f32 v115, v86, v87
    s_waitcnt lgkmcnt(2)
    v_mfma_f32_16x16x32_bf16 v[48:51], v[24:27], a[4:7], v[48:51]
    v_mfma_f32_16x16x32_bf16 v[52:55], v[28:31], a[4:7], v[52:55]
    ds_read_b128 v[40:43], v4 offset:3072
    v_mfma_f32_16x16x32_bf16 v[56:59], v[24:27], a[60:63], v[56:59]
    s_add_u32 s26, s38, 0
    buffer_store_dwordx4 v[112:115], v2, s[8:11], s26 offen sc1
    v_mfma_f32_16x16x32_bf16 v[60:63], v[28:31], a[60:63], v[60:63]
    ds_read_b128 v[44:47], v4 offset:17408
    v_cvt_pk_bf16_f32 v116, v88, v89
    v_mfma_f32_16x16x32_bf16 v[64:67], v[24:27], a[116:119], v[64:67]
    v_cvt_pk_bf16_f32 v118, v90, v91
    v_mfma_f32_16x16x32_bf16 v[68:71], v[28:31], a[116:119], v[68:71]
    v_cvt_pk_bf16_f32 v117, v92, v93
    v_mfma_f32_16x16x32_bf16 v[72:75], v[24:27], a[172:175], v[72:75]
    v_cvt_pk_bf16_f32 v119, v94, v95
    v_mfma_f32_16x16x32_bf16 v[76:79], v[28:31], a[172:175], v[76:79]
    s_waitcnt lgkmcnt(2)
    v_mfma_f32_16x16x32_bf16 v[48:51], v[32:35], a[8:11], v[48:51]
    s_add_u32 s26, s38, 16384
    buffer_store_dwordx4 v[116:119], v2, s[8:11], s26 offen sc1
    v_mfma_f32_16x16x32_bf16 v[52:55], v[36:39], a[8:11], v[52:55]
    ds_read_b128 v[16:19], v4 offset:4096
    v_cvt_pk_bf16_f32 v120, v96, v97
    v_mfma_f32_16x16x32_bf16 v[56:59], v[32:35], a[64:67], v[56:59]
    v_cvt_pk_bf16_f32 v122, v98, v99
    v_mfma_f32_16x16x32_bf16 v[60:63], v[36:39], a[64:67], v[60:63]
    ds_read_b128 v[20:23], v4 offset:18432
    v_cvt_pk_bf16_f32 v121, v100, v101
    v_mfma_f32_16x16x32_bf16 v[64:67], v[32:35], a[120:123], v[64:67]
    v_cvt_pk_bf16_f32 v123, v102, v103
    v_mfma_f32_16x16x32_bf16 v[68:71], v[36:39], a[120:123], v[68:71]
    v_mfma_f32_16x16x32_bf16 v[72:75], v[32:35], a[176:179], v[72:75]
    s_add_u32 s26, s38, 32768
    buffer_store_dwordx4 v[120:123], v2, s[8:11], s26 offen sc1
    v_mfma_f32_16x16x32_bf16 v[76:79], v[36:39], a[176:179], v[76:79]
    v_cvt_pk_bf16_f32 v124, v104, v105
    s_waitcnt lgkmcnt(2)
    v_mfma_f32_16x16x32_bf16 v[48:51], v[40:43], a[12:15], v[48:51]
    v_cvt_pk_bf16_f32 v126, v106, v107
    v_mfma_f32_16x16x32_bf16 v[52:55], v[44:47], a[12:15], v[52:55]
    ds_read_b128 v[24:27], v4 offset:5120
    v_cvt_pk_bf16_f32 v125, v108, v109
    v_mfma_f32_16x16x32_bf16 v[56:59], v[40:43], a[68:71], v[56:59]
    v_cvt_pk_bf16_f32 v127, v110, v111
    v_mfma_f32_16x16x32_bf16 v[60:63], v[44:47], a[68:71], v[60:63]
    ds_read_b128 v[28:31], v4 offset:19456
    v_mfma_f32_16x16x32_bf16 v[64:67], v[40:43], a[124:127], v[64:67]
    s_add_u32 s26, s38, 49152
    buffer_store_dwordx4 v[124:127], v2, s[8:11], s26 offen sc1
    v_mfma_f32_16x16x32_bf16 v[68:71], v[44:47], a[124:127], v[68:71]
    v_mfma_f32_16x16x32_bf16 v[72:75], v[40:43], a[180:183], v[72:75]
    s_add_u32 s38, s38, s27
    s_mov_b32 s27, 458752
    v_mfma_f32_16x16x32_bf16 v[76:79], v[44:47], a[180:183], v[76:79]
    s_waitcnt lgkmcnt(2)
    v_mfma_f32_16x16x32_bf16 v[48:51], v[16:19], a[16:19], v[48:51]
    v_mfma_f32_16x16x32_bf16 v[52:55], v[20:23], a[16:19], v[52:55]
    ds_read_b128 v[32:35], v4 offset:6144
    v_mfma_f32_16x16x32_bf16 v[56:59], v[16:19], a[72:75], v[56:59]
    v_mfma_f32_16x16x32_bf16 v[60:63], v[20:23], a[72:75], v[60:63]
    ds_read_b128 v[36:39], v4 offset:20480
    v_mfma_f32_16x16x32_bf16 v[64:67], v[16:19], a[128:131], v[64:67]
    v_mfma_f32_16x16x32_bf16 v[68:71], v[20:23], a[128:131], v[68:71]
    v_mfma_f32_16x16x32_bf16 v[72:75], v[16:19], a[184:187], v[72:75]
    v_mfma_f32_16x16x32_bf16 v[76:79], v[20:23], a[184:187], v[76:79]
    s_waitcnt lgkmcnt(2)
    v_mfma_f32_16x16x32_bf16 v[48:51], v[24:27], a[20:23], v[48:51]
    v_mfma_f32_16x16x32_bf16 v[52:55], v[28:31], a[20:23], v[52:55]
    ds_read_b128 v[40:43], v4 offset:7168
    v_mfma_f32_16x16x32_bf16 v[56:59], v[24:27], a[76:79], v[56:59]
    v_mfma_f32_16x16x32_bf16 v[60:63], v[28:31], a[76:79], v[60:63]
    ds_read_b128 v[44:47], v4 offset:21504
    v_mfma_f32_16x16x32_bf16 v[64:67], v[24:27], a[132:135], v[64:67]
    v_mfma_f32_16x16x32_bf16 v[68:71], v[28:31], a[132:135], v[68:71]
    v_mfma_f32_16x16x32_bf16 v[72:75], v[24:27], a[188:191], v[72:75]
    v_mfma_f32_16x16x32_bf16 v[76:79], v[28:31], a[188:191], v[76:79]
    s_waitcnt lgkmcnt(2)
    v_mfma_f32_16x16x32_bf16 v[48:51], v[32:35], a[24:27], v[48:51]
    v_mfma_f32_16x16x32_bf16 v[52:55], v[36:39], a[24:27], v[52:55]
    ds_read_b128 v[16:19], v4 offset:8192
    v_mfma_f32_16x16x32_bf16 v[56:59], v[32:35], a[80:83], v[56:59]
    v_mfma_f32_16x16x32_bf16 v[60:63], v[36:39], a[80:83], v[60:63]
    ds_read_b128 v[20:23], v4 offset:22528
    v_mfma_f32_16x16x32_bf16 v[64:67], v[32:35], a[136:139], v[64:67]
    v_mfma_f32_16x16x32_bf16 v[68:71], v[36:39], a[136:139], v[68:71]
    v_mfma_f32_16x16x32_bf16 v[72:75], v[32:35], a[192:195], v[72:75]
    v_mfma_f32_16x16x32_bf16 v[76:79], v[36:39], a[192:195], v[76:79]
    s_waitcnt lgkmcnt(2)
    v_mfma_f32_16x16x32_bf16 v[48:51], v[40:43], a[28:31], v[48:51]
    v_mfma_f32_16x16x32_bf16 v[52:55], v[44:47], a[28:31], v[52:55]
    ds_read_b128 v[24:27], v4 offset:9216
    v_mfma_f32_16x16x32_bf16 v[56:59], v[40:43], a[84:87], v[56:59]
    v_mfma_f32_16x16x32_bf16 v[60:63], v[44:47], a[84:87], v[60:63]
    ds_read_b128 v[28:31], v4 offset:23552
    v_mfma_f32_16x16x32_bf16 v[64:67], v[40:43], a[140:143], v[64:67]
    v_add_u32 v5, 28672, v4
    v_subrev_u32 v8, 114688, v5
    v_min_u32 v5, v5, v8
    v_mfma_f32_16x16x32_bf16 v[68:71], v[44:47], a[140:143], v[68:71]
    v_mfma_f32_16x16x32_bf16 v[72:75], v[40:43], a[196:199], v[72:75]
    v_mfma_f32_16x16x32_bf16 v[76:79], v[44:47], a[196:199], v[76:79]
    s_waitcnt lgkmcnt(2)
    v_mfma_f32_16x16x32_bf16 v[48:51], v[16:19], a[32:35], v[48:51]
    v_mfma_f32_16x16x32_bf16 v[52:55], v[20:23], a[32:35], v[52:55]
    ds_read_b128 v[32:35], v4 offset:10240
    v_mfma_f32_16x16x32_bf16 v[56:59], v[16:19], a[88:91], v[56:59]
    v_mfma_f32_16x16x32_bf16 v[60:63], v[20:23], a[88:91], v[60:63]
    ds_read_b128 v[36:39], v4 offset:24576
    v_mfma_f32_16x16x32_bf16 v[64:67], v[16:19], a[144:147], v[64:67]
    v_mfma_f32_16x16x32_bf16 v[68:71], v[20:23], a[144:147], v[68:71]
    v_mfma_f32_16x16x32_bf16 v[72:75], v[16:19], a[200:203], v[72:75]
    v_mfma_f32_16x16x32_bf16 v[76:79], v[20:23], a[200:203], v[76:79]
    s_waitcnt lgkmcnt(2)
    v_mfma_f32_16x16x32_bf16 v[48:51], v[24:27], a[36:39], v[48:51]
    v_mfma_f32_16x16x32_bf16 v[52:55], v[28:31], a[36:39], v[52:55]
    ds_read_b128 v[40:43], v4 offset:11264
    v_mfma_f32_16x16x32_bf16 v[56:59], v[24:27], a[92:95], v[56:59]
    v_mfma_f32_16x16x32_bf16 v[60:63], v[28:31], a[92:95], v[60:63]
    ds_read_b128 v[44:47], v4 offset:25600
    v_mfma_f32_16x16x32_bf16 v[64:67], v[24:27], a[148:151], v[64:67]
    v_mfma_f32_16x16x32_bf16 v[68:71], v[28:31], a[148:151], v[68:71]
    v_mfma_f32_16x16x32_bf16 v[72:75], v[24:27], a[204:207], v[72:75]
    v_mfma_f32_16x16x32_bf16 v[76:79], v[28:31], a[204:207], v[76:79]
    s_waitcnt lgkmcnt(2)
    v_mfma_f32_16x16x32_bf16 v[48:51], v[32:35], a[40:43], v[48:51]
    s_waitcnt vmcnt(11)
    s_barrier
    s_mov_b64 exec, 1
    buffer_atomic_add v7, v6, s[8:11], s41 offen
    s_mov_b64 exec, -1
    s_add_u32 s43, s43, 1
    s_cmp_ge_u32 s43, 2
    s_cselect_b32 s41, s44, s41
    s_cselect_b32 s45, s42, 0
    s_add_u32 s44, s44, s45
    v_mfma_f32_16x16x32_bf16 v[52:55], v[36:39], a[40:43], v[52:55]
    ds_read_b128 v[16:19], v4 offset:12288
    v_mfma_f32_16x16x32_bf16 v[56:59], v[32:35], a[96:99], v[56:59]
    s_add_u32 m0, s39, s46
    v_mfma_f32_16x16x32_bf16 v[60:63], v[36:39], a[96:99], v[60:63]
    ds_read_b128 v[20:23], v4 offset:26624
    v_mfma_f32_16x16x32_bf16 v[64:67], v[32:35], a[152:155], v[64:67]
    buffer_load_dwordx4 v2, s[8:11], s37 offen offset:0  lds
    v_mfma_f32_16x16x32_bf16 v[68:71], v[36:39], a[152:155], v[68:71]
    v_mfma_f32_16x16x32_bf16 v[72:75], v[32:35], a[208:211], v[72:75]
    buffer_load_dwordx4 v2, s[8:11], s37 offen offset:1024  lds
    v_mfma_f32_16x16x32_bf16 v[76:79], v[36:39], a[208:211], v[76:79]
    s_waitcnt lgkmcnt(2)
    v_mfma_f32_16x16x32_bf16 v[48:51], v[40:43], a[44:47], v[48:51]
    buffer_load_dwordx4 v2, s[8:11], s37 offen offset:2048  lds
    v_mfma_f32_16x16x32_bf16 v[52:55], v[44:47], a[44:47], v[52:55]
    ds_read_b128 v[24:27], v4 offset:13312
    v_mfma_f32_16x16x32_bf16 v[56:59], v[40:43], a[100:103], v[56:59]
    buffer_load_dwordx4 v2, s[8:11], s37 offen offset:3072  lds
    v_mfma_f32_16x16x32_bf16 v[60:63], v[44:47], a[100:103], v[60:63]
    ds_read_b128 v[28:31], v4 offset:27648
    v_mfma_f32_16x16x32_bf16 v[64:67], v[40:43], a[156:159], v[64:67]
    s_add_u32 m0, m0, 4096
    s_add_u32 s37, s37, 4096
    v_mfma_f32_16x16x32_bf16 v[68:71], v[44:47], a[156:159], v[68:71]
    v_mfma_f32_16x16x32_bf16 v[72:75], v[40:43], a[212:215], v[72:75]
    buffer_load_dwordx4 v2, s[8:11], s37 offen offset:0  lds
    v_mfma_f32_16x16x32_bf16 v[76:79], v[44:47], a[212:215], v[76:79]
    s_waitcnt lgkmcnt(2)
    v_mfma_f32_16x16x32_bf16 v[48:51], v[16:19], a[48:51], v[48:51]
    buffer_load_dwordx4 v2, s[8:11], s37 offen offset:1024  lds
    v_mfma_f32_16x16x32_bf16 v[52:55], v[20:23], a[48:51], v[52:55]
    ds_read_b128 v[32:35], v5 offset:0
    v_mfma_f32_16x16x32_bf16 v[56:59], v[16:19], a[104:107], v[56:59]
    buffer_load_dwordx4 v2, s[8:11], s37 offen offset:2048  lds
    v_mfma_f32_16x16x32_bf16 v[60:63], v[20:23], a[104:107], v[60:63]
    ds_read_b128 v[36:39], v5 offset:14336
    v_mfma_f32_16x16x32_bf16 v[64:67], v[16:19], a[160:163], v[64:67]
    s_add_u32 s37, s37, 24576
    v_mfma_f32_16x16x32_bf16 v[68:71], v[20:23], a[160:163], v[68:71]
    v_mfma_f32_16x16x32_bf16 v[72:75], v[16:19], a[216:219], v[72:75]
    s_add_u32 s46, s46, 28672
    s_cmp_ge_u32 s46, 114688
    s_cselect_b32 s46, 0, s46
    v_mfma_f32_16x16x32_bf16 v[76:79], v[20:23], a[216:219], v[76:79]
    s_waitcnt lgkmcnt(2)
    v_mfma_f32_16x16x32_bf16 v[48:51], v[24:27], a[52:55], v[48:51]
    v_mfma_f32_16x16x32_bf16 v[52:55], v[28:31], a[52:55], v[52:55]
    ds_read_b128 v[40:43], v5 offset:1024
    v_mfma_f32_16x16x32_bf16 v[56:59], v[24:27], a[108:111], v[56:59]
    v_mfma_f32_16x16x32_bf16 v[60:63], v[28:31], a[108:111], v[60:63]
    ds_read_b128 v[44:47], v5 offset:15360
    v_mfma_f32_16x16x32_bf16 v[64:67], v[24:27], a[164:167], v[64:67]
    v_mfma_f32_16x16x32_bf16 v[68:71], v[28:31], a[164:167], v[68:71]
    v_mfma_f32_16x16x32_bf16 v[72:75], v[24:27], a[220:223], v[72:75]
    v_mfma_f32_16x16x32_bf16 v[76:79], v[28:31], a[220:223], v[76:79]
    s_waitcnt lgkmcnt(2)
    v_mfma_f32_16x16x32_bf16 v[80:83], v[32:35], a[0:3], 0
    v_mfma_f32_16x16x32_bf16 v[84:87], v[36:39], a[0:3], 0
    ds_read_b128 v[16:19], v5 offset:2048
    v_mfma_f32_16x16x32_bf16 v[88:91], v[32:35], a[56:59], 0
    v_mfma_f32_16x16x32_bf16 v[92:95], v[36:39], a[56:59], 0
    ds_read_b128 v[20:23], v5 offset:16384
    v_mfma_f32_16x16x32_bf16 v[96:99], v[32:35], a[112:115], 0
    v_cvt_pk_bf16_f32 v112, v48, v49
    v_mfma_f32_16x16x32_bf16 v[100:103], v[36:39], a[112:115], 0
    v_cvt_pk_bf16_f32 v114, v50, v51
    v_mfma_f32_16x16x32_bf16 v[104:107], v[32:35], a[168:171], 0
    v_cvt_pk_bf16_f32 v113, v52, v53
    v_mfma_f32_16x16x32_bf16 v[108:111], v[36:39], a[168:171], 0
    v_cvt_pk_bf16_f32 v115, v54, v55
    s_waitcnt lgkmcnt(2)
    v_mfma_f32_16x16x32_bf16 v[80:83], v[40:43], a[4:7], v[80:83]
    v_mfma_f32_16x16x32_bf16 v[84:87], v[44:47], a[4:7], v[84:87]
    ds_read_b128 v[24:27], v5 offset:3072
    v_mfma_f32_16x16x32_bf16 v[88:91], v[40:43], a[60:63], v[88:91]
    s_add_u32 s26, s38, 0
    buffer_store_dwordx4 v[112:115], v2, s[8:11], s26 offen sc1
    v_mfma_f32_16x16x32_bf16 v[92:95], v[44:47], a[60:63], v[92:95]
    ds_read_b128 v[28:31], v5 offset:17408
    v_cvt_pk_bf16_f32 v116, v56, v57
    v_mfma_f32_16x16x32_bf16 v[96:99], v[40:43], a[116:119], v[96:99]
    v_cvt_pk_bf16_f32 v118, v58, v59
    v_mfma_f32_16x16x32_bf16 v[100:103], v[44:47], a[116:119], v[100:103]
    v_cvt_pk_bf16_f32 v117, v60, v61
    v_mfma_f32_16x16x32_bf16 v[104:107], v[40:43], a[172:175], v[104:107]
    v_cvt_pk_bf16_f32 v119, v62, v63
    v_mfma_f32_16x16x32_bf16 v[108:111], v[44:47], a[172:175], v[108:111]
    s_waitcnt lgkmcnt(2)
    v_mfma_f32_16x16x32_bf16 v[80:83], v[16:19], a[8:11], v[80:83]
    s_add_u32 s26, s38, 16384
    buffer_store_dwordx4 v[116:119], v2, s[8:11], s26 offen sc1
    v_mfma_f32_16x16x32_bf16 v[84:87], v[20:23], a[8:11], v[84:87]
    ds_read_b128 v[32:35], v5 offset:4096
    v_cvt_pk_bf16_f32 v120, v64, v65
    v_mfma_f32_16x16x32_bf16 v[88:91], v[16:19], a[64:67], v[88:91]
    v_cvt_pk_bf16_f32 v122, v66, v67
    v_mfma_f32_16x16x32_bf16 v[92:95], v[20:23], a[64:67], v[92:95]
    ds_read_b128 v[36:39], v5 offset:18432
    v_cvt_pk_bf16_f32 v121, v68, v69
    v_mfma_f32_16x16x32_bf16 v[96:99], v[16:19], a[120:123], v[96:99]
    v_cvt_pk_bf16_f32 v123, v70, v71
    v_mfma_f32_16x16x32_bf16 v[100:103], v[20:23], a[120:123], v[100:103]
    v_mfma_f32_16x16x32_bf16 v[104:107], v[16:19], a[176:179], v[104:107]
    s_add_u32 s26, s38, 32768
    buffer_store_dwordx4 v[120:123], v2, s[8:11], s26 offen sc1
    v_mfma_f32_16x16x32_bf16 v[108:111], v[20:23], a[176:179], v[108:111]
    v_cvt_pk_bf16_f32 v124, v72, v73
    s_waitcnt lgkmcnt(2)
    v_mfma_f32_16x16x32_bf16 v[80:83], v[24:27], a[12:15], v[80:83]
    v_cvt_pk_bf16_f32 v126, v74, v75
    v_mfma_f32_16x16x32_bf16 v[84:87], v[28:31], a[12:15], v[84:87]
    ds_read_b128 v[40:43], v5 offset:5120
    v_cvt_pk_bf16_f32 v125, v76, v77
    v_mfma_f32_16x16x32_bf16 v[88:91], v[24:27], a[68:71], v[88:91]
    v_cvt_pk_bf16_f32 v127, v78, v79
    v_mfma_f32_16x16x32_bf16 v[92:95], v[28:31], a[68:71], v[92:95]
    ds_read_b128 v[44:47], v5 offset:19456
    v_mfma_f32_16x16x32_bf16 v[96:99], v[24:27], a[124:127], v[96:99]
    s_add_u32 s26, s38, 49152
    buffer_store_dwordx4 v[124:127], v2, s[8:11], s26 offen sc1
    v_mfma_f32_16x16x32_bf16 v[100:103], v[28:31], a[124:127], v[100:103]
    v_mfma_f32_16x16x32_bf16 v[104:107], v[24:27], a[180:183], v[104:107]
    s_add_u32 s38, s38, s27
    s_mov_b32 s27, 458752
    v_mfma_f32_16x16x32_bf16 v[108:111], v[28:31], a[180:183], v[108:111]
    s_waitcnt lgkmcnt(2)
    v_mfma_f32_16x16x32_bf16 v[80:83], v[32:35], a[16:19], v[80:83]
    v_mfma_f32_16x16x32_bf16 v[84:87], v[36:39], a[16:19], v[84:87]
    ds_read_b128 v[16:19], v5 offset:6144
    v_mfma_f32_16x16x32_bf16 v[88:91], v[32:35], a[72:75], v[88:91]
    v_mfma_f32_16x16x32_bf16 v[92:95], v[36:39], a[72:75], v[92:95]
    ds_read_b128 v[20:23], v5 offset:20480
    v_mfma_f32_16x16x32_bf16 v[96:99], v[32:35], a[128:131], v[96:99]
    v_mfma_f32_16x16x32_bf16 v[100:103], v[36:39], a[128:131], v[100:103]
    v_mfma_f32_16x16x32_bf16 v[104:107], v[32:35], a[184:187], v[104:107]
    v_mfma_f32_16x16x32_bf16 v[108:111], v[36:39], a[184:187], v[108:111]
    s_waitcnt lgkmcnt(2)
    v_mfma_f32_16x16x32_bf16 v[80:83], v[40:43], a[20:23], v[80:83]
    v_mfma_f32_16x16x32_bf16 v[84:87], v[44:47], a[20:23], v[84:87]
    ds_read_b128 v[24:27], v5 offset:7168
    v_mfma_f32_16x16x32_bf16 v[88:91], v[40:43], a[76:79], v[88:91]
    v_mfma_f32_16x16x32_bf16 v[92:95], v[44:47], a[76:79], v[92:95]
    ds_read_b128 v[28:31], v5 offset:21504
    v_mfma_f32_16x16x32_bf16 v[96:99], v[40:43], a[132:135], v[96:99]
    v_mfma_f32_16x16x32_bf16 v[100:103], v[44:47], a[132:135], v[100:103]
    v_mfma_f32_16x16x32_bf16 v[104:107], v[40:43], a[188:191], v[104:107]
    v_mfma_f32_16x16x32_bf16 v[108:111], v[44:47], a[188:191], v[108:111]
    s_waitcnt lgkmcnt(2)
    v_mfma_f32_16x16x32_bf16 v[80:83], v[16:19], a[24:27], v[80:83]
    v_mfma_f32_16x16x32_bf16 v[84:87], v[20:23], a[24:27], v[84:87]
    ds_read_b128 v[32:35], v5 offset:8192
    v_mfma_f32_16x16x32_bf16 v[88:91], v[16:19], a[80:83], v[88:91]
    v_mfma_f32_16x16x32_bf16 v[92:95], v[20:23], a[80:83], v[92:95]
    ds_read_b128 v[36:39], v5 offset:22528
    v_mfma_f32_16x16x32_bf16 v[96:99], v[16:19], a[136:139], v[96:99]
    v_mfma_f32_16x16x32_bf16 v[100:103], v[20:23], a[136:139], v[100:103]
    v_mfma_f32_16x16x32_bf16 v[104:107], v[16:19], a[192:195], v[104:107]
    v_mfma_f32_16x16x32_bf16 v[108:111], v[20:23], a[192:195], v[108:111]
    s_waitcnt lgkmcnt(2)
    v_mfma_f32_16x16x32_bf16 v[80:83], v[24:27], a[28:31], v[80:83]
    v_mfma_f32_16x16x32_bf16 v[84:87], v[28:31], a[28:31], v[84:87]
    ds_read_b128 v[40:43], v5 offset:9216
    v_mfma_f32_16x16x32_bf16 v[88:91], v[24:27], a[84:87], v[88:91]
    v_mfma_f32_16x16x32_bf16 v[92:95], v[28:31], a[84:87], v[92:95]
    ds_read_b128 v[44:47], v5 offset:23552
    v_mfma_f32_16x16x32_bf16 v[96:99], v[24:27], a[140:143], v[96:99]
    v_add_u32 v4, 28672, v5
    v_subrev_u32 v8, 114688, v4
    v_min_u32 v4, v4, v8
    v_mfma_f32_16x16x32_bf16 v[100:103], v[28:31], a[140:143], v[100:103]
    v_mfma_f32_16x16x32_bf16 v[104:107], v[24:27], a[196:199], v[104:107]
    v_mfma_f32_16x16x32_bf16 v[108:111], v[28:31], a[196:199], v[108:111]
    s_waitcnt lgkmcnt(2)
    v_mfma_f32_16x16x32_bf16 v[80:83], v[32:35], a[32:35], v[80:83]
    v_mfma_f32_16x16x32_bf16 v[84:87], v[36:39], a[32:35], v[84:87]
    ds_read_b128 v[16:19], v5 offset:10240
    v_mfma_f32_16x16x32_bf16 v[88:91], v[32:35], a[88:91], v[88:91]
    v_mfma_f32_16x16x32_bf16 v[92:95], v[36:39], a[88:91], v[92:95]
    ds_read_b128 v[20:23], v5 offset:24576
    v_mfma_f32_16x16x32_bf16 v[96:99], v[32:35], a[144:147], v[96:99]
    v_mfma_f32_16x16x32_bf16 v[100:103], v[36:39], a[144:147], v[100:103]
    v_mfma_f32_16x16x32_bf16 v[104:107], v[32:35], a[200:203], v[104:107]
    v_mfma_f32_16x16x32_bf16 v[108:111], v[36:39], a[200:203], v[108:111]
    s_waitcnt lgkmcnt(2)
    v_mfma_f32_16x16x32_bf16 v[80:83], v[40:43], a[36:39], v[80:83]
    v_mfma_f32_16x16x32_bf16 v[84:87], v[44:47], a[36:39], v[84:87]
    ds_read_b128 v[24:27], v5 offset:11264
    v_mfma_f32_16x16x32_bf16 v[88:91], v[40:43], a[92:95], v[88:91]
    v_mfma_f32_16x16x32_bf16 v[92:95], v[44:47], a[92:95], v[92:95]
    ds_read_b128 v[28:31], v5 offset:25600
    v_mfma_f32_16x16x32_bf16 v[96:99], v[40:43], a[148:151], v[96:99]
    v_mfma_f32_16x16x32_bf16 v[100:103], v[44:47], a[148:151], v[100:103]
    v_mfma_f32_16x16x32_bf16 v[104:107], v[40:43], a[204:207], v[104:107]
    v_mfma_f32_16x16x32_bf16 v[108:111], v[44:47], a[204:207], v[108:111]
    s_waitcnt lgkmcnt(2)
    v_mfma_f32_16x16x32_bf16 v[80:83], v[16:19], a[40:43], v[80:83]
    s_waitcnt vmcnt(11)
    s_barrier
    s_mov_b64 exec, 1
    buffer_atomic_add v7, v6, s[8:11], s41 offen
    s_mov_b64 exec, -1
    s_add_u32 s43, s43, 1
    s_cmp_ge_u32 s43, 2
    s_cselect_b32 s41, s44, s41
    s_cselect_b32 s45, s42, 0
    s_add_u32 s44, s44, s45
    v_mfma_f32_16x16x32_bf16 v[84:87], v[20:23], a[40:43], v[84:87]
    ds_read_b128 v[32:35], v5 offset:12288
    v_mfma_f32_16x16x32_bf16 v[88:91], v[16:19], a[96:99], v[88:91]
    s_add_u32 m0, s39, s46
    v_mfma_f32_16x16x32_bf16 v[92:95], v[20:23], a[96:99], v[92:95]
    ds_read_b128 v[36:39], v5 offset:26624
    v_mfma_f32_16x16x32_bf16 v[96:99], v[16:19], a[152:155], v[96:99]
    buffer_load_dwordx4 v2, s[8:11], s37 offen offset:0  lds
    v_mfma_f32_16x16x32_bf16 v[100:103], v[20:23], a[152:155], v[100:103]
    v_mfma_f32_16x16x32_bf16 v[104:107], v[16:19], a[208:211], v[104:107]
    buffer_load_dwordx4 v2, s[8:11], s37 offen offset:1024  lds
    v_mfma_f32_16x16x32_bf16 v[108:111], v[20:23], a[208:211], v[108:111]
    s_waitcnt lgkmcnt(2)
    v_mfma_f32_16x16x32_bf16 v[80:83], v[24:27], a[44:47], v[80:83]
    buffer_load_dwordx4 v2, s[8:11], s37 offen offset:2048  lds
    v_mfma_f32_16x16x32_bf16 v[84:87], v[28:31], a[44:47], v[84:87]
    ds_read_b128 v[40:43], v5 offset:13312
    v_mfma_f32_16x16x32_bf16 v[88:91], v[24:27], a[100:103], v[88:91]
    buffer_load_dwordx4 v2, s[8:11], s37 offen offset:3072  lds
    v_mfma_f32_16x16x32_bf16 v[92:95], v[28:31], a[100:103], v[92:95]
    ds_read_b128 v[44:47], v5 offset:27648
    v_mfma_f32_16x16x32_bf16 v[96:99], v[24:27], a[156:159], v[96:99]
    s_add_u32 m0, m0, 4096
    s_add_u32 s37, s37, 4096
    v_mfma_f32_16x16x32_bf16 v[100:103], v[28:31], a[156:159], v[100:103]
    v_mfma_f32_16x16x32_bf16 v[104:107], v[24:27], a[212:215], v[104:107]
    buffer_load_dwordx4 v2, s[8:11], s37 offen offset:0  lds
    v_mfma_f32_16x16x32_bf16 v[108:111], v[28:31], a[212:215], v[108:111]
    s_waitcnt lgkmcnt(2)
    v_mfma_f32_16x16x32_bf16 v[80:83], v[32:35], a[48:51], v[80:83]
    buffer_load_dwordx4 v2, s[8:11], s37 offen offset:1024  lds
    v_mfma_f32_16x16x32_bf16 v[84:87], v[36:39], a[48:51], v[84:87]
    ds_read_b128 v[16:19], v4 offset:0
    v_mfma_f32_16x16x32_bf16 v[88:91], v[32:35], a[104:107], v[88:91]
    buffer_load_dwordx4 v2, s[8:11], s37 offen offset:2048  lds
    v_mfma_f32_16x16x32_bf16 v[92:95], v[36:39], a[104:107], v[92:95]
    ds_read_b128 v[20:23], v4 offset:14336
    v_mfma_f32_16x16x32_bf16 v[96:99], v[32:35], a[160:163], v[96:99]
    s_add_u32 s37, s37, 24576
    v_mfma_f32_16x16x32_bf16 v[100:103], v[36:39], a[160:163], v[100:103]
    v_mfma_f32_16x16x32_bf16 v[104:107], v[32:35], a[216:219], v[104:107]
    s_add_u32 s46, s46, 28672
    s_cmp_ge_u32 s46, 114688
    s_cselect_b32 s46, 0, s46
    v_mfma_f32_16x16x32_bf16 v[108:111], v[36:39], a[216:219], v[108:111]
    s_waitcnt lgkmcnt(2)
    v_mfma_f32_16x16x32_bf16 v[80:83], v[40:43], a[52:55], v[80:83]
    v_mfma_f32_16x16x32_bf16 v[84:87], v[44:47], a[52:55], v[84:87]
    ds_read_b128 v[24:27], v4 offset:1024
    v_mfma_f32_16x16x32_bf16 v[88:91], v[40:43], a[108:111], v[88:91]
    v_mfma_f32_16x16x32_bf16 v[92:95], v[44:47], a[108:111], v[92:95]
    ds_read_b128 v[28:31], v4 offset:15360
    v_mfma_f32_16x16x32_bf16 v[96:99], v[40:43], a[164:167], v[96:99]
    v_mfma_f32_16x16x32_bf16 v[100:103], v[44:47], a[164:167], v[100:103]
    v_mfma_f32_16x16x32_bf16 v[104:107], v[40:43], a[220:223], v[104:107]
    v_mfma_f32_16x16x32_bf16 v[108:111], v[44:47], a[220:223], v[108:111]
    s_add_u32 s40, s40, 1
    s_cmp_lt_u32 s40, s47
    s_nop 4
    s_cbranch_scc1 G_top1
    v_cvt_pk_bf16_f32 v112, v80, v81
    v_cvt_pk_bf16_f32 v114, v82, v83
    v_cvt_pk_bf16_f32 v113, v84, v85
    v_cvt_pk_bf16_f32 v115, v86, v87
    s_add_u32 s26, s38, 0
    buffer_store_dwordx4 v[112:115], v2, s[8:11], s26 offen sc1
    v_cvt_pk_bf16_f32 v116, v88, v89
    v_cvt_pk_bf16_f32 v118, v90, v91
    v_cvt_pk_bf16_f32 v117, v92, v93
    v_cvt_pk_bf16_f32 v119, v94, v95
    s_add_u32 s26, s38, 16384
    buffer_store_dwordx4 v[116:119], v2, s[8:11], s26 offen sc1
    v_cvt_pk_bf16_f32 v120, v96, v97
    v_cvt_pk_bf16_f32 v122, v98, v99
    v_cvt_pk_bf16_f32 v121, v100, v101
    v_cvt_pk_bf16_f32 v123, v102, v103
    s_add_u32 s26, s38, 32768
    buffer_store_dwordx4 v[120:123], v2, s[8:11], s26 offen sc1
    v_cvt_pk_bf16_f32 v124, v104, v105
    v_cvt_pk_bf16_f32 v126, v106, v107
    v_cvt_pk_bf16_f32 v125, v108, v109
    v_cvt_pk_bf16_f32 v127, v110, v111
    s_add_u32 s26, s38, 49152
    buffer_store_dwordx4 v[124:127], v2, s[8:11], s26 offen sc1
    s_waitcnt vmcnt(0) lgkmcnt(0)
    s_barrier
    s_mov_b64 exec, 1
    buffer_atomic_add v7, v6, s[8:11], s41 offen
    s_mov_b64 exec, -1
    s_add_u32 s43, s43, 1
    s_cmp_ge_u32 s43, 2
    s_cselect_b32 s41, s44, s41
    s_cselect_b32 s45, s42, 0
    s_add_u32 s44, s44, s45
    s_mov_b64 exec, 1
    buffer_atomic_add v7, v6, s[8:11], s41 offen
    s_mov_b64 exec, -1
    s_add_u32 s43, s43, 1
    s_cmp_ge_u32 s43, 2
    s_cselect_b32 s41, s44, s41
    s_cselect_b32 s45, s42, 0
    s_add_u32 s44, s44, s45
    s_branch G_done
G_done:
M_attn:
    s_mov_b32 s29, 160000
A_top:
    v_mov_b32 v4, 163824
    s_cmp_lg_u32 s17, 0
    s_barrier
    s_cbranch_scc1 A_tw
    s_mov_b64 exec, 1
    s_lshl_b32 s26, s78, 7
    s_add_u32 s26, s26, 23063552
    v_mov_b32 v2, s26
    v_mov_b32 v3, 1
    buffer_atomic_add v3, v2, s[8:11], 0 offen sc0
    s_waitcnt vmcnt(0)
    ds_write_b32 v4, v3
    s_mov_b64 exec, -1
    s_waitcnt lgkmcnt(0)
A_tw:
    s_barrier
    ds_read_b32 v2, v4
    s_waitcnt lgkmcnt(0)
    v_readfirstlane_b32 s16, v2
    s_nop 0
    s_mul_i32 s16, s16, 7
    s_add_u32 s16, s16, s78
    s_cmp_ge_u32 s16, 128
    s_cbranch_scc1 L_exit
    v_mbcnt_lo_u32_b32 v40, -1, 0
    v_mbcnt_hi_u32_b32 v40, -1, v40
    s_load_dwordx2 s[4:5], s[0:1], 0
    s_lshr_b32 s36, s16, 1
    s_and_b32 s37, s16, 1
    v_lshlrev_b32 v0, 3, v40
    s_mul_i32 s26, s17, 1792
    v_lshlrev_b32 v1, 4, v40
    v_add_u32 v1, s26, v1
    v_and_b32 v41, 2, v40
    v_cmp_ne_u32 vcc, 0, v41
    v_mov_b32 v41, 0x4444
    v_mov_b32 v42, 0xeeee
    v_cndmask_b32 v2, v41, v42, vcc
    v_lshlrev_b32 v3, 4, v40
    s_waitcnt lgkmcnt(0)
    s_mov_b32 s44, s4
    s_and_b32 s45, s5, 0xffff
    s_mov_b32 s46, 1835008
    s_mov_b32 s47, 0x20000
    v_and_b32 v41, 15, v40
    v_lshrrev_b32 v42, 4, v40
    s_lshl_b32 s26, s37, 4
    v_add_u32 v43, s26, v41
    v_lshlrev_b32 v44, 2, v42
    v_mov_b32 v45, 0
    v_mov_b32 v46, 0xff800000
    v_add_u32 v47, 0, v44
    v_cmp_gt_u32 vcc, v47, v43
    s_nop 1
    v_cndmask_b32 v4, v45, v46, vcc
    v_add_u32 v47, 1, v44
    v_cmp_gt_u32 vcc, v47, v43
    s_nop 1
    v_cndmask_b32 v5, v45, v46, vcc
    v_add_u32 v47, 2, v44
    v_cmp_gt_u32 vcc, v47, v43
    s_nop 1
    v_cndmask_b32 v6, v45, v46, vcc
    v_add_u32 v47, 3, v44
    v_cmp_gt_u32 vcc, v47, v43
    s_nop 1
    v_cndmask_b32 v7, v45, v46, vcc
    v_add_u32 v47, 16, v44
    v_cmp_gt_u32 vcc, v47, v43
    s_nop 1
    v_cndmask_b32 v8, v45, v46, vcc
    v_add_u32 v47, 17, v44
    v_cmp_gt_u32 vcc, v47, v43
    s_nop 1
    v_cndmask_b32 v9, v45, v46, vcc
    v_add_u32 v47, 18, v44
    v_cmp_gt_u32 vcc, v47, v43
    s_nop 1
    v_cndmask_b32 v10, v45, v46, vcc
    v_add_u32 v47, 19, v44
    v_cmp_gt_u32 vcc, v47, v43
    s_nop 1
    v_cndmask_b32 v11, v45, v46, vcc
    s_lshl_b32 s40, s36, 7
    s_add_u32 s40, s40, 23011328
    s_mov_b32 s28, 0
    v_mov_b32 v43, 0
L_wc_190:
    buffer_load_dword v44, v43, s[8:11], s40 offen sc1
L_wcp_192:
    s_add_u32 s28, s28, 1
    s_waitcnt vmcnt(0)
    v_readfirstlane_b32 s26, v44
    s_nop 0
    s_cmp_ge_u32 s26, 28
    s_nop 1
    s_cbranch_scc1 L_wcd_191
    s_sleep 4
    s_cmp_lt_u32 s28, s29
    s_cbranch_scc1 L_wc_190
    s_mov_b32 s29, 1
L_wcd_191:
    s_sub_u32 s40, s40, 8192
    s_mov_b32 s28, 0
    v_mov_b32 v43, 0
L_wc_193:
    buffer_load_dword v44, v43, s[8:11], s40 offen sc1
L_wcp_195:
    s_add_u32 s28, s28, 1
    s_waitcnt vmcnt(0)
    v_readfirstlane_b32 s26, v44
    s_nop 0
    s_cmp_ge_u32 s26, 28
    s_nop 1
    s_cbranch_scc1 L_wcd_194
    s_sleep 4
    s_cmp_lt_u32 s28, s29
    s_cbranch_scc1 L_wc_193
    s_mov_b32 s29, 1
L_wcd_194:
    s_mul_i32 s40, s36, 28672
    s_mul_i32 s41, s17, 7168
    s_add_u32 s40, s40, s41
    s_add_u32 s40, s40, 0
    s_add_u32 s41, s41, 28672
    s_mov_b32 m0, s41
    s_nop 0
    buffer_load_dwordx4 v3, s[8:11], s40 offen offset:0  lds
    buffer_load_dwordx4 v3, s[8:11], s40 offen offset:1024  lds
    buffer_load_dwordx4 v3, s[8:11], s40 offen offset:2048  lds
    buffer_load_dwordx4 v3, s[8:11], s40 offen offset:3072  lds
    s_add_u32 s40, s40, 4096
    s_add_u32 s41, s41, 4096
    s_mov_b32 m0, s41
    s_nop 0
    buffer_load_dwordx4 v3, s[8:11], s40 offen offset:0  lds
    buffer_load_dwordx4 v3, s[8:11], s40 offen offset:1024  lds
    buffer_load_dwordx4 v3, s[8:11], s40 offen offset:2048  lds
    s_mul_i32 s38, s36, 458752
    s_mov_b32 s39, s38
    s_mul_i32 s26, s17, 114688
    s_add_u32 s38, s38, s26
    s_mul_i32 s26, s37, 14336
    s_add_u32 s38, s38, s26
    s_add_u32 s38, s38, 37748736
    s_mul_i32 s26, s17, 114688
    s_add_u32 s39, s39, s26
    s_add_u32 s39, s39, 67108864
    s_add_u32 s26, s38, 0
    buffer_load_dwordx4 a[0:3], v3, s[8:11], s26 offen offset:0 sc1
    buffer_load_dwordx4 a[4:7], v3, s[8:11], s26 offen offset:1024 sc1
    buffer_load_dwordx4 a[8:11], v3, s[8:11], s26 offen offset:2048 sc1
    buffer_load_dwordx4 a[12:15], v3, s[8:11], s26 offen offset:3072 sc1
    s_add_u32 s26, s26, 4096
    buffer_load_dwordx4 a[16:19], v3, s[8:11], s26 offen offset:0 sc1
    buffer_load_dwordx4 a[20:23], v3, s[8:11], s26 offen offset:1024 sc1
    buffer_load_dwordx4 a[24:27], v3, s[8:11], s26 offen offset:2048 sc1
    buffer_load_dwordx4 a[28:31], v3, s[8:11], s26 offen offset:3072 sc1
    s_add_u32 s26, s26, 4096
    buffer_load_dwordx4 a[32:35], v3, s[8:11], s26 offen offset:0 sc1
    buffer_load_dwordx4 a[36:39], v3, s[8:11], s26 offen offset:1024 sc1
    buffer_load_dwordx4 a[40:43], v3, s[8:11], s26 offen offset:2048 sc1
    buffer_load_dwordx4 a[44:47], v3, s[8:11], s26 offen offset:3072 sc1
    s_add_u32 s26, s26, 4096
    buffer_load_dwordx4 a[48:51], v3, s[8:11], s26 offen offset:0 sc1
    buffer_load_dwordx4 a[52:55], v3, s[8:11], s26 offen offset:1024 sc1
    s_add_u32 s26, s38, 28672
    buffer_load_dwordx4 a[56:59], v3, s[8:11], s26 offen offset:0 sc1
    buffer_load_dwordx4 a[60:63], v3, s[8:11], s26 offen offset:1024 sc1
    buffer_load_dwordx4 a[64:67], v3, s[8:11], s26 offen offset:2048 sc1
    buffer_load_dwordx4 a[68:71], v3, s[8:11], s26 offen offset:3072 sc1
    s_add_u32 s26, s26, 4096
    buffer_load_dwordx4 a[72:75], v3, s[8:11], s26 offen offset:0 sc1
    buffer_load_dwordx4 a[76:79], v3, s[8:11], s26 offen offset:1024 sc1
    buffer_load_dwordx4 a[80:83], v3, s[8:11], s26 offen offset:2048 sc1
    buffer_load_dwordx4 a[84:87], v3, s[8:11], s26 offen offset:3072 sc1
    s_add_u32 s26, s26, 4096
    buffer_load_dwordx4 a[88:91], v3, s[8:11], s26 offen offset:0 sc1
    buffer_load_dwordx4 a[92:95], v3, s[8:11], s26 offen offset:1024 sc1
    buffer_load_dwordx4 a[96:99], v3, s[8:11], s26 offen offset:2048 sc1
    buffer_load_dwordx4 a[100:103], v3, s[8:11], s26 offen offset:3072 sc1
    s_add_u32 s26, s26, 4096
    buffer_load_dwordx4 a[104:107], v3, s[8:11], s26 offen offset:0 sc1
    buffer_load_dwordx4 a[108:111], v3, s[8:11], s26 offen offset:1024 sc1
    s_add_u32 s26, s38, 57344
    buffer_load_dwordx4 a[112:115], v3, s[8:11], s26 offen offset:0 sc1
    buffer_load_dwordx4 a[116:119], v3, s[8:11], s26 offen offset:1024 sc1
    buffer_load_dwordx4 a[120:123], v3, s[8:11], s26 offen offset:2048 sc1
    buffer_load_dwordx4 a[124:127], v3, s[8:11], s26 offen offset:3072 sc1
    s_add_u32 s26, s26, 4096
    buffer_load_dwordx4 a[128:131], v3, s[8:11], s26 offen offset:0 sc1
    buffer_load_dwordx4 a[132:135], v3, s[8:11], s26 offen offset:1024 sc1
    buffer_load_dwordx4 a[136:139], v3, s[8:11], s26 offen offset:2048 sc1
    buffer_load_dwordx4 a[140:143], v3, s[8:11], s26 offen offset:3072 sc1
    s_add_u32 s26, s26, 4096
    buffer_load_dwordx4 a[144:147], v3, s[8:11], s26 offen offset:0 sc1
    buffer_load_dwordx4 a[148:151], v3, s[8:11], s26 offen offset:1024 sc1
    buffer_load_dwordx4 a[152:155], v3, s[8:11], s26 offen offset:2048 sc1
    buffer_load_dwordx4 a[156:159], v3, s[8:11], s26 offen offset:3072 sc1
    s_add_u32 s26, s26, 4096
    buffer_load_dwordx4 a[160:163], v3, s[8:11], s26 offen offset:0 sc1
    buffer_load_dwordx4 a[164:167], v3, s[8:11], s26 offen offset:1024 sc1
    s_add_u32 s26, s38, 86016
    buffer_load_dwordx4 a[168:171], v3, s[8:11], s26 offen offset:0 sc1
    buffer_load_dwordx4 a[172:175], v3, s[8:11], s26 offen offset:1024 sc1
    buffer_load_dwordx4 a[176:179], v3, s[8:11], s26 offen offset:2048 sc1
    buffer_load_dwordx4 a[180:183], v3, s[8:11], s26 offen offset:3072 sc1
    s_add_u32 s26, s26, 4096
    buffer_load_dwordx4 a[184:187], v3, s[8:11], s26 offen offset:0 sc1
    buffer_load_dwordx4 a[188:191], v3, s[8:11], s26 offen offset:1024 sc1
    buffer_load_dwordx4 a[192:195], v3, s[8:11], s26 offen offset:2048 sc1
    buffer_load_dwordx4 a[196:199], v3, s[8:11], s26 offen offset:3072 sc1
    s_add_u32 s26, s26, 4096
    buffer_load_dwordx4 a[200:203], v3, s[8:11], s26 offen offset:0 sc1
    buffer_load_dwordx4 a[204:207], v3, s[8:11], s26 offen offset:1024 sc1
    buffer_load_dwordx4 a[208:211], v3, s[8:11], s26 offen offset:2048 sc1
    buffer_load_dwordx4 a[212:215], v3, s[8:11], s26 offen offset:3072 sc1
    s_add_u32 s26, s26, 4096
    buffer_load_dwordx4 a[216:219], v3, s[8:11], s26 offen offset:0 sc1
    buffer_load_dwordx4 a[220:223], v3, s[8:11], s26 offen offset:1024 sc1
    s_waitcnt vmcnt(56)
    s_barrier
    ds_read_b128 v[64:67], v3 offset:28672
    ds_read_b128 v[68:71], v3 offset:29696
    ds_read_b128 v[72:75], v3 offset:30720
    ds_read_b128 v[76:79], v3 offset:31744
    ds_read_b128 v[80:83], v3 offset:32768
    ds_read_b128 v[84:87], v3 offset:33792
    ds_read_b128 v[88:91], v3 offset:34816
    ds_read_b128 v[92:95], v3 offset:35840
    ds_read_b128 v[96:99], v3 offset:36864
    ds_read_b128 v[100:103], v3 offset:37888
    ds_read_b128 v[104:107], v3 offset:38912
    ds_read_b128 v[108:111], v3 offset:39936
    ds_read_b128 v[112:115], v3 offset:40960
    ds_read_b128 v[116:119], v3 offset:41984
    ds_read_b128 v[120:123], v3 offset:43008
    ds_read_b128 v[124:127], v3 offset:44032
    ds_read_b128 v[128:131], v3 offset:45056
    ds_read_b128 v[132:135], v3 offset:46080
    ds_read_b128 v[136:139], v3 offset:47104
    ds_read_b128 v[140:143], v3 offset:48128
    ds_read_b128 v[144:147], v3 offset:49152
    ds_read_b128 v[148:151], v3 offset:50176
    ds_read_b128 v[152:155], v3 offset:51200
    ds_read_b128 v[156:159], v3 offset:52224
    ds_read_b128 v[160:163], v3 offset:53248
    ds_read_b128 v[164:167], v3 offset:54272
    ds_read_b128 v[168:171], v3 offset:55296
    ds_read_b128 v[172:175], v3 offset:56320
    s_waitcnt lgkmcnt(0)
    s_mul_i32 s41, s17, 24576
    s_add_u32 s41, s41, 57344
    v_add_u32 v63, s41, v3
    s_waitcnt vmcnt(42)
    s_add_u32 m0, s41, 0
    s_add_u32 s27, s39, 0
    buffer_load_dwordx4 v3, s[8:11], s27 offen sc1 lds
    s_add_u32 m0, s41, 1024
    s_add_u32 s27, s39, 1024
    buffer_load_dwordx4 v3, s[8:11], s27 offen sc1 lds
    s_add_u32 m0, s41, 2048
    s_add_u32 s27, s39, 2048
    buffer_load_dwordx4 v3, s[8:11], s27 offen sc1 lds
    s_add_u32 m0, s41, 3072
    s_add_u32 s27, s39, 3072
    buffer_load_dwordx4 v3, s[8:11], s27 offen sc1 lds
    s_add_u32 m0, s41, 4096
    s_add_u32 s27, s39, 4096
    buffer_load_dwordx4 v3, s[8:11], s27 offen sc1 lds
    s_add_u32 m0, s41, 5120
    s_add_u32 s27, s39, 5120
    buffer_load_dwordx4 v3, s[8:11], s27 offen sc1 lds
    s_add_u32 m0, s41, 6144
    s_add_u32 s27, s39, 6144
    buffer_load_dwordx4 v3, s[8:11], s27 offen sc1 lds
    s_add_u32 m0, s41, 7168
    s_add_u32 s27, s39, 7168
    buffer_load_dwordx4 v3, s[8:11], s27 offen sc1 lds
    s_add_u32 m0, s41, 8192
    s_add_u32 s27, s39, 8192
    buffer_load_dwordx4 v3, s[8:11], s27 offen sc1 lds
    s_add_u32 m0, s41, 9216
    s_add_u32 s27, s39, 9216
    buffer_load_dwordx4 v3, s[8:11], s27 offen sc1 lds
    s_add_u32 m0, s41, 10240
    s_add_u32 s27, s39, 10240
    buffer_load_dwordx4 v3, s[8:11], s27 offen sc1 lds
    s_add_u32 m0, s41, 11264
    s_add_u32 s27, s39, 11264
    buffer_load_dwordx4 v3, s[8:11], s27 offen sc1 lds
    v_mfma_f32_16x16x32_bf16 v[176:179], v[64:67], a[0:3], 0
    v_mfma_f32_16x16x32_bf16 v[180:183], v[120:123], a[0:3], 0
    v_mfma_f32_16x16x32_bf16 v[176:179], v[68:71], a[4:7], v[176:179]
    v_mfma_f32_16x16x32_bf16 v[180:183], v[124:127], a[4:7], v[180:183]
    v_mfma_f32_16x16x32_bf16 v[176:179], v[72:75], a[8:11], v[176:179]
    v_mfma_f32_16x16x32_bf16 v[180:183], v[128:131], a[8:11], v[180:183]
    v_mfma_f32_16x16x32_bf16 v[176:179], v[76:79], a[12:15], v[176:179]
    v_mfma_f32_16x16x32_bf16 v[180:183], v[132:135], a[12:15], v[180:183]
    v_mfma_f32_16x16x32_bf16 v[176:179], v[80:83], a[16:19], v[176:179]
    v_mfma_f32_16x16x32_bf16 v[180:183], v[136:139], a[16:19], v[180:183]
    v_mfma_f32_16x16x32_bf16 v[176:179], v[84:87], a[20:23], v[176:179]
    v_mfma_f32_16x16x32_bf16 v[180:183], v[140:143], a[20:23], v[180:183]
    v_mfma_f32_16x16x32_bf16 v[176:179], v[88:91], a[24:27], v[176:179]
    v_mfma_f32_16x16x32_bf16 v[180:183], v[144:147], a[24:27], v[180:183]
    v_mfma_f32_16x16x32_bf16 v[176:179], v[92:95], a[28:31], v[176:179]
    v_mfma_f32_16x16x32_bf16 v[180:183], v[148:151], a[28:31], v[180:183]
    v_mfma_f32_16x16x32_bf16 v[176:179], v[96:99], a[32:35], v[176:179]
    v_mfma_f32_16x16x32_bf16 v[180:183], v[152:155], a[32:35], v[180:183]
    v_mfma_f32_16x16x32_bf16 v[176:179], v[100:103], a[36:39], v[176:179]
    v_mfma_f32_16x16x32_bf16 v[180:183], v[156:159], a[36:39], v[180:183]
    v_mfma_f32_16x16x32_bf16 v[176:179], v[104:107], a[40:43], v[176:179]
    v_mfma_f32_16x16x32_bf16 v[180:183], v[160:163], a[40:43], v[180:183]
    v_mfma_f32_16x16x32_bf16 v[176:179], v[108:111], a[44:47], v[176:179]
    v_mfma_f32_16x16x32_bf16 v[180:183], v[164:167], a[44:47], v[180:183]
    v_mfma_f32_16x16x32_bf16 v[176:179], v[112:115], a[48:51], v[176:179]
    v_mfma_f32_16x16x32_bf16 v[180:183], v[168:171], a[48:51], v[180:183]
    v_mfma_f32_16x16x32_bf16 v[176:179], v[116:119], a[52:55], v[176:179]
    v_mfma_f32_16x16x32_bf16 v[180:183], v[172:175], a[52:55], v[180:183]
    s_waitcnt vmcnt(40)
    s_add_u32 m0, s41, 12288
    s_add_u32 s27, s39, 12288
    buffer_load_dwordx4 v3, s[8:11], s27 offen sc1 lds
    s_add_u32 m0, s41, 13312
    s_add_u32 s27, s39, 13312
    buffer_load_dwordx4 v3, s[8:11], s27 offen sc1 lds
    s_add_u32 m0, s41, 14336
    s_add_u32 s27, s39, 14336
    buffer_load_dwordx4 v3, s[8:11], s27 offen sc1 lds
    s_add_u32 m0, s41, 15360
    s_add_u32 s27, s39, 15360
    buffer_load_dwordx4 v3, s[8:11], s27 offen sc1 lds
    s_add_u32 m0, s41, 16384
    s_add_u32 s27, s39, 16384
    buffer_load_dwordx4 v3, s[8:11], s27 offen sc1 lds
    s_add_u32 m0, s41, 17408
    s_add_u32 s27, s39, 17408
    buffer_load_dwordx4 v3, s[8:11], s27 offen sc1 lds
    s_add_u32 m0, s41, 18432
    s_add_u32 s27, s39, 18432
    buffer_load_dwordx4 v3, s[8:11], s27 offen sc1 lds
    s_add_u32 m0, s41, 19456
    s_add_u32 s27, s39, 19456
    buffer_load_dwordx4 v3, s[8:11], s27 offen sc1 lds
    s_add_u32 m0, s41, 20480
    s_add_u32 s27, s39, 20480
    buffer_load_dwordx4 v3, s[8:11], s27 offen sc1 lds
    s_add_u32 m0, s41, 21504
    s_add_u32 s27, s39, 21504
    buffer_load_dwordx4 v3, s[8:11], s27 offen sc1 lds
    s_add_u32 m0, s41, 22528
    s_add_u32 s27, s39, 22528
    buffer_load_dwordx4 v3, s[8:11], s27 offen sc1 lds
    s_add_u32 m0, s41, 23552
    s_add_u32 s27, s39, 23552
    buffer_load_dwordx4 v3, s[8:11], s27 offen sc1 lds
    v_mfma_f32_16x16x32_bf16 v[184:187], v[64:67], a[56:59], 0
    v_mfma_f32_16x16x32_bf16 v[188:191], v[120:123], a[56:59], 0
    v_mfma_f32_16x16x32_bf16 v[184:187], v[68:71], a[60:63], v[184:187]
    v_mfma_f32_16x16x32_bf16 v[188:191], v[124:127], a[60:63], v[188:191]
    v_mfma_f32_16x16x32_bf16 v[184:187], v[72:75], a[64:67], v[184:187]
    v_mfma_f32_16x16x32_bf16 v[188:191], v[128:131], a[64:67], v[188:191]
    v_mfma_f32_16x16x32_bf16 v[184:187], v[76:79], a[68:71], v[184:187]
    v_mfma_f32_16x16x32_bf16 v[188:191], v[132:135], a[68:71], v[188:191]
    v_mfma_f32_16x16x32_bf16 v[184:187], v[80:83], a[72:75], v[184:187]
    v_mfma_f32_16x16x32_bf16 v[188:191], v[136:139], a[72:75], v[188:191]
    v_mfma_f32_16x16x32_bf16 v[184:187], v[84:87], a[76:79], v[184:187]
    v_mfma_f32_16x16x32_bf16 v[188:191], v[140:143], a[76:79], v[188:191]
    v_mfma_f32_16x16x32_bf16 v[184:187], v[88:91], a[80:83], v[184:187]
    v_mfma_f32_16x16x32_bf16 v[188:191], v[144:147], a[80:83], v[188:191]
    v_mfma_f32_16x16x32_bf16 v[184:187], v[92:95], a[84:87], v[184:187]
    v_mfma_f32_16x16x32_bf16 v[188:191], v[148:151], a[84:87], v[188:191]
    v_mfma_f32_16x16x32_bf16 v[184:187], v[96:99], a[88:91], v[184:187]
    v_mfma_f32_16x16x32_bf16 v[188:191], v[152:155], a[88:91], v[188:191]
    v_mfma_f32_16x16x32_bf16 v[184:187], v[100:103], a[92:95], v[184:187]
    v_mfma_f32_16x16x32_bf16 v[188:191], v[156:159], a[92:95], v[188:191]
    v_mfma_f32_16x16x32_bf16 v[184:187], v[104:107], a[96:99], v[184:187]
    v_mfma_f32_16x16x32_bf16 v[188:191], v[160:163], a[96:99], v[188:191]
    v_mfma_f32_16x16x32_bf16 v[184:187], v[108:111], a[100:103], v[184:187]
    v_mfma_f32_16x16x32_bf16 v[188:191], v[164:167], a[100:103], v[188:191]
    v_mfma_f32_16x16x32_bf16 v[184:187], v[112:115], a[104:107], v[184:187]
    v_mfma_f32_16x16x32_bf16 v[188:191], v[168:171], a[104:107], v[188:191]
    v_mfma_f32_16x16x32_bf16 v[184:187], v[116:119], a[108:111], v[184:187]
    v_mfma_f32_16x16x32_bf16 v[188:191], v[172:175], a[108:111], v[188:191]
    s_waitcnt vmcnt(38)
    v_mfma_f32_16x16x32_bf16 v[192:195], v[64:67], a[112:115], 0
    v_mfma_f32_16x16x32_bf16 v[196:199], v[120:123], a[112:115], 0
    v_mfma_f32_16x16x32_bf16 v[192:195], v[68:71], a[116:119], v[192:195]
    v_mfma_f32_16x16x32_bf16 v[196:199], v[124:127], a[116:119], v[196:199]
    v_mfma_f32_16x16x32_bf16 v[192:195], v[72:75], a[120:123], v[192:195]
    v_mfma_f32_16x16x32_bf16 v[196:199], v[128:131], a[120:123], v[196:199]
    v_mfma_f32_16x16x32_bf16 v[192:195], v[76:79], a[124:127], v[192:195]
    v_mfma_f32_16x16x32_bf16 v[196:199], v[132:135], a[124:127], v[196:199]
    v_mfma_f32_16x16x32_bf16 v[192:195], v[80:83], a[128:131], v[192:195]
    v_mfma_f32_16x16x32_bf16 v[196:199], v[136:139], a[128:131], v[196:199]
    v_mfma_f32_16x16x32_bf16 v[192:195], v[84:87], a[132:135], v[192:195]
    v_mfma_f32_16x16x32_bf16 v[196:199], v[140:143], a[132:135], v[196:199]
    v_mfma_f32_16x16x32_bf16 v[192:195], v[88:91], a[136:139], v[192:195]
    v_mfma_f32_16x16x32_bf16 v[196:199], v[144:147], a[136:139], v[196:199]
    v_mfma_f32_16x16x32_bf16 v[192:195], v[92:95], a[140:143], v[192:195]
    v_mfma_f32_16x16x32_bf16 v[196:199], v[148:151], a[140:143], v[196:199]
    v_mfma_f32_16x16x32_bf16 v[192:195], v[96:99], a[144:147], v[192:195]
    v_mfma_f32_16x16x32_bf16 v[196:199], v[152:155], a[144:147], v[196:199]
    v_mfma_f32_16x16x32_bf16 v[192:195], v[100:103], a[148:151], v[192:195]
    v_mfma_f32_16x16x32_bf16 v[196:199], v[156:159], a[148:151], v[196:199]
    v_mfma_f32_16x16x32_bf16 v[192:195], v[104:107], a[152:155], v[192:195]
    v_mfma_f32_16x16x32_bf16 v[196:199], v[160:163], a[152:155], v[196:199]
    v_mfma_f32_16x16x32_bf16 v[192:195], v[108:111], a[156:159], v[192:195]
    v_mfma_f32_16x16x32_bf16 v[196:199], v[164:167], a[156:159], v[196:199]
    v_mfma_f32_16x16x32_bf16 v[192:195], v[112:115], a[160:163], v[192:195]
    v_mfma_f32_16x16x32_bf16 v[196:199], v[168:171], a[160:163], v[196:199]
    v_mfma_f32_16x16x32_bf16 v[192:195], v[116:119], a[164:167], v[192:195]
    v_mfma_f32_16x16x32_bf16 v[196:199], v[172:175], a[164:167], v[196:199]
    s_waitcnt vmcnt(24)
    v_mfma_f32_16x16x32_bf16 v[200:203], v[64:67], a[168:171], 0
    v_mfma_f32_16x16x32_bf16 v[204:207], v[120:123], a[168:171], 0
    v_mfma_f32_16x16x32_bf16 v[200:203], v[68:71], a[172:175], v[200:203]
    v_mfma_f32_16x16x32_bf16 v[204:207], v[124:127], a[172:175], v[204:207]
    v_mfma_f32_16x16x32_bf16 v[200:203], v[72:75], a[176:179], v[200:203]
    v_mfma_f32_16x16x32_bf16 v[204:207], v[128:131], a[176:179], v[204:207]
    v_mfma_f32_16x16x32_bf16 v[200:203], v[76:79], a[180:183], v[200:203]
    v_mfma_f32_16x16x32_bf16 v[204:207], v[132:135], a[180:183], v[204:207]
    v_mfma_f32_16x16x32_bf16 v[200:203], v[80:83], a[184:187], v[200:203]
    v_mfma_f32_16x16x32_bf16 v[204:207], v[136:139], a[184:187], v[204:207]
    v_mfma_f32_16x16x32_bf16 v[200:203], v[84:87], a[188:191], v[200:203]
    v_mfma_f32_16x16x32_bf16 v[204:207], v[140:143], a[188:191], v[204:207]
    v_mfma_f32_16x16x32_bf16 v[200:203], v[88:91], a[192:195], v[200:203]
    v_mfma_f32_16x16x32_bf16 v[204:207], v[144:147], a[192:195], v[204:207]
    v_mfma_f32_16x16x32_bf16 v[200:203], v[92:95], a[196:199], v[200:203]
    v_mfma_f32_16x16x32_bf16 v[204:207], v[148:151], a[196:199], v[204:207]
    v_mfma_f32_16x16x32_bf16 v[200:203], v[96:99], a[200:203], v[200:203]
    v_mfma_f32_16x16x32_bf16 v[204:207], v[152:155], a[200:203], v[204:207]
    v_mfma_f32_16x16x32_bf16 v[200:203], v[100:103], a[204:207], v[200:203]
    v_mfma_f32_16x16x32_bf16 v[204:207], v[156:159], a[204:207], v[204:207]
    v_mfma_f32_16x16x32_bf16 v[200:203], v[104:107], a[208:211], v[200:203]
    v_mfma_f32_16x16x32_bf16 v[204:207], v[160:163], a[208:211], v[204:207]
    v_mfma_f32_16x16x32_bf16 v[200:203], v[108:111], a[212:215], v[200:203]
    v_mfma_f32_16x16x32_bf16 v[204:207], v[164:167], a[212:215], v[204:207]
    v_mfma_f32_16x16x32_bf16 v[200:203], v[112:115], a[216:219], v[200:203]
    v_mfma_f32_16x16x32_bf16 v[204:207], v[168:171], a[216:219], v[204:207]
    v_mfma_f32_16x16x32_bf16 v[200:203], v[116:119], a[220:223], v[200:203]
    v_mfma_f32_16x16x32_bf16 v[204:207], v[172:175], a[220:223], v[204:207]
    v_add_f32 v176, v176, v4
    v_add_f32 v177, v177, v5
    v_add_f32 v178, v178, v6
    v_add_f32 v179, v179, v7
    v_add_f32 v180, v180, v8
    v_add_f32 v181, v181, v9
    v_add_f32 v182, v182, v10
    v_add_f32 v183, v183, v11
    v_max3_f32 v48, v176, v177, v178
    v_max3_f32 v48, v48, v179, v180
    v_max3_f32 v48, v48, v181, v182
    v_max_f32 v48, v48, v183
    v_mov_b32 v208, v48
    s_nop 1
    v_permlane16_swap_b32 v48, v208
    v_max_f32 v48, v48, v208
    v_mov_b32 v208, v48
    s_nop 1
    v_permlane32_swap_b32 v48, v208
    v_max_f32 v48, v48, v208
    v_sub_f32 v176, v176, v48
    v_sub_f32 v177, v177, v48
    v_sub_f32 v178, v178, v48
    v_sub_f32 v179, v179, v48
    v_sub_f32 v180, v180, v48
    v_sub_f32 v181, v181, v48
    v_sub_f32 v182, v182, v48
    v_sub_f32 v183, v183, v48
    v_exp_f32 v176, v176
    v_exp_f32 v177, v177
    v_exp_f32 v178, v178
    v_exp_f32 v179, v179
    v_exp_f32 v180, v180
    v_exp_f32 v181, v181
    v_exp_f32 v182, v182
    v_exp_f32 v183, v183
    v_add_f32 v52, v176, v177
    v_add_f32 v52, v52, v178
    v_add_f32 v52, v52, v179
    v_add_f32 v52, v52, v180
    v_add_f32 v52, v52, v181
    v_add_f32 v52, v52, v182
    v_add_f32 v52, v52, v183
    v_mov_b32 v208, v52
    s_nop 1
    v_permlane16_swap_b32 v52, v208
    v_add_f32 v52, v52, v208
    v_mov_b32 v208, v52
    s_nop 1
    v_permlane32_swap_b32 v52, v208
    v_add_f32 v52, v52, v208
    v_cvt_pk_bf16_f32 v212, v176, v177
    v_cvt_pk_bf16_f32 v214, v178, v179
    v_cvt_pk_bf16_f32 v213, v180, v181
    v_cvt_pk_bf16_f32 v215, v182, v183
    s_lshl_b32 s26, s17, 12
    v_add_u32 v41, s26, v3
    ds_write_b128 v41, v[212:215] offset:8192
    v_add_f32 v184, v184, v4
    v_add_f32 v185, v185, v5
    v_add_f32 v186, v186, v6
    v_add_f32 v187, v187, v7
    v_add_f32 v188, v188, v8
    v_add_f32 v189, v189, v9
    v_add_f32 v190, v190, v10
    v_add_f32 v191, v191, v11
    v_max3_f32 v49, v184, v185, v186
    v_max3_f32 v49, v49, v187, v188
    v_max3_f32 v49, v49, v189, v190
    v_max_f32 v49, v49, v191
    v_mov_b32 v208, v49
    s_nop 1
    v_permlane16_swap_b32 v49, v208
    v_max_f32 v49, v49, v208
    v_mov_b32 v208, v49
    s_nop 1
    v_permlane32_swap_b32 v49, v208
    v_max_f32 v49, v49, v208
    v_sub_f32 v184, v184, v49
    v_sub_f32 v185, v185, v49
    v_sub_f32 v186, v186, v49
    v_sub_f32 v187, v187, v49
    v_sub_f32 v188, v188, v49
    v_sub_f32 v189, v189, v49
    v_sub_f32 v190, v190, v49
    v_sub_f32 v191, v191, v49
    v_exp_f32 v184, v184
    v_exp_f32 v185, v185
    v_exp_f32 v186, v186
    v_exp_f32 v187, v187
    v_exp_f32 v188, v188
    v_exp_f32 v189, v189
    v_exp_f32 v190, v190
    v_exp_f32 v191, v191
    v_add_f32 v53, v184, v185
    v_add_f32 v53, v53, v186
    v_add_f32 v53, v53, v187
    v_add_f32 v53, v53, v188
    v_add_f32 v53, v53, v189
    v_add_f32 v53, v53, v190
    v_add_f32 v53, v53, v191
    v_mov_b32 v208, v53
    s_nop 1
    v_permlane16_swap_b32 v53, v208
    v_add_f32 v53, v53, v208
    v_mov_b32 v208, v53
    s_nop 1
    v_permlane32_swap_b32 v53, v208
    v_add_f32 v53, v53, v208
    v_cvt_pk_bf16_f32 v212, v184, v185
    v_cvt_pk_bf16_f32 v214, v186, v187
    v_cvt_pk_bf16_f32 v213, v188, v189
    v_cvt_pk_bf16_f32 v215, v190, v191
    ds_write_b128 v41, v[212:215] offset:9216
    v_add_f32 v192, v192, v4
    v_add_f32 v193, v193, v5
    v_add_f32 v194, v194, v6
    v_add_f32 v195, v195, v7
    v_add_f32 v196, v196, v8
    v_add_f32 v197, v197, v9
    v_add_f32 v198, v198, v10
    v_add_f32 v199, v199, v11
    v_max3_f32 v50, v192, v193, v194
    v_max3_f32 v50, v50, v195, v196
    v_max3_f32 v50, v50, v197, v198
    v_max_f32 v50, v50, v199
    v_mov_b32 v208, v50
    s_nop 1
    v_permlane16_swap_b32 v50, v208
    v_max_f32 v50, v50, v208
    v_mov_b32 v208, v50
    s_nop 1
    v_permlane32_swap_b32 v50, v208
    v_max_f32 v50, v50, v208
    v_sub_f32 v192, v192, v50
    v_sub_f32 v193, v193, v50
    v_sub_f32 v194, v194, v50
    v_sub_f32 v195, v195, v50
    v_sub_f32 v196, v196, v50
    v_sub_f32 v197, v197, v50
    v_sub_f32 v198, v198, v50
    v_sub_f32 v199, v199, v50
    v_exp_f32 v192, v192
    v_exp_f32 v193, v193
    v_exp_f32 v194, v194
    v_exp_f32 v195, v195
    v_exp_f32 v196, v196
    v_exp_f32 v197, v197
    v_exp_f32 v198, v198
    v_exp_f32 v199, v199
    v_add_f32 v54, v192, v193
    v_add_f32 v54, v54, v194
    v_add_f32 v54, v54, v195
    v_add_f32 v54, v54, v196
    v_add_f32 v54, v54, v197
    v_add_f32 v54, v54, v198
    v_add_f32 v54, v54, v199
    v_mov_b32 v208, v54
    s_nop 1
    v_permlane16_swap_b32 v54, v208
    v_add_f32 v54, v54, v208
    v_mov_b32 v208, v54
    s_nop 1
    v_permlane32_swap_b32 v54, v208
    v_add_f32 v54, v54, v208
    v_cvt_pk_bf16_f32 v212, v192, v193
    v_cvt_pk_bf16_f32 v214, v194, v195
    v_cvt_pk_bf16_f32 v213, v196, v197
    v_cvt_pk_bf16_f32 v215, v198, v199
    ds_write_b128 v41, v[212:215] offset:10240
    v_add_f32 v200, v200, v4
    v_add_f32 v201, v201, v5
    v_add_f32 v202, v202, v6
    v_add_f32 v203, v203, v7
    v_add_f32 v204, v204, v8
    v_add_f32 v205, v205, v9
    v_add_f32 v206, v206, v10
    v_add_f32 v207, v207, v11
    v_max3_f32 v51, v200, v201, v202
    v_max3_f32 v51, v51, v203, v204
    v_max3_f32 v51, v51, v205, v206
    v_max_f32 v51, v51, v207
    v_mov_b32 v208, v51
    s_nop 1
    v_permlane16_swap_b32 v51, v208
    v_max_f32 v51, v51, v208
    v_mov_b32 v208, v51
    s_nop 1
    v_permlane32_swap_b32 v51, v208
    v_max_f32 v51, v51, v208
    v_sub_f32 v200, v200, v51
    v_sub_f32 v201, v201, v51
    v_sub_f32 v202, v202, v51
    v_sub_f32 v203, v203, v51
    v_sub_f32 v204, v204, v51
    v_sub_f32 v205, v205, v51
    v_sub_f32 v206, v206, v51
    v_sub_f32 v207, v207, v51
    v_exp_f32 v200, v200
    v_exp_f32 v201, v201
    v_exp_f32 v202, v202
    v_exp_f32 v203, v203
    v_exp_f32 v204, v204
    v_exp_f32 v205, v205
    v_exp_f32 v206, v206
    v_exp_f32 v207, v207
    v_add_f32 v55, v200, v201
    v_add_f32 v55, v55, v202
    v_add_f32 v55, v55, v203
    v_add_f32 v55, v55, v204
    v_add_f32 v55, v55, v205
    v_add_f32 v55, v55, v206
    v_add_f32 v55, v55, v207
    v_mov_b32 v208, v55
    s_nop 1
    v_permlane16_swap_b32 v55, v208
    v_add_f32 v55, v55, v208
    v_mov_b32 v208, v55
    s_nop 1
    v_permlane32_swap_b32 v55, v208
    v_add_f32 v55, v55, v208
    v_cvt_pk_bf16_f32 v212, v200, v201
    v_cvt_pk_bf16_f32 v214, v202, v203
    v_cvt_pk_bf16_f32 v213, v204, v205
    v_cvt_pk_bf16_f32 v215, v206, v207
    ds_write_b128 v41, v[212:215] offset:11264
    s_waitcnt lgkmcnt(0)
    s_barrier
    ds_read_b128 v[12:15], v3 offset:8192
    ds_read_b128 v[16:19], v3 offset:9216
    ds_read_b128 v[20:23], v3 offset:10240
    s_waitcnt vmcnt(23)
    ds_read_b128 v[4:7], v63 offset:0
    s_waitcnt vmcnt(22)
    ds_read_b128 v[8:11], v63 offset:1024
    s_waitcnt lgkmcnt(4)
    s_waitcnt lgkmcnt(1)
    v_mfma_f32_16x16x32_bf16 v[28:31], v[12:15], v[4:7], 0
    s_add_u32 m0, s41, 0
    s_add_u32 s27, s39, 24576
    buffer_load_dwordx4 v3, s[8:11], s27 offen sc1 lds
    s_waitcnt vmcnt(22)
    ds_read_b128 v[44:47], v63 offset:2048
    ds_read_b128 v[24:27], v3 offset:11264
    s_waitcnt lgkmcnt(2)
    v_mfma_f32_16x16x32_bf16 v[32:35], v[16:19], v[8:11], 0
    s_add_u32 m0, s41, 1024
    s_add_u32 s27, s39, 25600
    buffer_load_dwordx4 v3, s[8:11], s27 offen sc1 lds
    s_waitcnt vmcnt(22)
    ds_read_b128 v[4:7], v63 offset:3072
    ds_read_b128 v[12:15], v3 offset:12288
    s_waitcnt lgkmcnt(3)
    v_mfma_f32_16x16x32_bf16 v[36:39], v[20:23], v[44:47], 0
    s_add_u32 m0, s41, 2048
    s_add_u32 s27, s39, 26624
    buffer_load_dwordx4 v3, s[8:11], s27 offen sc1 lds
    s_waitcnt vmcnt(22)
    ds_read_b128 v[8:11], v63 offset:4096
    ds_read_b128 v[16:19], v3 offset:13312
    s_waitcnt lgkmcnt(4)
    s_waitcnt lgkmcnt(3)
    v_mfma_f32_16x16x32_bf16 v[56:59], v[24:27], v[4:7], 0
    s_add_u32 m0, s41, 3072
    s_add_u32 s27, s39, 27648
    buffer_load_dwordx4 v3, s[8:11], s27 offen sc1 lds
    s_waitcnt vmcnt(22)
    ds_read_b128 v[44:47], v63 offset:5120
    ds_read_b128 v[20:23], v3 offset:14336
    v_cvt_pk_bf16_f32 v64, v28, v29
    v_cvt_pk_bf16_f32 v65, v30, v31
    s_waitcnt lgkmcnt(4)
    s_waitcnt lgkmcnt(3)
    v_mfma_f32_16x16x32_bf16 v[28:31], v[12:15], v[8:11], 0
    s_add_u32 m0, s41, 4096
    s_add_u32 s27, s39, 28672
    buffer_load_dwordx4 v3, s[8:11], s27 offen sc1 lds
    s_waitcnt vmcnt(22)
    ds_read_b128 v[4:7], v63 offset:6144
    ds_read_b128 v[24:27], v3 offset:15360
    v_cvt_pk_bf16_f32 v66, v32, v33
    v_cvt_pk_bf16_f32 v67, v34, v35
    s_waitcnt lgkmcnt(4)
    s_waitcnt lgkmcnt(3)
    v_mfma_f32_16x16x32_bf16 v[32:35], v[16:19], v[44:47], 0
    s_add_u32 m0, s41, 5120
    s_add_u32 s27, s39, 29696
    buffer_load_dwordx4 v3, s[8:11], s27 offen sc1 lds
    s_waitcnt vmcnt(22)
    ds_read_b128 v[8:11], v63 offset:7168
    ds_read_b128 v[12:15], v3 offset:16384
    v_cvt_pk_bf16_f32 v68, v36, v37
    v_cvt_pk_bf16_f32 v69, v38, v39
    s_waitcnt lgkmcnt(4)
    s_waitcnt lgkmcnt(3)
    v_mfma_f32_16x16x32_bf16 v[36:39], v[20:23], v[4:7], 0
    s_add_u32 m0, s41, 6144
    s_add_u32 s27, s39, 30720
    buffer_load_dwordx4 v3, s[8:11], s27 offen sc1 lds
    s_waitcnt vmcnt(22)
    ds_read_b128 v[44:47], v63 offset:8192
    ds_read_b128 v[16:19], v3 offset:17408
    v_cvt_pk_bf16_f32 v70, v56, v57
    v_cvt_pk_bf16_f32 v71, v58, v59
    s_waitcnt lgkmcnt(4)
    s_waitcnt lgkmcnt(3)
    v_mfma_f32_16x16x32_bf16 v[56:59], v[24:27], v[8:11], 0
    s_add_u32 m0, s41, 7168
    s_add_u32 s27, s39, 31744
    buffer_load_dwordx4 v3, s[8:11], s27 offen sc1 lds
    s_waitcnt vmcnt(22)
    ds_read_b128 v[4:7], v63 offset:9216
    ds_read_b128 v[20:23], v3 offset:18432
    v_cvt_pk_bf16_f32 v72, v28, v29
    v_cvt_pk_bf16_f32 v73, v30, v31
    s_waitcnt lgkmcnt(4)
    s_waitcnt lgkmcnt(3)
    v_mfma_f32_16x16x32_bf16 v[28:31], v[12:15], v[44:47], 0
    s_add_u32 m0, s41, 8192
    s_add_u32 s27, s39, 32768
    buffer_load_dwordx4 v3, s[8:11], s27 offen sc1 lds
    s_waitcnt vmcnt(22)
    ds_read_b128 v[8:11], v63 offset:10240
    ds_read_b128 v[24:27], v3 offset:19456
    v_cvt_pk_bf16_f32 v74, v32, v33
    v_cvt_pk_bf16_f32 v75, v34, v35
    s_waitcnt lgkmcnt(4)
    s_waitcnt lgkmcnt(3)
    v_mfma_f32_16x16x32_bf16 v[32:35], v[16:19], v[4:7], 0
    s_add_u32 m0, s41, 9216
    s_add_u32 s27, s39, 33792
    buffer_load_dwordx4 v3, s[8:11], s27 offen sc1 lds
    s_waitcnt vmcnt(22)
    ds_read_b128 v[44:47], v63 offset:11264
    ds_read_b128 v[12:15], v3 offset:20480
    v_cvt_pk_bf16_f32 v76, v36, v37
    v_cvt_pk_bf16_f32 v77, v38, v39
    s_waitcnt lgkmcnt(4)
    s_waitcnt lgkmcnt(3)
    v_mfma_f32_16x16x32_bf16 v[36:39], v[20:23], v[8:11], 0
    s_add_u32 m0, s41, 10240
    s_add_u32 s27, s39, 34816
    buffer_load_dwordx4 v3, s[8:11], s27 offen sc1 lds
    s_waitcnt vmcnt(22)
    ds_read_b128 v[4:7], v63 offset:12288
    ds_read_b128 v[16:19], v3 offset:21504
    v_cvt_pk_bf16_f32 v78, v56, v57
    v_cvt_pk_bf16_f32 v79, v58, v59
    s_waitcnt lgkmcnt(4)
    s_waitcnt lgkmcnt(3)
    v_mfma_f32_16x16x32_bf16 v[56:59], v[24:27], v[44:47], 0
    s_add_u32 m0, s41, 11264
    s_add_u32 s27, s39, 35840
    buffer_load_dwordx4 v3, s[8:11], s27 offen sc1 lds
    s_waitcnt vmcnt(22)
    ds_read_b128 v[8:11], v63 offset:13312
    ds_read_b128 v[20:23], v3 offset:22528
    v_cvt_pk_bf16_f32 v80, v28, v29
    v_cvt_pk_bf16_f32 v81, v30, v31
    s_waitcnt lgkmcnt(4)
    s_waitcnt lgkmcnt(3)
    v_mfma_f32_16x16x32_bf16 v[28:31], v[12:15], v[4:7], 0
    s_add_u32 m0, s41, 12288
    s_add_u32 s27, s39, 36864
    buffer_load_dwordx4 v3, s[8:11], s27 offen sc1 lds
    s_waitcnt vmcnt(22)
    ds_read_b128 v[44:47], v63 offset:14336
    ds_read_b128 v[24:27], v3 offset:23552
    v_cvt_pk_bf16_f32 v82, v32, v33
    v_cvt_pk_bf16_f32 v83, v34, v35
    s_waitcnt lgkmcnt(4)
    s_waitcnt lgkmcnt(3)
    v_mfma_f32_16x16x32_bf16 v[32:35], v[16:19], v[8:11], 0
    s_add_u32 m0, s41, 13312
    s_add_u32 s27, s39, 37888
    buffer_load_dwordx4 v3, s[8:11], s27 offen sc1 lds
    s_waitcnt vmcnt(22)
    ds_read_b128 v[4:7], v63 offset:15360
    ds_read_b128 v[12:15], v3 offset:8192
    v_cvt_pk_bf16_f32 v84, v36, v37
    v_cvt_pk_bf16_f32 v85, v38, v39
    s_waitcnt lgkmcnt(4)
    s_waitcnt lgkmcnt(3)
    v_mfma_f32_16x16x32_bf16 v[36:39], v[20:23], v[44:47], 0
    s_add_u32 m0, s41, 14336
    s_add_u32 s27, s39, 38912
    buffer_load_dwordx4 v3, s[8:11], s27 offen sc1 lds
    s_waitcnt vmcnt(22)
    ds_read_b128 v[8:11], v63 offset:16384
    ds_read_b128 v[16:19], v3 offset:9216
    v_cvt_pk_bf16_f32 v86, v56, v57
    v_cvt_pk_bf16_f32 v87, v58, v59
    s_waitcnt lgkmcnt(4)
    s_waitcnt lgkmcnt(3)
    v_mfma_f32_16x16x32_bf16 v[56:59], v[24:27], v[4:7], 0
    s_add_u32 m0, s41, 15360
    s_add_u32 s27, s39, 39936
    buffer_load_dwordx4 v3, s[8:11], s27 offen sc1 lds
    s_waitcnt vmcnt(22)
    ds_read_b128 v[44:47], v63 offset:17408
    ds_read_b128 v[20:23], v3 offset:10240
    v_cvt_pk_bf16_f32 v88, v28, v29
    v_cvt_pk_bf16_f32 v89, v30, v31
    s_waitcnt lgkmcnt(4)
    s_waitcnt lgkmcnt(3)
    v_mfma_f32_16x16x32_bf16 v[28:31], v[12:15], v[8:11], 0
    s_add_u32 m0, s41, 16384
    s_add_u32 s27, s39, 40960
    buffer_load_dwordx4 v3, s[8:11], s27 offen sc1 lds
    s_waitcnt vmcnt(22)
    ds_read_b128 v[4:7], v63 offset:18432
    ds_read_b128 v[24:27], v3 offset:11264
    v_cvt_pk_bf16_f32 v90, v32, v33
    v_cvt_pk_bf16_f32 v91, v34, v35
    s_waitcnt lgkmcnt(4)
    s_waitcnt lgkmcnt(3)
    v_mfma_f32_16x16x32_bf16 v[32:35], v[16:19], v[44:47], 0
    s_add_u32 m0, s41, 17408
    s_add_u32 s27, s39, 41984
    buffer_load_dwordx4 v3, s[8:11], s27 offen sc1 lds
    s_waitcnt vmcnt(22)
    ds_read_b128 v[8:11], v63 offset:19456
    ds_read_b128 v[12:15], v3 offset:12288
    v_cvt_pk_bf16_f32 v92, v36, v37
    v_cvt_pk_bf16_f32 v93, v38, v39
    s_waitcnt lgkmcnt(4)
    s_waitcnt lgkmcnt(3)
    v_mfma_f32_16x16x32_bf16 v[36:39], v[20:23], v[4:7], 0
    s_add_u32 m0, s41, 18432
    s_add_u32 s27, s39, 43008
    buffer_load_dwordx4 v3, s[8:11], s27 offen sc1 lds
    s_waitcnt vmcnt(22)
    ds_read_b128 v[44:47], v63 offset:20480
    ds_read_b128 v[16:19], v3 offset:13312
    v_cvt_pk_bf16_f32 v94, v56, v57
    v_cvt_pk_bf16_f32 v95, v58, v59
    s_waitcnt lgkmcnt(4)
    s_waitcnt lgkmcnt(3)
    v_mfma_f32_16x16x32_bf16 v[56:59], v[24:27], v[8:11], 0
    s_add_u32 m0, s41, 19456
    s_add_u32 s27, s39, 44032
    buffer_load_dwordx4 v3, s[8:11], s27 offen sc1 lds
    s_waitcnt vmcnt(22)
    ds_read_b128 v[4:7], v63 offset:21504
    ds_read_b128 v[20:23], v3 offset:14336
    v_cvt_pk_bf16_f32 v96, v28, v29
    v_cvt_pk_bf16_f32 v97, v30, v31
    s_waitcnt lgkmcnt(4)
    s_waitcnt lgkmcnt(3)
    v_mfma_f32_16x16x32_bf16 v[28:31], v[12:15], v[44:47], 0
    s_add_u32 m0, s41, 20480
    s_add_u32 s27, s39, 45056
    buffer_load_dwordx4 v3, s[8:11], s27 offen sc1 lds
    s_waitcnt vmcnt(22)
    ds_read_b128 v[8:11], v63 offset:22528
    ds_read_b128 v[24:27], v3 offset:15360
    v_cvt_pk_bf16_f32 v98, v32, v33
    v_cvt_pk_bf16_f32 v99, v34, v35
    s_waitcnt lgkmcnt(4)
    s_waitcnt lgkmcnt(3)
    v_mfma_f32_16x16x32_bf16 v[32:35], v[16:19], v[4:7], 0
    s_add_u32 m0, s41, 21504
    s_add_u32 s27, s39, 46080
    buffer_load_dwordx4 v3, s[8:11], s27 offen sc1 lds
    s_waitcnt vmcnt(22)
    ds_read_b128 v[44:47], v63 offset:23552
    ds_read_b128 v[12:15], v3 offset:16384
    v_cvt_pk_bf16_f32 v100, v36, v37
    v_cvt_pk_bf16_f32 v101, v38, v39
    s_waitcnt lgkmcnt(4)
    s_waitcnt lgkmcnt(3)
    v_mfma_f32_16x16x32_bf16 v[36:39], v[20:23], v[8:11], 0
    s_add_u32 m0, s41, 22528
    s_add_u32 s27, s39, 47104
    buffer_load_dwordx4 v3, s[8:11], s27 offen sc1 lds
    s_waitcnt vmcnt(22)
    ds_read_b128 v[4:7], v63 offset:0
    ds_read_b128 v[16:19], v3 offset:17408
    v_cvt_pk_bf16_f32 v102, v56, v57
    v_cvt_pk_bf16_f32 v103, v58, v59
    s_waitcnt lgkmcnt(4)
    s_waitcnt lgkmcnt(3)
    v_mfma_f32_16x16x32_bf16 v[56:59], v[24:27], v[44:47], 0
    s_add_u32 m0, s41, 23552
    s_add_u32 s27, s39, 48128
    buffer_load_dwordx4 v3, s[8:11], s27 offen sc1 lds
    s_waitcnt vmcnt(22)
    ds_read_b128 v[8:11], v63 offset:1024
    ds_read_b128 v[20:23], v3 offset:18432
    v_cvt_pk_bf16_f32 v104, v28, v29
    v_cvt_pk_bf16_f32 v105, v30, v31
    s_waitcnt lgkmcnt(4)
    s_waitcnt lgkmcnt(3)
    v_mfma_f32_16x16x32_bf16 v[28:31], v[12:15], v[4:7], 0
    s_add_u32 m0, s41, 0
    s_add_u32 s27, s39, 49152
    buffer_load_dwordx4 v3, s[8:11], s27 offen sc1 lds
    s_waitcnt vmcnt(22)
    ds_read_b128 v[44:47], v63 offset:2048
    ds_read_b128 v[24:27], v3 offset:19456
    v_cvt_pk_bf16_f32 v106, v32, v33
    v_cvt_pk_bf16_f32 v107, v34, v35
    s_waitcnt lgkmcnt(4)
    s_waitcnt lgkmcnt(3)
    v_mfma_f32_16x16x32_bf16 v[32:35], v[16:19], v[8:11], 0
    s_add_u32 m0, s41, 1024
    s_add_u32 s27, s39, 50176
    buffer_load_dwordx4 v3, s[8:11], s27 offen sc1 lds
    s_waitcnt vmcnt(22)
    ds_read_b128 v[4:7], v63 offset:3072
    ds_read_b128 v[12:15], v3 offset:20480
    v_cvt_pk_bf16_f32 v108, v36, v37
    v_cvt_pk_bf16_f32 v109, v38, v39
    s_waitcnt lgkmcnt(4)
    s_waitcnt lgkmcnt(3)
    v_mfma_f32_16x16x32_bf16 v[36:39], v[20:23], v[44:47], 0
    s_add_u32 m0, s41, 2048
    s_add_u32 s27, s39, 51200
    buffer_load_dwordx4 v3, s[8:11], s27 offen sc1 lds
    s_waitcnt vmcnt(22)
    ds_read_b128 v[8:11], v63 offset:4096
    ds_read_b128 v[16:19], v3 offset:21504
    v_cvt_pk_bf16_f32 v110, v56, v57
    v_cvt_pk_bf16_f32 v111, v58, v59
    s_waitcnt lgkmcnt(4)
    s_waitcnt lgkmcnt(3)
    v_mfma_f32_16x16x32_bf16 v[56:59], v[24:27], v[4:7], 0
    s_add_u32 m0, s41, 3072
    s_add_u32 s27, s39, 52224
    buffer_load_dwordx4 v3, s[8:11], s27 offen sc1 lds
    s_waitcnt vmcnt(22)
    ds_read_b128 v[44:47], v63 offset:5120
    ds_read_b128 v[20:23], v3 offset:22528
    v_cvt_pk_bf16_f32 v112, v28, v29
    v_cvt_pk_bf16_f32 v113, v30, v31
    s_waitcnt lgkmcnt(4)
    s_waitcnt lgkmcnt(3)
    v_mfma_f32_16x16x32_bf16 v[28:31], v[12:15], v[8:11], 0
    s_add_u32 m0, s41, 4096
    s_add_u32 s27, s39, 53248
    buffer_load_dwordx4 v3, s[8:11], s27 offen sc1 lds
    s_waitcnt vmcnt(22)
    ds_read_b128 v[4:7], v63 offset:6144
    ds_read_b128 v[24:27], v3 offset:23552
    v_cvt_pk_bf16_f32 v114, v32, v33
    v_cvt_pk_bf16_f32 v115, v34, v35
    s_waitcnt lgkmcnt(4)
    s_waitcnt lgkmcnt(3)
    v_mfma_f32_16x16x32_bf16 v[32:35], v[16:19], v[44:47], 0
    s_add_u32 m0, s41, 5120
    s_add_u32 s27, s39, 54272
    buffer_load_dwordx4 v3, s[8:11], s27 offen sc1 lds
    s_waitcnt vmcnt(22)
    ds_read_b128 v[8:11], v63 offset:7168
    ds_read_b128 v[12:15], v3 offset:8192
    v_cvt_pk_bf16_f32 v116, v36, v37
    v_cvt_pk_bf16_f32 v117, v38, v39
    s_waitcnt lgkmcnt(4)
    s_waitcnt lgkmcnt(3)
    v_mfma_f32_16x16x32_bf16 v[36:39], v[20:23], v[4:7], 0
    s_add_u32 m0, s41, 6144
    s_add_u32 s27, s39, 55296
    buffer_load_dwordx4 v3, s[8:11], s27 offen sc1 lds
    s_waitcnt vmcnt(22)
    ds_read_b128 v[44:47], v63 offset:8192
    ds_read_b128 v[16:19], v3 offset:9216
    v_cvt_pk_bf16_f32 v118, v56, v57
    v_cvt_pk_bf16_f32 v119, v58, v59
    s_waitcnt lgkmcnt(4)
    s_waitcnt lgkmcnt(3)
    v_mfma_f32_16x16x32_bf16 v[56:59], v[24:27], v[8:11], 0
    s_add_u32 m0, s41, 7168
    s_add_u32 s27, s39, 56320
    buffer_load_dwordx4 v3, s[8:11], s27 offen sc1 lds
    s_waitcnt vmcnt(22)
    ds_read_b128 v[4:7], v63 offset:9216
    ds_read_b128 v[20:23], v3 offset:10240
    v_cvt_pk_bf16_f32 v120, v28, v29
    v_cvt_pk_bf16_f32 v121, v30, v31
    s_waitcnt lgkmcnt(4)
    s_waitcnt lgkmcnt(3)
    v_mfma_f32_16x16x32_bf16 v[28:31], v[12:15], v[44:47], 0
    s_add_u32 m0, s41, 8192
    s_add_u32 s27, s39, 57344
    buffer_load_dwordx4 v3, s[8:11], s27 offen sc1 lds
    s_waitcnt vmcnt(22)
    ds_read_b128 v[8:11], v63 offset:10240
    ds_read_b128 v[24:27], v3 offset:11264
    v_cvt_pk_bf16_f32 v122, v32, v33
    v_cvt_pk_bf16_f32 v123, v34, v35
    s_waitcnt lgkmcnt(4)
    s_waitcnt lgkmcnt(3)
    v_mfma_f32_16x16x32_bf16 v[32:35], v[16:19], v[4:7], 0
    s_add_u32 m0, s41, 9216
    s_add_u32 s27, s39, 58368
    buffer_load_dwordx4 v3, s[8:11], s27 offen sc1 lds
    s_waitcnt vmcnt(22)
    ds_read_b128 v[44:47], v63 offset:11264
    ds_read_b128 v[12:15], v3 offset:12288
    v_cvt_pk_bf16_f32 v124, v36, v37
    v_cvt_pk_bf16_f32 v125, v38, v39
    s_waitcnt lgkmcnt(4)
    s_waitcnt lgkmcnt(3)
    v_mfma_f32_16x16x32_bf16 v[36:39], v[20:23], v[8:11], 0
    s_add_u32 m0, s41, 10240
    s_add_u32 s27, s39, 59392
    buffer_load_dwordx4 v3, s[8:11], s27 offen sc1 lds
    s_waitcnt vmcnt(22)
    ds_read_b128 v[4:7], v63 offset:12288
    ds_read_b128 v[16:19], v3 offset:13312
    v_cvt_pk_bf16_f32 v126, v56, v57
    v_cvt_pk_bf16_f32 v127, v58, v59
    s_waitcnt lgkmcnt(4)
    s_waitcnt lgkmcnt(3)
    v_mfma_f32_16x16x32_bf16 v[56:59], v[24:27], v[44:47], 0
    s_add_u32 m0, s41, 11264
    s_add_u32 s27, s39, 60416
    buffer_load_dwordx4 v3, s[8:11], s27 offen sc1 lds
    s_waitcnt vmcnt(22)
    ds_read_b128 v[8:11], v63 offset:13312
    ds_read_b128 v[20:23], v3 offset:14336
    v_cvt_pk_bf16_f32 v128, v28, v29
    v_cvt_pk_bf16_f32 v129, v30, v31
    s_waitcnt lgkmcnt(4)
    s_waitcnt lgkmcnt(3)
    v_mfma_f32_16x16x32_bf16 v[28:31], v[12:15], v[4:7], 0
    s_add_u32 m0, s41, 12288
    s_add_u32 s27, s39, 61440
    buffer_load_dwordx4 v3, s[8:11], s27 offen sc1 lds
    s_waitcnt vmcnt(22)
    ds_read_b128 v[44:47], v63 offset:14336
    ds_read_b128 v[24:27], v3 offset:15360
    v_cvt_pk_bf16_f32 v130, v32, v33
    v_cvt_pk_bf16_f32 v131, v34, v35
    s_waitcnt lgkmcnt(4)
    s_waitcnt lgkmcnt(3)
    v_mfma_f32_16x16x32_bf16 v[32:35], v[16:19], v[8:11], 0
    s_add_u32 m0, s41, 13312
    s_add_u32 s27, s39, 62464
    buffer_load_dwordx4 v3, s[8:11], s27 offen sc1 lds
    s_waitcnt vmcnt(22)
    ds_read_b128 v[4:7], v63 offset:15360
    ds_read_b128 v[12:15], v3 offset:16384
    v_cvt_pk_bf16_f32 v132, v36, v37
    v_cvt_pk_bf16_f32 v133, v38, v39
    s_waitcnt lgkmcnt(4)
    s_waitcnt lgkmcnt(3)
    v_mfma_f32_16x16x32_bf16 v[36:39], v[20:23], v[44:47], 0
    s_add_u32 m0, s41, 14336
    s_add_u32 s27, s39, 63488
    buffer_load_dwordx4 v3, s[8:11], s27 offen sc1 lds
    s_waitcnt vmcnt(22)
    ds_read_b128 v[8:11], v63 offset:16384
    ds_read_b128 v[16:19], v3 offset:17408
    v_cvt_pk_bf16_f32 v134, v56, v57
    v_cvt_pk_bf16_f32 v135, v58, v59
    s_waitcnt lgkmcnt(4)
    s_waitcnt lgkmcnt(3)
    v_mfma_f32_16x16x32_bf16 v[56:59], v[24:27], v[4:7], 0
    s_add_u32 m0, s41, 15360
    s_add_u32 s27, s39, 64512
    buffer_load_dwordx4 v3, s[8:11], s27 offen sc1 lds
    s_waitcnt vmcnt(22)
    ds_read_b128 v[44:47], v63 offset:17408
    ds_read_b128 v[20:23], v3 offset:18432
    v_cvt_pk_bf16_f32 v136, v28, v29
    v_cvt_pk_bf16_f32 v137, v30, v31
    s_waitcnt lgkmcnt(4)
    s_waitcnt lgkmcnt(3)
    v_mfma_f32_16x16x32_bf16 v[28:31], v[12:15], v[8:11], 0
    s_add_u32 m0, s41, 16384
    s_add_u32 s27, s39, 65536
    buffer_load_dwordx4 v3, s[8:11], s27 offen sc1 lds
    s_waitcnt vmcnt(22)
    ds_read_b128 v[4:7], v63 offset:18432
    ds_read_b128 v[24:27], v3 offset:19456
    v_cvt_pk_bf16_f32 v138, v32, v33
    v_cvt_pk_bf16_f32 v139, v34, v35
    s_waitcnt lgkmcnt(4)
    s_waitcnt lgkmcnt(3)
    v_mfma_f32_16x16x32_bf16 v[32:35], v[16:19], v[44:47], 0
    s_add_u32 m0, s41, 17408
    s_add_u32 s27, s39, 66560
    buffer_load_dwordx4 v3, s[8:11], s27 offen sc1 lds
    s_waitcnt vmcnt(22)
    ds_read_b128 v[8:11], v63 offset:19456
    ds_read_b128 v[12:15], v3 offset:20480
    v_cvt_pk_bf16_f32 v140, v36, v37
    v_cvt_pk_bf16_f32 v141, v38, v39
    s_waitcnt lgkmcnt(4)
    s_waitcnt lgkmcnt(3)
    v_mfma_f32_16x16x32_bf16 v[36:39], v[20:23], v[4:7], 0
    s_add_u32 m0, s41, 18432
    s_add_u32 s27, s39, 67584
    buffer_load_dwordx4 v3, s[8:11], s27 offen sc1 lds
    s_waitcnt vmcnt(22)
    ds_read_b128 v[44:47], v63 offset:20480
    ds_read_b128 v[16:19], v3 offset:21504
    v_cvt_pk_bf16_f32 v142, v56, v57
    v_cvt_pk_bf16_f32 v143, v58, v59
    s_waitcnt lgkmcnt(4)
    s_waitcnt lgkmcnt(3)
    v_mfma_f32_16x16x32_bf16 v[56:59], v[24:27], v[8:11], 0
    s_add_u32 m0, s41, 19456
    s_add_u32 s27, s39, 68608
    buffer_load_dwordx4 v3, s[8:11], s27 offen sc1 lds
    s_waitcnt vmcnt(22)
    ds_read_b128 v[4:7], v63 offset:21504
    ds_read_b128 v[20:23], v3 offset:22528
    v_cvt_pk_bf16_f32 v144, v28, v29
    v_cvt_pk_bf16_f32 v145, v30, v31
    s_waitcnt lgkmcnt(4)
    s_waitcnt lgkmcnt(3)
    v_mfma_f32_16x16x32_bf16 v[28:31], v[12:15], v[44:47], 0
    s_add_u32 m0, s41, 20480
    s_add_u32 s27, s39, 69632
    buffer_load_dwordx4 v3, s[8:11], s27 offen sc1 lds
    s_waitcnt vmcnt(22)
    ds_read_b128 v[8:11], v63 offset:22528
    ds_read_b128 v[24:27], v3 offset:23552
    v_cvt_pk_bf16_f32 v146, v32, v33
    v_cvt_pk_bf16_f32 v147, v34, v35
    s_waitcnt lgkmcnt(4)
    s_waitcnt lgkmcnt(3)
    v_mfma_f32_16x16x32_bf16 v[32:35], v[16:19], v[4:7], 0
    s_add_u32 m0, s41, 21504
    s_add_u32 s27, s39, 70656
    buffer_load_dwordx4 v3, s[8:11], s27 offen sc1 lds
    s_waitcnt vmcnt(22)
    ds_read_b128 v[44:47], v63 offset:23552
    ds_read_b128 v[12:15], v3 offset:8192
    v_cvt_pk_bf16_f32 v148, v36, v37
    v_cvt_pk_bf16_f32 v149, v38, v39
    s_waitcnt lgkmcnt(4)
    s_waitcnt lgkmcnt(3)
    v_mfma_f32_16x16x32_bf16 v[36:39], v[20:23], v[8:11], 0
    s_add_u32 m0, s41, 22528
    s_add_u32 s27, s39, 71680
    buffer_load_dwordx4 v3, s[8:11], s27 offen sc1 lds
    s_waitcnt vmcnt(22)
    ds_read_b128 v[4:7], v63 offset:0
    ds_read_b128 v[16:19], v3 offset:9216
    v_cvt_pk_bf16_f32 v150, v56, v57
    v_cvt_pk_bf16_f32 v151, v58, v59
    s_waitcnt lgkmcnt(4)
    s_waitcnt lgkmcnt(3)
    v_mfma_f32_16x16x32_bf16 v[56:59], v[24:27], v[44:47], 0
    s_add_u32 m0, s41, 23552
    s_add_u32 s27, s39, 72704
    buffer_load_dwordx4 v3, s[8:11], s27 offen sc1 lds
    s_waitcnt vmcnt(22)
    ds_read_b128 v[8:11], v63 offset:1024
    ds_read_b128 v[20:23], v3 offset:10240
    v_cvt_pk_bf16_f32 v152, v28, v29
    v_cvt_pk_bf16_f32 v153, v30, v31
    s_waitcnt lgkmcnt(4)
    s_waitcnt lgkmcnt(3)
    v_mfma_f32_16x16x32_bf16 v[28:31], v[12:15], v[4:7], 0
    s_add_u32 m0, s41, 0
    s_add_u32 s27, s39, 73728
    buffer_load_dwordx4 v3, s[8:11], s27 offen sc1 lds
    s_waitcnt vmcnt(22)
    ds_read_b128 v[44:47], v63 offset:2048
    ds_read_b128 v[24:27], v3 offset:11264
    v_cvt_pk_bf16_f32 v154, v32, v33
    v_cvt_pk_bf16_f32 v155, v34, v35
    s_waitcnt lgkmcnt(4)
    s_waitcnt lgkmcnt(3)
    v_mfma_f32_16x16x32_bf16 v[32:35], v[16:19], v[8:11], 0
    s_add_u32 m0, s41, 1024
    s_add_u32 s27, s39, 74752
    buffer_load_dwordx4 v3, s[8:11], s27 offen sc1 lds
    s_waitcnt vmcnt(22)
    ds_read_b128 v[4:7], v63 offset:3072
    ds_read_b128 v[12:15], v3 offset:12288
    v_cvt_pk_bf16_f32 v156, v36, v37
    v_cvt_pk_bf16_f32 v157, v38, v39
    s_waitcnt lgkmcnt(4)
    s_waitcnt lgkmcnt(3)
    v_mfma_f32_16x16x32_bf16 v[36:39], v[20:23], v[44:47], 0
    s_add_u32 m0, s41, 2048
    s_add_u32 s27, s39, 75776
    buffer_load_dwordx4 v3, s[8:11], s27 offen sc1 lds
    s_waitcnt vmcnt(22)
    ds_read_b128 v[8:11], v63 offset:4096
    ds_read_b128 v[16:19], v3 offset:13312
    v_cvt_pk_bf16_f32 v158, v56, v57
    v_cvt_pk_bf16_f32 v159, v58, v59
    s_waitcnt lgkmcnt(4)
    s_waitcnt lgkmcnt(3)
    v_mfma_f32_16x16x32_bf16 v[56:59], v[24:27], v[4:7], 0
    s_add_u32 m0, s41, 3072
    s_add_u32 s27, s39, 76800
    buffer_load_dwordx4 v3, s[8:11], s27 offen sc1 lds
    s_waitcnt vmcnt(22)
    ds_read_b128 v[44:47], v63 offset:5120
    ds_read_b128 v[20:23], v3 offset:14336
    v_cvt_pk_bf16_f32 v160, v28, v29
    v_cvt_pk_bf16_f32 v161, v30, v31
    s_waitcnt lgkmcnt(4)
    s_waitcnt lgkmcnt(3)
    v_mfma_f32_16x16x32_bf16 v[28:31], v[12:15], v[8:11], 0
    s_add_u32 m0, s41, 4096
    s_add_u32 s27, s39, 77824
    buffer_load_dwordx4 v3, s[8:11], s27 offen sc1 lds
    s_waitcnt vmcnt(22)
    ds_read_b128 v[4:7], v63 offset:6144
    ds_read_b128 v[24:27], v3 offset:15360
    v_cvt_pk_bf16_f32 v162, v32, v33
    v_cvt_pk_bf16_f32 v163, v34, v35
    s_waitcnt lgkmcnt(4)
    s_waitcnt lgkmcnt(3)
    v_mfma_f32_16x16x32_bf16 v[32:35], v[16:19], v[44:47], 0
    s_add_u32 m0, s41, 5120
    s_add_u32 s27, s39, 78848
    buffer_load_dwordx4 v3, s[8:11], s27 offen sc1 lds
    s_waitcnt vmcnt(22)
    ds_read_b128 v[8:11], v63 offset:7168
    ds_read_b128 v[12:15], v3 offset:16384
    v_cvt_pk_bf16_f32 v164, v36, v37
    v_cvt_pk_bf16_f32 v165, v38, v39
    s_waitcnt lgkmcnt(4)
    s_waitcnt lgkmcnt(3)
    v_mfma_f32_16x16x32_bf16 v[36:39], v[20:23], v[4:7], 0
    s_add_u32 m0, s41, 6144
    s_add_u32 s27, s39, 79872
    buffer_load_dwordx4 v3, s[8:11], s27 offen sc1 lds
    s_waitcnt vmcnt(22)
    ds_read_b128 v[44:47], v63 offset:8192
    ds_read_b128 v[16:19], v3 offset:17408
    v_cvt_pk_bf16_f32 v166, v56, v57
    v_cvt_pk_bf16_f32 v167, v58, v59
    s_waitcnt lgkmcnt(4)
    s_waitcnt lgkmcnt(3)
    v_mfma_f32_16x16x32_bf16 v[56:59], v[24:27], v[8:11], 0
    s_add_u32 m0, s41, 7168
    s_add_u32 s27, s39, 80896
    buffer_load_dwordx4 v3, s[8:11], s27 offen sc1 lds
    s_waitcnt vmcnt(22)
    ds_read_b128 v[4:7], v63 offset:9216
    ds_read_b128 v[20:23], v3 offset:18432
    v_cvt_pk_bf16_f32 v168, v28, v29
    v_cvt_pk_bf16_f32 v169, v30, v31
    s_waitcnt lgkmcnt(4)
    s_waitcnt lgkmcnt(3)
    v_mfma_f32_16x16x32_bf16 v[28:31], v[12:15], v[44:47], 0
    s_add_u32 m0, s41, 8192
    s_add_u32 s27, s39, 81920
    buffer_load_dwordx4 v3, s[8:11], s27 offen sc1 lds
    s_waitcnt vmcnt(22)
    ds_read_b128 v[8:11], v63 offset:10240
    ds_read_b128 v[24:27], v3 offset:19456
    v_cvt_pk_bf16_f32 v170, v32, v33
    v_cvt_pk_bf16_f32 v171, v34, v35
    s_waitcnt lgkmcnt(4)
    s_waitcnt lgkmcnt(3)
    v_mfma_f32_16x16x32_bf16 v[32:35], v[16:19], v[4:7], 0
    s_add_u32 m0, s41, 9216
    s_add_u32 s27, s39, 82944
    buffer_load_dwordx4 v3, s[8:11], s27 offen sc1 lds
    s_waitcnt vmcnt(22)
    ds_read_b128 v[44:47], v63 offset:11264
    ds_read_b128 v[12:15], v3 offset:20480
    v_cvt_pk_bf16_f32 v172, v36, v37
    v_cvt_pk_bf16_f32 v173, v38, v39
    s_waitcnt lgkmcnt(4)
    s_waitcnt lgkmcnt(3)
    v_mfma_f32_16x16x32_bf16 v[36:39], v[20:23], v[8:11], 0
    s_add_u32 m0, s41, 10240
    s_add_u32 s27, s39, 83968
    buffer_load_dwordx4 v3, s[8:11], s27 offen sc1 lds
    s_waitcnt vmcnt(22)
    ds_read_b128 v[4:7], v63 offset:12288
    ds_read_b128 v[16:19], v3 offset:21504
    v_cvt_pk_bf16_f32 v174, v56, v57
    v_cvt_pk_bf16_f32 v175, v58, v59
    s_waitcnt lgkmcnt(4)
    s_waitcnt lgkmcnt(3)
    v_mfma_f32_16x16x32_bf16 v[56:59], v[24:27], v[44:47], 0
    s_add_u32 m0, s41, 11264
    s_add_u32 s27, s39, 84992
    buffer_load_dwordx4 v3, s[8:11], s27 offen sc1 lds
    s_waitcnt vmcnt(22)
    ds_read_b128 v[8:11], v63 offset:13312
    ds_read_b128 v[20:23], v3 offset:22528
    v_cvt_pk_bf16_f32 v176, v28, v29
    v_cvt_pk_bf16_f32 v177, v30, v31
    s_waitcnt lgkmcnt(4)
    s_waitcnt lgkmcnt(3)
    v_mfma_f32_16x16x32_bf16 v[28:31], v[12:15], v[4:7], 0
    s_add_u32 m0, s41, 12288
    s_add_u32 s27, s39, 86016
    buffer_load_dwordx4 v3, s[8:11], s27 offen sc1 lds
    s_waitcnt vmcnt(22)
    ds_read_b128 v[44:47], v63 offset:14336
    ds_read_b128 v[24:27], v3 offset:23552
    v_cvt_pk_bf16_f32 v178, v32, v33
    v_cvt_pk_bf16_f32 v179, v34, v35
    s_waitcnt lgkmcnt(4)
    s_waitcnt lgkmcnt(3)
    v_mfma_f32_16x16x32_bf16 v[32:35], v[16:19], v[8:11], 0
    s_add_u32 m0, s41, 13312
    s_add_u32 s27, s39, 87040
    buffer_load_dwordx4 v3, s[8:11], s27 offen sc1 lds
    s_waitcnt vmcnt(22)
    ds_read_b128 v[4:7], v63 offset:15360
    ds_read_b128 v[12:15], v3 offset:8192
    v_cvt_pk_bf16_f32 v180, v36, v37
    v_cvt_pk_bf16_f32 v181, v38, v39
    s_waitcnt lgkmcnt(4)
    s_waitcnt lgkmcnt(3)
    v_mfma_f32_16x16x32_bf16 v[36:39], v[20:23], v[44:47], 0
    s_add_u32 m0, s41, 14336
    s_add_u32 s27, s39, 88064
    buffer_load_dwordx4 v3, s[8:11], s27 offen sc1 lds
    s_waitcnt vmcnt(22)
    ds_read_b128 v[8:11], v63 offset:16384
    ds_read_b128 v[16:19], v3 offset:9216
    v_cvt_pk_bf16_f32 v182, v56, v57
    v_cvt_pk_bf16_f32 v183, v58, v59
    s_waitcnt lgkmcnt(4)
    s_waitcnt lgkmcnt(3)
    v_mfma_f32_16x16x32_bf16 v[56:59], v[24:27], v[4:7], 0
    s_add_u32 m0, s41, 15360
    s_add_u32 s27, s39, 89088
    buffer_load_dwordx4 v3, s[8:11], s27 offen sc1 lds
    s_waitcnt vmcnt(22)
    ds_read_b128 v[44:47], v63 offset:17408
    ds_read_b128 v[20:23], v3 offset:10240
    v_cvt_pk_bf16_f32 v184, v28, v29
    v_cvt_pk_bf16_f32 v185, v30, v31
    s_waitcnt lgkmcnt(4)
    s_waitcnt lgkmcnt(3)
    v_mfma_f32_16x16x32_bf16 v[28:31], v[12:15], v[8:11], 0
    s_add_u32 m0, s41, 16384
    s_add_u32 s27, s39, 90112
    buffer_load_dwordx4 v3, s[8:11], s27 offen sc1 lds
    s_waitcnt vmcnt(22)
    ds_read_b128 v[4:7], v63 offset:18432
    ds_read_b128 v[24:27], v3 offset:11264
    v_cvt_pk_bf16_f32 v186, v32, v33
    v_cvt_pk_bf16_f32 v187, v34, v35
    s_waitcnt lgkmcnt(4)
    s_waitcnt lgkmcnt(3)
    v_mfma_f32_16x16x32_bf16 v[32:35], v[16:19], v[44:47], 0
    s_add_u32 m0, s41, 17408
    s_add_u32 s27, s39, 91136
    buffer_load_dwordx4 v3, s[8:11], s27 offen sc1 lds
    s_waitcnt vmcnt(22)
    ds_read_b128 v[8:11], v63 offset:19456
    ds_read_b128 v[12:15], v3 offset:12288
    v_cvt_pk_bf16_f32 v188, v36, v37
    v_cvt_pk_bf16_f32 v189, v38, v39
    s_waitcnt lgkmcnt(4)
    s_waitcnt lgkmcnt(3)
    v_mfma_f32_16x16x32_bf16 v[36:39], v[20:23], v[4:7], 0
    s_add_u32 m0, s41, 18432
    s_add_u32 s27, s39, 92160
    buffer_load_dwordx4 v3, s[8:11], s27 offen sc1 lds
    s_waitcnt vmcnt(22)
    ds_read_b128 v[44:47], v63 offset:20480
    ds_read_b128 v[16:19], v3 offset:13312
    v_cvt_pk_bf16_f32 v190, v56, v57
    v_cvt_pk_bf16_f32 v191, v58, v59
    s_waitcnt lgkmcnt(4)
    s_waitcnt lgkmcnt(3)
    v_mfma_f32_16x16x32_bf16 v[56:59], v[24:27], v[8:11], 0
    s_add_u32 m0, s41, 19456
    s_add_u32 s27, s39, 93184
    buffer_load_dwordx4 v3, s[8:11], s27 offen sc1 lds
    s_waitcnt vmcnt(22)
    ds_read_b128 v[4:7], v63 offset:21504
    ds_read_b128 v[20:23], v3 offset:14336
    v_cvt_pk_bf16_f32 v192, v28, v29
    v_cvt_pk_bf16_f32 v193, v30, v31
    s_waitcnt lgkmcnt(4)
    s_waitcnt lgkmcnt(3)
    v_mfma_f32_16x16x32_bf16 v[28:31], v[12:15], v[44:47], 0
    s_add_u32 m0, s41, 20480
    s_add_u32 s27, s39, 94208
    buffer_load_dwordx4 v3, s[8:11], s27 offen sc1 lds
    s_waitcnt vmcnt(22)
    ds_read_b128 v[8:11], v63 offset:22528
    ds_read_b128 v[24:27], v3 offset:15360
    v_cvt_pk_bf16_f32 v194, v32, v33
    v_cvt_pk_bf16_f32 v195, v34, v35
    s_waitcnt lgkmcnt(4)
    s_waitcnt lgkmcnt(3)
    v_mfma_f32_16x16x32_bf16 v[32:35], v[16:19], v[4:7], 0
    s_add_u32 m0, s41, 21504
    s_add_u32 s27, s39, 95232
    buffer_load_dwordx4 v3, s[8:11], s27 offen sc1 lds
    s_waitcnt vmcnt(22)
    ds_read_b128 v[44:47], v63 offset:23552
    ds_read_b128 v[12:15], v3 offset:16384
    v_cvt_pk_bf16_f32 v196, v36, v37
    v_cvt_pk_bf16_f32 v197, v38, v39
    s_waitcnt lgkmcnt(4)
    s_waitcnt lgkmcnt(3)
    v_mfma_f32_16x16x32_bf16 v[36:39], v[20:23], v[8:11], 0
    s_add_u32 m0, s41, 22528
    s_add_u32 s27, s39, 96256
    buffer_load_dwordx4 v3, s[8:11], s27 offen sc1 lds
    s_waitcnt vmcnt(22)
    ds_read_b128 v[4:7], v63 offset:0
    ds_read_b128 v[16:19], v3 offset:17408
    v_cvt_pk_bf16_f32 v198, v56, v57
    v_cvt_pk_bf16_f32 v199, v58, v59
    s_waitcnt lgkmcnt(4)
    s_waitcnt lgkmcnt(3)
    v_mfma_f32_16x16x32_bf16 v[56:59], v[24:27], v[44:47], 0
    s_add_u32 m0, s41, 23552
    s_add_u32 s27, s39, 97280
    buffer_load_dwordx4 v3, s[8:11], s27 offen sc1 lds
    s_waitcnt vmcnt(22)
    ds_read_b128 v[8:11], v63 offset:1024
    ds_read_b128 v[20:23], v3 offset:18432
    v_cvt_pk_bf16_f32 v200, v28, v29
    v_cvt_pk_bf16_f32 v201, v30, v31
    s_waitcnt lgkmcnt(4)
    s_waitcnt lgkmcnt(3)
    v_mfma_f32_16x16x32_bf16 v[28:31], v[12:15], v[4:7], 0
    s_add_u32 m0, s41, 0
    s_add_u32 s27, s39, 98304
    buffer_load_dwordx4 v3, s[8:11], s27 offen sc1 lds
    s_waitcnt vmcnt(22)
    ds_read_b128 v[44:47], v63 offset:2048
    ds_read_b128 v[24:27], v3 offset:19456
    v_cvt_pk_bf16_f32 v202, v32, v33
    v_cvt_pk_bf16_f32 v203, v34, v35
    s_waitcnt lgkmcnt(4)
    s_waitcnt lgkmcnt(3)
    v_mfma_f32_16x16x32_bf16 v[32:35], v[16:19], v[8:11], 0
    s_add_u32 m0, s41, 1024
    s_add_u32 s27, s39, 99328
    buffer_load_dwordx4 v3, s[8:11], s27 offen sc1 lds
    s_waitcnt vmcnt(22)
    ds_read_b128 v[4:7], v63 offset:3072
    ds_read_b128 v[12:15], v3 offset:20480
    v_cvt_pk_bf16_f32 v204, v36, v37
    v_cvt_pk_bf16_f32 v205, v38, v39
    s_waitcnt lgkmcnt(4)
    s_waitcnt lgkmcnt(3)
    v_mfma_f32_16x16x32_bf16 v[36:39], v[20:23], v[44:47], 0
    s_add_u32 m0, s41, 2048
    s_add_u32 s27, s39, 100352
    buffer_load_dwordx4 v3, s[8:11], s27 offen sc1 lds
    s_waitcnt vmcnt(22)
    ds_read_b128 v[8:11], v63 offset:4096
    ds_read_b128 v[16:19], v3 offset:21504
    v_cvt_pk_bf16_f32 v206, v56, v57
    v_cvt_pk_bf16_f32 v207, v58, v59
    s_waitcnt lgkmcnt(4)
    s_waitcnt lgkmcnt(3)
    v_mfma_f32_16x16x32_bf16 v[56:59], v[24:27], v[4:7], 0
    s_add_u32 m0, s41, 3072
    s_add_u32 s27, s39, 101376
    buffer_load_dwordx4 v3, s[8:11], s27 offen sc1 lds
    s_waitcnt vmcnt(22)
    ds_read_b128 v[44:47], v63 offset:5120
    ds_read_b128 v[20:23], v3 offset:22528
    v_cvt_pk_bf16_f32 v208, v28, v29
    v_cvt_pk_bf16_f32 v209, v30, v31
    s_waitcnt lgkmcnt(4)
    s_waitcnt lgkmcnt(3)
    v_mfma_f32_16x16x32_bf16 v[28:31], v[12:15], v[8:11], 0
    s_add_u32 m0, s41, 4096
    s_add_u32 s27, s39, 102400
    buffer_load_dwordx4 v3, s[8:11], s27 offen sc1 lds
    s_waitcnt vmcnt(22)
    ds_read_b128 v[4:7], v63 offset:6144
    ds_read_b128 v[24:27], v3 offset:23552
    v_cvt_pk_bf16_f32 v210, v32, v33
    v_cvt_pk_bf16_f32 v211, v34, v35
    s_waitcnt lgkmcnt(4)
    s_waitcnt lgkmcnt(3)
    v_mfma_f32_16x16x32_bf16 v[32:35], v[16:19], v[44:47], 0
    s_add_u32 m0, s41, 5120
    s_add_u32 s27, s39, 103424
    buffer_load_dwordx4 v3, s[8:11], s27 offen sc1 lds
    s_waitcnt vmcnt(22)
    ds_read_b128 v[8:11], v63 offset:7168
    ds_read_b128 v[12:15], v3 offset:8192
    v_cvt_pk_bf16_f32 v212, v36, v37
    v_cvt_pk_bf16_f32 v213, v38, v39
    s_waitcnt lgkmcnt(4)
    s_waitcnt lgkmcnt(3)
    v_mfma_f32_16x16x32_bf16 v[36:39], v[20:23], v[4:7], 0
    s_add_u32 m0, s41, 6144
    s_add_u32 s27, s39, 104448
    buffer_load_dwordx4 v3, s[8:11], s27 offen sc1 lds
    s_waitcnt vmcnt(22)
    ds_read_b128 v[44:47], v63 offset:8192
    ds_read_b128 v[16:19], v3 offset:9216
    v_cvt_pk_bf16_f32 v214, v56, v57
    v_cvt_pk_bf16_f32 v215, v58, v59
    s_waitcnt lgkmcnt(4)
    s_waitcnt lgkmcnt(3)
    v_mfma_f32_16x16x32_bf16 v[56:59], v[24:27], v[8:11], 0
    s_add_u32 m0, s41, 7168
    s_add_u32 s27, s39, 105472
    buffer_load_dwordx4 v3, s[8:11], s27 offen sc1 lds
    s_waitcnt vmcnt(22)
    ds_read_b128 v[4:7], v63 offset:9216
    ds_read_b128 v[20:23], v3 offset:10240
    v_cvt_pk_bf16_f32 v216, v28, v29
    v_cvt_pk_bf16_f32 v217, v30, v31
    s_waitcnt lgkmcnt(4)
    s_waitcnt lgkmcnt(3)
    v_mfma_f32_16x16x32_bf16 v[28:31], v[12:15], v[44:47], 0
    s_add_u32 m0, s41, 8192
    s_add_u32 s27, s39, 106496
    buffer_load_dwordx4 v3, s[8:11], s27 offen sc1 lds
    s_waitcnt vmcnt(22)
    ds_read_b128 v[8:11], v63 offset:10240
    ds_read_b128 v[24:27], v3 offset:11264
    v_cvt_pk_bf16_f32 v218, v32, v33
    v_cvt_pk_bf16_f32 v219, v34, v35
    s_waitcnt lgkmcnt(4)
    s_waitcnt lgkmcnt(3)
    v_mfma_f32_16x16x32_bf16 v[32:35], v[16:19], v[4:7], 0
    s_add_u32 m0, s41, 9216
    s_add_u32 s27, s39, 107520
    buffer_load_dwordx4 v3, s[8:11], s27 offen sc1 lds
    s_waitcnt vmcnt(22)
    ds_read_b128 v[44:47], v63 offset:11264
    ds_read_b128 v[12:15], v3 offset:12288
    v_cvt_pk_bf16_f32 v220, v36, v37
    v_cvt_pk_bf16_f32 v221, v38, v39
    s_waitcnt lgkmcnt(4)
    s_waitcnt lgkmcnt(3)
    v_mfma_f32_16x16x32_bf16 v[36:39], v[20:23], v[8:11], 0
    s_add_u32 m0, s41, 10240
    s_add_u32 s27, s39, 108544
    buffer_load_dwordx4 v3, s[8:11], s27 offen sc1 lds
    s_waitcnt vmcnt(22)
    ds_read_b128 v[4:7], v63 offset:12288
    ds_read_b128 v[16:19], v3 offset:13312
    v_cvt_pk_bf16_f32 v222, v56, v57
    v_cvt_pk_bf16_f32 v223, v58, v59
    s_waitcnt lgkmcnt(4)
    s_waitcnt lgkmcnt(3)
    v_mfma_f32_16x16x32_bf16 v[56:59], v[24:27], v[44:47], 0
    s_add_u32 m0, s41, 11264
    s_add_u32 s27, s39, 109568
    buffer_load_dwordx4 v3, s[8:11], s27 offen sc1 lds
    s_waitcnt vmcnt(22)
    ds_read_b128 v[8:11], v63 offset:13312
    ds_read_b128 v[20:23], v3 offset:14336
    v_cvt_pk_bf16_f32 v224, v28, v29
    v_cvt_pk_bf16_f32 v225, v30, v31
    s_waitcnt lgkmcnt(4)
    s_waitcnt lgkmcnt(3)
    v_mfma_f32_16x16x32_bf16 v[28:31], v[12:15], v[4:7], 0
    s_add_u32 m0, s41, 12288
    s_add_u32 s27, s39, 110592
    buffer_load_dwordx4 v3, s[8:11], s27 offen sc1 lds
    s_waitcnt vmcnt(22)
    ds_read_b128 v[44:47], v63 offset:14336
    ds_read_b128 v[24:27], v3 offset:15360
    v_cvt_pk_bf16_f32 v226, v32, v33
    v_cvt_pk_bf16_f32 v227, v34, v35
    s_waitcnt lgkmcnt(4)
    s_waitcnt lgkmcnt(3)
    v_mfma_f32_16x16x32_bf16 v[32:35], v[16:19], v[8:11], 0
    s_add_u32 m0, s41, 13312
    s_add_u32 s27, s39, 111616
    buffer_load_dwordx4 v3, s[8:11], s27 offen sc1 lds
    s_waitcnt vmcnt(22)
    ds_read_b128 v[4:7], v63 offset:15360
    ds_read_b128 v[12:15], v3 offset:16384
    v_cvt_pk_bf16_f32 v228, v36, v37
    v_cvt_pk_bf16_f32 v229, v38, v39
    s_waitcnt lgkmcnt(4)
    s_waitcnt lgkmcnt(3)
    v_mfma_f32_16x16x32_bf16 v[36:39], v[20:23], v[44:47], 0
    s_add_u32 m0, s41, 14336
    s_add_u32 s27, s39, 112640
    buffer_load_dwordx4 v3, s[8:11], s27 offen sc1 lds
    s_waitcnt vmcnt(22)
    ds_read_b128 v[8:11], v63 offset:16384
    ds_read_b128 v[16:19], v3 offset:17408
    v_cvt_pk_bf16_f32 v230, v56, v57
    v_cvt_pk_bf16_f32 v231, v58, v59
    s_waitcnt lgkmcnt(4)
    s_waitcnt lgkmcnt(3)
    v_mfma_f32_16x16x32_bf16 v[56:59], v[24:27], v[4:7], 0
    s_add_u32 m0, s41, 15360
    s_add_u32 s27, s39, 113664
    buffer_load_dwordx4 v3, s[8:11], s27 offen sc1 lds
    s_waitcnt vmcnt(22)
    ds_read_b128 v[44:47], v63 offset:17408
    ds_read_b128 v[20:23], v3 offset:18432
    v_cvt_pk_bf16_f32 v232, v28, v29
    v_cvt_pk_bf16_f32 v233, v30, v31
    s_waitcnt lgkmcnt(4)
    s_waitcnt lgkmcnt(3)
    v_mfma_f32_16x16x32_bf16 v[28:31], v[12:15], v[8:11], 0
    s_waitcnt vmcnt(21)
    ds_read_b128 v[4:7], v63 offset:18432
    ds_read_b128 v[24:27], v3 offset:19456
    v_cvt_pk_bf16_f32 v234, v32, v33
    v_cvt_pk_bf16_f32 v235, v34, v35
    s_waitcnt lgkmcnt(4)
    s_waitcnt lgkmcnt(3)
    v_mfma_f32_16x16x32_bf16 v[32:35], v[16:19], v[44:47], 0
    s_waitcnt vmcnt(20)
    ds_read_b128 v[8:11], v63 offset:19456
    ds_read_b128 v[12:15], v3 offset:20480
    v_cvt_pk_bf16_f32 v236, v36, v37
    v_cvt_pk_bf16_f32 v237, v38, v39
    s_waitcnt lgkmcnt(4)
    s_waitcnt lgkmcnt(3)
    v_mfma_f32_16x16x32_bf16 v[36:39], v[20:23], v[4:7], 0
    s_waitcnt vmcnt(19)
    ds_read_b128 v[44:47], v63 offset:20480
    ds_read_b128 v[16:19], v3 offset:21504
    v_cvt_pk_bf16_f32 v238, v56, v57
    v_cvt_pk_bf16_f32 v239, v58, v59
    s_waitcnt lgkmcnt(4)
    s_waitcnt lgkmcnt(3)
    v_mfma_f32_16x16x32_bf16 v[56:59], v[24:27], v[8:11], 0
    s_waitcnt vmcnt(18)
    ds_read_b128 v[4:7], v63 offset:21504
    ds_read_b128 v[20:23], v3 offset:22528
    v_cvt_pk_bf16_f32 v240, v28, v29
    v_cvt_pk_bf16_f32 v241, v30, v31
    s_waitcnt lgkmcnt(4)
    s_waitcnt lgkmcnt(3)
    v_mfma_f32_16x16x32_bf16 v[28:31], v[12:15], v[44:47], 0
    s_waitcnt vmcnt(17)
    ds_read_b128 v[8:11], v63 offset:22528
    ds_read_b128 v[24:27], v3 offset:23552
    v_cvt_pk_bf16_f32 v242, v32, v33
    v_cvt_pk_bf16_f32 v243, v34, v35
    s_waitcnt lgkmcnt(4)
    s_waitcnt lgkmcnt(3)
    v_mfma_f32_16x16x32_bf16 v[32:35], v[16:19], v[4:7], 0
    s_waitcnt vmcnt(16)
    ds_read_b128 v[44:47], v63 offset:23552
    ds_read_b128 v[12:15], v3 offset:8192
    v_cvt_pk_bf16_f32 v244, v36, v37
    v_cvt_pk_bf16_f32 v245, v38, v39
    s_waitcnt lgkmcnt(4)
    s_waitcnt lgkmcnt(3)
    v_mfma_f32_16x16x32_bf16 v[36:39], v[20:23], v[8:11], 0
    s_waitcnt vmcnt(15)
    ds_read_b128 v[4:7], v63 offset:0
    ds_read_b128 v[16:19], v3 offset:9216
    v_cvt_pk_bf16_f32 v246, v56, v57
    v_cvt_pk_bf16_f32 v247, v58, v59
    s_waitcnt lgkmcnt(4)
    s_waitcnt lgkmcnt(3)
    v_mfma_f32_16x16x32_bf16 v[56:59], v[24:27], v[44:47], 0
    s_waitcnt vmcnt(14)
    ds_read_b128 v[8:11], v63 offset:1024
    ds_read_b128 v[20:23], v3 offset:10240
    v_cvt_pk_bf16_f32 v248, v28, v29
    v_cvt_pk_bf16_f32 v249, v30, v31
    s_waitcnt lgkmcnt(4)
    s_waitcnt lgkmcnt(3)
    v_mfma_f32_16x16x32_bf16 v[28:31], v[12:15], v[4:7], 0
    s_waitcnt vmcnt(13)
    ds_read_b128 v[44:47], v63 offset:2048
    ds_read_b128 v[24:27], v3 offset:11264
    v_cvt_pk_bf16_f32 v250, v32, v33
    v_cvt_pk_bf16_f32 v251, v34, v35
    s_waitcnt lgkmcnt(4)
    s_waitcnt lgkmcnt(3)
    v_mfma_f32_16x16x32_bf16 v[32:35], v[16:19], v[8:11], 0
    s_waitcnt vmcnt(12)
    ds_read_b128 v[4:7], v63 offset:3072
    ds_read_b128 v[12:15], v3 offset:12288
    v_cvt_pk_bf16_f32 v252, v36, v37
    v_cvt_pk_bf16_f32 v253, v38, v39
    s_waitcnt lgkmcnt(4)
    s_waitcnt lgkmcnt(3)
    v_mfma_f32_16x16x32_bf16 v[36:39], v[20:23], v[44:47], 0
    s_waitcnt vmcnt(11)
    ds_read_b128 v[8:11], v63 offset:4096
    ds_read_b128 v[16:19], v3 offset:13312
    v_cvt_pk_bf16_f32 v254, v56, v57
    v_cvt_pk_bf16_f32 v255, v58, v59
    s_waitcnt lgkmcnt(4)
    s_waitcnt lgkmcnt(3)
    v_mfma_f32_16x16x32_bf16 v[56:59], v[24:27], v[4:7], 0
    s_waitcnt vmcnt(10)
    ds_read_b128 v[44:47], v63 offset:5120
    ds_read_b128 v[20:23], v3 offset:14336
    v_cvt_pk_bf16_f32 v28, v28, v29
    v_cvt_pk_bf16_f32 v30, v30, v31
    v_accvgpr_write_b32 a224, v28
    v_accvgpr_write_b32 a225, v30
    s_waitcnt lgkmcnt(4)
    s_waitcnt lgkmcnt(3)
    v_mfma_f32_16x16x32_bf16 v[28:31], v[12:15], v[8:11], 0
    s_waitcnt vmcnt(9)
    ds_read_b128 v[4:7], v63 offset:6144
    ds_read_b128 v[24:27], v3 offset:15360
    v_cvt_pk_bf16_f32 v32, v32, v33
    v_cvt_pk_bf16_f32 v34, v34, v35
    v_accvgpr_write_b32 a226, v32
    v_accvgpr_write_b32 a227, v34
    s_waitcnt lgkmcnt(4)
    s_waitcnt lgkmcnt(3)
    v_mfma_f32_16x16x32_bf16 v[32:35], v[16:19], v[44:47], 0
    s_waitcnt vmcnt(8)
    ds_read_b128 v[8:11], v63 offset:7168
    ds_read_b128 v[12:15], v3 offset:16384
    v_cvt_pk_bf16_f32 v36, v36, v37
    v_cvt_pk_bf16_f32 v38, v38, v39
    v_accvgpr_write_b32 a228, v36
    v_accvgpr_write_b32 a229, v38
    s_waitcnt lgkmcnt(4)
    s_waitcnt lgkmcnt(3)
    v_mfma_f32_16x16x32_bf16 v[36:39], v[20:23], v[4:7], 0
    s_waitcnt vmcnt(7)
    ds_read_b128 v[44:47], v63 offset:8192
    ds_read_b128 v[16:19], v3 offset:17408
    v_cvt_pk_bf16_f32 v56, v56, v57
    v_cvt_pk_bf16_f32 v58, v58, v59
    v_accvgpr_write_b32 a230, v56
    v_accvgpr_write_b32 a231, v58
    s_waitcnt lgkmcnt(4)
    s_waitcnt lgkmcnt(3)
    v_mfma_f32_16x16x32_bf16 v[56:59], v[24:27], v[8:11], 0
    s_waitcnt vmcnt(6)
    ds_read_b128 v[4:7], v63 offset:9216
    ds_read_b128 v[20:23], v3 offset:18432
    v_cvt_pk_bf16_f32 v28, v28, v29
    v_cvt_pk_bf16_f32 v30, v30, v31
    v_accvgpr_write_b32 a232, v28
    v_accvgpr_write_b32 a233, v30
    s_waitcnt lgkmcnt(4)
    s_waitcnt lgkmcnt(3)
    v_mfma_f32_16x16x32_bf16 v[28:31], v[12:15], v[44:47], 0
    s_waitcnt vmcnt(5)
    ds_read_b128 v[8:11], v63 offset:10240
    ds_read_b128 v[24:27], v3 offset:19456
    v_cvt_pk_bf16_f32 v32, v32, v33
    v_cvt_pk_bf16_f32 v34, v34, v35
    v_accvgpr_write_b32 a234, v32
    v_accvgpr_write_b32 a235, v34
    s_waitcnt lgkmcnt(4)
    s_waitcnt lgkmcnt(3)
    v_mfma_f32_16x16x32_bf16 v[32:35], v[16:19], v[4:7], 0
    s_waitcnt vmcnt(4)
    ds_read_b128 v[44:47], v63 offset:11264
    ds_read_b128 v[12:15], v3 offset:20480
    v_cvt_pk_bf16_f32 v36, v36, v37
    v_cvt_pk_bf16_f32 v38, v38, v39
    v_accvgpr_write_b32 a236, v36
    v_accvgpr_write_b32 a237, v38
    s_waitcnt lgkmcnt(4)
    s_waitcnt lgkmcnt(3)
    v_mfma_f32_16x16x32_bf16 v[36:39], v[20:23], v[8:11], 0
    s_waitcnt vmcnt(3)
    ds_read_b128 v[4:7], v63 offset:12288
    ds_read_b128 v[16:19], v3 offset:21504
    v_cvt_pk_bf16_f32 v56, v56, v57
    v_cvt_pk_bf16_f32 v58, v58, v59
    v_accvgpr_write_b32 a238, v56
    v_accvgpr_write_b32 a239, v58
    s_waitcnt lgkmcnt(4)
    s_waitcnt lgkmcnt(3)
    v_mfma_f32_16x16x32_bf16 v[56:59], v[24:27], v[44:47], 0
    s_waitcnt vmcnt(2)
    ds_read_b128 v[8:11], v63 offset:13312
    ds_read_b128 v[20:23], v3 offset:22528
    v_cvt_pk_bf16_f32 v28, v28, v29
    v_cvt_pk_bf16_f32 v30, v30, v31
    v_accvgpr_write_b32 a240, v28
    v_accvgpr_write_b32 a241, v30
    s_waitcnt lgkmcnt(4)
    s_waitcnt lgkmcnt(3)
    v_mfma_f32_16x16x32_bf16 v[28:31], v[12:15], v[4:7], 0
    s_waitcnt vmcnt(1)
    ds_read_b128 v[44:47], v63 offset:14336
    ds_read_b128 v[24:27], v3 offset:23552
    v_cvt_pk_bf16_f32 v32, v32, v33
    v_cvt_pk_bf16_f32 v34, v34, v35
    v_accvgpr_write_b32 a242, v32
    v_accvgpr_write_b32 a243, v34
    s_waitcnt lgkmcnt(4)
    s_waitcnt lgkmcnt(3)
    v_mfma_f32_16x16x32_bf16 v[32:35], v[16:19], v[8:11], 0
    s_waitcnt vmcnt(0)
    ds_read_b128 v[4:7], v63 offset:15360
    v_cvt_pk_bf16_f32 v36, v36, v37
    v_cvt_pk_bf16_f32 v38, v38, v39
    v_accvgpr_write_b32 a244, v36
    v_accvgpr_write_b32 a245, v38
    s_waitcnt lgkmcnt(3)
    s_waitcnt lgkmcnt(2)
    v_mfma_f32_16x16x32_bf16 v[36:39], v[20:23], v[44:47], 0
    v_cvt_pk_bf16_f32 v56, v56, v57
    v_cvt_pk_bf16_f32 v58, v58, v59
    v_accvgpr_write_b32 a246, v56
    v_accvgpr_write_b32 a247, v58
    s_waitcnt lgkmcnt(1)
    s_waitcnt lgkmcnt(0)
    v_mfma_f32_16x16x32_bf16 v[56:59], v[24:27], v[4:7], 0
    v_cvt_pk_bf16_f32 v28, v28, v29
    v_cvt_pk_bf16_f32 v30, v30, v31
    v_accvgpr_write_b32 a248, v28
    v_accvgpr_write_b32 a249, v30
    v_cvt_pk_bf16_f32 v32, v32, v33
    v_cvt_pk_bf16_f32 v34, v34, v35
    v_accvgpr_write_b32 a250, v32
    v_accvgpr_write_b32 a251, v34
    v_cvt_pk_bf16_f32 v36, v36, v37
    v_cvt_pk_bf16_f32 v38, v38, v39
    v_accvgpr_write_b32 a252, v36
    v_accvgpr_write_b32 a253, v38
    v_cvt_pk_bf16_f32 v56, v56, v57
    v_cvt_pk_bf16_f32 v58, v58, v59
    v_accvgpr_write_b32 a254, v56
    v_accvgpr_write_b32 a255, v58
    s_nop 7
    v_and_b32 v41, 15, v40
    v_lshrrev_b32 v42, 4, v40
    v_mul_u32_u24 v43, 896, v41
    v_lshl_add_u32 v43, v42, 3, v43
    s_mul_i32 s26, s16, 14336
    s_mul_i32 s27, s17, 224
    s_add_u32 s26, s26, s27
    buffer_load_dwordx2 v[4:5], v43, s[44:47], s26 offen offset:0
    buffer_load_dwordx2 v[6:7], v43, s[44:47], s26 offen offset:32
    buffer_load_dwordx2 v[8:9], v43, s[44:47], s26 offen offset:64
    buffer_load_dwordx2 v[10:11], v43, s[44:47], s26 offen offset:96
    buffer_load_dwordx2 v[56:57], v43, s[44:47], s26 offen offset:128
    buffer_load_dwordx2 v[58:59], v43, s[44:47], s26 offen offset:160
    buffer_load_dwordx2 v[60:61], v43, s[44:47], s26 offen offset:192
    v_and_b32 v44, 1, v41
    v_lshlrev_b32 v44, 4, v44
    v_mov_b32 v45, 0xffff
    v_lshlrev_b32 v45, v44, v45
    v_lshrrev_b32 v44, 1, v41
    v_lshlrev_b32 v46, 1, v42
    v_mov_b32 v47, 0
    v_cmp_eq_u32 vcc, v44, v46
    v_add_u32 v46, 1, v46
    s_nop 0
    v_cndmask_b32 v62, v47, v45, vcc
    v_cmp_eq_u32 vcc, v44, v46
    s_lshl_b32 s21, s36, 13
    s_add_u32 s21, s21, 22151168
    v_cndmask_b32 v63, v47, v45, vcc
    s_waitcnt vmcnt(40)
    s_mov_b32 s40, 23061888
    s_mov_b32 s28, 0
    v_mov_b32 v12, 0
L_wc_196:
    buffer_load_dword v13, v12, s[8:11], s40 offen sc1
L_wcp_198:
    s_add_u32 s28, s28, 1
    s_waitcnt vmcnt(0)
    v_readfirstlane_b32 s26, v13
    s_nop 0
    s_cmp_ge_u32 s26, 98
    s_nop 1
    s_cbranch_scc1 L_wcd_197
    s_sleep 4
    s_cmp_lt_u32 s28, s29
    s_cbranch_scc1 L_wc_196
    s_mov_b32 s29, 1
L_wcd_197:
    s_lshl_b32 s40, s78, 7
    s_add_u32 s40, s40, 23062528
    buffer_load_dword v13, v12, s[8:11], s40 offen sc1
    s_add_u32 s27, s78, 1
    s_waitcnt vmcnt(0)
    v_readfirstlane_b32 s26, v13
    s_nop 0
    s_cmp_eq_u32 s26, 14
    s_cselect_b32 s20, 1, 0
    s_cmp_eq_u32 s27, s18
    s_cselect_b32 s20, s20, 0
    s_cmp_ge_u32 s16, 114
    s_cselect_b32 s20, s20, 0
    s_cmp_eq_u32 s36, 0
    s_cbranch_scc1 A_near_200
    s_sub_u32 s40, s21, 8192
    s_mov_b32 s28, 0
    v_mov_b32 v12, 0
A_far_199:
    buffer_load_dword v13, v12, s[8:11], s40 offen sc1
    s_add_u32 s28, s28, 1
    s_waitcnt vmcnt(0)
    v_cmp_eq_u32 vcc, -1, v13
    s_cbranch_vccz A_near_200
    s_sleep 16
    s_cmp_lt_u32 s28, s29
    s_cbranch_scc1 A_far_199
A_near_200:
    s_mov_b32 s28, 0
L_pm_201:
    buffer_load_dwordx4 v[12:15], v1, s[8:11], s21 offen sc1
    buffer_load_dwordx4 v[16:19], v1, s[8:11], s21 offen offset:768 sc1
    s_add_u32 s28, s28, 1
    s_waitcnt vmcnt(1)
    ds_write_b128 v1, v[12:15]
    v_max3_u32 v20, v12, v13, v14
    s_waitcnt vmcnt(0)
    ds_write_b128 v1, v[16:19] offset:768
    v_max3_u32 v20, v20, v15, v16
    v_max3_u32 v20, v20, v17, v18
    v_max_u32 v20, v20, v19
    v_cmp_eq_u32 vcc, -1, v20
    s_cbranch_vccz L_pmd_202
    s_sleep 1
    s_cmp_lt_u32 s28, s29
    s_cbranch_scc1 L_pm_201
    s_mov_b32 s29, 1
L_pmd_202:
    s_waitcnt lgkmcnt(0)
    s_barrier
    ds_read_b64_tr_b16 v[12:13], v0 offset:0
    ds_read_b64_tr_b16 v[14:15], v0 offset:512
    ds_read_b64_tr_b16 v[16:17], v0 offset:1024
    ds_read_b64_tr_b16 v[18:19], v0 offset:1536
    ds_read_b64_tr_b16 v[20:21], v0 offset:2048
    ds_read_b64_tr_b16 v[22:23], v0 offset:2560
    ds_read_b64_tr_b16 v[24:25], v0 offset:3072
    ds_read_b64_tr_b16 v[26:27], v0 offset:3584
    ds_read_b64_tr_b16 v[28:29], v0 offset:4096
    ds_read_b64_tr_b16 v[30:31], v0 offset:4608
    ds_read_b64_tr_b16 v[32:33], v0 offset:5120
    ds_read_b64_tr_b16 v[34:35], v0 offset:5632
    ds_read_b64_tr_b16 v[36:37], v0 offset:6144
    ds_read_b64_tr_b16 v[38:39], v0 offset:6656
    v_mov_b64 v[40:41], 0
    v_mov_b64 v[42:43], 0
    v_mov_b64 v[44:45], 0
    v_mov_b64 v[46:47], 0
    s_waitcnt lgkmcnt(12)
    v_smfmac_f32_16x16x64_bf16 v[40:43], v[12:15], a[0:7], v2
    v_smfmac_f32_16x16x64_bf16 v[44:47], v[12:15], a[56:63], v2
    s_waitcnt lgkmcnt(10)
    v_smfmac_f32_16x16x64_bf16 v[40:43], v[16:19], a[8:15], v2
    v_smfmac_f32_16x16x64_bf16 v[44:47], v[16:19], a[64:71], v2
    s_waitcnt lgkmcnt(8)
    v_smfmac_f32_16x16x64_bf16 v[40:43], v[20:23], a[16:23], v2
    v_smfmac_f32_16x16x64_bf16 v[44:47], v[20:23], a[72:79], v2
    s_waitcnt lgkmcnt(6)
    v_smfmac_f32_16x16x64_bf16 v[40:43], v[24:27], a[24:31], v2
    v_smfmac_f32_16x16x64_bf16 v[44:47], v[24:27], a[80:87], v2
    s_waitcnt lgkmcnt(4)
    v_smfmac_f32_16x16x64_bf16 v[40:43], v[28:31], a[32:39], v2
    v_smfmac_f32_16x16x64_bf16 v[44:47], v[28:31], a[88:95], v2
    s_waitcnt lgkmcnt(2)
    v_smfmac_f32_16x16x64_bf16 v[40:43], v[32:35], a[40:47], v2
    v_smfmac_f32_16x16x64_bf16 v[44:47], v[32:35], a[96:103], v2
    s_waitcnt lgkmcnt(0)
    v_smfmac_f32_16x16x64_bf16 v[40:43], v[36:39], a[48:55], v2
    v_smfmac_f32_16x16x64_bf16 v[44:47], v[36:39], a[104:111], v2
    s_nop 4
    v_add_f32 v40, v40, v42
    v_add_f32 v41, v41, v43
    v_accvgpr_write_b32 a0, v40
    v_accvgpr_write_b32 a1, v41
    v_add_f32 v44, v44, v46
    v_add_f32 v45, v45, v47
    v_accvgpr_write_b32 a2, v44
    v_accvgpr_write_b32 a3, v45
    v_mov_b64 v[40:41], 0
    v_mov_b64 v[42:43], 0
    v_mov_b64 v[44:45], 0
    v_mov_b64 v[46:47], 0
    v_smfmac_f32_16x16x64_bf16 v[40:43], v[12:15], a[112:119], v2
    s_nop 0
    v_smfmac_f32_16x16x64_bf16 v[44:47], v[12:15], a[168:175], v2
    v_smfmac_f32_16x16x64_bf16 v[40:43], v[16:19], a[120:127], v2
    v_smfmac_f32_16x16x64_bf16 v[44:47], v[16:19], a[176:183], v2
    v_smfmac_f32_16x16x64_bf16 v[40:43], v[20:23], a[128:135], v2
    v_smfmac_f32_16x16x64_bf16 v[44:47], v[20:23], a[184:191], v2
    v_smfmac_f32_16x16x64_bf16 v[40:43], v[24:27], a[136:143], v2
    v_smfmac_f32_16x16x64_bf16 v[44:47], v[24:27], a[192:199], v2
    v_smfmac_f32_16x16x64_bf16 v[40:43], v[28:31], a[144:151], v2
    v_smfmac_f32_16x16x64_bf16 v[44:47], v[28:31], a[200:207], v2
    v_smfmac_f32_16x16x64_bf16 v[40:43], v[32:35], a[152:159], v2
    v_smfmac_f32_16x16x64_bf16 v[44:47], v[32:35], a[208:215], v2
    v_smfmac_f32_16x16x64_bf16 v[40:43], v[36:39], a[160:167], v2
    v_smfmac_f32_16x16x64_bf16 v[44:47], v[36:39], a[216:223], v2
    s_nop 4
    v_add_f32 v16, v40, v42
    v_add_f32 v17, v41, v43
    s_nop 0
    v_add_f32 v18, v44, v46
    v_add_f32 v19, v45, v47
    v_accvgpr_read_b32 v12, a0
    v_accvgpr_read_b32 v13, a1
    v_accvgpr_read_b32 v14, a2
    v_accvgpr_read_b32 v15, a3
    s_mul_i32 s40, s36, 114688
    s_mul_i32 s41, s17, 28672
    s_add_u32 s40, s40, s41
    s_add_u32 s40, s40, 29360128
    v_min_u32 v1, 432, v3
    v_lshlrev_b32 v1, 6, v1
    buffer_load_dword v1, v1, s[8:11], s40 offen sc1
    v_max3_f32 v20, v12, v13, v48
    v_max3_f32 v21, v14, v15, v49
    v_max3_f32 v22, v16, v17, v50
    v_max3_f32 v23, v18, v19, v51
    v_mov_b32 v24, v20
    v_mov_b32 v25, v21
    v_mov_b32 v26, v22
    v_mov_b32 v27, v23
    v_permlane16_swap_b32 v20, v24
    v_permlane16_swap_b32 v21, v25
    v_permlane16_swap_b32 v22, v26
    v_permlane16_swap_b32 v23, v27
    v_max_f32 v20, v20, v24
    v_max_f32 v21, v21, v25
    v_max_f32 v22, v22, v26
    v_max_f32 v23, v23, v27
    v_mov_b32 v24, v20
    v_mov_b32 v25, v21
    v_mov_b32 v26, v22
    v_mov_b32 v27, v23
    v_permlane32_swap_b32 v20, v24
    v_permlane32_swap_b32 v21, v25
    v_permlane32_swap_b32 v22, v26
    v_permlane32_swap_b32 v23, v27
    v_max_f32 v20, v20, v24
    v_max_f32 v21, v21, v25
    v_max_f32 v22, v22, v26
    v_max_f32 v23, v23, v27
    v_sub_f32 v12, v12, v20
    v_sub_f32 v13, v13, v20
    v_sub_f32 v28, v48, v20
    v_sub_f32 v14, v14, v21
    v_sub_f32 v15, v15, v21
    v_sub_f32 v29, v49, v21
    v_sub_f32 v16, v16, v22
    v_sub_f32 v17, v17, v22
    v_sub_f32 v30, v50, v22
    v_sub_f32 v18, v18, v23
    v_sub_f32 v19, v19, v23
    v_sub_f32 v31, v51, v23
    v_exp_f32 v12, v12
    v_exp_f32 v13, v13
    v_exp_f32 v28, v28
    v_exp_f32 v14, v14
    v_exp_f32 v15, v15
    v_exp_f32 v29, v29
    v_exp_f32 v16, v16
    v_exp_f32 v17, v17
    v_exp_f32 v30, v30
    v_exp_f32 v18, v18
    v_exp_f32 v19, v19
    v_exp_f32 v31, v31
    v_add_f32 v32, v12, v13
    v_add_f32 v33, v14, v15
    v_add_f32 v34, v16, v17
    v_add_f32 v35, v18, v19
    v_mov_b32 v24, v32
    v_mov_b32 v25, v33
    v_mov_b32 v26, v34
    v_mov_b32 v27, v35
    v_permlane16_swap_b32 v32, v24
    v_permlane16_swap_b32 v33, v25
    v_permlane16_swap_b32 v34, v26
    v_permlane16_swap_b32 v35, v27
    v_add_f32 v32, v32, v24
    v_add_f32 v33, v33, v25
    v_add_f32 v34, v34, v26
    v_add_f32 v35, v35, v27
    v_mov_b32 v24, v32
    v_mov_b32 v25, v33
    v_mov_b32 v26, v34
    v_mov_b32 v27, v35
    v_permlane32_swap_b32 v32, v24
    v_permlane32_swap_b32 v33, v25
    v_permlane32_swap_b32 v34, v26
    v_permlane32_swap_b32 v35, v27
    v_add_f32 v32, v32, v24
    v_add_f32 v33, v33, v25
    v_add_f32 v34, v34, v26
    v_add_f32 v35, v35, v27
    v_fmac_f32 v32, v28, v52
    v_fmac_f32 v33, v29, v53
    v_fmac_f32 v34, v30, v54
    v_fmac_f32 v35, v31, v55
    v_rcp_f32 v32, v32
    v_rcp_f32 v33, v33
    v_rcp_f32 v34, v34
    v_rcp_f32 v35, v35
    v_mul_f32 v12, v12, v32
    v_mul_f32 v13, v13, v32
    v_mul_f32 v28, v28, v32
    v_mul_f32 v14, v14, v33
    v_mul_f32 v15, v15, v33
    v_mul_f32 v29, v29, v33
    v_mul_f32 v16, v16, v34
    v_mul_f32 v17, v17, v34
    v_mul_f32 v30, v30, v34
    v_mul_f32 v18, v18, v35
    v_mul_f32 v19, v19, v35
    v_mul_f32 v31, v31, v35
    v_cvt_pk_bf16_f32 v36, v12, v13
    v_cvt_pk_bf16_f32 v28, v28, v28
    v_cvt_pk_bf16_f32 v37, v14, v15
    v_cvt_pk_bf16_f32 v29, v29, v29
    v_cvt_pk_bf16_f32 v38, v16, v17
    v_cvt_pk_bf16_f32 v30, v30, v30
    v_cvt_pk_bf16_f32 v39, v18, v19
    v_cvt_pk_bf16_f32 v31, v31, v31
    v_and_b32 v40, v28, v62
    v_and_b32 v41, v28, v63
    v_and_b32 v42, v29, v62
    v_and_b32 v43, v29, v63
    v_and_b32 v44, v30, v62
    v_and_b32 v45, v30, v63
    v_and_b32 v46, v31, v62
    v_and_b32 v47, v31, v63
    s_mul_i32 s26, s17, 3072
    v_add_u32 v20, s26, v3
    ds_write_b128 v20, v[40:43] offset:8192
    ds_write_b128 v20, v[44:47] offset:9216
    ds_write_b128 v20, v[36:39] offset:10240
    s_waitcnt vmcnt(0) lgkmcnt(0)
    s_barrier
    s_mul_i32 s40, s36, 114688
    s_mul_i32 s41, s17, 28672
    s_add_u32 s40, s40, s41
    s_add_u32 s40, s40, 29360128
    s_mov_b32 s39, 0
    s_mov_b32 s28, 0
    v_min_u32 v40, 432, v3
    v_lshlrev_b32 v40, 6, v40
    v_mov_b32 v41, v1
    ds_read_b128 a[128:131], v3 offset:8192
    ds_read_b128 a[132:135], v3 offset:9216
    ds_read_b128 a[136:139], v3 offset:10240
    ds_read_b128 a[140:143], v3 offset:11264
    ds_read_b128 a[144:147], v3 offset:12288
    ds_read_b128 a[148:151], v3 offset:13312
    ds_read_b128 a[152:155], v3 offset:14336
    ds_read_b128 a[156:159], v3 offset:15360
    ds_read_b128 a[160:163], v3 offset:16384
    ds_read_b128 a[164:167], v3 offset:17408
    ds_read_b128 a[168:171], v3 offset:18432
    ds_read_b128 a[172:175], v3 offset:19456
    v_cmp_eq_u32 vcc, -1, v41
    s_cbranch_vccz A_vg_205
    s_mov_b32 s28, 0
    buffer_load_dword v41, v40, s[8:11], s40 offen offset:0 sc1
    s_nop 15
    buffer_load_dword v42, v40, s[8:11], s40 offen offset:0 sc1
    s_nop 15
L_h_207:
    buffer_load_dword v43, v40, s[8:11], s40 offen offset:0 sc1
    s_waitcnt vmcnt(2)
    v_cmp_eq_u32 vcc, -1, v41
    s_cbranch_vccz L_hd_208
    s_nop 15
    buffer_load_dword v41, v40, s[8:11], s40 offen offset:0 sc1
    s_waitcnt vmcnt(2)
    v_cmp_eq_u32 vcc, -1, v42
    s_cbranch_vccz L_hd_208
    s_nop 15
    buffer_load_dword v42, v40, s[8:11], s40 offen offset:0 sc1
    s_waitcnt vmcnt(2)
    v_cmp_eq_u32 vcc, -1, v43
    s_cbranch_vccz L_hd_208
    s_nop 15
    s_add_u32 s28, s28, 1
    s_cmp_lt_u32 s28, s29
    s_cbranch_scc1 L_h_207
L_hd_208:
A_vg_205:
    s_mov_b32 s28, 0
    s_mov_b32 s41, s40
    buffer_load_dwordx4 a[8:11], v3, s[8:11], s41 offen offset:0 sc1
    buffer_load_dwordx4 a[12:15], v3, s[8:11], s41 offen offset:1024 sc1
    buffer_load_dwordx4 a[16:19], v3, s[8:11], s41 offen offset:2048 sc1
    buffer_load_dwordx4 a[20:23], v3, s[8:11], s41 offen offset:3072 sc1
    s_add_u32 s41, s41, 4096
    buffer_load_dwordx4 a[24:27], v3, s[8:11], s41 offen offset:0 sc1
    buffer_load_dwordx4 a[28:31], v3, s[8:11], s41 offen offset:1024 sc1
    s_waitcnt lgkmcnt(0)
    v_mfma_f32_16x16x32_bf16 v[12:15], v[64:67], a[128:131], 0
    v_mfma_f32_16x16x32_bf16 v[16:19], v[96:99], a[128:131], 0
    v_mfma_f32_16x16x32_bf16 v[20:23], v[128:131], a[128:131], 0
    v_mfma_f32_16x16x32_bf16 v[24:27], v[160:163], a[128:131], 0
    buffer_load_dwordx4 a[32:35], v3, s[8:11], s41 offen offset:2048 sc1
    v_mfma_f32_16x16x32_bf16 v[28:31], v[192:195], a[128:131], 0
    v_mfma_f32_16x16x32_bf16 v[32:35], v[224:227], a[128:131], 0
    v_mfma_f32_16x16x32_bf16 v[36:39], a[224:227], a[128:131], 0
    v_mfma_f32_16x16x32_bf16 v[12:15], v[68:71], a[132:135], v[12:15]
    buffer_load_dwordx4 a[36:39], v3, s[8:11], s41 offen offset:3072 sc1
    v_mfma_f32_16x16x32_bf16 v[16:19], v[100:103], a[132:135], v[16:19]
    v_mfma_f32_16x16x32_bf16 v[20:23], v[132:135], a[132:135], v[20:23]
    v_mfma_f32_16x16x32_bf16 v[24:27], v[164:167], a[132:135], v[24:27]
    v_mfma_f32_16x16x32_bf16 v[28:31], v[196:199], a[132:135], v[28:31]
    s_add_u32 s41, s41, 4096
    buffer_load_dwordx4 a[40:43], v3, s[8:11], s41 offen offset:0 sc1
    v_mfma_f32_16x16x32_bf16 v[32:35], v[228:231], a[132:135], v[32:35]
    v_mfma_f32_16x16x32_bf16 v[36:39], a[228:231], a[132:135], v[36:39]
    v_mfma_f32_16x16x32_bf16 v[12:15], v[72:75], a[140:143], v[12:15]
    v_mfma_f32_16x16x32_bf16 v[16:19], v[104:107], a[140:143], v[16:19]
    buffer_load_dwordx4 a[44:47], v3, s[8:11], s41 offen offset:1024 sc1
    v_mfma_f32_16x16x32_bf16 v[20:23], v[136:139], a[140:143], v[20:23]
    v_mfma_f32_16x16x32_bf16 v[24:27], v[168:171], a[140:143], v[24:27]
    v_mfma_f32_16x16x32_bf16 v[28:31], v[200:203], a[140:143], v[28:31]
    v_mfma_f32_16x16x32_bf16 v[32:35], v[232:235], a[140:143], v[32:35]
    buffer_load_dwordx4 a[48:51], v3, s[8:11], s41 offen offset:2048 sc1
    v_mfma_f32_16x16x32_bf16 v[36:39], a[232:235], a[140:143], v[36:39]
    v_mfma_f32_16x16x32_bf16 v[12:15], v[76:79], a[144:147], v[12:15]
    v_mfma_f32_16x16x32_bf16 v[16:19], v[108:111], a[144:147], v[16:19]
    v_mfma_f32_16x16x32_bf16 v[20:23], v[140:143], a[144:147], v[20:23]
    buffer_load_dwordx4 a[52:55], v3, s[8:11], s41 offen offset:3072 sc1
    v_mfma_f32_16x16x32_bf16 v[24:27], v[172:175], a[144:147], v[24:27]
    v_mfma_f32_16x16x32_bf16 v[28:31], v[204:207], a[144:147], v[28:31]
    v_mfma_f32_16x16x32_bf16 v[32:35], v[236:239], a[144:147], v[32:35]
    v_mfma_f32_16x16x32_bf16 v[36:39], a[236:239], a[144:147], v[36:39]
    s_add_u32 s41, s41, 4096
    buffer_load_dwordx4 a[56:59], v3, s[8:11], s41 offen offset:0 sc1
    v_mfma_f32_16x16x32_bf16 v[12:15], v[80:83], a[152:155], v[12:15]
    v_mfma_f32_16x16x32_bf16 v[16:19], v[112:115], a[152:155], v[16:19]
    v_mfma_f32_16x16x32_bf16 v[20:23], v[144:147], a[152:155], v[20:23]
    v_mfma_f32_16x16x32_bf16 v[24:27], v[176:179], a[152:155], v[24:27]
    buffer_load_dwordx4 a[60:63], v3, s[8:11], s41 offen offset:1024 sc1
    v_mfma_f32_16x16x32_bf16 v[28:31], v[208:211], a[152:155], v[28:31]
    v_mfma_f32_16x16x32_bf16 v[32:35], v[240:243], a[152:155], v[32:35]
    v_mfma_f32_16x16x32_bf16 v[36:39], a[240:243], a[152:155], v[36:39]
    v_mfma_f32_16x16x32_bf16 v[12:15], v[84:87], a[156:159], v[12:15]
    buffer_load_dwordx4 a[64:67], v3, s[8:11], s41 offen offset:2048 sc1
    v_mfma_f32_16x16x32_bf16 v[16:19], v[116:119], a[156:159], v[16:19]
    v_mfma_f32_16x16x32_bf16 v[20:23], v[148:151], a[156:159], v[20:23]
    v_mfma_f32_16x16x32_bf16 v[24:27], v[180:183], a[156:159], v[24:27]
    v_mfma_f32_16x16x32_bf16 v[28:31], v[212:215], a[156:159], v[28:31]
    buffer_load_dwordx4 a[68:71], v3, s[8:11], s41 offen offset:3072 sc1
    v_mfma_f32_16x16x32_bf16 v[32:35], v[244:247], a[156:159], v[32:35]
    v_mfma_f32_16x16x32_bf16 v[36:39], a[244:247], a[156:159], v[36:39]
    v_mfma_f32_16x16x32_bf16 v[12:15], v[88:91], a[164:167], v[12:15]
    v_mfma_f32_16x16x32_bf16 v[16:19], v[120:123], a[164:167], v[16:19]
    s_add_u32 s41, s41, 4096
    buffer_load_dwordx4 a[72:75], v3, s[8:11], s41 offen offset:0 sc1
    v_mfma_f32_16x16x32_bf16 v[20:23], v[152:155], a[164:167], v[20:23]
    v_mfma_f32_16x16x32_bf16 v[24:27], v[184:187], a[164:167], v[24:27]
    v_mfma_f32_16x16x32_bf16 v[28:31], v[216:219], a[164:167], v[28:31]
    v_mfma_f32_16x16x32_bf16 v[32:35], v[248:251], a[164:167], v[32:35]
    buffer_load_dwordx4 a[76:79], v3, s[8:11], s41 offen offset:1024 sc1
    v_mfma_f32_16x16x32_bf16 v[36:39], a[248:251], a[164:167], v[36:39]
    v_mfma_f32_16x16x32_bf16 v[12:15], v[92:95], a[168:171], v[12:15]
    v_mfma_f32_16x16x32_bf16 v[16:19], v[124:127], a[168:171], v[16:19]
    v_mfma_f32_16x16x32_bf16 v[20:23], v[156:159], a[168:171], v[20:23]
    buffer_load_dwordx4 a[80:83], v3, s[8:11], s41 offen offset:2048 sc1
    v_mfma_f32_16x16x32_bf16 v[24:27], v[188:191], a[168:171], v[24:27]
    v_mfma_f32_16x16x32_bf16 v[28:31], v[220:223], a[168:171], v[28:31]
    v_mfma_f32_16x16x32_bf16 v[32:35], v[252:255], a[168:171], v[32:35]
    v_mfma_f32_16x16x32_bf16 v[36:39], a[252:255], a[168:171], v[36:39]
    buffer_load_dwordx4 a[84:87], v3, s[8:11], s41 offen offset:3072 sc1
    s_add_u32 s41, s41, 4096
    buffer_load_dwordx4 a[88:91], v3, s[8:11], s41 offen offset:0 sc1
    buffer_load_dwordx4 a[92:95], v3, s[8:11], s41 offen offset:1024 sc1
    buffer_load_dwordx4 a[96:99], v3, s[8:11], s41 offen offset:2048 sc1
    buffer_load_dwordx4 a[100:103], v3, s[8:11], s41 offen offset:3072 sc1
    s_add_u32 s41, s41, 4096
    buffer_load_dwordx4 a[104:107], v3, s[8:11], s41 offen offset:0 sc1
    buffer_load_dwordx4 a[108:111], v3, s[8:11], s41 offen offset:1024 sc1
    buffer_load_dwordx4 a[112:115], v3, s[8:11], s41 offen offset:2048 sc1
    buffer_load_dwordx4 a[116:119], v3, s[8:11], s41 offen offset:3072 sc1
A_vr_206:
    s_add_u32 s28, s28, 1
    s_waitcnt vmcnt(24)
    v_mfma_f32_16x16x32_bf16 v[240:243], a[8:11], a[136:139], v[12:15]
    v_accvgpr_read_b32 v44, a8
    v_mfma_f32_16x16x32_bf16 v[240:243], a[12:15], a[148:151], v[240:243]
    v_accvgpr_read_b32 v45, a12
    v_mfma_f32_16x16x32_bf16 v[240:243], a[16:19], a[160:163], v[240:243]
    v_accvgpr_read_b32 v46, a16
    v_mfma_f32_16x16x32_bf16 v[240:243], a[20:23], a[172:175], v[240:243]
    v_accvgpr_read_b32 v47, a20
    v_max_u32 v43, v44, v45
    v_max3_u32 v43, v43, v46, v47
    s_waitcnt vmcnt(20)
    v_mfma_f32_16x16x32_bf16 v[244:247], a[24:27], a[136:139], v[16:19]
    v_accvgpr_read_b32 v44, a24
    v_mfma_f32_16x16x32_bf16 v[244:247], a[28:31], a[148:151], v[244:247]
    v_accvgpr_read_b32 v45, a28
    v_mfma_f32_16x16x32_bf16 v[244:247], a[32:35], a[160:163], v[244:247]
    v_accvgpr_read_b32 v46, a32
    v_mfma_f32_16x16x32_bf16 v[244:247], a[36:39], a[172:175], v[244:247]
    v_accvgpr_read_b32 v47, a36
    v_max3_u32 v43, v43, v44, v45
    v_max3_u32 v43, v43, v46, v47
    v_cvt_pk_bf16_f32 v240, v240, v241
    v_and_b32 v241, 0xffff0000, v240
    v_lshlrev_b32 v240, 16, v240
    v_lshlrev_b32 v80, 16, v4
    v_and_b32 v81, 0xffff0000, v4
    v_pk_add_f32 v[240:241], v[240:241], v[80:81]
    v_cvt_pk_bf16_f32 v64, v240, v241
    v_lshlrev_b32 v80, 16, v64
    v_and_b32 v81, 0xffff0000, v64
    v_cvt_pk_bf16_f32 v242, v242, v243
    v_and_b32 v243, 0xffff0000, v242
    v_lshlrev_b32 v242, 16, v242
    v_lshlrev_b32 v82, 16, v5
    v_and_b32 v83, 0xffff0000, v5
    v_pk_add_f32 v[242:243], v[242:243], v[82:83]
    v_cvt_pk_bf16_f32 v65, v242, v243
    v_lshlrev_b32 v82, 16, v65
    v_and_b32 v83, 0xffff0000, v65
    s_waitcnt vmcnt(16)
    v_mfma_f32_16x16x32_bf16 v[240:243], a[40:43], a[136:139], v[20:23]
    v_accvgpr_read_b32 v44, a40
    v_mfma_f32_16x16x32_bf16 v[240:243], a[44:47], a[148:151], v[240:243]
    v_accvgpr_read_b32 v45, a44
    v_mfma_f32_16x16x32_bf16 v[240:243], a[48:51], a[160:163], v[240:243]
    v_accvgpr_read_b32 v46, a48
    v_mfma_f32_16x16x32_bf16 v[240:243], a[52:55], a[172:175], v[240:243]
    v_accvgpr_read_b32 v47, a52
    v_max3_u32 v43, v43, v44, v45
    v_max3_u32 v43, v43, v46, v47
    v_cvt_pk_bf16_f32 v244, v244, v245
    v_and_b32 v245, 0xffff0000, v244
    v_lshlrev_b32 v244, 16, v244
    v_lshlrev_b32 v84, 16, v6
    v_and_b32 v85, 0xffff0000, v6
    v_pk_add_f32 v[244:245], v[244:245], v[84:85]
    v_cvt_pk_bf16_f32 v66, v244, v245
    v_lshlrev_b32 v84, 16, v66
    v_and_b32 v85, 0xffff0000, v66
    v_cvt_pk_bf16_f32 v246, v246, v247
    v_and_b32 v247, 0xffff0000, v246
    v_lshlrev_b32 v246, 16, v246
    v_lshlrev_b32 v86, 16, v7
    v_and_b32 v87, 0xffff0000, v7
    v_pk_add_f32 v[246:247], v[246:247], v[86:87]
    v_cvt_pk_bf16_f32 v67, v246, v247
    v_lshlrev_b32 v86, 16, v67
    v_and_b32 v87, 0xffff0000, v67
    s_waitcnt vmcnt(12)
    v_mfma_f32_16x16x32_bf16 v[244:247], a[56:59], a[136:139], v[24:27]
    v_accvgpr_read_b32 v44, a56
    v_mfma_f32_16x16x32_bf16 v[244:247], a[60:63], a[148:151], v[244:247]
    v_accvgpr_read_b32 v45, a60
    v_mfma_f32_16x16x32_bf16 v[244:247], a[64:67], a[160:163], v[244:247]
    v_accvgpr_read_b32 v46, a64
    v_mfma_f32_16x16x32_bf16 v[244:247], a[68:71], a[172:175], v[244:247]
    v_accvgpr_read_b32 v47, a68
    v_max3_u32 v43, v43, v44, v45
    v_max3_u32 v43, v43, v46, v47
    v_cvt_pk_bf16_f32 v240, v240, v241
    v_and_b32 v241, 0xffff0000, v240
    v_lshlrev_b32 v240, 16, v240
    v_lshlrev_b32 v88, 16, v8
    v_and_b32 v89, 0xffff0000, v8
    v_pk_add_f32 v[240:241], v[240:241], v[88:89]
    v_cvt_pk_bf16_f32 v68, v240, v241
    v_lshlrev_b32 v88, 16, v68
    v_and_b32 v89, 0xffff0000, v68
    v_cvt_pk_bf16_f32 v242, v242, v243
    v_and_b32 v243, 0xffff0000, v242
    v_lshlrev_b32 v242, 16, v242
    v_lshlrev_b32 v90, 16, v9
    v_and_b32 v91, 0xffff0000, v9
    v_pk_add_f32 v[242:243], v[242:243], v[90:91]
    v_cvt_pk_bf16_f32 v69, v242, v243
    v_lshlrev_b32 v90, 16, v69
    v_and_b32 v91, 0xffff0000, v69
    s_waitcnt vmcnt(8)
    v_mfma_f32_16x16x32_bf16 v[240:243], a[72:75], a[136:139], v[28:31]
    v_accvgpr_read_b32 v44, a72
    v_mfma_f32_16x16x32_bf16 v[240:243], a[76:79], a[148:151], v[240:243]
    v_accvgpr_read_b32 v45, a76
    v_mfma_f32_16x16x32_bf16 v[240:243], a[80:83], a[160:163], v[240:243]
    v_accvgpr_read_b32 v46, a80
    v_mfma_f32_16x16x32_bf16 v[240:243], a[84:87], a[172:175], v[240:243]
    v_accvgpr_read_b32 v47, a84
    v_max3_u32 v43, v43, v44, v45
    v_max3_u32 v43, v43, v46, v47
    v_cvt_pk_bf16_f32 v244, v244, v245
    v_and_b32 v245, 0xffff0000, v244
    v_lshlrev_b32 v244, 16, v244
    v_lshlrev_b32 v92, 16, v10
    v_and_b32 v93, 0xffff0000, v10
    v_pk_add_f32 v[244:245], v[244:245], v[92:93]
    v_cvt_pk_bf16_f32 v70, v244, v245
    v_lshlrev_b32 v92, 16, v70
    v_and_b32 v93, 0xffff0000, v70
    v_cvt_pk_bf16_f32 v246, v246, v247
    v_and_b32 v247, 0xffff0000, v246
    v_lshlrev_b32 v246, 16, v246
    v_lshlrev_b32 v94, 16, v11
    v_and_b32 v95, 0xffff0000, v11
    v_pk_add_f32 v[246:247], v[246:247], v[94:95]
    v_cvt_pk_bf16_f32 v71, v246, v247
    v_lshlrev_b32 v94, 16, v71
    v_and_b32 v95, 0xffff0000, v71
    s_waitcnt vmcnt(4)
    v_mfma_f32_16x16x32_bf16 v[244:247], a[88:91], a[136:139], v[32:35]
    v_accvgpr_read_b32 v44, a88
    v_mfma_f32_16x16x32_bf16 v[244:247], a[92:95], a[148:151], v[244:247]
    v_accvgpr_read_b32 v45, a92
    v_mfma_f32_16x16x32_bf16 v[244:247], a[96:99], a[160:163], v[244:247]
    v_accvgpr_read_b32 v46, a96
    v_mfma_f32_16x16x32_bf16 v[244:247], a[100:103], a[172:175], v[244:247]
    v_accvgpr_read_b32 v47, a100
    v_max3_u32 v43, v43, v44, v45
    v_max3_u32 v43, v43, v46, v47
    v_cvt_pk_bf16_f32 v240, v240, v241
    v_and_b32 v241, 0xffff0000, v240
    v_lshlrev_b32 v240, 16, v240
    v_lshlrev_b32 v96, 16, v56
    v_and_b32 v97, 0xffff0000, v56
    v_pk_add_f32 v[240:241], v[240:241], v[96:97]
    v_cvt_pk_bf16_f32 v72, v240, v241
    v_lshlrev_b32 v96, 16, v72
    v_and_b32 v97, 0xffff0000, v72
    v_cvt_pk_bf16_f32 v242, v242, v243
    v_and_b32 v243, 0xffff0000, v242
    v_lshlrev_b32 v242, 16, v242
    v_lshlrev_b32 v98, 16, v57
    v_and_b32 v99, 0xffff0000, v57
    v_pk_add_f32 v[242:243], v[242:243], v[98:99]
    v_cvt_pk_bf16_f32 v73, v242, v243
    v_lshlrev_b32 v98, 16, v73
    v_and_b32 v99, 0xffff0000, v73
    s_waitcnt vmcnt(0)
    v_mfma_f32_16x16x32_bf16 v[240:243], a[104:107], a[136:139], v[36:39]
    v_accvgpr_read_b32 v44, a104
    v_mfma_f32_16x16x32_bf16 v[240:243], a[108:111], a[148:151], v[240:243]
    v_accvgpr_read_b32 v45, a108
    v_mfma_f32_16x16x32_bf16 v[240:243], a[112:115], a[160:163], v[240:243]
    v_accvgpr_read_b32 v46, a112
    v_mfma_f32_16x16x32_bf16 v[240:243], a[116:119], a[172:175], v[240:243]
    v_accvgpr_read_b32 v47, a116
    v_max3_u32 v43, v43, v44, v45
    v_max3_u32 v43, v43, v46, v47
    v_cvt_pk_bf16_f32 v244, v244, v245
    v_and_b32 v245, 0xffff0000, v244
    v_lshlrev_b32 v244, 16, v244
    v_lshlrev_b32 v100, 16, v58
    v_and_b32 v101, 0xffff0000, v58
    v_pk_add_f32 v[244:245], v[244:245], v[100:101]
    v_cvt_pk_bf16_f32 v74, v244, v245
    v_lshlrev_b32 v100, 16, v74
    v_and_b32 v101, 0xffff0000, v74
    v_cvt_pk_bf16_f32 v246, v246, v247
    v_and_b32 v247, 0xffff0000, v246
    v_lshlrev_b32 v246, 16, v246
    v_lshlrev_b32 v102, 16, v59
    v_and_b32 v103, 0xffff0000, v59
    v_pk_add_f32 v[246:247], v[246:247], v[102:103]
    v_cvt_pk_bf16_f32 v75, v246, v247
    v_lshlrev_b32 v102, 16, v75
    v_and_b32 v103, 0xffff0000, v75
    v_cmp_eq_u32 vcc, -1, v43
    s_cbranch_vccz A_vd_204
    s_cmp_lt_u32 s28, s29
    s_cbranch_scc1 A_vl_203
    s_mov_b32 s29, 1
A_vd_204:
    v_cvt_pk_bf16_f32 v240, v240, v241
    v_and_b32 v241, 0xffff0000, v240
    v_lshlrev_b32 v240, 16, v240
    v_lshlrev_b32 v104, 16, v60
    v_and_b32 v105, 0xffff0000, v60
    v_pk_add_f32 v[240:241], v[240:241], v[104:105]
    v_cvt_pk_bf16_f32 v76, v240, v241
    v_lshlrev_b32 v104, 16, v76
    v_and_b32 v105, 0xffff0000, v76
    v_cvt_pk_bf16_f32 v242, v242, v243
    v_and_b32 v243, 0xffff0000, v242
    v_lshlrev_b32 v242, 16, v242
    v_lshlrev_b32 v106, 16, v61
    v_and_b32 v107, 0xffff0000, v61
    v_pk_add_f32 v[242:243], v[242:243], v[106:107]
    v_cvt_pk_bf16_f32 v77, v242, v243
    v_lshlrev_b32 v106, 16, v77
    v_and_b32 v107, 0xffff0000, v77
    s_mul_i32 s40, s16, 14336
    s_mul_i32 s26, s17, 3584
    s_add_u32 s41, s40, s26
    s_add_u32 s41, s41, 96468992
    s_mov_b32 s39, s41
    v_pk_add_f32 v[40:41], v[80:81], v[82:83]
    v_pk_add_f32 v[40:41], v[40:41], v[84:85]
    v_pk_add_f32 v[40:41], v[40:41], v[86:87]
    v_pk_add_f32 v[40:41], v[40:41], v[88:89]
    v_pk_add_f32 v[40:41], v[40:41], v[90:91]
    v_pk_add_f32 v[40:41], v[40:41], v[92:93]
    v_pk_add_f32 v[40:41], v[40:41], v[94:95]
    v_pk_add_f32 v[40:41], v[40:41], v[96:97]
    v_pk_add_f32 v[40:41], v[40:41], v[98:99]
    v_pk_add_f32 v[40:41], v[40:41], v[100:101]
    v_pk_add_f32 v[40:41], v[40:41], v[102:103]
    v_pk_add_f32 v[40:41], v[40:41], v[104:105]
    v_pk_add_f32 v[40:41], v[40:41], v[106:107]
    v_add_f32 v40, v40, v41
    v_mov_b32 v44, v40
    s_nop 1
    v_permlane16_swap_b32 v40, v44
    v_add_f32 v40, v40, v44
    v_mov_b32 v44, v40
    s_nop 1
    v_permlane32_swap_b32 v40, v44
    v_add_f32 v40, v40, v44
    v_mul_f32 v42, 0xbc124925, v40
    v_mul_f32 v43, 0xbc124925, v40
    v_pk_add_f32 v[44:45], v[80:81], v[42:43]
    v_pk_mul_f32 v[40:41], v[44:45], v[44:45]
    v_pk_add_f32 v[46:47], v[82:83], v[42:43]
    v_pk_fma_f32 v[40:41], v[46:47], v[46:47], v[40:41]
    v_pk_add_f32 v[44:45], v[84:85], v[42:43]
    v_pk_fma_f32 v[40:41], v[44:45], v[44:45], v[40:41]
    v_pk_add_f32 v[46:47], v[86:87], v[42:43]
    v_pk_fma_f32 v[40:41], v[46:47], v[46:47], v[40:41]
    v_pk_add_f32 v[44:45], v[88:89], v[42:43]
    v_pk_fma_f32 v[40:41], v[44:45], v[44:45], v[40:41]
    v_pk_add_f32 v[46:47], v[90:91], v[42:43]
    v_pk_fma_f32 v[40:41], v[46:47], v[46:47], v[40:41]
    v_pk_add_f32 v[44:45], v[92:93], v[42:43]
    v_pk_fma_f32 v[40:41], v[44:45], v[44:45], v[40:41]
    v_pk_add_f32 v[46:47], v[94:95], v[42:43]
    v_pk_fma_f32 v[40:41], v[46:47], v[46:47], v[40:41]
    v_pk_add_f32 v[44:45], v[96:97], v[42:43]
    v_pk_fma_f32 v[40:41], v[44:45], v[44:45], v[40:41]
    v_pk_add_f32 v[46:47], v[98:99], v[42:43]
    v_pk_fma_f32 v[40:41], v[46:47], v[46:47], v[40:41]
    v_pk_add_f32 v[44:45], v[100:101], v[42:43]
    v_pk_fma_f32 v[40:41], v[44:45], v[44:45], v[40:41]
    v_pk_add_f32 v[46:47], v[102:103], v[42:43]
    v_pk_fma_f32 v[40:41], v[46:47], v[46:47], v[40:41]
    v_pk_add_f32 v[44:45], v[104:105], v[42:43]
    v_pk_fma_f32 v[40:41], v[44:45], v[44:45], v[40:41]
    v_pk_add_f32 v[46:47], v[106:107], v[42:43]
    v_pk_fma_f32 v[40:41], v[46:47], v[46:47], v[40:41]
    v_add_f32 v43, v40, v41
    v_mov_b32 v44, v43
    s_nop 1
    v_permlane16_swap_b32 v43, v44
    v_add_f32 v43, v43, v44
    v_mov_b32 v44, v43
    s_nop 1
    v_permlane32_swap_b32 v43, v44
    v_add_f32 v43, v43, v44
    s_lshl_b32 s26, s17, 9
    v_add_u32 v44, s26, v0
    ds_write_b64 v44, v[42:43] offset:24576
    s_waitcnt lgkmcnt(0)
    s_barrier
    ds_read_b64 v[48:49], v0 offset:24576
    ds_read_b64 v[50:51], v0 offset:25088
    ds_read_b64 v[52:53], v0 offset:25600
    ds_read_b64 v[54:55], v0 offset:26112
    s_waitcnt lgkmcnt(0)
    v_add_f32 v42, v48, v50
    v_add_f32 v44, v52, v54
    v_add_f32 v42, v42, v44
    v_mul_f32 v42, 0.25, v42
    v_add_f32 v46, v49, v51
    v_add_f32 v44, v53, v55
    v_add_f32 v46, v46, v44
    v_sub_f32 v48, v48, v42
    v_sub_f32 v50, v50, v42
    v_sub_f32 v52, v52, v42
    v_sub_f32 v54, v54, v42
    v_mul_f32 v44, v48, v48
    v_fmac_f32 v44, v50, v50
    v_fmac_f32 v44, v52, v52
    v_fmac_f32 v44, v54, v54
    v_fmac_f32 v46, 0x42e00000, v44
    v_mul_f32 v46, 0x3b124925, v46
    v_cvt_pk_bf16_f32 v46, v46, v46
    v_and_b32 v46, 0xffff0000, v46
    v_add_f32 v46, 0x3727c5ac, v46
    v_cvt_pk_bf16_f32 v46, v46, v46
    v_and_b32 v46, 0xffff0000, v46
    v_sqrt_f32 v46, v46
    s_nop 0
    v_cvt_pk_bf16_f32 v46, v46, v46
    v_and_b32 v46, 0xffff0000, v46
    v_rcp_f32 v46, v46
    v_cvt_pk_bf16_f32 v42, v42, v42
    v_and_b32 v42, 0xffff0000, v42
    v_mov_b32 v43, v42
    v_mov_b32 v47, v46
    v_pk_add_f32 v[80:81], v[80:81], v[42:43]
    v_cvt_pk_bf16_f32 v108, v80, v81
    v_lshlrev_b32 v80, 16, v108
    v_and_b32 v81, 0xffff0000, v108
    v_pk_mul_f32 v[80:81], v[80:81], v[46:47]
    v_cvt_pk_bf16_f32 v108, v80, v81
    v_pk_add_f32 v[82:83], v[82:83], v[42:43]
    v_cvt_pk_bf16_f32 v109, v82, v83
    v_lshlrev_b32 v82, 16, v109
    v_and_b32 v83, 0xffff0000, v109
    v_pk_mul_f32 v[82:83], v[82:83], v[46:47]
    v_cvt_pk_bf16_f32 v109, v82, v83
    v_pk_add_f32 v[84:85], v[84:85], v[42:43]
    v_cvt_pk_bf16_f32 v110, v84, v85
    v_lshlrev_b32 v84, 16, v110
    v_and_b32 v85, 0xffff0000, v110
    v_pk_mul_f32 v[84:85], v[84:85], v[46:47]
    v_cvt_pk_bf16_f32 v110, v84, v85
    v_pk_add_f32 v[86:87], v[86:87], v[42:43]
    v_cvt_pk_bf16_f32 v111, v86, v87
    v_lshlrev_b32 v86, 16, v111
    v_and_b32 v87, 0xffff0000, v111
    v_pk_mul_f32 v[86:87], v[86:87], v[46:47]
    v_cvt_pk_bf16_f32 v111, v86, v87
    v_pk_add_f32 v[88:89], v[88:89], v[42:43]
    v_cvt_pk_bf16_f32 v112, v88, v89
    v_lshlrev_b32 v88, 16, v112
    v_and_b32 v89, 0xffff0000, v112
    v_pk_mul_f32 v[88:89], v[88:89], v[46:47]
    v_cvt_pk_bf16_f32 v112, v88, v89
    v_pk_add_f32 v[90:91], v[90:91], v[42:43]
    v_cvt_pk_bf16_f32 v113, v90, v91
    v_lshlrev_b32 v90, 16, v113
    v_and_b32 v91, 0xffff0000, v113
    v_pk_mul_f32 v[90:91], v[90:91], v[46:47]
    v_cvt_pk_bf16_f32 v113, v90, v91
    v_pk_add_f32 v[92:93], v[92:93], v[42:43]
    v_cvt_pk_bf16_f32 v114, v92, v93
    v_lshlrev_b32 v92, 16, v114
    v_and_b32 v93, 0xffff0000, v114
    v_pk_mul_f32 v[92:93], v[92:93], v[46:47]
    v_cvt_pk_bf16_f32 v114, v92, v93
    v_pk_add_f32 v[94:95], v[94:95], v[42:43]
    v_cvt_pk_bf16_f32 v115, v94, v95
    v_lshlrev_b32 v94, 16, v115
    v_and_b32 v95, 0xffff0000, v115
    v_pk_mul_f32 v[94:95], v[94:95], v[46:47]
    v_cvt_pk_bf16_f32 v115, v94, v95
    v_pk_add_f32 v[96:97], v[96:97], v[42:43]
    v_cvt_pk_bf16_f32 v116, v96, v97
    v_lshlrev_b32 v96, 16, v116
    v_and_b32 v97, 0xffff0000, v116
    v_pk_mul_f32 v[96:97], v[96:97], v[46:47]
    v_cvt_pk_bf16_f32 v116, v96, v97
    v_pk_add_f32 v[98:99], v[98:99], v[42:43]
    v_cvt_pk_bf16_f32 v117, v98, v99
    v_lshlrev_b32 v98, 16, v117
    v_and_b32 v99, 0xffff0000, v117
    v_pk_mul_f32 v[98:99], v[98:99], v[46:47]
    v_cvt_pk_bf16_f32 v117, v98, v99
    v_pk_add_f32 v[100:101], v[100:101], v[42:43]
    v_cvt_pk_bf16_f32 v118, v100, v101
    v_lshlrev_b32 v100, 16, v118
    v_and_b32 v101, 0xffff0000, v118
    v_pk_mul_f32 v[100:101], v[100:101], v[46:47]
    v_cvt_pk_bf16_f32 v118, v100, v101
    v_pk_add_f32 v[102:103], v[102:103], v[42:43]
    v_cvt_pk_bf16_f32 v119, v102, v103
    v_lshlrev_b32 v102, 16, v119
    v_and_b32 v103, 0xffff0000, v119
    v_pk_mul_f32 v[102:103], v[102:103], v[46:47]
    v_cvt_pk_bf16_f32 v119, v102, v103
    v_pk_add_f32 v[104:105], v[104:105], v[42:43]
    v_cvt_pk_bf16_f32 v120, v104, v105
    v_lshlrev_b32 v104, 16, v120
    v_and_b32 v105, 0xffff0000, v120
    v_pk_mul_f32 v[104:105], v[104:105], v[46:47]
    v_cvt_pk_bf16_f32 v120, v104, v105
    v_pk_add_f32 v[106:107], v[106:107], v[42:43]
    v_cvt_pk_bf16_f32 v121, v106, v107
    v_lshlrev_b32 v106, 16, v121
    v_and_b32 v107, 0xffff0000, v121
    v_pk_mul_f32 v[106:107], v[106:107], v[46:47]
    v_cvt_pk_bf16_f32 v121, v106, v107
    s_mul_i32 s26, s17, 3072
    s_add_u32 s40, s40, 98566144
    s_add_u32 s41, s40, s26
    s_lshr_b32 s26, s17, 1
    s_lshl_b32 s26, s26, 10
    s_and_b32 s27, s17, 1
    s_lshl_b32 s27, s27, 3
    s_add_u32 s26, s26, s27
    s_add_u32 s40, s40, s26
    s_add_u32 s40, s40, 12288
    s_cmp_eq_u32 s20, 0
    s_cbranch_scc1 A_sf_209
    buffer_store_dwordx4 v[108:111], v3, s[8:11], s41 offen offset:0
    buffer_store_dwordx4 v[112:115], v3, s[8:11], s41 offen offset:1024
    buffer_store_dwordx4 v[116:119], v3, s[8:11], s41 offen offset:2048
    buffer_store_dwordx2 v[120:121], v3, s[8:11], s40 offen
    buffer_store_dwordx2 v[64:65], v0, s[8:11], s39 offen offset:0
    buffer_store_dwordx2 v[66:67], v0, s[8:11], s39 offen offset:512
    buffer_store_dwordx2 v[68:69], v0, s[8:11], s39 offen offset:1024
    buffer_store_dwordx2 v[70:71], v0, s[8:11], s39 offen offset:1536
    buffer_store_dwordx2 v[72:73], v0, s[8:11], s39 offen offset:2048
    buffer_store_dwordx2 v[74:75], v0, s[8:11], s39 offen offset:2560
    buffer_store_dwordx2 v[76:77], v0, s[8:11], s39 offen offset:3072
A_sj_210:
    s_branch A_top
A_vl_203:
    s_mov_b32 s41, s40
    buffer_load_dwordx4 a[8:11], v3, s[8:11], s41 offen offset:0 sc1
    buffer_load_dwordx4 a[12:15], v3, s[8:11], s41 offen offset:1024 sc1
    buffer_load_dwordx4 a[16:19], v3, s[8:11], s41 offen offset:2048 sc1
    buffer_load_dwordx4 a[20:23], v3, s[8:11], s41 offen offset:3072 sc1
    s_add_u32 s41, s41, 4096
    buffer_load_dwordx4 a[24:27], v3, s[8:11], s41 offen offset:0 sc1
    buffer_load_dwordx4 a[28:31], v3, s[8:11], s41 offen offset:1024 sc1
    buffer_load_dwordx4 a[32:35], v3, s[8:11], s41 offen offset:2048 sc1
    buffer_load_dwordx4 a[36:39], v3, s[8:11], s41 offen offset:3072 sc1
    s_add_u32 s41, s41, 4096
    buffer_load_dwordx4 a[40:43], v3, s[8:11], s41 offen offset:0 sc1
    buffer_load_dwordx4 a[44:47], v3, s[8:11], s41 offen offset:1024 sc1
    buffer_load_dwordx4 a[48:51], v3, s[8:11], s41 offen offset:2048 sc1
    buffer_load_dwordx4 a[52:55], v3, s[8:11], s41 offen offset:3072 sc1
    s_add_u32 s41, s41, 4096
    buffer_load_dwordx4 a[56:59], v3, s[8:11], s41 offen offset:0 sc1
    buffer_load_dwordx4 a[60:63], v3, s[8:11], s41 offen offset:1024 sc1
    buffer_load_dwordx4 a[64:67], v3, s[8:11], s41 offen offset:2048 sc1
    buffer_load_dwordx4 a[68:71], v3, s[8:11], s41 offen offset:3072 sc1
    s_add_u32 s41, s41, 4096
    buffer_load_dwordx4 a[72:75], v3, s[8:11], s41 offen offset:0 sc1
    buffer_load_dwordx4 a[76:79], v3, s[8:11], s41 offen offset:1024 sc1
    buffer_load_dwordx4 a[80:83], v3, s[8:11], s41 offen offset:2048 sc1
    buffer_load_dwordx4 a[84:87], v3, s[8:11], s41 offen offset:3072 sc1
    s_add_u32 s41, s41, 4096
    buffer_load_dwordx4 a[88:91], v3, s[8:11], s41 offen offset:0 sc1
    buffer_load_dwordx4 a[92:95], v3, s[8:11], s41 offen offset:1024 sc1
    buffer_load_dwordx4 a[96:99], v3, s[8:11], s41 offen offset:2048 sc1
    buffer_load_dwordx4 a[100:103], v3, s[8:11], s41 offen offset:3072 sc1
    s_add_u32 s41, s41, 4096
    buffer_load_dwordx4 a[104:107], v3, s[8:11], s41 offen offset:0 sc1
    buffer_load_dwordx4 a[108:111], v3, s[8:11], s41 offen offset:1024 sc1
    buffer_load_dwordx4 a[112:115], v3, s[8:11], s41 offen offset:2048 sc1
    buffer_load_dwordx4 a[116:119], v3, s[8:11], s41 offen offset:3072 sc1
    s_branch A_vr_206
A_sf_209:
    buffer_store_dwordx4 v[108:111], v3, s[8:11], s41 offen offset:0 sc1
    buffer_store_dwordx4 v[112:115], v3, s[8:11], s41 offen offset:1024 sc1
    buffer_store_dwordx4 v[116:119], v3, s[8:11], s41 offen offset:2048 sc1
    buffer_store_dwordx2 v[120:121], v3, s[8:11], s40 offen sc1
    buffer_store_dwordx2 v[64:65], v0, s[8:11], s39 offen offset:0 sc1
    buffer_store_dwordx2 v[66:67], v0, s[8:11], s39 offen offset:512 sc1
    buffer_store_dwordx2 v[68:69], v0, s[8:11], s39 offen offset:1024 sc1
    buffer_store_dwordx2 v[70:71], v0, s[8:11], s39 offen offset:1536 sc1
    buffer_store_dwordx2 v[72:73], v0, s[8:11], s39 offen offset:2048 sc1
    buffer_store_dwordx2 v[74:75], v0, s[8:11], s39 offen offset:2560 sc1
    buffer_store_dwordx2 v[76:77], v0, s[8:11], s39 offen offset:3072 sc1
    s_branch A_sj_210
M_ffn:
    s_mov_b32 s37, s26
    s_sub_u32 s36, s27, 16
    v_mbcnt_lo_u32_b32 v1, -1, 0
    v_mbcnt_hi_u32_b32 v1, -1, v1
    s_load_dwordx4 s[4:7], s[0:1], 64
    s_load_dwordx2 s[52:53], s[0:1], 80
    s_mov_b32 s29, 160000
    v_lshlrev_b32 v2, 4, v1
    v_lshlrev_b32 v3, 3, v1
    s_lshl_b32 s26, s17, 6
    v_add_u32 v0, s26, v1
    s_waitcnt lgkmcnt(0)
    v_mov_b32 v12, -1
    v_mov_b32 v13, -1
    v_mov_b32 v14, -1
    v_mov_b32 v15, -1
    s_mul_i32 s40, s37, 14
    s_add_u32 s40, s40, s36
    s_lshl_b32 s40, s40, 2
    s_add_u32 s40, s40, s17
    s_lshl_b32 s40, s40, 10
    s_add_u32 s40, s40, 29360128
F_fill:
    buffer_store_dwordx4 v[12:15], v2, s[8:11], s40 offen sc1
    s_add_u32 s40, s40, 401408
    s_cmp_lt_u32 s40, 36700160
    s_cbranch_scc1 F_fill
    s_mov_b32 s26, 23061760
    v_mov_b32 v8, 0
    v_mov_b32 v9, 1
    s_cmp_lg_u32 s17, 0
    s_waitcnt vmcnt(0)
    s_barrier
    s_cbranch_scc1 F_fill1
    s_mov_b64 exec, 1
    buffer_atomic_add v9, v8, s[8:11], s26 offen
    s_mov_b64 exec, -1
F_fill1:
    s_mov_b32 s44, s4
    s_and_b32 s45, s5, 0xffff
    s_mov_b32 s46, 1605632
    s_mov_b32 s47, 0x20000
    s_mov_b32 s48, s52
    s_and_b32 s49, s53, 0xffff
    s_mov_b32 s50, 1835008
    s_mov_b32 s51, 0x20000
    v_lshrrev_b32 v4, 4, v0
    v_and_b32 v5, 15, v0
    v_mul_u32_u24 v6, 3584, v4
    v_lshl_add_u32 v6, v5, 4, v6
    v_mul_u32_u24 v7, 272, v4
    v_lshl_add_u32 v7, v5, 4, v7
    v_add_u32 v9, 60928, v7
    s_lshl_b32 s38, s36, 8
    buffer_load_dwordx4 v[16:19], v6, s[44:47], s38 offen
    s_add_u32 s38, s38, 57344
    buffer_load_dwordx4 v[20:23], v6, s[44:47], s38 offen
    s_add_u32 s38, s38, 57344
    buffer_load_dwordx4 v[24:27], v6, s[44:47], s38 offen
    s_add_u32 s38, s38, 57344
    buffer_load_dwordx4 v[28:31], v6, s[44:47], s38 offen
    s_add_u32 s38, s38, 57344
    buffer_load_dwordx4 v[32:35], v6, s[44:47], s38 offen
    s_add_u32 s38, s38, 57344
    buffer_load_dwordx4 v[36:39], v6, s[44:47], s38 offen
    s_add_u32 s38, s38, 57344
    buffer_load_dwordx4 v[40:43], v6, s[44:47], s38 offen
    s_add_u32 s38, s38, 57344
    buffer_load_dwordx4 v[44:47], v6, s[44:47], s38 offen
    s_add_u32 s38, s38, 57344
    buffer_load_dwordx4 v[48:51], v6, s[44:47], s38 offen
    s_add_u32 s38, s38, 57344
    buffer_load_dwordx4 v[52:55], v6, s[44:47], s38 offen
    s_add_u32 s38, s38, 57344
    buffer_load_dwordx4 v[56:59], v6, s[44:47], s38 offen
    s_add_u32 s38, s38, 57344
    buffer_load_dwordx4 v[60:63], v6, s[44:47], s38 offen
    s_add_u32 s38, s38, 57344
    buffer_load_dwordx4 v[64:67], v6, s[44:47], s38 offen
    s_add_u32 s38, s38, 57344
    buffer_load_dwordx4 v[68:71], v6, s[44:47], s38 offen
    s_add_u32 s38, s38, 57344
    buffer_load_dwordx4 v[72:75], v6, s[44:47], s38 offen
    s_add_u32 s38, s38, 57344
    buffer_load_dwordx4 v[76:79], v6, s[44:47], s38 offen
    s_add_u32 s38, s38, 57344
    buffer_load_dwordx4 v[80:83], v6, s[44:47], s38 offen
    s_add_u32 s38, s38, 57344
    buffer_load_dwordx4 v[84:87], v6, s[44:47], s38 offen
    s_add_u32 s38, s38, 57344
    buffer_load_dwordx4 v[88:91], v6, s[44:47], s38 offen
    s_add_u32 s38, s38, 57344
    buffer_load_dwordx4 v[92:95], v6, s[44:47], s38 offen
    s_add_u32 s38, s38, 57344
    buffer_load_dwordx4 v[96:99], v6, s[44:47], s38 offen
    s_add_u32 s38, s38, 57344
    buffer_load_dwordx4 v[100:103], v6, s[44:47], s38 offen
    s_add_u32 s38, s38, 57344
    buffer_load_dwordx4 v[104:107], v6, s[44:47], s38 offen
    s_add_u32 s38, s38, 57344
    buffer_load_dwordx4 v[108:111], v6, s[44:47], s38 offen
    s_add_u32 s38, s38, 57344
    buffer_load_dwordx4 v[112:115], v6, s[44:47], s38 offen
    s_add_u32 s38, s38, 57344
    buffer_load_dwordx4 v[116:119], v6, s[44:47], s38 offen
    s_add_u32 s38, s38, 57344
    buffer_load_dwordx4 v[120:123], v6, s[44:47], s38 offen
    s_add_u32 s38, s38, 57344
    buffer_load_dwordx4 v[124:127], v6, s[44:47], s38 offen
    s_add_u32 s38, s38, 57344
    s_mov_b32 s44, s6
    s_and_b32 s45, s7, 0xffff
    s_mov_b32 s46, 1605632
    s_mov_b32 s47, 0x20000
    v_lshrrev_b32 v4, 2, v0
    v_and_b32 v5, 3, v0
    v_mul_u32_u24 v6, 896, v4
    v_lshl_add_u32 v6, v5, 4, v6
    v_lshlrev_b32 v8, 5, v4
    v_and_b32 v5, 1, v0
    v_lshl_add_u32 v8, v5, 4, v8
    v_bfe_u32 v5, v0, 1, 1
    v_mul_u32_u24 v5, 57344, v5
    v_add_u32 v8, v8, v5
    s_lshl_b32 s38, s36, 6
    buffer_load_dwordx4 v[128:131], v6, s[44:47], s38 offen
    s_add_u32 s38, s38, 57344
    buffer_load_dwordx4 v[132:135], v6, s[44:47], s38 offen
    s_add_u32 s38, s38, 57344
    buffer_load_dwordx4 v[136:139], v6, s[44:47], s38 offen
    s_add_u32 s38, s38, 57344
    buffer_load_dwordx4 v[140:143], v6, s[44:47], s38 offen
    s_add_u32 s38, s38, 57344
    buffer_load_dwordx4 v[144:147], v6, s[44:47], s38 offen
    s_add_u32 s38, s38, 57344
    buffer_load_dwordx4 v[148:151], v6, s[44:47], s38 offen
    s_add_u32 s38, s38, 57344
    buffer_load_dwordx4 v[152:155], v6, s[44:47], s38 offen
    s_add_u32 s38, s38, 57344
    buffer_load_dwordx4 v[156:159], v6, s[44:47], s38 offen
    s_add_u32 s38, s38, 57344
    buffer_load_dwordx4 v[160:163], v6, s[44:47], s38 offen
    s_add_u32 s38, s38, 57344
    buffer_load_dwordx4 v[164:167], v6, s[44:47], s38 offen
    s_add_u32 s38, s38, 57344
    buffer_load_dwordx4 v[168:171], v6, s[44:47], s38 offen
    s_add_u32 s38, s38, 57344
    buffer_load_dwordx4 v[172:175], v6, s[44:47], s38 offen
    s_add_u32 s38, s38, 57344
    buffer_load_dwordx4 v[176:179], v6, s[44:47], s38 offen
    s_add_u32 s38, s38, 57344
    buffer_load_dwordx4 v[180:183], v6, s[44:47], s38 offen
    s_add_u32 s38, s38, 57344
    buffer_load_dwordx4 v[184:187], v6, s[44:47], s38 offen
    s_add_u32 s38, s38, 57344
    buffer_load_dwordx4 v[188:191], v6, s[44:47], s38 offen
    s_add_u32 s38, s38, 57344
    buffer_load_dwordx4 v[192:195], v6, s[44:47], s38 offen
    s_add_u32 s38, s38, 57344
    buffer_load_dwordx4 v[196:199], v6, s[44:47], s38 offen
    s_add_u32 s38, s38, 57344
    buffer_load_dwordx4 v[200:203], v6, s[44:47], s38 offen
    s_add_u32 s38, s38, 57344
    buffer_load_dwordx4 v[204:207], v6, s[44:47], s38 offen
    s_add_u32 s38, s38, 57344
    buffer_load_dwordx4 v[208:211], v6, s[44:47], s38 offen
    s_add_u32 s38, s38, 57344
    buffer_load_dwordx4 v[212:215], v6, s[44:47], s38 offen
    s_add_u32 s38, s38, 57344
    buffer_load_dwordx4 v[216:219], v6, s[44:47], s38 offen
    s_add_u32 s38, s38, 57344
    buffer_load_dwordx4 v[220:223], v6, s[44:47], s38 offen
    s_add_u32 s38, s38, 57344
    buffer_load_dwordx4 v[224:227], v6, s[44:47], s38 offen
    s_add_u32 s38, s38, 57344
    buffer_load_dwordx4 v[228:231], v6, s[44:47], s38 offen
    s_add_u32 s38, s38, 57344
    buffer_load_dwordx4 v[232:235], v6, s[44:47], s38 offen
    s_add_u32 s38, s38, 57344
    buffer_load_dwordx4 v[236:239], v6, s[44:47], s38 offen
    s_add_u32 s38, s38, 57344
    s_waitcnt vmcnt(55)
    ds_write_b128 v7, v[16:19] offset:0
    s_waitcnt vmcnt(54)
    ds_write_b128 v7, v[20:23] offset:4352
    s_waitcnt vmcnt(53)
    ds_write_b128 v7, v[24:27] offset:8704
    s_waitcnt vmcnt(52)
    ds_write_b128 v7, v[28:31] offset:13056
    s_waitcnt vmcnt(51)
    ds_write_b128 v7, v[32:35] offset:17408
    s_waitcnt vmcnt(50)
    ds_write_b128 v7, v[36:39] offset:21760
    s_waitcnt vmcnt(49)
    ds_write_b128 v7, v[40:43] offset:26112
    s_waitcnt vmcnt(48)
    ds_write_b128 v7, v[44:47] offset:30464
    s_waitcnt vmcnt(47)
    ds_write_b128 v7, v[48:51] offset:34816
    s_waitcnt vmcnt(46)
    ds_write_b128 v7, v[52:55] offset:39168
    s_waitcnt vmcnt(45)
    ds_write_b128 v7, v[56:59] offset:43520
    s_waitcnt vmcnt(44)
    ds_write_b128 v7, v[60:63] offset:47872
    s_waitcnt vmcnt(43)
    ds_write_b128 v7, v[64:67] offset:52224
    s_waitcnt vmcnt(42)
    ds_write_b128 v7, v[68:71] offset:56576
    s_waitcnt vmcnt(41)
    ds_write_b128 v9, v[72:75] offset:0
    s_waitcnt vmcnt(40)
    ds_write_b128 v9, v[76:79] offset:4352
    s_waitcnt vmcnt(39)
    ds_write_b128 v9, v[80:83] offset:8704
    s_waitcnt vmcnt(38)
    ds_write_b128 v9, v[84:87] offset:13056
    s_waitcnt vmcnt(37)
    ds_write_b128 v9, v[88:91] offset:17408
    s_waitcnt vmcnt(36)
    ds_write_b128 v9, v[92:95] offset:21760
    s_waitcnt vmcnt(35)
    ds_write_b128 v9, v[96:99] offset:26112
    s_waitcnt vmcnt(34)
    ds_write_b128 v9, v[100:103] offset:30464
    s_waitcnt vmcnt(33)
    ds_write_b128 v9, v[104:107] offset:34816
    s_waitcnt vmcnt(32)
    ds_write_b128 v9, v[108:111] offset:39168
    s_waitcnt vmcnt(31)
    ds_write_b128 v9, v[112:115] offset:43520
    s_waitcnt vmcnt(30)
    ds_write_b128 v9, v[116:119] offset:47872
    s_waitcnt vmcnt(29)
    ds_write_b128 v9, v[120:123] offset:52224
    s_waitcnt vmcnt(28)
    ds_write_b128 v9, v[124:127] offset:56576
    v_lshrrev_b32 v4, 2, v1
    v_mul_u32_u24 v4, 272, v4
    v_and_b32 v5, 3, v1
    v_lshl_add_u32 v4, v5, 3, v4
    s_lshl_b32 s26, s17, 6
    v_add_u32 v4, s26, v4
    v_add_u32 v10, 60928, v4
    s_mul_i32 s26, s17, 14336
    v_add_u32 v5, s26, v3
    v_add_u32 v11, 57344, v5
    s_waitcnt lgkmcnt(0)
    s_barrier
    ds_read_b64_tr_b16 a[0:1], v4 offset:0
    ds_read_b64_tr_b16 a[2:3], v4 offset:4352
    ds_read_b64_tr_b16 a[4:5], v4 offset:8704
    ds_read_b64_tr_b16 a[6:7], v4 offset:13056
    ds_read_b64_tr_b16 a[8:9], v4 offset:17408
    ds_read_b64_tr_b16 a[10:11], v4 offset:21760
    ds_read_b64_tr_b16 a[12:13], v4 offset:30464
    ds_read_b64_tr_b16 a[14:15], v4 offset:34816
    ds_read_b64_tr_b16 a[16:17], v4 offset:39168
    ds_read_b64_tr_b16 a[18:19], v4 offset:43520
    ds_read_b64_tr_b16 a[20:21], v4 offset:47872
    ds_read_b64_tr_b16 a[22:23], v4 offset:52224
    ds_read_b64_tr_b16 a[24:25], v10 offset:0
    ds_read_b64_tr_b16 a[26:27], v10 offset:4352
    ds_read_b64_tr_b16 a[28:29], v10 offset:8704
    ds_read_b64_tr_b16 a[30:31], v10 offset:13056
    ds_read_b64_tr_b16 a[32:33], v10 offset:17408
    ds_read_b64_tr_b16 a[34:35], v10 offset:21760
    ds_read_b64_tr_b16 a[36:37], v10 offset:30464
    ds_read_b64_tr_b16 a[38:39], v10 offset:34816
    ds_read_b64_tr_b16 a[40:41], v10 offset:39168
    ds_read_b64_tr_b16 a[42:43], v10 offset:43520
    ds_read_b64_tr_b16 a[44:45], v10 offset:47872
    ds_read_b64_tr_b16 a[46:47], v10 offset:52224
    ds_read_b64_tr_b16 a[48:49], v4 offset:26112
    ds_read_b64_tr_b16 a[50:51], v4 offset:56576
    ds_read_b64_tr_b16 a[52:53], v10 offset:26112
    ds_read_b64_tr_b16 a[54:55], v10 offset:56576
    ds_read_b64_tr_b16 a[56:57], v4 offset:32
    ds_read_b64_tr_b16 a[58:59], v4 offset:4384
    ds_read_b64_tr_b16 a[60:61], v4 offset:8736
    ds_read_b64_tr_b16 a[62:63], v4 offset:13088
    ds_read_b64_tr_b16 a[64:65], v4 offset:17440
    ds_read_b64_tr_b16 a[66:67], v4 offset:21792
    ds_read_b64_tr_b16 a[68:69], v4 offset:30496
    ds_read_b64_tr_b16 a[70:71], v4 offset:34848
    ds_read_b64_tr_b16 a[72:73], v4 offset:39200
    ds_read_b64_tr_b16 a[74:75], v4 offset:43552
    ds_read_b64_tr_b16 a[76:77], v4 offset:47904
    ds_read_b64_tr_b16 a[78:79], v4 offset:52256
    ds_read_b64_tr_b16 a[80:81], v10 offset:32
    ds_read_b64_tr_b16 a[82:83], v10 offset:4384
    ds_read_b64_tr_b16 a[84:85], v10 offset:8736
    ds_read_b64_tr_b16 a[86:87], v10 offset:13088
    ds_read_b64_tr_b16 a[88:89], v10 offset:17440
    ds_read_b64_tr_b16 a[90:91], v10 offset:21792
    ds_read_b64_tr_b16 a[92:93], v10 offset:30496
    ds_read_b64_tr_b16 a[94:95], v10 offset:34848
    ds_read_b64_tr_b16 a[96:97], v10 offset:39200
    ds_read_b64_tr_b16 a[98:99], v10 offset:43552
    ds_read_b64_tr_b16 a[100:101], v10 offset:47904
    ds_read_b64_tr_b16 a[102:103], v10 offset:52256
    ds_read_b64_tr_b16 a[104:105], v4 offset:26144
    ds_read_b64_tr_b16 a[106:107], v4 offset:56608
    ds_read_b64_tr_b16 a[108:109], v10 offset:26144
    ds_read_b64_tr_b16 a[110:111], v10 offset:56608
    s_waitcnt lgkmcnt(0)
    s_barrier
    s_waitcnt vmcnt(27)
    ds_write_b128 v8, v[128:131] offset:0
    s_waitcnt vmcnt(26)
    ds_write_b128 v8, v[132:135] offset:2048
    s_waitcnt vmcnt(25)
    ds_write_b128 v8, v[136:139] offset:4096
    s_waitcnt vmcnt(24)
    ds_write_b128 v8, v[140:143] offset:6144
    s_waitcnt vmcnt(23)
    ds_write_b128 v8, v[144:147] offset:8192
    s_waitcnt vmcnt(22)
    ds_write_b128 v8, v[148:151] offset:10240
    s_waitcnt vmcnt(21)
    ds_write_b128 v8, v[152:155] offset:12288
    s_waitcnt vmcnt(20)
    ds_write_b128 v8, v[156:159] offset:14336
    s_waitcnt vmcnt(19)
    ds_write_b128 v8, v[160:163] offset:16384
    s_waitcnt vmcnt(18)
    ds_write_b128 v8, v[164:167] offset:18432
    s_waitcnt vmcnt(17)
    ds_write_b128 v8, v[168:171] offset:20480
    s_waitcnt vmcnt(16)
    ds_write_b128 v8, v[172:175] offset:22528
    s_waitcnt vmcnt(15)
    ds_write_b128 v8, v[176:179] offset:24576
    s_waitcnt vmcnt(14)
    ds_write_b128 v8, v[180:183] offset:26624
    s_waitcnt vmcnt(13)
    ds_write_b128 v8, v[184:187] offset:28672
    s_waitcnt vmcnt(12)
    ds_write_b128 v8, v[188:191] offset:30720
    s_waitcnt vmcnt(11)
    ds_write_b128 v8, v[192:195] offset:32768
    s_waitcnt vmcnt(10)
    ds_write_b128 v8, v[196:199] offset:34816
    s_waitcnt vmcnt(9)
    ds_write_b128 v8, v[200:203] offset:36864
    s_waitcnt vmcnt(8)
    ds_write_b128 v8, v[204:207] offset:38912
    s_waitcnt vmcnt(7)
    ds_write_b128 v8, v[208:211] offset:40960
    s_waitcnt vmcnt(6)
    ds_write_b128 v8, v[212:215] offset:43008
    s_waitcnt vmcnt(5)
    ds_write_b128 v8, v[216:219] offset:45056
    s_waitcnt vmcnt(4)
    ds_write_b128 v8, v[220:223] offset:47104
    s_waitcnt vmcnt(3)
    ds_write_b128 v8, v[224:227] offset:49152
    s_waitcnt vmcnt(2)
    ds_write_b128 v8, v[228:231] offset:51200
    s_waitcnt vmcnt(1)
    ds_write_b128 v8, v[232:235] offset:53248
    s_waitcnt vmcnt(0)
    ds_write_b128 v8, v[236:239] offset:55296
    s_waitcnt lgkmcnt(0)
    s_barrier
    ds_read_b64_tr_b16 a[112:113], v5 offset:0
    ds_read_b64_tr_b16 a[114:115], v5 offset:512
    ds_read_b64_tr_b16 a[116:117], v5 offset:1024
    ds_read_b64_tr_b16 a[118:119], v5 offset:1536
    ds_read_b64_tr_b16 a[120:121], v5 offset:2048
    ds_read_b64_tr_b16 a[122:123], v5 offset:2560
    ds_read_b64_tr_b16 a[124:125], v5 offset:3072
    ds_read_b64_tr_b16 a[126:127], v5 offset:3584
    ds_read_b64_tr_b16 a[128:129], v5 offset:4096
    ds_read_b64_tr_b16 a[130:131], v5 offset:4608
    ds_read_b64_tr_b16 a[132:133], v5 offset:5120
    ds_read_b64_tr_b16 a[134:135], v5 offset:5632
    ds_read_b64_tr_b16 a[136:137], v5 offset:6144
    ds_read_b64_tr_b16 a[138:139], v5 offset:6656
    ds_read_b64_tr_b16 a[140:141], v5 offset:7168
    ds_read_b64_tr_b16 a[142:143], v5 offset:7680
    ds_read_b64_tr_b16 a[144:145], v5 offset:8192
    ds_read_b64_tr_b16 a[146:147], v5 offset:8704
    ds_read_b64_tr_b16 a[148:149], v5 offset:9216
    ds_read_b64_tr_b16 a[150:151], v5 offset:9728
    ds_read_b64_tr_b16 a[152:153], v5 offset:10240
    ds_read_b64_tr_b16 a[154:155], v5 offset:10752
    ds_read_b64_tr_b16 a[156:157], v5 offset:11264
    ds_read_b64_tr_b16 a[158:159], v5 offset:11776
    ds_read_b64_tr_b16 a[160:161], v5 offset:12288
    ds_read_b64_tr_b16 a[162:163], v5 offset:12800
    ds_read_b64_tr_b16 a[164:165], v5 offset:13312
    ds_read_b64_tr_b16 a[166:167], v5 offset:13824
    ds_read_b64_tr_b16 a[168:169], v11 offset:0
    ds_read_b64_tr_b16 a[170:171], v11 offset:512
    ds_read_b64_tr_b16 a[172:173], v11 offset:1024
    ds_read_b64_tr_b16 a[174:175], v11 offset:1536
    ds_read_b64_tr_b16 a[176:177], v11 offset:2048
    ds_read_b64_tr_b16 a[178:179], v11 offset:2560
    ds_read_b64_tr_b16 a[180:181], v11 offset:3072
    ds_read_b64_tr_b16 a[182:183], v11 offset:3584
    ds_read_b64_tr_b16 a[184:185], v11 offset:4096
    ds_read_b64_tr_b16 a[186:187], v11 offset:4608
    ds_read_b64_tr_b16 a[188:189], v11 offset:5120
    ds_read_b64_tr_b16 a[190:191], v11 offset:5632
    ds_read_b64_tr_b16 a[192:193], v11 offset:6144
    ds_read_b64_tr_b16 a[194:195], v11 offset:6656
    ds_read_b64_tr_b16 a[196:197], v11 offset:7168
    ds_read_b64_tr_b16 a[198:199], v11 offset:7680
    ds_read_b64_tr_b16 a[200:201], v11 offset:8192
    ds_read_b64_tr_b16 a[202:203], v11 offset:8704
    ds_read_b64_tr_b16 a[204:205], v11 offset:9216
    ds_read_b64_tr_b16 a[206:207], v11 offset:9728
    ds_read_b64_tr_b16 a[208:209], v11 offset:10240
    ds_read_b64_tr_b16 a[210:211], v11 offset:10752
    ds_read_b64_tr_b16 a[212:213], v11 offset:11264
    ds_read_b64_tr_b16 a[214:215], v11 offset:11776
    ds_read_b64_tr_b16 a[216:217], v11 offset:12288
    ds_read_b64_tr_b16 a[218:219], v11 offset:12800
    ds_read_b64_tr_b16 a[220:221], v11 offset:13312
    ds_read_b64_tr_b16 a[222:223], v11 offset:13824
    v_and_b32 v4, 15, v1
    v_mul_u32_u24 v4, 896, v4
    v_lshrrev_b32 v5, 4, v1
    v_lshl_add_u32 v4, v5, 3, v4
    s_lshl_b32 s26, s17, 11
    v_add_u32 v5, s26, v2
    s_and_b32 s26, s17, 1
    s_lshl_b32 s26, s26, 10
    v_add_u32 v6, s26, v2
    v_mov_b32 v8, 0
    v_min_u32 v7, 13, v1
    v_lshlrev_b32 v7, 10, v7
    s_lshl_b32 s26, s17, 12
    s_min_u32 s26, s26, 10240
    v_add_u32 v9, s26, v2
    s_waitcnt lgkmcnt(0)
    s_mov_b32 s38, 22159360
    s_mov_b32 s28, 0
F_go:
    buffer_load_dword v10, v8, s[8:11], s38 offen sc1
    s_add_u32 s28, s28, 1
    s_waitcnt vmcnt(0)
    v_cmp_eq_u32 vcc, -1, v10
    s_cbranch_vccz F_god
    s_sleep 16
    s_cmp_lt_u32 s28, s29
    s_cbranch_scc1 F_go
F_god:
    s_lshl_b32 s38, s36, 2
    s_add_u32 s38, s38, s17
    s_lshl_b32 s38, s38, 10
    s_mul_i32 s26, s37, 57344
    s_add_u32 s38, s38, s26
    s_add_u32 s38, s38, 100663296
    s_mul_i32 s39, s37, 14336
    s_lshl_b32 s26, s36, 10
    s_add_u32 s39, s39, s26
    s_cmp_eq_u32 s17, 0
    s_cselect_b32 s26, 2097152, 0
    s_add_u32 s39, s39, s26
    s_add_u32 s39, s39, 96468992
    s_mov_b32 s27, s37
F_fill2:
    buffer_store_dwordx4 v[12:15], v2, s[8:11], s38 offen sc1
    s_cmp_ge_u32 s17, 2
    s_cbranch_scc1 F_fill3
    buffer_store_dwordx4 v[12:15], v2, s[8:11], s39 offen sc1
    s_nop 1
F_fill3:
    s_add_u32 s38, s38, 401408
    s_add_u32 s39, s39, 100352
    s_add_u32 s27, s27, 7
    s_cmp_lt_u32 s27, 128
    s_cbranch_scc1 F_fill2
    s_add_u32 s27, s37, 1
    s_cmp_eq_u32 s18, s27
    s_cselect_b32 s27, 1, 0x10001
    s_lshl_b32 s41, s37, 7
    s_add_u32 s41, s41, 23062528
    s_mov_b32 s26, 23061888
    v_mov_b32 v11, 1
    v_mov_b32 v10, s27
    s_cmp_lg_u32 s17, 0
    s_waitcnt vmcnt(0)
    s_barrier
    s_cbranch_scc1 F_fill4
    s_mov_b64 exec, 1
    buffer_atomic_add v11, v8, s[8:11], s26 offen
    buffer_atomic_add v10, v8, s[8:11], s41 offen
    s_mov_b64 exec, -1
F_fill4:
    s_mov_b32 s28, 0
F_mode:
    buffer_load_dword v10, v8, s[8:11], s41 offen sc1
    s_add_u32 s28, s28, 1
    s_waitcnt vmcnt(0)
    v_readfirstlane_b32 s26, v10
    s_nop 0
    s_and_b32 s27, s26, 0xffff
    s_cmp_ge_u32 s27, 14
    s_nop 0
    s_cbranch_scc1 F_moded
    s_sleep 4
    s_cmp_lt_u32 s28, s29
    s_cbranch_scc1 F_mode
    s_mov_b32 s26, 0x10000
F_moded:
    s_lshr_b32 s20, s26, 16
F_top:
    s_mul_i32 s38, s37, 14336
    s_lshl_b32 s40, s36, 1
    s_and_b32 s26, s17, 1
    s_add_u32 s40, s40, s26
    s_lshl_b32 s40, s40, 9
    s_add_u32 s40, s40, s38
    s_add_u32 s40, s40, 96468992
    s_add_u32 s38, s38, 98566144
    s_mov_b32 s28, 0
    s_cmp_ge_u32 s37, 121
    s_cbranch_scc1 F_hn
F_lt:
    buffer_load_dword v11, v8, s[8:11], s38 offen sc1
    s_add_u32 s28, s28, 1
    s_waitcnt vmcnt(0)
    v_cmp_eq_u32 vcc, -1, v11
    s_cbranch_vccz F_hn
    s_sleep 4
    s_cmp_lt_u32 s28, s29
    s_cbranch_scc1 F_lt
F_hn:
    buffer_load_dwordx4 v[16:19], v9, s[8:11], s38 offen offset:0 sc1
    buffer_load_dwordx4 v[20:23], v9, s[8:11], s38 offen offset:1024 sc1
    buffer_load_dwordx4 v[24:27], v9, s[8:11], s38 offen offset:2048 sc1
    buffer_load_dwordx4 v[28:31], v9, s[8:11], s38 offen offset:3072 sc1
    s_add_u32 s28, s28, 1
    s_waitcnt vmcnt(3)
    ds_write_b128 v9, v[16:19] offset:8192
    v_max_u32 v11, v16, v18
    s_waitcnt vmcnt(2)
    ds_write_b128 v9, v[20:23] offset:9216
    v_max3_u32 v11, v11, v20, v22
    s_waitcnt vmcnt(1)
    ds_write_b128 v9, v[24:27] offset:10240
    v_max3_u32 v11, v11, v24, v26
    s_waitcnt vmcnt(0)
    ds_write_b128 v9, v[28:31] offset:11264
    v_max3_u32 v11, v11, v28, v30
    v_cmp_eq_u32 vcc, -1, v11
    s_cbranch_vccz F_hnd
    s_sleep 1
    s_cmp_lt_u32 s28, s29
    s_cbranch_scc1 F_hn
    s_mov_b32 s29, 1
F_hnd:
    s_waitcnt lgkmcnt(0)
    s_barrier
    ds_read_b128 v[16:19], v2 offset:8192
    ds_read_b128 v[20:23], v2 offset:9216
    ds_read_b128 v[24:27], v2 offset:10240
    ds_read_b128 v[28:31], v2 offset:11264
    ds_read_b128 v[32:35], v2 offset:12288
    ds_read_b128 v[36:39], v2 offset:13312
    ds_read_b128 v[40:43], v2 offset:14336
    ds_read_b128 v[44:47], v2 offset:15360
    ds_read_b128 v[48:51], v2 offset:16384
    ds_read_b128 v[52:55], v2 offset:17408
    ds_read_b128 v[56:59], v2 offset:18432
    ds_read_b128 v[60:63], v2 offset:19456
    ds_read_b128 v[64:67], v2 offset:20480
    ds_read_b128 v[68:71], v2 offset:21504
    s_waitcnt lgkmcnt(13)
    v_mfma_f32_16x16x32_bf16 v[128:131], a[0:3], v[16:19], 0
    v_mfma_f32_16x16x32_bf16 v[132:135], a[56:59], v[16:19], 0
    s_waitcnt lgkmcnt(12)
    v_mfma_f32_16x16x32_bf16 v[128:131], a[4:7], v[20:23], v[128:131]
    v_mfma_f32_16x16x32_bf16 v[132:135], a[60:63], v[20:23], v[132:135]
    s_waitcnt lgkmcnt(11)
    v_mfma_f32_16x16x32_bf16 v[128:131], a[8:11], v[24:27], v[128:131]
    v_mfma_f32_16x16x32_bf16 v[132:135], a[64:67], v[24:27], v[132:135]
    s_waitcnt lgkmcnt(10)
    v_mfma_f32_16x16x32_bf16 v[128:131], a[12:15], v[28:31], v[128:131]
    v_mfma_f32_16x16x32_bf16 v[132:135], a[68:71], v[28:31], v[132:135]
    s_waitcnt lgkmcnt(9)
    v_mfma_f32_16x16x32_bf16 v[128:131], a[16:19], v[32:35], v[128:131]
    v_mfma_f32_16x16x32_bf16 v[132:135], a[72:75], v[32:35], v[132:135]
    s_waitcnt lgkmcnt(8)
    v_mfma_f32_16x16x32_bf16 v[128:131], a[20:23], v[36:39], v[128:131]
    v_mfma_f32_16x16x32_bf16 v[132:135], a[76:79], v[36:39], v[132:135]
    s_waitcnt lgkmcnt(7)
    v_mfma_f32_16x16x32_bf16 v[128:131], a[24:27], v[40:43], v[128:131]
    v_mfma_f32_16x16x32_bf16 v[132:135], a[80:83], v[40:43], v[132:135]
    s_waitcnt lgkmcnt(6)
    v_mfma_f32_16x16x32_bf16 v[128:131], a[28:31], v[44:47], v[128:131]
    v_mfma_f32_16x16x32_bf16 v[132:135], a[84:87], v[44:47], v[132:135]
    s_waitcnt lgkmcnt(5)
    v_mfma_f32_16x16x32_bf16 v[128:131], a[32:35], v[48:51], v[128:131]
    v_mfma_f32_16x16x32_bf16 v[132:135], a[88:91], v[48:51], v[132:135]
    s_waitcnt lgkmcnt(4)
    v_mfma_f32_16x16x32_bf16 v[128:131], a[36:39], v[52:55], v[128:131]
    v_mfma_f32_16x16x32_bf16 v[132:135], a[92:95], v[52:55], v[132:135]
    s_waitcnt lgkmcnt(3)
    v_mfma_f32_16x16x32_bf16 v[128:131], a[40:43], v[56:59], v[128:131]
    v_mfma_f32_16x16x32_bf16 v[132:135], a[96:99], v[56:59], v[132:135]
    s_waitcnt lgkmcnt(2)
    v_mfma_f32_16x16x32_bf16 v[128:131], a[44:47], v[60:63], v[128:131]
    v_mfma_f32_16x16x32_bf16 v[132:135], a[100:103], v[60:63], v[132:135]
    s_waitcnt lgkmcnt(1)
    v_mfma_f32_16x16x32_bf16 v[128:131], a[48:51], v[64:67], v[128:131]
    v_mfma_f32_16x16x32_bf16 v[132:135], a[104:107], v[64:67], v[132:135]
    s_waitcnt lgkmcnt(0)
    v_mfma_f32_16x16x32_bf16 v[128:131], a[52:55], v[68:71], v[128:131]
    v_mfma_f32_16x16x32_bf16 v[132:135], a[108:111], v[68:71], v[132:135]
    s_mul_i32 s39, s37, 57344
    s_add_u32 s39, s39, 100663296
    s_lshl_b32 s26, s36, 2
    s_add_u32 s26, s26, s17
    s_lshl_b32 s26, s26, 10
    s_add_u32 s38, s39, s26
    s_mul_i32 s26, s17, 14336
    s_add_u32 s39, s39, s26
    s_cmp_lt_u32 s37, 114
    s_cselect_b32 s26, 1, s20
    s_cmp_lg_u32 s26, 0
    v_max_f32 v128, 0, v128
    v_max_f32 v129, 0, v129
    v_max_f32 v130, 0, v130
    v_max_f32 v131, 0, v131
    v_max_f32 v132, 0, v132
    v_max_f32 v133, 0, v133
    v_max_f32 v134, 0, v134
    v_max_f32 v135, 0, v135
    v_cvt_pk_bf16_f32 v136, v128, v129
    v_cvt_pk_bf16_f32 v137, v130, v131
    v_cvt_pk_bf16_f32 v138, v132, v133
    v_cvt_pk_bf16_f32 v139, v134, v135
    s_cbranch_scc1 F_st1
    buffer_store_dwordx4 v[136:139], v2, s[8:11], s38 offen
    s_nop 0
    s_branch F_st2
F_st1:
    buffer_store_dwordx4 v[136:139], v2, s[8:11], s38 offen sc1
    s_nop 1
F_st2:
    buffer_load_dwordx2 v[12:13], v3, s[8:11], s40 offen sc1
    s_mov_b32 s28, 0
    buffer_load_dword v140, v7, s[8:11], s39 offen offset:0 sc1
    s_nop 14
    buffer_load_dword v141, v7, s[8:11], s39 offen offset:0 sc1
    s_nop 14
L_h_211:
    buffer_load_dword v142, v7, s[8:11], s39 offen offset:0 sc1
    s_waitcnt vmcnt(2)
    v_cmp_eq_u32 vcc, -1, v140
    s_cbranch_vccz L_hd_212
    s_nop 10
    buffer_load_dword v140, v7, s[8:11], s39 offen offset:0 sc1
    s_waitcnt vmcnt(2)
    v_cmp_eq_u32 vcc, -1, v141
    s_cbranch_vccz L_hd_212
    s_nop 10
    buffer_load_dword v141, v7, s[8:11], s39 offen offset:0 sc1
    s_waitcnt vmcnt(2)
    v_cmp_eq_u32 vcc, -1, v142
    s_cbranch_vccz L_hd_212
    s_nop 10
    s_add_u32 s28, s28, 1
    s_cmp_lt_u32 s28, s29
    s_cbranch_scc1 L_h_211
L_hd_212:
    s_mov_b32 s28, 0
F_hid:
    s_mov_b32 s38, s39
    s_add_u32 s28, s28, 1
    buffer_load_dwordx4 v[16:19], v2, s[8:11], s38 offen offset:0 sc1
    buffer_load_dwordx4 v[20:23], v2, s[8:11], s38 offen offset:1024 sc1
    buffer_load_dwordx4 v[24:27], v2, s[8:11], s38 offen offset:2048 sc1
    buffer_load_dwordx4 v[28:31], v2, s[8:11], s38 offen offset:3072 sc1
    s_add_u32 s38, s38, 4096
    buffer_load_dwordx4 v[32:35], v2, s[8:11], s38 offen offset:0 sc1
    buffer_load_dwordx4 v[36:39], v2, s[8:11], s38 offen offset:1024 sc1
    buffer_load_dwordx4 v[40:43], v2, s[8:11], s38 offen offset:2048 sc1
    buffer_load_dwordx4 v[44:47], v2, s[8:11], s38 offen offset:3072 sc1
    s_add_u32 s38, s38, 4096
    buffer_load_dwordx4 v[48:51], v2, s[8:11], s38 offen offset:0 sc1
    buffer_load_dwordx4 v[52:55], v2, s[8:11], s38 offen offset:1024 sc1
    buffer_load_dwordx4 v[56:59], v2, s[8:11], s38 offen offset:2048 sc1
    buffer_load_dwordx4 v[60:63], v2, s[8:11], s38 offen offset:3072 sc1
    s_add_u32 s38, s38, 4096
    buffer_load_dwordx4 v[64:67], v2, s[8:11], s38 offen offset:0 sc1
    buffer_load_dwordx4 v[68:71], v2, s[8:11], s38 offen offset:1024 sc1
    s_waitcnt vmcnt(13)
    v_mfma_f32_16x16x32_bf16 v[128:131], a[112:115], v[16:19], 0
    v_mfma_f32_16x16x32_bf16 v[132:135], a[168:171], v[16:19], 0
    v_max3_u32 v11, v12, v13, v16
    s_waitcnt vmcnt(12)
    v_mfma_f32_16x16x32_bf16 v[128:131], a[116:119], v[20:23], v[128:131]
    v_mfma_f32_16x16x32_bf16 v[132:135], a[172:175], v[20:23], v[132:135]
    v_max_u32 v11, v11, v20
    s_waitcnt vmcnt(11)
    v_mfma_f32_16x16x32_bf16 v[128:131], a[120:123], v[24:27], v[128:131]
    v_mfma_f32_16x16x32_bf16 v[132:135], a[176:179], v[24:27], v[132:135]
    v_max_u32 v11, v11, v24
    s_waitcnt vmcnt(10)
    v_mfma_f32_16x16x32_bf16 v[128:131], a[124:127], v[28:31], v[128:131]
    v_mfma_f32_16x16x32_bf16 v[132:135], a[180:183], v[28:31], v[132:135]
    v_max_u32 v11, v11, v28
    s_waitcnt vmcnt(9)
    v_mfma_f32_16x16x32_bf16 v[128:131], a[128:131], v[32:35], v[128:131]
    v_mfma_f32_16x16x32_bf16 v[132:135], a[184:187], v[32:35], v[132:135]
    v_max_u32 v11, v11, v32
    s_waitcnt vmcnt(8)
    v_mfma_f32_16x16x32_bf16 v[128:131], a[132:135], v[36:39], v[128:131]
    v_mfma_f32_16x16x32_bf16 v[132:135], a[188:191], v[36:39], v[132:135]
    v_max_u32 v11, v11, v36
    s_waitcnt vmcnt(7)
    v_mfma_f32_16x16x32_bf16 v[128:131], a[136:139], v[40:43], v[128:131]
    v_mfma_f32_16x16x32_bf16 v[132:135], a[192:195], v[40:43], v[132:135]
    v_max_u32 v11, v11, v40
    s_waitcnt vmcnt(6)
    v_mfma_f32_16x16x32_bf16 v[128:131], a[140:143], v[44:47], v[128:131]
    v_mfma_f32_16x16x32_bf16 v[132:135], a[196:199], v[44:47], v[132:135]
    v_max_u32 v11, v11, v44
    s_waitcnt vmcnt(5)
    v_mfma_f32_16x16x32_bf16 v[128:131], a[144:147], v[48:51], v[128:131]
    v_mfma_f32_16x16x32_bf16 v[132:135], a[200:203], v[48:51], v[132:135]
    v_max_u32 v11, v11, v48
    s_waitcnt vmcnt(4)
    v_mfma_f32_16x16x32_bf16 v[128:131], a[148:151], v[52:55], v[128:131]
    v_mfma_f32_16x16x32_bf16 v[132:135], a[204:207], v[52:55], v[132:135]
    v_max_u32 v11, v11, v52
    s_waitcnt vmcnt(3)
    v_mfma_f32_16x16x32_bf16 v[128:131], a[152:155], v[56:59], v[128:131]
    v_mfma_f32_16x16x32_bf16 v[132:135], a[208:211], v[56:59], v[132:135]
    v_max_u32 v11, v11, v56
    s_waitcnt vmcnt(2)
    v_mfma_f32_16x16x32_bf16 v[128:131], a[156:159], v[60:63], v[128:131]
    v_mfma_f32_16x16x32_bf16 v[132:135], a[212:215], v[60:63], v[132:135]
    v_max_u32 v11, v11, v60
    s_waitcnt vmcnt(1)
    v_mfma_f32_16x16x32_bf16 v[128:131], a[160:163], v[64:67], v[128:131]
    v_mfma_f32_16x16x32_bf16 v[132:135], a[216:219], v[64:67], v[132:135]
    v_max_u32 v11, v11, v64
    s_waitcnt vmcnt(0)
    v_mfma_f32_16x16x32_bf16 v[128:131], a[164:167], v[68:71], v[128:131]
    v_mfma_f32_16x16x32_bf16 v[132:135], a[220:223], v[68:71], v[132:135]
    v_max_u32 v11, v11, v68
    v_cmp_eq_u32 vcc, -1, v11
    s_nop 4
    s_cbranch_vccz F_hidd
    buffer_load_dwordx2 v[12:13], v3, s[8:11], s40 offen sc1
    s_cmp_lt_u32 s28, s29
    s_cbranch_scc1 F_hid
    s_mov_b32 s29, 1
    s_waitcnt vmcnt(0)
F_hidd:
    ds_write_b128 v5, v[128:131] offset:0
    ds_write_b128 v5, v[132:135] offset:1024
    s_cmp_ge_u32 s17, 2
    s_waitcnt lgkmcnt(0)
    s_barrier
    s_cbranch_scc1 F_fin_213
    ds_read_b128 v[136:139], v6 offset:0
    ds_read_b128 v[140:143], v6 offset:2048
    ds_read_b128 v[144:147], v6 offset:4096
    ds_read_b128 v[148:151], v6 offset:6144
    s_mul_i32 s38, s37, 14336
    s_lshl_b32 s26, s36, 1
    s_add_u32 s26, s26, s17
    s_lshl_b32 s26, s26, 5
    s_add_u32 s38, s38, s26
    v_lshlrev_b32 v128, 16, v12
    v_and_b32 v129, 0xffff0000, v12
    v_lshlrev_b32 v130, 16, v13
    v_and_b32 v131, 0xffff0000, v13
    s_waitcnt lgkmcnt(0)
    v_pk_add_f32 v[136:137], v[136:137], v[140:141]
    v_pk_add_f32 v[144:145], v[144:145], v[148:149]
    v_pk_add_f32 v[136:137], v[136:137], v[144:145]
    v_cvt_pk_bf16_f32 v136, v136, v137
    v_and_b32 v137, 0xffff0000, v136
    v_lshlrev_b32 v136, 16, v136
    v_pk_add_f32 v[136:137], v[136:137], v[128:129]
    v_cvt_pk_bf16_f32 v14, v136, v137
    v_pk_add_f32 v[138:139], v[138:139], v[142:143]
    v_pk_add_f32 v[146:147], v[146:147], v[150:151]
    v_pk_add_f32 v[138:139], v[138:139], v[146:147]
    v_cvt_pk_bf16_f32 v138, v138, v139
    v_and_b32 v139, 0xffff0000, v138
    v_lshlrev_b32 v138, 16, v138
    v_pk_add_f32 v[138:139], v[138:139], v[130:131]
    v_cvt_pk_bf16_f32 v15, v138, v139
    buffer_store_dwordx2 v[14:15], v4, s[48:51], s38 offen
F_fin_213:
    s_add_u32 s37, s37, 7
    s_cmp_lt_u32 s37, 128
    s_cbranch_scc1 F_top
L_exit:
L_end:
    s_endpgm
.section .rodata,"a"
.p2align 6
.amdhsa_kernel prep_kernel
  .amdhsa_next_free_vgpr 512
  .amdhsa_next_free_sgpr 102
  .amdhsa_accum_offset 256
  .amdhsa_group_segment_fixed_size 0
  .amdhsa_kernarg_size 104
  .amdhsa_user_sgpr_count 2
  .amdhsa_user_sgpr_kernarg_segment_ptr 1
  .amdhsa_system_sgpr_workgroup_id_x 1
.end_amdhsa_kernel
.p2align 6
.amdhsa_kernel main_kernel
  .amdhsa_next_free_vgpr 512
  .amdhsa_next_free_sgpr 102
  .amdhsa_accum_offset 256
  .amdhsa_group_segment_fixed_size 0
  .amdhsa_kernarg_size 104
  .amdhsa_user_sgpr_count 2
  .amdhsa_user_sgpr_kernarg_segment_ptr 1
  .amdhsa_system_sgpr_workgroup_id_x 1
.end_amdhsa_kernel
```
